```python
import torch

def _softmax(x, axis=-1):
    return torch.softmax(x, dim=axis)

def _gelu(x):
    return torch.nn.functional.gelu(x, approximate='tanh')

def _silu(x):
    return torch.nn.functional.silu(x)

def _sigmoid(x):
    return torch.sigmoid(x)

def _layernorm(x, axis=-1, eps=1e-05):
    m = x.mean(dim=axis, keepdim=True)
    v = x.var(dim=axis, keepdim=True, unbiased=False)
    return (x - m) / torch.sqrt(v + eps)

def _scatter_add(tgt, idx, src, axis=0):
    return tgt.clone().index_add_(axis, idx, src)

def _segment_sum(src, seg, n):
    out = torch.zeros((n,) + src.shape[1:], dtype=src.dtype)
    return out.index_add_(0, seg, src)

def _pad(x, pw):
    flat = tuple((v for pair in reversed(pw) for v in pair))
    return torch.nn.functional.pad(x, flat)
kernel_name = 'interleave_layers__spectral_fnet__mixer_gmlp__prompt'

def setup_inputs():

    _w = lambda a: (lambda t: t.to(torch.bfloat16) if t.is_floating_point() else t)(torch.as_tensor(a))

    def _A_setup():
        B, S, D = (1, 2048, 576)
        ns = torch.arange(S)[:, None] * torch.arange(S)[None, :]
        nd = torch.arange(D)[:, None] * torch.arange(D)[None, :]
        Ws_re = torch.cos(-2.0 * torch.pi * ns / S).to(float)
        Ws_im = torch.sin(-2.0 * torch.pi * ns / S).to(float)
        Wd_re = torch.cos(-2.0 * torch.pi * nd / D).to(float)
        Wd_im = torch.sin(-2.0 * torch.pi * nd / D).to(float)
        return {'x': _w((lambda *s: torch.randn(*s, dtype=torch.bfloat16) * 0.05)(B, S, D)), 'dft_seq_re': _w(Ws_re), 'dft_seq_im': _w(Ws_im), 'dft_hid_re': _w(Wd_re), 'dft_hid_im': _w(Wd_im)}
    _A_in = _A_setup()

    def _B_setup():
        B, S, D, F = (1, 2048, 576, 4608)
        Fh = F // 2
        return {'x': _w((lambda *s: torch.randn(*s, dtype=torch.bfloat16) * 0.05)(B, S, D)), 'w_in': _w((lambda *s: torch.randn(*s, dtype=torch.bfloat16) * 1.6)(D, 2 * Fh)), 'w_sp': _w(0.01 * (lambda *s: torch.randn(*s, dtype=torch.bfloat16) * 1.6)(S, S)), 'b_sp': _w(1.0 + 0.01 * (lambda *s: torch.randn(*s, dtype=torch.bfloat16) * 1.6)(S)), 'w_out': _w((lambda *s: torch.randn(*s, dtype=torch.bfloat16) * 1.6)(Fh, D))}
    _B_in = _B_setup()
    return {'A_x': _A_in['x'], 'A_dft_seq_re': _A_in['dft_seq_re'], 'A_dft_seq_im': _A_in['dft_seq_im'], 'A_dft_hid_re': _A_in['dft_hid_re'], 'A_dft_hid_im': _A_in['dft_hid_im'], 'B_x': _B_in['x'], 'B_w_in': _B_in['w_in'], 'B_w_sp': _B_in['w_sp'], 'B_b_sp': _B_in['b_sp'], 'B_w_out': _B_in['w_out']}

def reference(A_x, A_dft_seq_re, A_dft_seq_im, A_dft_hid_re, A_dft_hid_im, B_x, B_w_in, B_w_sp, B_b_sp, B_w_out):

    def _A_ref(x, dft_seq_re, dft_seq_im, dft_hid_re, dft_hid_im):
        a = torch.einsum('bsd,ed->bse', x, dft_hid_re)
        b = torch.einsum('bsd,ed->bse', x, dft_hid_im)
        y = torch.einsum('ts,bse->bte', dft_seq_re, a) - torch.einsum('ts,bse->bte', dft_seq_im, b)
        return y

    def _B_ref(x, w_in, w_sp, b_sp, w_out):
        B, S, D = x.shape
        F = w_in.shape[-1]
        Fh = F // 2
        z = _gelu(torch.einsum('bsd,df->bsf', x, w_in))
        z1 = z[..., :Fh].clone()
        z2 = _layernorm(z[..., Fh:], axis=-1)
        g = torch.einsum('ts,bsf->btf', w_sp, z2) + b_sp[None, :, None]
        return torch.einsum('bsf,fd->bsd', z1 * g, w_out)
    x = A_x
    x = x + _A_ref(_layernorm(x, axis=-1), A_dft_seq_re, A_dft_seq_im, A_dft_hid_re, A_dft_hid_im)
    x = x + _B_ref(_layernorm(x, axis=-1), B_w_in, B_w_sp, B_b_sp, B_w_out)
    x = x + _A_ref(_layernorm(x, axis=-1), A_dft_seq_re, A_dft_seq_im, A_dft_hid_re, A_dft_hid_im)
    x = x + _B_ref(_layernorm(x, axis=-1), B_w_in, B_w_sp, B_b_sp, B_w_out)
    return x
```

```asm
; @launch grid=(256,1,1) block=(256,1,1) lds=163840
.amdgcn_target "amdgcn-amd-amdhsa--gfx950"
.macro mf d, a, b, c
v_mfma_f32_16x16x32_bf16 \d, \a, \b, \c
.endm
.text
.globl interleave_layers__spectral_fnet__mixer_gmlp__prompt_kernel
.p2align 8
.type interleave_layers__spectral_fnet__mixer_gmlp__prompt_kernel,@function
interleave_layers__spectral_fnet__mixer_gmlp__prompt_kernel:
s_cmp_lt_u32 s2,256
s_cbranch_scc1 Lgo
s_endpgm
Lgo:
s_load_dwordx2 s[46:47],s[0:1],0
s_load_dwordx2 s[44:45],s[0:1],96
s_load_dwordx8 s[32:39],s[0:1],48
s_load_dwordx4 s[40:43],s[0:1],80
v_lshrrev_b32 v1,6,v0
v_and_b32 v0,63,v0
v_readfirstlane_b32 s24,v1
s_nop 0
s_cmp_lg_u32 s24,3
s_cbranch_scc1 Lwc1
s_getpc_b64 s[52:53]
Lwc1a:
s_mov_b32 s54,Lexit-Lwc1a
s_mov_b32 s55,0x20000
s_lshr_b32 s48,s2,3
s_mul_i32 s48,s48,2944
v_lshlrev_b32 v106,7,v0
s_mov_b32 exec_hi,0
s_mov_b32 exec_lo,8388607
buffer_load_dword v107,v106,s[52:55],s48 offen
s_mov_b64 exec,-1
Lwc1:
v_lshlrev_b32 v1,4,v0
v_add_u32 v2,4096,v1
v_add_u32 v3,8192,v1
v_and_b32 v4,15,v0
v_lshrrev_b32 v5,4,v0
v_add_u32 v6,36864,v1
v_add_u32 v7,73728,v1
v_add_u32 v8,110592,v1
v_mov_b32 v9,0
s_and_b32 s48,s2,7
s_lshr_b32 s49,s2,3
s_lshl_b32 s25,s48,2
s_lshr_b32 s50,s49,3
s_add_u32 s25,s25,s50
s_and_b32 s26,s49,7
s_lshr_b32 s30,s25,1
s_and_b32 s31,s25,1
s_mov_b32 s29,0
s_sub_u32 s50,16,s48
s_cmp_eq_u32 s48,0
s_cselect_b32 s50,8,s50
s_bitcmp1_b32 s49,4
s_cselect_b32 s30,s50,s48
s_lshl_b32 s25,s30,1
s_add_u32 s25,s25,s31
s_and_b32 s50,s48,1
s_lshl_b32 s50,s50,3
s_and_b32 s27,s49,7
s_add_u32 s27,s27,s50
s_lshr_b32 s50,s48,1
s_lshl_b32 s50,s50,2
s_lshr_b32 s28,s49,3
s_add_u32 s28,s28,s50
s_mul_i32 s61,s24,9216
s_mul_i32 s62,s28,331776
s_mov_b32 s63,0x3727c5ac
s_mov_b32 s64,0x05040100
s_mov_b32 s65,0x07060302
s_waitcnt lgkmcnt(0)
s_mov_b32 s8,s46
s_mov_b32 s9,s47
s_mov_b32 s10,2359296
s_mov_b32 s11,0x20000
s_mov_b32 s4,s44
s_mov_b32 s5,s45
s_mov_b32 s6,23068672
s_mov_b32 s7,0x20000
s_add_u32 s20,s44,23068672
s_addc_u32 s21,s45,0
s_mov_b32 s22,69206016
s_mov_b32 s23,0x20000
s_add_u32 s12,s44,17825792
s_addc_u32 s13,s45,0
s_mov_b32 s14,2359296
s_mov_b32 s15,0x20000
s_cmp_ge_u32 s26,6
s_cbranch_scc1 Lprep
v_lshrrev_b32 v23,2,v0
v_mul_u32_u24 v23,147456,v23
v_and_b32 v11,2,v5
v_xor_b32 v11,v11,v0
v_and_b32 v11,3,v11
v_lshl_add_u32 v23,v11,4,v23
s_lshl_b32 s89,s31,2
s_add_u32 s89,s89,s24
s_lshl_b32 s89,s89,4
s_add_u32 s89,s89,s30
s_mul_i32 s89,s89,1152
s_add_u32 s91,s89,1152
s_mul_i32 s48,s26,192
s_add_u32 s87,s89,s48
s_lshl_b32 s90,s24,10
s_add_u32 m0,s90,73728
s_nop 0
buffer_load_dwordx4 v23,s[8:11],s87 offen lds
s_add_u32 m0,s90,77760
s_nop 0
buffer_load_dwordx4 v23,s[8:11],s87 offen offset:64 lds
s_add_u32 m0,s90,81792
s_nop 0
buffer_load_dwordx4 v23,s[8:11],s87 offen offset:128 lds
s_mov_b32 s16,s34
s_mov_b32 s17,s35
s_mov_b32 s18,8388608
s_mov_b32 s19,0x20000
s_cmp_lt_u32 s28,16
s_cselect_b32 s18,s18,0
s_lshr_b32 s94,s28,1
s_lshl_b32 s49,0,2
s_add_u32 s94,s94,s49
s_lshl_b32 s94,s94,4
s_add_u32 s94,s94,s27
s_lshl_b32 s94,s94,12
s_and_b32 s49,s28,1
s_lshl_b32 s49,s49,22
s_add_u32 s94,s94,s49
s_mul_i32 s49,s24,1048576
s_add_u32 s94,s94,s49
s_mul_i32 s95,s24,2080
s_mul_i32 s96,s25,6
s_add_u32 s96,s96,s26
s_lshl_b32 s96,s96,2
s_add_u32 s96,s96,s24
s_mul_i32 s97,s96,7282
s_lshr_b32 s97,s97,16
s_mul_i32 s48,s97,9
s_sub_u32 s98,s96,s48
s_mul_i32 s48,s97,3641
s_lshr_b32 s48,s48,16
s_mul_i32 s49,s48,18
s_sub_u32 s49,s97,s49
s_lshl_b32 s48,s48,2
s_lshr_b32 s52,s49,2
s_add_u32 s52,s52,s48
s_mul_i32 s52,s52,9
s_and_b32 s53,s49,3
s_lshl_b32 s53,s53,1
s_add_u32 s52,s52,s53
s_add_u32 s53,s53,s48
s_mul_i32 s53,s53,9
s_add_u32 s53,s53,8
s_cmp_ge_u32 s49,16
s_cselect_b32 s52,s53,s52
s_cselect_b32 s53,9,1
s_add_u32 s53,s53,s52
s_lshl_b32 s54,s98,7
s_lshr_b32 s48,s52,3
s_lshl_b32 s48,s48,7
s_and_b32 s49,s52,7
s_add_u32 s48,s48,s49
s_mul_i32 s48,s48,1152
s_add_u32 s85,s48,s54
s_lshr_b32 s48,s53,3
s_lshl_b32 s48,s48,7
s_and_b32 s49,s53,7
s_add_u32 s48,s48,s49
s_mul_i32 s48,s48,1152
s_add_u32 s86,s48,s54
s_mov_b32 s80,s38
s_mov_b32 s81,s39
s_mov_b32 s82,2654208
s_mov_b32 s83,0x20000
v_bfe_u32 v240,v4,1,1
v_lshlrev_b32 v240,3,v240
v_lshrrev_b32 v241,2,v4
v_lshl_add_u32 v240,v241,1,v240
v_and_b32 v241,1,v4
v_add_u32 v240,v240,v241
v_mul_u32_u24 v241,36864,v5
v_lshl_add_u32 v241,v240,3,v241
buffer_load_dwordx2 v[204:205],v241,s[80:83],s85 offen
s_add_u32 s85,s85,9216
buffer_load_dwordx2 v[206:207],v241,s[80:83],s85 offen
s_add_u32 s85,s85,9216
buffer_load_dwordx2 v[208:209],v241,s[80:83],s85 offen
s_add_u32 s85,s85,9216
buffer_load_dwordx2 v[210:211],v241,s[80:83],s85 offen
buffer_load_dwordx2 v[212:213],v241,s[80:83],s86 offen
s_add_u32 s86,s86,9216
buffer_load_dwordx2 v[214:215],v241,s[80:83],s86 offen
s_add_u32 s86,s86,9216
buffer_load_dwordx2 v[216:217],v241,s[80:83],s86 offen
s_add_u32 s86,s86,9216
buffer_load_dwordx2 v[218:219],v241,s[80:83],s86 offen
v_lshrrev_b32 v21,2,v4
v_and_b32 v21,2,v21
v_xor_b32 v21,v21,v5
v_lshl_add_u32 v21,v4,2,v21
v_lshlrev_b32 v21,4,v21
v_add_u32 v21,73728,v21
v_add_u32 v22,36864,v21
s_cmp_eq_u32 s24,3
s_cbranch_scc1 La2
s_mul_i32 s60,s26,3
s_add_u32 s60,s60,s24
s_lshl_b32 s60,s60,4
s_add_u32 s60,s60,1
v_add_u32 v12,s60,v4
v_lshlrev_b32 v254,31,v12
v_or_b32 v254,1.0,v254
s_mul_i32 s60,s26,96
v_lshl_add_u32 v13,v5,3,s60
v_mul_u32_u24 v13,v13,v12
v_cvt_f32_u32 v12,v12
v_mul_f32 v12,0x3ae38e39,v12
v_cvt_f32_u32 v13,v13
v_mul_f32 v13,0x3ae38e39,v13
v_fract_f32 v13,v13
v_fmamk_f32 v14,v12,0x00000000,v13
v_fmamk_f32 v15,v12,0x3f800000,v13
v_cos_f32 v16,v14
v_cos_f32 v17,v15
v_sin_f32 v18,v14
v_sin_f32_e64 v19,v15
v_cvt_pk_bf16_f32 v100,v16,v17
v_cvt_pk_bf16_f32 v104,v18,v19
v_fmamk_f32 v14,v12,0x40000000,v13
v_fmamk_f32 v15,v12,0x40400000,v13
v_cos_f32 v16,v14
v_cos_f32 v17,v15
v_sin_f32 v18,v14
v_sin_f32 v19,v15
v_cvt_pk_bf16_f32 v101,v16,v17
v_cvt_pk_bf16_f32 v105,v18,v19
v_fmamk_f32 v14,v12,0x40800000,v13
v_fmamk_f32 v15,v12,0x40a00000,v13
v_cos_f32 v16,v14
v_cos_f32 v17,v15
v_sin_f32 v18,v14
v_sin_f32 v19,v15
v_cvt_pk_bf16_f32 v102,v16,v17
v_cvt_pk_bf16_f32 v106,v18,v19
v_fmamk_f32 v14,v12,0x40c00000,v13
v_fmamk_f32 v15,v12,0x40e00000,v13
v_cos_f32 v16,v14
v_cos_f32 v17,v15
v_sin_f32 v18,v14
v_sin_f32 v19,v15
v_cvt_pk_bf16_f32 v103,v16,v17
v_cvt_pk_bf16_f32 v107,v18,v19
v_fmamk_f32 v14,v12,0x42000000,v13
v_fmamk_f32 v15,v12,0x42040000,v13
v_cos_f32 v16,v14
v_cos_f32 v17,v15
v_sin_f32 v18,v14
v_sin_f32 v19,v15
v_cvt_pk_bf16_f32 v108,v16,v17
v_cvt_pk_bf16_f32 v112,v18,v19
v_fmamk_f32 v14,v12,0x42080000,v13
v_fmamk_f32 v15,v12,0x420c0000,v13
v_cos_f32 v16,v14
v_cos_f32 v17,v15
v_sin_f32 v18,v14
v_sin_f32 v19,v15
v_cvt_pk_bf16_f32 v109,v16,v17
v_cvt_pk_bf16_f32 v113,v18,v19
v_fmamk_f32 v14,v12,0x42100000,v13
v_fmamk_f32 v15,v12,0x42140000,v13
v_cos_f32 v16,v14
v_cos_f32 v17,v15
v_sin_f32 v18,v14
v_sin_f32 v19,v15
v_cvt_pk_bf16_f32 v110,v16,v17
v_cvt_pk_bf16_f32 v114,v18,v19
v_fmamk_f32 v14,v12,0x42180000,v13
v_fmamk_f32 v15,v12,0x421c0000,v13
v_cos_f32 v16,v14
v_cos_f32 v17,v15
v_sin_f32 v18,v14
v_sin_f32 v19,v15
v_cvt_pk_bf16_f32 v111,v16,v17
v_cvt_pk_bf16_f32 v115,v18,v19
v_fmamk_f32 v14,v12,0x42800000,v13
v_fmamk_f32 v15,v12,0x42820000,v13
v_cos_f32 v16,v14
v_cos_f32 v17,v15
v_sin_f32 v18,v14
v_sin_f32 v19,v15
v_cvt_pk_bf16_f32 v116,v16,v17
v_cvt_pk_bf16_f32 v120,v18,v19
v_fmamk_f32 v14,v12,0x42840000,v13
v_fmamk_f32 v15,v12,0x42860000,v13
v_cos_f32 v16,v14
v_cos_f32 v17,v15
v_sin_f32 v18,v14
v_sin_f32 v19,v15
v_cvt_pk_bf16_f32 v117,v16,v17
v_cvt_pk_bf16_f32 v121,v18,v19
v_fmamk_f32 v14,v12,0x42880000,v13
v_fmamk_f32 v15,v12,0x428a0000,v13
v_cos_f32 v16,v14
v_cos_f32 v17,v15
v_sin_f32 v18,v14
v_sin_f32 v19,v15
v_cvt_pk_bf16_f32 v118,v16,v17
v_cvt_pk_bf16_f32 v122,v18,v19
v_fmamk_f32 v14,v12,0x428c0000,v13
v_fmamk_f32 v15,v12,0x428e0000,v13
v_cos_f32 v16,v14
v_cos_f32 v17,v15
v_sin_f32 v18,v14
v_sin_f32 v19,v15
v_cvt_pk_bf16_f32 v119,v16,v17
v_cvt_pk_bf16_f32 v123,v18,v19
v_fmamk_f32 v14,v12,0x42c00000,v13
v_fmamk_f32 v15,v12,0x42c20000,v13
v_cos_f32 v16,v14
v_cos_f32 v17,v15
v_sin_f32 v18,v14
v_sin_f32 v19,v15
v_cvt_pk_bf16_f32 v124,v16,v17
v_cvt_pk_bf16_f32 v128,v18,v19
v_fmamk_f32 v14,v12,0x42c40000,v13
v_fmamk_f32 v15,v12,0x42c60000,v13
v_cos_f32 v16,v14
v_cos_f32 v17,v15
v_sin_f32 v18,v14
v_sin_f32 v19,v15
v_cvt_pk_bf16_f32 v125,v16,v17
v_cvt_pk_bf16_f32 v129,v18,v19
v_fmamk_f32 v14,v12,0x42c80000,v13
v_fmamk_f32 v15,v12,0x42ca0000,v13
v_cos_f32 v16,v14
v_cos_f32 v17,v15
v_sin_f32 v18,v14
v_sin_f32 v19,v15
v_cvt_pk_bf16_f32 v126,v16,v17
v_cvt_pk_bf16_f32 v130,v18,v19
v_fmamk_f32 v14,v12,0x42cc0000,v13
v_fmamk_f32 v15,v12,0x42ce0000,v13
v_cos_f32 v16,v14
v_cos_f32 v17,v15
v_sin_f32 v18,v14
v_sin_f32 v19,v15
v_cvt_pk_bf16_f32 v127,v16,v17
v_cvt_pk_bf16_f32 v131,v18,v19
v_fmamk_f32 v14,v12,0x43000000,v13
v_fmamk_f32 v15,v12,0x43010000,v13
v_cos_f32 v16,v14
v_cos_f32 v17,v15
v_sin_f32 v18,v14
v_sin_f32 v19,v15
v_cvt_pk_bf16_f32 v132,v16,v17
v_cvt_pk_bf16_f32 v136,v18,v19
v_fmamk_f32 v14,v12,0x43020000,v13
v_fmamk_f32 v15,v12,0x43030000,v13
v_cos_f32 v16,v14
v_cos_f32 v17,v15
v_sin_f32 v18,v14
v_sin_f32 v19,v15
v_cvt_pk_bf16_f32 v133,v16,v17
v_cvt_pk_bf16_f32 v137,v18,v19
v_fmamk_f32 v14,v12,0x43040000,v13
v_fmamk_f32 v15,v12,0x43050000,v13
v_cos_f32 v16,v14
v_cos_f32 v17,v15
v_sin_f32 v18,v14
v_sin_f32 v19,v15
v_cvt_pk_bf16_f32 v134,v16,v17
v_cvt_pk_bf16_f32 v138,v18,v19
v_fmamk_f32 v14,v12,0x43060000,v13
v_fmamk_f32 v15,v12,0x43070000,v13
v_cos_f32 v16,v14
v_cos_f32 v17,v15
v_sin_f32 v18,v14
v_sin_f32 v19,v15
v_cvt_pk_bf16_f32 v135,v16,v17
v_cvt_pk_bf16_f32 v139,v18,v19
v_fmamk_f32 v14,v12,0x43200000,v13
v_fmamk_f32 v15,v12,0x43210000,v13
v_cos_f32 v16,v14
v_cos_f32 v17,v15
v_sin_f32 v18,v14
v_sin_f32 v19,v15
v_cvt_pk_bf16_f32 v140,v16,v17
v_cvt_pk_bf16_f32 v144,v18,v19
v_fmamk_f32 v14,v12,0x43220000,v13
v_fmamk_f32 v15,v12,0x43230000,v13
v_cos_f32 v16,v14
v_cos_f32 v17,v15
v_sin_f32 v18,v14
v_sin_f32 v19,v15
v_cvt_pk_bf16_f32 v141,v16,v17
v_cvt_pk_bf16_f32 v145,v18,v19
v_fmamk_f32 v14,v12,0x43240000,v13
v_fmamk_f32 v15,v12,0x43250000,v13
v_cos_f32 v16,v14
v_cos_f32 v17,v15
v_sin_f32 v18,v14
v_sin_f32 v19,v15
v_cvt_pk_bf16_f32 v142,v16,v17
v_cvt_pk_bf16_f32 v146,v18,v19
v_fmamk_f32 v14,v12,0x43260000,v13
v_fmamk_f32 v15,v12,0x43270000,v13
v_cos_f32 v16,v14
v_cos_f32 v17,v15
v_sin_f32 v18,v14
v_sin_f32 v19,v15
v_cvt_pk_bf16_f32 v143,v16,v17
v_cvt_pk_bf16_f32 v147,v18,v19
v_fmamk_f32 v14,v12,0x43400000,v13
v_fmamk_f32 v15,v12,0x43410000,v13
v_cos_f32 v16,v14
v_cos_f32 v17,v15
v_sin_f32 v18,v14
v_sin_f32 v19,v15
v_cvt_pk_bf16_f32 v148,v16,v17
v_cvt_pk_bf16_f32 v152,v18,v19
v_fmamk_f32 v14,v12,0x43420000,v13
v_fmamk_f32 v15,v12,0x43430000,v13
v_cos_f32 v16,v14
v_cos_f32 v17,v15
v_sin_f32 v18,v14
v_sin_f32 v19,v15
v_cvt_pk_bf16_f32 v149,v16,v17
v_cvt_pk_bf16_f32 v153,v18,v19
v_fmamk_f32 v14,v12,0x43440000,v13
v_fmamk_f32 v15,v12,0x43450000,v13
v_cos_f32 v16,v14
v_cos_f32 v17,v15
v_sin_f32 v18,v14
v_sin_f32 v19,v15
v_cvt_pk_bf16_f32 v150,v16,v17
v_cvt_pk_bf16_f32 v154,v18,v19
v_fmamk_f32 v14,v12,0x43460000,v13
v_fmamk_f32 v15,v12,0x43470000,v13
v_cos_f32 v16,v14
v_cos_f32 v17,v15
v_sin_f32 v18,v14
v_sin_f32 v19,v15
v_cvt_pk_bf16_f32 v151,v16,v17
v_cvt_pk_bf16_f32 v155,v18,v19
v_fmamk_f32 v14,v12,0x43600000,v13
v_fmamk_f32 v15,v12,0x43610000,v13
v_cos_f32 v16,v14
v_cos_f32 v17,v15
v_sin_f32 v18,v14
v_sin_f32 v19,v15
v_cvt_pk_bf16_f32 v156,v16,v17
v_cvt_pk_bf16_f32 v160,v18,v19
v_fmamk_f32 v14,v12,0x43620000,v13
v_fmamk_f32 v15,v12,0x43630000,v13
v_cos_f32 v16,v14
v_cos_f32 v17,v15
v_sin_f32 v18,v14
v_sin_f32 v19,v15
v_cvt_pk_bf16_f32 v157,v16,v17
v_cvt_pk_bf16_f32 v161,v18,v19
v_fmamk_f32 v14,v12,0x43640000,v13
v_fmamk_f32 v15,v12,0x43650000,v13
v_cos_f32 v16,v14
v_cos_f32 v17,v15
v_sin_f32 v18,v14
v_sin_f32 v19,v15
v_cvt_pk_bf16_f32 v158,v16,v17
v_cvt_pk_bf16_f32 v162,v18,v19
v_fmamk_f32 v14,v12,0x43660000,v13
v_fmamk_f32 v15,v12,0x43670000,v13
v_cos_f32 v16,v14
v_cos_f32 v17,v15
v_sin_f32 v18,v14
v_sin_f32 v19,v15
v_cvt_pk_bf16_f32 v159,v16,v17
v_cvt_pk_bf16_f32 v163,v18,v19
v_fmamk_f32 v14,v12,0x43800000,v13
v_fmamk_f32 v15,v12,0x43808000,v13
v_cos_f32 v16,v14
v_cos_f32 v17,v15
v_sin_f32 v18,v14
v_sin_f32 v19,v15
v_cvt_pk_bf16_f32 v164,v16,v17
v_cvt_pk_bf16_f32 v168,v18,v19
v_fmamk_f32 v14,v12,0x43810000,v13
v_fmamk_f32 v15,v12,0x43818000,v13
v_cos_f32 v16,v14
v_cos_f32 v17,v15
v_sin_f32 v18,v14
v_sin_f32 v19,v15
v_cvt_pk_bf16_f32 v165,v16,v17
v_cvt_pk_bf16_f32 v169,v18,v19
v_fmamk_f32 v14,v12,0x43820000,v13
v_fmamk_f32 v15,v12,0x43828000,v13
v_cos_f32 v16,v14
v_cos_f32 v17,v15
v_sin_f32 v18,v14
v_sin_f32 v19,v15
v_cvt_pk_bf16_f32 v166,v16,v17
v_cvt_pk_bf16_f32 v170,v18,v19
v_fmamk_f32 v14,v12,0x43830000,v13
v_fmamk_f32 v15,v12,0x43838000,v13
v_cos_f32 v16,v14
v_cos_f32 v17,v15
v_sin_f32 v18,v14
v_sin_f32 v19,v15
v_cvt_pk_bf16_f32 v167,v16,v17
v_cvt_pk_bf16_f32 v171,v18,v19
La2:
s_add_u32 s87,s87,192
s_cmp_eq_u32 s87,s91
s_cselect_b32 s87,s89,s87
s_add_u32 m0,s90,86016
s_nop 0
buffer_load_dwordx4 v23,s[8:11],s87 offen lds
s_add_u32 m0,s90,90048
s_nop 0
buffer_load_dwordx4 v23,s[8:11],s87 offen offset:64 lds
s_add_u32 m0,s90,94080
s_nop 0
buffer_load_dwordx4 v23,s[8:11],s87 offen offset:128 lds
s_add_u32 s87,s87,192
s_cmp_eq_u32 s87,s91
s_cselect_b32 s87,s89,s87
s_add_u32 m0,s90,98304
s_nop 0
buffer_load_dwordx4 v23,s[8:11],s87 offen lds
s_add_u32 m0,s90,102336
s_nop 0
buffer_load_dwordx4 v23,s[8:11],s87 offen offset:64 lds
s_add_u32 m0,s90,106368
s_nop 0
buffer_load_dwordx4 v23,s[8:11],s87 offen offset:128 lds
s_cmp_eq_u32 s24,3
s_cbranch_scc1 La3
v_mov_b32 v44,0x3f803f80
v_mov_b32 v45,0x3f803f80
v_mov_b32 v46,0x3f803f80
v_mov_b32 v47,0x3f803f80
s_nop 1
mf v[36:39],v[44:47],v[100:103],0
mf v[40:43],v[44:47],v[104:107],0
mf v[36:39],v[44:47],v[108:111],v[36:39]
mf v[40:43],v[44:47],v[112:115],v[40:43]
mf v[36:39],v[44:47],v[116:119],v[36:39]
mf v[40:43],v[44:47],v[120:123],v[40:43]
mf v[36:39],v[44:47],v[124:127],v[36:39]
mf v[40:43],v[44:47],v[128:131],v[40:43]
mf v[36:39],v[44:47],v[132:135],v[36:39]
mf v[40:43],v[44:47],v[136:139],v[40:43]
mf v[36:39],v[44:47],v[140:143],v[36:39]
mf v[40:43],v[44:47],v[144:147],v[40:43]
mf v[36:39],v[44:47],v[148:151],v[36:39]
mf v[40:43],v[44:47],v[152:155],v[40:43]
mf v[36:39],v[44:47],v[156:159],v[36:39]
mf v[40:43],v[44:47],v[160:163],v[40:43]
mf v[36:39],v[44:47],v[164:167],v[36:39]
mf v[40:43],v[44:47],v[168:171],v[40:43]
v_cvt_f32_u32 v12,v4
v_mul_f32 v12,0x3d800000,v12
v_lshlrev_b32 v13,2,v5
v_cvt_f32_u32 v13,v13
v_mul_f32 v13,v12,v13
v_fmamk_f32 v14,v12,0x00000000,v13
v_fmamk_f32 v15,v12,0x3f800000,v13
v_cos_f32 v16,v14
v_cos_f32 v17,v15
v_sin_f32 v18,v14
v_sin_f32_e64 v19,v15
v_cvt_pk_bf16_f32 v28,v16,v17
v_cvt_pk_bf16_f32 v34,v16,v17
v_cvt_pk_bf16_f32 v32,v18,v19
v_cvt_pk_bf16_f32 v30,-v18,-v19
v_fmamk_f32 v14,v12,0x40000000,v13
v_fmamk_f32 v15,v12,0x40400000,v13
v_cos_f32 v16,v14
v_cos_f32 v17,v15
v_sin_f32 v18,v14
v_sin_f32 v19,v15
v_cvt_pk_bf16_f32 v29,v16,v17
v_cvt_pk_bf16_f32 v35,v16,v17
v_cvt_pk_bf16_f32 v33,v18,v19
v_cvt_pk_bf16_f32 v31,-v18,-v19
v_fma_f32 v238,v36,v254,v36
v_fma_f32 v239,v40,v254,v40
s_lshl_b32 s60,s31,2
s_add_u32 s60,s60,s24
s_lshl_b32 s60,s60,4
s_add_u32 s60,s60,s30
v_lshl_add_u32 v244,v4,7,s60
v_cvt_f32_u32 v244,v244
s_mov_b32 s74,0xba000000
s_cmp_ge_u32 s26,3
s_cselect_b32 s74,0x3a000000,s74
v_mul_f32 v244,s74,v244
v_and_b32 v245,1,v5
v_lshlrev_b32 v245,6,v245
v_lshrrev_b32 v246,1,v5
v_add_u32 v245,v245,v246
v_cvt_f32_u32 v245,v245
v_mul_f32 v245,v244,v245
s_branch La4
La3:
s_lshl_b32 s60,s31,2
s_add_u32 s60,s60,s24
s_lshl_b32 s60,s60,4
s_add_u32 s60,s60,s30
v_lshl_add_u32 v244,v4,7,s60
v_cvt_f32_u32 v244,v244
s_mov_b32 s74,0xba000000
s_cmp_ge_u32 s26,3
s_cselect_b32 s74,0x3a000000,s74
v_mul_f32 v244,s74,v244
v_and_b32 v245,1,v5
v_lshlrev_b32 v245,6,v245
v_lshrrev_b32 v246,1,v5
v_add_u32 v245,v245,v246
v_cvt_f32_u32 v245,v245
v_mul_f32 v245,v244,v245
v_fmamk_f32 v246,v244,0x00000000,v245
v_fmamk_f32 v247,v244,0x41800000,v245
v_cos_f32 v248,v246
v_sin_f32 v249,v246
v_cos_f32 v250,v247
v_sin_f32_e64 v251,v247
v_cvt_pk_bf16_f32 v68,v248,v249
v_cvt_pk_bf16_f32 v69,v250,v251
v_fmamk_f32 v246,v244,0x42000000,v245
v_fmamk_f32 v247,v244,0x42400000,v245
v_cos_f32 v248,v246
v_sin_f32 v249,v246
v_cos_f32 v250,v247
v_sin_f32 v251,v247
v_cvt_pk_bf16_f32 v70,v248,v249
v_cvt_pk_bf16_f32 v71,v250,v251
v_fmamk_f32 v246,v244,0x40000000,v245
v_fmamk_f32 v247,v244,0x41900000,v245
v_cos_f32 v248,v246
v_sin_f32 v249,v246
v_cos_f32 v250,v247
v_sin_f32 v251,v247
v_cvt_pk_bf16_f32 v72,v248,v249
v_cvt_pk_bf16_f32 v73,v250,v251
v_fmamk_f32 v246,v244,0x42080000,v245
v_fmamk_f32 v247,v244,0x42480000,v245
v_cos_f32 v248,v246
v_sin_f32 v249,v246
v_cos_f32 v250,v247
v_sin_f32 v251,v247
v_cvt_pk_bf16_f32 v74,v248,v249
v_cvt_pk_bf16_f32 v75,v250,v251
v_fmamk_f32 v246,v244,0x40800000,v245
v_fmamk_f32 v247,v244,0x41a00000,v245
v_cos_f32 v248,v246
v_sin_f32 v249,v246
v_cos_f32 v250,v247
v_sin_f32 v251,v247
v_cvt_pk_bf16_f32 v76,v248,v249
v_cvt_pk_bf16_f32 v77,v250,v251
v_fmamk_f32 v246,v244,0x42100000,v245
v_fmamk_f32 v247,v244,0x42500000,v245
v_cos_f32 v248,v246
v_sin_f32 v249,v246
v_cos_f32 v250,v247
v_sin_f32 v251,v247
v_cvt_pk_bf16_f32 v78,v248,v249
v_cvt_pk_bf16_f32 v79,v250,v251
v_fmamk_f32 v246,v244,0x40c00000,v245
v_fmamk_f32 v247,v244,0x41b00000,v245
v_cos_f32 v248,v246
v_sin_f32 v249,v246
v_cos_f32 v250,v247
v_sin_f32 v251,v247
v_cvt_pk_bf16_f32 v80,v248,v249
v_cvt_pk_bf16_f32 v81,v250,v251
v_fmamk_f32 v246,v244,0x42180000,v245
v_fmamk_f32 v247,v244,0x42580000,v245
v_cos_f32 v248,v246
v_sin_f32 v249,v246
v_cos_f32 v250,v247
v_sin_f32 v251,v247
v_cvt_pk_bf16_f32 v82,v248,v249
v_cvt_pk_bf16_f32 v83,v250,v251
v_fmamk_f32 v246,v244,0x41000000,v245
v_fmamk_f32 v247,v244,0x41c00000,v245
v_cos_f32 v248,v246
v_sin_f32 v249,v246
v_cos_f32 v250,v247
v_sin_f32 v251,v247
v_cvt_pk_bf16_f32 v84,v248,v249
v_cvt_pk_bf16_f32 v85,v250,v251
v_fmamk_f32 v246,v244,0x42200000,v245
v_fmamk_f32 v247,v244,0x42600000,v245
v_cos_f32 v248,v246
v_sin_f32 v249,v246
v_cos_f32 v250,v247
v_sin_f32 v251,v247
v_cvt_pk_bf16_f32 v86,v248,v249
v_cvt_pk_bf16_f32 v87,v250,v251
v_fmamk_f32 v246,v244,0x41200000,v245
v_fmamk_f32 v247,v244,0x41d00000,v245
v_cos_f32 v248,v246
v_sin_f32 v249,v246
v_cos_f32 v250,v247
v_sin_f32 v251,v247
v_cvt_pk_bf16_f32 v88,v248,v249
v_cvt_pk_bf16_f32 v89,v250,v251
v_fmamk_f32 v246,v244,0x42280000,v245
v_fmamk_f32 v247,v244,0x42680000,v245
v_cos_f32 v248,v246
v_sin_f32 v249,v246
v_cos_f32 v250,v247
v_sin_f32 v251,v247
v_cvt_pk_bf16_f32 v90,v248,v249
v_cvt_pk_bf16_f32 v91,v250,v251
v_fmamk_f32 v246,v244,0x41400000,v245
v_fmamk_f32 v247,v244,0x41e00000,v245
v_cos_f32 v248,v246
v_sin_f32 v249,v246
v_cos_f32 v250,v247
v_sin_f32 v251,v247
v_cvt_pk_bf16_f32 v92,v248,v249
v_cvt_pk_bf16_f32 v93,v250,v251
v_fmamk_f32 v246,v244,0x42300000,v245
v_fmamk_f32 v247,v244,0x42700000,v245
v_cos_f32 v248,v246
v_sin_f32 v249,v246
v_cos_f32 v250,v247
v_sin_f32 v251,v247
v_cvt_pk_bf16_f32 v94,v248,v249
v_cvt_pk_bf16_f32 v95,v250,v251
v_fmamk_f32 v246,v244,0x41600000,v245
v_fmamk_f32 v247,v244,0x41f00000,v245
v_cos_f32 v248,v246
v_sin_f32 v249,v246
v_cos_f32 v250,v247
v_sin_f32 v251,v247
v_cvt_pk_bf16_f32 v96,v248,v249
v_cvt_pk_bf16_f32 v97,v250,v251
v_fmamk_f32 v246,v244,0x42380000,v245
v_fmamk_f32 v247,v244,0x42780000,v245
v_cos_f32 v248,v246
v_sin_f32 v249,v246
v_cos_f32 v250,v247
v_sin_f32 v251,v247
v_cvt_pk_bf16_f32 v98,v248,v249
v_cvt_pk_bf16_f32 v99,v250,v251
La4:
s_cmp_eq_u32 s24,3
s_cbranch_scc1 Lst5
v_lshlrev_b32 v11,4,v5
v_add_u32 v11,148736,v11
v_mul_u32_u24 v10,589824,v5
v_lshl_add_u32 v10,v4,4,v10
s_mul_i32 s50,s26,3
s_add_u32 s50,s50,s24
s_lshl_b32 s51,s50,8
s_mul_i32 s49,s25,4608
s_add_u32 s51,s51,s49
s_lshl_b32 s49,s24,12
v_add_u32 v252,s49,v21
s_mul_i32 s72,s25,72
s_add_u32 s72,s72,s50
s_lshl_b32 s72,s72,7
s_add_u32 s72,s72,4718592
s_add_u32 s73,s72,34603008
v_mul_u32_u24 v20,2304,v5
v_lshl_add_u32 v20,v4,3,v20
v_mov_b32 v16,-1
v_mov_b32 v17,-1
v_mov_b32 v18,-1
v_mov_b32 v19,-1
s_waitcnt vmcnt(5)
s_barrier
ds_read_b128 a[0:3],v21
ds_read_b128 a[4:7],v21 offset:1024
ds_read_b128 a[8:11],v21 offset:2048
ds_read_b128 a[12:15],v21 offset:3072
ds_read_b128 a[16:19],v21 offset:4096
ds_read_b128 a[20:23],v21 offset:5120
s_waitcnt lgkmcnt(4)
mf v[36:39],a[0:3],v[100:103],0
ds_read_b128 a[24:27],v21 offset:6144
s_add_u32 s87,s87,192
mf v[40:43],a[0:3],v[104:107],0
s_cmp_eq_u32 s87,s91
s_cselect_b32 s87,s89,s87
s_add_u32 m0,s90,110592
mf v[44:47],a[4:7],v[100:103],0
buffer_load_dwordx4 v23,s[8:11],s87 offen lds
mf v[48:51],a[4:7],v[104:107],0
ds_read_b128 a[28:31],v21 offset:7168
s_waitcnt lgkmcnt(4)
mf v[52:55],a[8:11],v[100:103],0
ds_read_b128 a[0:3],v21 offset:8192
s_add_u32 m0,s90,114624
mf v[56:59],a[8:11],v[104:107],0
v_fmamk_f32 v246,v244,0x00000000,v245
v_fmamk_f32 v247,v244,0x41800000,v245
mf v[60:63],a[12:15],v[100:103],0
buffer_load_dwordx4 v23,s[8:11],s87 offen offset:64 lds
mf v[64:67],a[12:15],v[104:107],0
ds_read_b128 a[4:7],v21 offset:9216
s_waitcnt lgkmcnt(4)
mf v[36:39],a[16:19],v[108:111],v[36:39]
ds_read_b128 a[8:11],v21 offset:10240
s_add_u32 m0,s90,118656
mf v[40:43],a[16:19],v[112:115],v[40:43]
v_cos_f32 v248,v246
mf v[44:47],a[20:23],v[108:111],v[44:47]
buffer_load_dwordx4 v23,s[8:11],s87 offen offset:128 lds
mf v[48:51],a[20:23],v[112:115],v[48:51]
ds_read_b128 a[12:15],v21 offset:11264
s_waitcnt lgkmcnt(4)
mf v[52:55],a[24:27],v[108:111],v[52:55]
ds_read_b128 a[16:19],v21 offset:12288
s_add_u32 s87,s87,192
mf v[56:59],a[24:27],v[112:115],v[56:59]
s_cmp_eq_u32 s87,s91
s_cselect_b32 s87,s89,s87
s_add_u32 m0,s90,122880
mf v[60:63],a[28:31],v[108:111],v[60:63]
buffer_load_dwordx4 v23,s[8:11],s87 offen lds
mf v[64:67],a[28:31],v[112:115],v[64:67]
ds_read_b128 a[20:23],v21 offset:13312
s_waitcnt lgkmcnt(4)
mf v[36:39],a[0:3],v[116:119],v[36:39]
ds_read_b128 a[24:27],v21 offset:14336
s_add_u32 m0,s90,126912
mf v[40:43],a[0:3],v[120:123],v[40:43]
v_sin_f32 v249,v246
mf v[44:47],a[4:7],v[116:119],v[44:47]
buffer_load_dwordx4 v23,s[8:11],s87 offen offset:64 lds
mf v[48:51],a[4:7],v[120:123],v[48:51]
ds_read_b128 a[28:31],v21 offset:15360
s_waitcnt lgkmcnt(4)
mf v[52:55],a[8:11],v[116:119],v[52:55]
s_waitcnt vmcnt(4)
s_barrier
ds_read_b128 a[0:3],v21 offset:16384
s_add_u32 m0,s90,130944
mf v[56:59],a[8:11],v[120:123],v[56:59]
v_cos_f32 v250,v247
mf v[60:63],a[12:15],v[116:119],v[60:63]
buffer_load_dwordx4 v23,s[8:11],s87 offen offset:128 lds
mf v[64:67],a[12:15],v[120:123],v[64:67]
ds_read_b128 a[4:7],v21 offset:17408
s_waitcnt lgkmcnt(4)
mf v[36:39],a[16:19],v[124:127],v[36:39]
ds_read_b128 a[8:11],v21 offset:18432
s_add_u32 s87,s87,192
mf v[40:43],a[16:19],v[128:131],v[40:43]
s_cmp_eq_u32 s87,s91
s_cselect_b32 s87,s89,s87
s_add_u32 m0,s90,135168
mf v[44:47],a[20:23],v[124:127],v[44:47]
buffer_load_dwordx4 v23,s[8:11],s87 offen lds
mf v[48:51],a[20:23],v[128:131],v[48:51]
ds_read_b128 a[12:15],v21 offset:19456
s_waitcnt lgkmcnt(4)
mf v[52:55],a[24:27],v[124:127],v[52:55]
ds_read_b128 a[16:19],v21 offset:20480
s_add_u32 m0,s90,139200
mf v[56:59],a[24:27],v[128:131],v[56:59]
v_sin_f32 v251,v247
mf v[60:63],a[28:31],v[124:127],v[60:63]
buffer_load_dwordx4 v23,s[8:11],s87 offen offset:64 lds
mf v[64:67],a[28:31],v[128:131],v[64:67]
ds_read_b128 a[20:23],v21 offset:21504
s_waitcnt lgkmcnt(4)
mf v[36:39],a[0:3],v[132:135],v[36:39]
ds_read_b128 a[24:27],v21 offset:22528
s_add_u32 m0,s90,143232
mf v[40:43],a[0:3],v[136:139],v[40:43]
v_cvt_pk_bf16_f32 v68,v248,v249
v_cvt_pk_bf16_f32 v69,v250,v251
mf v[44:47],a[4:7],v[132:135],v[44:47]
buffer_load_dwordx4 v23,s[8:11],s87 offen offset:128 lds
mf v[48:51],a[4:7],v[136:139],v[48:51]
ds_read_b128 a[28:31],v21 offset:23552
s_waitcnt lgkmcnt(4)
mf v[52:55],a[8:11],v[132:135],v[52:55]
ds_read_b128 a[0:3],v21 offset:24576
v_fmamk_f32 v246,v244,0x42000000,v245
mf v[56:59],a[8:11],v[136:139],v[56:59]
v_fmamk_f32 v247,v244,0x42400000,v245
mf v[60:63],a[12:15],v[132:135],v[60:63]
buffer_store_dwordx2 v[16:17],v20,s[20:23],s72 offen sc1
mf v[64:67],a[12:15],v[136:139],v[64:67]
ds_read_b128 a[4:7],v21 offset:25600
s_waitcnt lgkmcnt(4)
mf v[36:39],a[16:19],v[140:143],v[36:39]
ds_read_b128 a[8:11],v21 offset:26624
mf v[40:43],a[16:19],v[144:147],v[40:43]
v_cos_f32 v248,v246
mf v[44:47],a[20:23],v[140:143],v[44:47]
buffer_store_dwordx2 v[16:17],v20,s[20:23],s73 offen sc1
mf v[48:51],a[20:23],v[144:147],v[48:51]
ds_read_b128 a[12:15],v21 offset:27648
s_waitcnt lgkmcnt(4)
mf v[52:55],a[24:27],v[140:143],v[52:55]
ds_read_b128 a[16:19],v21 offset:28672
s_add_u32 m0,s95,0
mf v[56:59],a[24:27],v[144:147],v[56:59]
v_sin_f32 v249,v246
mf v[60:63],a[28:31],v[140:143],v[60:63]
buffer_load_dwordx4 v1,s[16:19],s94 offen lds
mf v[64:67],a[28:31],v[144:147],v[64:67]
ds_read_b128 a[20:23],v21 offset:29696
s_waitcnt lgkmcnt(4)
mf v[36:39],a[0:3],v[148:151],v[36:39]
ds_read_b128 a[24:27],v21 offset:30720
s_add_u32 m0,s95,7424
mf v[40:43],a[0:3],v[152:155],v[40:43]
v_cos_f32 v250,v247
mf v[44:47],a[4:7],v[148:151],v[44:47]
buffer_load_dwordx4 v1,s[16:19],s94 offen offset:1024 lds
mf v[48:51],a[4:7],v[152:155],v[48:51]
ds_read_b128 a[28:31],v21 offset:31744
s_waitcnt lgkmcnt(4)
mf v[52:55],a[8:11],v[148:151],v[52:55]
ds_read_b128 a[0:3],v21 offset:32768
s_add_u32 m0,s95,14848
mf v[56:59],a[8:11],v[152:155],v[56:59]
v_sin_f32 v251,v247
mf v[60:63],a[12:15],v[148:151],v[60:63]
buffer_load_dwordx4 v1,s[16:19],s94 offen offset:2048 lds
mf v[64:67],a[12:15],v[152:155],v[64:67]
ds_read_b128 a[4:7],v21 offset:33792
s_waitcnt lgkmcnt(4)
mf v[36:39],a[16:19],v[156:159],v[36:39]
ds_read_b128 a[8:11],v21 offset:34816
s_add_u32 m0,s95,22272
mf v[40:43],a[16:19],v[160:163],v[40:43]
v_cvt_pk_bf16_f32 v70,v248,v249
v_cvt_pk_bf16_f32 v71,v250,v251
mf v[44:47],a[20:23],v[156:159],v[44:47]
buffer_load_dwordx4 v1,s[16:19],s94 offen offset:3072 lds
mf v[48:51],a[20:23],v[160:163],v[48:51]
ds_read_b128 a[12:15],v21 offset:35840
s_waitcnt lgkmcnt(4)
mf v[52:55],a[24:27],v[156:159],v[52:55]
ds_read_b128 a[16:19],v22
s_add_u32 s94,s94,524288
mf v[56:59],a[24:27],v[160:163],v[56:59]
s_add_u32 m0,s95,1040
v_fmamk_f32 v246,v244,0x40000000,v245
mf v[60:63],a[28:31],v[156:159],v[60:63]
buffer_load_dwordx4 v1,s[16:19],s94 offen lds
mf v[64:67],a[28:31],v[160:163],v[64:67]
ds_read_b128 a[20:23],v22 offset:1024
s_waitcnt lgkmcnt(4)
mf v[36:39],a[0:3],v[164:167],v[36:39]
ds_read_b128 a[24:27],v22 offset:2048
s_add_u32 m0,s95,8464
mf v[40:43],a[0:3],v[168:171],v[40:43]
v_fmamk_f32 v247,v244,0x41900000,v245
mf v[44:47],a[4:7],v[164:167],v[44:47]
buffer_load_dwordx4 v1,s[16:19],s94 offen offset:1024 lds
mf v[48:51],a[4:7],v[168:171],v[48:51]
ds_read_b128 a[28:31],v22 offset:3072
s_waitcnt lgkmcnt(4)
mf v[52:55],a[8:11],v[164:167],v[52:55]
s_waitcnt vmcnt(8)
s_barrier
ds_read_b128 a[0:3],v22 offset:4096
s_add_u32 m0,s95,15888
mf v[56:59],a[8:11],v[168:171],v[56:59]
v_cos_f32 v248,v246
mf v[60:63],a[12:15],v[164:167],v[60:63]
buffer_load_dwordx4 v1,s[16:19],s94 offen offset:2048 lds
mf v[64:67],a[12:15],v[168:171],v[64:67]
ds_read_b128 a[4:7],v22 offset:5120
s_waitcnt lgkmcnt(4)
mf v[172:175],a[16:19],v[100:103],0
ds_read_b128 a[8:11],v22 offset:6144
s_add_u32 m0,s95,23312
mf v[176:179],a[16:19],v[104:107],0
v_sin_f32 v249,v246
mf v[180:183],a[20:23],v[100:103],0
buffer_load_dwordx4 v1,s[16:19],s94 offen offset:3072 lds
mf v[184:187],a[20:23],v[104:107],0
ds_read_b128 a[12:15],v22 offset:7168
s_waitcnt lgkmcnt(4)
mf v[188:191],a[24:27],v[100:103],0
ds_read_b128 a[16:19],v22 offset:8192
mf v[192:195],a[24:27],v[104:107],0
v_cos_f32 v250,v247
mf v[196:199],a[28:31],v[100:103],0
ds_read_b128 a[20:23],v22 offset:9216
mf v[200:203],a[28:31],v[104:107],0
s_waitcnt lgkmcnt(4)
mf v[172:175],a[0:3],v[108:111],v[172:175]
ds_read_b128 a[24:27],v22 offset:10240
mf v[176:179],a[0:3],v[112:115],v[176:179]
v_sin_f32 v251,v247
mf v[180:183],a[4:7],v[108:111],v[180:183]
ds_read_b128 a[28:31],v22 offset:11264
v_cvt_pk_bf16_f32 v72,v248,v249
mf v[184:187],a[4:7],v[112:115],v[184:187]
v_cvt_pk_bf16_f32 v73,v250,v251
s_waitcnt lgkmcnt(4)
mf v[188:191],a[8:11],v[108:111],v[188:191]
ds_read_b128 a[0:3],v22 offset:12288
v_fmamk_f32 v246,v244,0x42080000,v245
mf v[192:195],a[8:11],v[112:115],v[192:195]
v_fmamk_f32 v247,v244,0x42480000,v245
mf v[196:199],a[12:15],v[108:111],v[196:199]
ds_read_b128 a[4:7],v22 offset:13312
mf v[200:203],a[12:15],v[112:115],v[200:203]
s_waitcnt lgkmcnt(4)
mf v[172:175],a[16:19],v[116:119],v[172:175]
ds_read_b128 a[8:11],v22 offset:14336
mf v[176:179],a[16:19],v[120:123],v[176:179]
v_cos_f32 v248,v246
mf v[180:183],a[20:23],v[116:119],v[180:183]
ds_read_b128 a[12:15],v22 offset:15360
mf v[184:187],a[20:23],v[120:123],v[184:187]
s_waitcnt lgkmcnt(4)
mf v[188:191],a[24:27],v[116:119],v[188:191]
ds_read_b128 a[16:19],v22 offset:16384
mf v[192:195],a[24:27],v[120:123],v[192:195]
v_sin_f32 v249,v246
mf v[196:199],a[28:31],v[116:119],v[196:199]
ds_read_b128 a[20:23],v22 offset:17408
mf v[200:203],a[28:31],v[120:123],v[200:203]
s_waitcnt lgkmcnt(4)
mf v[172:175],a[0:3],v[124:127],v[172:175]
ds_read_b128 a[24:27],v22 offset:18432
mf v[176:179],a[0:3],v[128:131],v[176:179]
v_cos_f32 v250,v247
mf v[180:183],a[4:7],v[124:127],v[180:183]
ds_read_b128 a[28:31],v22 offset:19456
mf v[184:187],a[4:7],v[128:131],v[184:187]
s_waitcnt lgkmcnt(4)
mf v[188:191],a[8:11],v[124:127],v[188:191]
ds_read_b128 a[0:3],v22 offset:20480
mf v[192:195],a[8:11],v[128:131],v[192:195]
v_sin_f32 v251,v247
mf v[196:199],a[12:15],v[124:127],v[196:199]
ds_read_b128 a[4:7],v22 offset:21504
v_cvt_pk_bf16_f32 v74,v248,v249
mf v[200:203],a[12:15],v[128:131],v[200:203]
v_cvt_pk_bf16_f32 v75,v250,v251
s_waitcnt lgkmcnt(4)
mf v[172:175],a[16:19],v[132:135],v[172:175]
ds_read_b128 a[8:11],v22 offset:22528
v_fmamk_f32 v246,v244,0x40800000,v245
mf v[176:179],a[16:19],v[136:139],v[176:179]
v_fmamk_f32 v247,v244,0x41a00000,v245
mf v[180:183],a[20:23],v[132:135],v[180:183]
ds_read_b128 a[12:15],v22 offset:23552
mf v[184:187],a[20:23],v[136:139],v[184:187]
s_waitcnt lgkmcnt(4)
mf v[188:191],a[24:27],v[132:135],v[188:191]
ds_read_b128 a[16:19],v22 offset:24576
mf v[192:195],a[24:27],v[136:139],v[192:195]
v_cos_f32 v248,v246
mf v[196:199],a[28:31],v[132:135],v[196:199]
ds_read_b128 a[20:23],v22 offset:25600
mf v[200:203],a[28:31],v[136:139],v[200:203]
s_waitcnt lgkmcnt(4)
mf v[172:175],a[0:3],v[140:143],v[172:175]
ds_read_b128 a[24:27],v22 offset:26624
mf v[176:179],a[0:3],v[144:147],v[176:179]
v_sin_f32 v249,v246
mf v[180:183],a[4:7],v[140:143],v[180:183]
ds_read_b128 a[28:31],v22 offset:27648
mf v[184:187],a[4:7],v[144:147],v[184:187]
s_waitcnt lgkmcnt(4)
mf v[188:191],a[8:11],v[140:143],v[188:191]
ds_read_b128 a[0:3],v22 offset:28672
mf v[192:195],a[8:11],v[144:147],v[192:195]
v_cos_f32 v250,v247
mf v[196:199],a[12:15],v[140:143],v[196:199]
ds_read_b128 a[4:7],v22 offset:29696
mf v[200:203],a[12:15],v[144:147],v[200:203]
s_waitcnt lgkmcnt(4)
mf v[172:175],a[16:19],v[148:151],v[172:175]
ds_read_b128 a[8:11],v22 offset:30720
mf v[176:179],a[16:19],v[152:155],v[176:179]
v_sin_f32 v251,v247
mf v[180:183],a[20:23],v[148:151],v[180:183]
ds_read_b128 a[12:15],v22 offset:31744
v_cvt_pk_bf16_f32 v76,v248,v249
mf v[184:187],a[20:23],v[152:155],v[184:187]
v_cvt_pk_bf16_f32 v77,v250,v251
s_waitcnt lgkmcnt(4)
mf v[188:191],a[24:27],v[148:151],v[188:191]
ds_read_b128 a[16:19],v22 offset:32768
v_fmamk_f32 v246,v244,0x42100000,v245
mf v[192:195],a[24:27],v[152:155],v[192:195]
v_fmamk_f32 v247,v244,0x42500000,v245
mf v[196:199],a[28:31],v[148:151],v[196:199]
ds_read_b128 a[20:23],v22 offset:33792
mf v[200:203],a[28:31],v[152:155],v[200:203]
s_waitcnt lgkmcnt(4)
mf v[172:175],a[0:3],v[156:159],v[172:175]
ds_read_b128 a[24:27],v22 offset:34816
mf v[176:179],a[0:3],v[160:163],v[176:179]
v_cos_f32 v248,v246
mf v[180:183],a[4:7],v[156:159],v[180:183]
ds_read_b128 a[28:31],v22 offset:35840
mf v[184:187],a[4:7],v[160:163],v[184:187]
s_waitcnt lgkmcnt(4)
mf v[188:191],a[8:11],v[156:159],v[188:191]
v_sin_f32 v249,v246
mf v[192:195],a[8:11],v[160:163],v[192:195]
v_cos_f32 v250,v247
mf v[196:199],a[12:15],v[156:159],v[196:199]
v_sin_f32 v251,v247
mf v[200:203],a[12:15],v[160:163],v[200:203]
v_cvt_pk_bf16_f32 v78,v248,v249
s_waitcnt lgkmcnt(2)
mf v[172:175],a[16:19],v[164:167],v[172:175]
v_cvt_pk_bf16_f32 v79,v250,v251
v_fmamk_f32 v246,v244,0x40c00000,v245
mf v[176:179],a[16:19],v[168:171],v[176:179]
v_fmamk_f32 v247,v244,0x41b00000,v245
mf v[180:183],a[20:23],v[164:167],v[180:183]
v_cos_f32 v248,v246
mf v[184:187],a[20:23],v[168:171],v[184:187]
s_waitcnt lgkmcnt(0)
mf v[188:191],a[24:27],v[164:167],v[188:191]
v_sin_f32 v249,v246
mf v[192:195],a[24:27],v[168:171],v[192:195]
v_cos_f32 v250,v247
mf v[196:199],a[28:31],v[164:167],v[196:199]
v_sin_f32 v251,v247
mf v[200:203],a[28:31],v[168:171],v[200:203]
v_cvt_pk_bf16_f32 v80,v248,v249
v_pk_fma_f32 v[36:37],v[172:173],v[254:255],v[36:37] op_sel_hi:[1,0,1]
v_pk_fma_f32 v[38:39],v[174:175],v[254:255],v[38:39] op_sel_hi:[1,0,1]
v_pk_fma_f32 v[40:41],v[176:177],v[254:255],v[40:41] op_sel_hi:[1,0,1]
v_pk_fma_f32 v[42:43],v[178:179],v[254:255],v[42:43] op_sel_hi:[1,0,1]
v_pk_fma_f32 v[44:45],v[180:181],v[254:255],v[44:45] op_sel_hi:[1,0,1]
v_pk_fma_f32 v[46:47],v[182:183],v[254:255],v[46:47] op_sel_hi:[1,0,1]
v_pk_fma_f32 v[48:49],v[184:185],v[254:255],v[48:49] op_sel_hi:[1,0,1]
v_pk_fma_f32 v[50:51],v[186:187],v[254:255],v[50:51] op_sel_hi:[1,0,1]
v_pk_fma_f32 v[52:53],v[188:189],v[254:255],v[52:53] op_sel_hi:[1,0,1]
v_pk_fma_f32 v[54:55],v[190:191],v[254:255],v[54:55] op_sel_hi:[1,0,1]
v_pk_fma_f32 v[56:57],v[192:193],v[254:255],v[56:57] op_sel_hi:[1,0,1]
v_pk_fma_f32 v[58:59],v[194:195],v[254:255],v[58:59] op_sel_hi:[1,0,1]
v_pk_fma_f32 v[60:61],v[196:197],v[254:255],v[60:61] op_sel_hi:[1,0,1]
v_pk_fma_f32 v[62:63],v[198:199],v[254:255],v[62:63] op_sel_hi:[1,0,1]
v_pk_fma_f32 v[64:65],v[200:201],v[254:255],v[64:65] op_sel_hi:[1,0,1]
v_pk_fma_f32 v[66:67],v[202:203],v[254:255],v[66:67] op_sel_hi:[1,0,1]
s_barrier
ds_read_b128 v[172:175],v11 offset:256
ds_read_b128 v[12:15],v11
ds_read_b128 v[176:179],v11 offset:320
ds_read_b128 v[16:19],v11 offset:64
ds_read_b128 v[180:183],v11 offset:384
ds_read_b128 v[20:23],v11 offset:128
ds_read_b128 v[184:187],v11 offset:448
ds_read_b128 v[24:27],v11 offset:192
s_waitcnt lgkmcnt(6)
v_pk_fma_f32 v[36:37],v[172:173],v[238:239],v[36:37] op_sel:[0,0,0] op_sel_hi:[1,0,1]
v_pk_fma_f32 v[38:39],v[174:175],v[238:239],v[38:39] op_sel:[0,0,0] op_sel_hi:[1,0,1]
v_pk_fma_f32 v[40:41],v[172:173],v[238:239],v[40:41] op_sel:[0,1,0] op_sel_hi:[1,1,1]
v_pk_fma_f32 v[42:43],v[174:175],v[238:239],v[42:43] op_sel:[0,1,0] op_sel_hi:[1,1,1]
v_pk_mul_f32 v[36:37],v[36:37],v[12:13]
v_pk_mul_f32 v[38:39],v[38:39],v[14:15]
v_pk_mul_f32 v[40:41],v[40:41],v[12:13]
v_pk_mul_f32 v[42:43],v[42:43],v[14:15]
v_cvt_pk_bf16_f32 v100,v36,v37
v_cvt_pk_bf16_f32 v101,v38,v39
v_cvt_pk_bf16_f32 v102,v40,v41
v_cvt_pk_bf16_f32 v103,v42,v43
s_waitcnt lgkmcnt(4)
s_nop 0
v_pk_fma_f32 v[44:45],v[176:177],v[238:239],v[44:45] op_sel:[0,0,0] op_sel_hi:[1,0,1]
v_pk_fma_f32 v[46:47],v[178:179],v[238:239],v[46:47] op_sel:[0,0,0] op_sel_hi:[1,0,1]
v_pk_fma_f32 v[48:49],v[176:177],v[238:239],v[48:49] op_sel:[0,1,0] op_sel_hi:[1,1,1]
v_pk_fma_f32 v[50:51],v[178:179],v[238:239],v[50:51] op_sel:[0,1,0] op_sel_hi:[1,1,1]
v_pk_mul_f32 v[44:45],v[44:45],v[16:17]
v_pk_mul_f32 v[46:47],v[46:47],v[18:19]
v_pk_mul_f32 v[48:49],v[48:49],v[16:17]
v_pk_mul_f32 v[50:51],v[50:51],v[18:19]
v_cvt_pk_bf16_f32 v104,v44,v45
v_cvt_pk_bf16_f32 v105,v46,v47
v_cvt_pk_bf16_f32 v106,v48,v49
v_cvt_pk_bf16_f32 v107,v50,v51
s_waitcnt lgkmcnt(2)
s_nop 0
v_pk_fma_f32 v[52:53],v[180:181],v[238:239],v[52:53] op_sel:[0,0,0] op_sel_hi:[1,0,1]
v_pk_fma_f32 v[54:55],v[182:183],v[238:239],v[54:55] op_sel:[0,0,0] op_sel_hi:[1,0,1]
v_pk_fma_f32 v[56:57],v[180:181],v[238:239],v[56:57] op_sel:[0,1,0] op_sel_hi:[1,1,1]
v_pk_fma_f32 v[58:59],v[182:183],v[238:239],v[58:59] op_sel:[0,1,0] op_sel_hi:[1,1,1]
v_pk_mul_f32 v[52:53],v[52:53],v[20:21]
v_pk_mul_f32 v[54:55],v[54:55],v[22:23]
v_pk_mul_f32 v[56:57],v[56:57],v[20:21]
v_pk_mul_f32 v[58:59],v[58:59],v[22:23]
v_cvt_pk_bf16_f32 v108,v52,v53
v_cvt_pk_bf16_f32 v109,v54,v55
v_cvt_pk_bf16_f32 v110,v56,v57
v_cvt_pk_bf16_f32 v111,v58,v59
s_waitcnt lgkmcnt(0)
s_nop 0
v_pk_fma_f32 v[60:61],v[184:185],v[238:239],v[60:61] op_sel:[0,0,0] op_sel_hi:[1,0,1]
v_pk_fma_f32 v[62:63],v[186:187],v[238:239],v[62:63] op_sel:[0,0,0] op_sel_hi:[1,0,1]
v_pk_fma_f32 v[64:65],v[184:185],v[238:239],v[64:65] op_sel:[0,1,0] op_sel_hi:[1,1,1]
v_pk_fma_f32 v[66:67],v[186:187],v[238:239],v[66:67] op_sel:[0,1,0] op_sel_hi:[1,1,1]
v_pk_mul_f32 v[60:61],v[60:61],v[24:25]
v_pk_mul_f32 v[62:63],v[62:63],v[26:27]
v_pk_mul_f32 v[64:65],v[64:65],v[24:25]
v_pk_mul_f32 v[66:67],v[66:67],v[26:27]
v_cvt_pk_bf16_f32 v112,v60,v61
v_cvt_pk_bf16_f32 v113,v62,v63
v_cvt_pk_bf16_f32 v114,v64,v65
v_cvt_pk_bf16_f32 v115,v66,v67
mf v[36:39],v[28:31],v[100:103],0
mf v[40:43],v[32:35],v[100:103],0
mf v[44:47],v[28:31],v[104:107],0
mf v[48:51],v[32:35],v[104:107],0
mf v[52:55],v[28:31],v[108:111],0
mf v[56:59],v[32:35],v[108:111],0
mf v[60:63],v[28:31],v[112:115],0
mf v[64:67],v[32:35],v[112:115],0
s_nop 1
v_cvt_pk_bf16_f32 v116,v36,v40
s_nop 0
v_cvt_pk_bf16_f32 v117,v44,v48
s_nop 0
v_cvt_pk_bf16_f32 v118,v52,v56
s_nop 0
v_cvt_pk_bf16_f32 v119,v60,v64
buffer_store_dwordx4 v[116:119],v10,s[20:23],s51 offen sc1
s_add_u32 s51,s51,147456
v_cvt_pk_bf16_f32 v120,v37,v41
v_cvt_pk_bf16_f32 v121,v45,v49
v_cvt_pk_bf16_f32 v122,v53,v57
v_cvt_pk_bf16_f32 v123,v61,v65
buffer_store_dwordx4 v[120:123],v10,s[20:23],s51 offen sc1
s_add_u32 s51,s51,147456
v_cvt_pk_bf16_f32 v124,v38,v42
v_cvt_pk_bf16_f32 v125,v46,v50
v_cvt_pk_bf16_f32 v126,v54,v58
v_cvt_pk_bf16_f32 v127,v62,v66
buffer_store_dwordx4 v[124:127],v10,s[20:23],s51 offen sc1
s_add_u32 s51,s51,147456
v_cvt_pk_bf16_f32 v128,v39,v43
v_cvt_pk_bf16_f32 v129,v47,v51
v_cvt_pk_bf16_f32 v130,v55,v59
v_cvt_pk_bf16_f32 v131,v63,v67
buffer_store_dwordx4 v[128:131],v10,s[20:23],s51 offen sc1
ds_read_b128 v[132:135],v252
ds_read_b128 v[136:139],v252 offset:1024
ds_read_b128 v[140:143],v252 offset:2048
ds_read_b128 v[144:147],v252 offset:3072
v_cvt_pk_bf16_f32 v81,v250,v251
v_fmamk_f32 v246,v244,0x42180000,v245
v_fmamk_f32 v247,v244,0x42580000,v245
v_cos_f32 v248,v246
v_sin_f32 v249,v246
v_cos_f32 v250,v247
v_sin_f32 v251,v247
v_cvt_pk_bf16_f32 v82,v248,v249
v_cvt_pk_bf16_f32 v83,v250,v251
v_fmamk_f32 v246,v244,0x41000000,v245
v_fmamk_f32 v247,v244,0x41c00000,v245
v_cos_f32 v248,v246
v_sin_f32 v249,v246
v_cos_f32 v250,v247
v_sin_f32 v251,v247
v_cvt_pk_bf16_f32 v84,v248,v249
v_cvt_pk_bf16_f32 v85,v250,v251
v_fmamk_f32 v246,v244,0x42200000,v245
v_fmamk_f32 v247,v244,0x42600000,v245
v_cos_f32 v248,v246
v_sin_f32 v249,v246
v_cos_f32 v250,v247
v_sin_f32 v251,v247
v_cvt_pk_bf16_f32 v86,v248,v249
v_cvt_pk_bf16_f32 v87,v250,v251
v_fmamk_f32 v246,v244,0x41200000,v245
v_fmamk_f32 v247,v244,0x41d00000,v245
v_cos_f32 v248,v246
v_sin_f32 v249,v246
v_cos_f32 v250,v247
v_sin_f32 v251,v247
v_cvt_pk_bf16_f32 v88,v248,v249
v_cvt_pk_bf16_f32 v89,v250,v251
v_fmamk_f32 v246,v244,0x42280000,v245
v_fmamk_f32 v247,v244,0x42680000,v245
v_cos_f32 v248,v246
v_sin_f32 v249,v246
v_cos_f32 v250,v247
v_sin_f32 v251,v247
v_cvt_pk_bf16_f32 v90,v248,v249
v_cvt_pk_bf16_f32 v91,v250,v251
v_fmamk_f32 v246,v244,0x41400000,v245
v_fmamk_f32 v247,v244,0x41e00000,v245
v_cos_f32 v248,v246
v_sin_f32 v249,v246
v_cos_f32 v250,v247
v_sin_f32 v251,v247
v_cvt_pk_bf16_f32 v92,v248,v249
v_cvt_pk_bf16_f32 v93,v250,v251
v_fmamk_f32 v246,v244,0x42300000,v245
v_fmamk_f32 v247,v244,0x42700000,v245
v_cos_f32 v248,v246
v_sin_f32 v249,v246
v_cos_f32 v250,v247
v_sin_f32 v251,v247
v_cvt_pk_bf16_f32 v94,v248,v249
v_cvt_pk_bf16_f32 v95,v250,v251
v_fmamk_f32 v246,v244,0x41600000,v245
v_fmamk_f32 v247,v244,0x41f00000,v245
v_cos_f32 v248,v246
v_sin_f32 v249,v246
v_cos_f32 v250,v247
v_sin_f32 v251,v247
v_cvt_pk_bf16_f32 v96,v248,v249
v_cvt_pk_bf16_f32 v97,v250,v251
v_fmamk_f32 v246,v244,0x42380000,v245
v_fmamk_f32 v247,v244,0x42780000,v245
v_cos_f32 v248,v246
v_sin_f32 v249,v246
v_cos_f32 v250,v247
v_sin_f32 v251,v247
v_cvt_pk_bf16_f32 v98,v248,v249
v_cvt_pk_bf16_f32 v99,v250,v251
s_lshl_b32 s48,s24,13
v_add_u32 v10,s48,v8
ds_write_b128 v10,v[68:71]
ds_write_b128 v10,v[72:75] offset:1024
ds_write_b128 v10,v[76:79] offset:2048
ds_write_b128 v10,v[80:83] offset:3072
ds_write_b128 v10,v[84:87] offset:4096
ds_write_b128 v10,v[88:91] offset:5120
ds_write_b128 v10,v[92:95] offset:6144
ds_write_b128 v10,v[96:99] offset:7168
s_waitcnt lgkmcnt(8)
v_lshlrev_b32 v36,16,v132
v_and_b32 v37,0xffff0000,v132
v_lshlrev_b32 v38,16,v133
v_and_b32 v39,0xffff0000,v133
v_lshlrev_b32 v40,16,v134
v_and_b32 v41,0xffff0000,v134
v_lshlrev_b32 v42,16,v135
v_and_b32 v43,0xffff0000,v135
v_lshlrev_b32 v44,16,v136
v_and_b32 v45,0xffff0000,v136
v_lshlrev_b32 v46,16,v137
v_and_b32 v47,0xffff0000,v137
v_lshlrev_b32 v48,16,v138
v_and_b32 v49,0xffff0000,v138
v_lshlrev_b32 v50,16,v139
v_and_b32 v51,0xffff0000,v139
v_lshlrev_b32 v52,16,v140
v_and_b32 v53,0xffff0000,v140
v_lshlrev_b32 v54,16,v141
v_and_b32 v55,0xffff0000,v141
v_lshlrev_b32 v56,16,v142
v_and_b32 v57,0xffff0000,v142
v_lshlrev_b32 v58,16,v143
v_and_b32 v59,0xffff0000,v143
v_lshlrev_b32 v60,16,v144
v_and_b32 v61,0xffff0000,v144
v_lshlrev_b32 v62,16,v145
v_and_b32 v63,0xffff0000,v145
v_lshlrev_b32 v64,16,v146
v_and_b32 v65,0xffff0000,v146
v_lshlrev_b32 v66,16,v147
v_and_b32 v67,0xffff0000,v147
s_waitcnt vmcnt(0) lgkmcnt(0)
s_barrier
ds_read_b128 a[0:3],v8
ds_read_b128 a[4:7],v8 offset:1024
ds_read_b128 a[8:11],v8 offset:2048
ds_read_b128 a[12:15],v8 offset:3072
ds_read_b128 a[16:19],v8 offset:4096
ds_read_b128 a[20:23],v8 offset:5120
ds_read_b128 a[24:27],v8 offset:6144
ds_read_b128 a[28:31],v8 offset:7168
ds_read_b128 a[32:35],v8 offset:8192
ds_read_b128 a[36:39],v8 offset:9216
ds_read_b128 a[40:43],v8 offset:10240
ds_read_b128 a[44:47],v8 offset:11264
ds_read_b128 a[48:51],v8 offset:12288
ds_read_b128 a[52:55],v8 offset:13312
ds_read_b128 a[56:59],v8 offset:14336
ds_read_b128 a[60:63],v8 offset:15360
ds_read_b128 a[64:67],v8 offset:16384
ds_read_b128 a[68:71],v8 offset:17408
ds_read_b128 a[72:75],v8 offset:18432
ds_read_b128 a[76:79],v8 offset:19456
ds_read_b128 a[80:83],v8 offset:20480
ds_read_b128 a[84:87],v8 offset:21504
ds_read_b128 a[88:91],v8 offset:22528
ds_read_b128 a[92:95],v8 offset:23552
ds_read_b128 a[96:99],v8 offset:24576
ds_read_b128 a[100:103],v8 offset:25600
ds_read_b128 a[104:107],v8 offset:26624
ds_read_b128 a[108:111],v8 offset:27648
ds_read_b128 a[112:115],v8 offset:28672
ds_read_b128 a[116:119],v8 offset:29696
ds_read_b128 a[120:123],v8 offset:30720
ds_read_b128 a[124:127],v8 offset:31744
v_and_b32 v25,7,v0
v_bfe_u32 v26,v0,3,1
v_mul_u32_u24 v24,1040,v25
v_mul_u32_u24 v27,8448,v5
v_lshl_add_u32 v24,v26,7,v24
s_lshr_b32 s48,s24,1
s_lshl_b32 s48,s48,6
s_and_b32 s49,s24,1
s_lshl_b32 s49,s49,4
s_add_u32 s48,s48,s49
s_add_u32 s48,s48,0
v_add3_u32 v24,v24,v27,s48
ds_read_b128 v[68:71],v24
ds_read_b128 v[84:87],v24 offset:32
ds_read_b128 v[72:75],v24 offset:256
ds_read_b128 v[88:91],v24 offset:288
ds_read_b128 v[76:79],v24 offset:512
ds_read_b128 v[92:95],v24 offset:544
ds_read_b128 v[80:83],v24 offset:768
ds_read_b128 v[96:99],v24 offset:800
s_waitcnt lgkmcnt(0)
s_nop 0
v_perm_b32 v12,v72,v68,s64
v_perm_b32 v13,v80,v76,s64
v_perm_b32 v14,v88,v84,s64
v_perm_b32 v15,v96,v92,s64
v_accvgpr_write_b32 a192,v12
v_accvgpr_write_b32 a193,v13
v_accvgpr_write_b32 a194,v14
v_accvgpr_write_b32 a195,v15
v_perm_b32 v16,v72,v68,s65
v_perm_b32 v17,v80,v76,s65
v_perm_b32 v18,v88,v84,s65
v_perm_b32 v19,v96,v92,s65
v_accvgpr_write_b32 a196,v16
v_accvgpr_write_b32 a197,v17
v_accvgpr_write_b32 a198,v18
v_accvgpr_write_b32 a199,v19
v_perm_b32 v12,v73,v69,s64
v_perm_b32 v13,v81,v77,s64
v_perm_b32 v14,v89,v85,s64
v_perm_b32 v15,v97,v93,s64
v_accvgpr_write_b32 a200,v12
v_accvgpr_write_b32 a201,v13
v_accvgpr_write_b32 a202,v14
v_accvgpr_write_b32 a203,v15
v_perm_b32 v16,v73,v69,s65
v_perm_b32 v17,v81,v77,s65
v_perm_b32 v18,v89,v85,s65
v_perm_b32 v19,v97,v93,s65
v_accvgpr_write_b32 a204,v16
v_accvgpr_write_b32 a205,v17
v_accvgpr_write_b32 a206,v18
v_accvgpr_write_b32 a207,v19
v_perm_b32 v12,v74,v70,s64
v_perm_b32 v13,v82,v78,s64
v_perm_b32 v14,v90,v86,s64
v_perm_b32 v15,v98,v94,s64
v_accvgpr_write_b32 a208,v12
v_accvgpr_write_b32 a209,v13
v_accvgpr_write_b32 a210,v14
v_accvgpr_write_b32 a211,v15
v_perm_b32 v16,v74,v70,s65
v_perm_b32 v17,v82,v78,s65
v_perm_b32 v18,v90,v86,s65
v_perm_b32 v19,v98,v94,s65
v_accvgpr_write_b32 a212,v16
v_accvgpr_write_b32 a213,v17
v_accvgpr_write_b32 a214,v18
v_accvgpr_write_b32 a215,v19
v_perm_b32 v12,v75,v71,s64
v_perm_b32 v13,v83,v79,s64
v_perm_b32 v14,v91,v87,s64
v_perm_b32 v15,v99,v95,s64
v_accvgpr_write_b32 a216,v12
v_accvgpr_write_b32 a217,v13
v_accvgpr_write_b32 a218,v14
v_accvgpr_write_b32 a219,v15
v_perm_b32 v16,v75,v71,s65
v_perm_b32 v17,v83,v79,s65
v_perm_b32 v18,v91,v87,s65
v_perm_b32 v19,v99,v95,s65
v_accvgpr_write_b32 a220,v16
v_accvgpr_write_b32 a221,v17
v_accvgpr_write_b32 a222,v18
v_accvgpr_write_b32 a223,v19
v_perm_b32 v220,v206,v204,s64
v_perm_b32 v221,v210,v208,s64
v_perm_b32 v222,v214,v212,s64
v_perm_b32 v223,v218,v216,s64
v_perm_b32 v224,v206,v204,s65
v_perm_b32 v225,v210,v208,s65
v_perm_b32 v226,v214,v212,s65
v_perm_b32 v227,v218,v216,s65
v_perm_b32 v228,v207,v205,s64
v_perm_b32 v229,v211,v209,s64
v_perm_b32 v230,v215,v213,s64
v_perm_b32 v231,v219,v217,s64
v_perm_b32 v232,v207,v205,s65
v_perm_b32 v233,v211,v209,s65
v_perm_b32 v234,v215,v213,s65
v_perm_b32 v235,v219,v217,s65
s_cmp_lg_u32 s98,8
s_cbranch_scc1 Lo8
v_lshrrev_b32 v241,2,v240
v_lshlrev_b32 v241,10,v241
v_and_b32_e64 v242,3,v240
v_lshl_add_u32 v241,v242,6,v241
v_lshl_add_u32 v241,v5,8,v241
v_add_u32 v241,150336,v241
v_add_u32 v242,150336,v1
ds_write_b128 v241,v[220:223]
ds_write_b128 v241,v[224:227] offset:16
ds_write_b128 v241,v[228:231] offset:32
ds_write_b128 v241,v[232:235] offset:48
ds_read_b128 v[220:223],v242
ds_read_b128 v[224:227],v242 offset:1024
ds_read_b128 v[228:231],v242 offset:2048
ds_read_b128 v[232:235],v242 offset:3072
s_waitcnt lgkmcnt(0)
Lo8:
s_mul_i32 s48,s97,3641
s_lshr_b32 s48,s48,16
s_mul_i32 s49,s48,18
s_sub_u32 s49,s97,s49
s_lshl_b32 s48,s48,2
s_lshr_b32 s50,s98,1
s_and_b32 s76,s98,1
s_lshl_b32 s76,s76,2
s_mov_b32 s77,14680064
s_cmp_lt_u32 s96,648
s_cselect_b32 s77,s77,23068672
s_and_b32 s56,s49,3
s_mul_i32 s55,s56,3
s_add_u32 s55,s55,3
s_add_u32 s53,s76,0
s_cmp_eq_u32 s98,8
s_cselect_b32 s52,0,s50
s_cselect_b32 s53,8,s53
s_lshr_b32 s54,s49,2
s_sub_u32 s54,s54,s52
s_and_b32 s54,s54,3
s_add_u32 s60,s54,s55
s_cmp_eq_u32 s54,0
s_cselect_b32 s54,s56,s60
s_cmp_lt_u32 s49,16
s_cselect_b32 s54,s54,s49
s_add_u32 s52,s52,s48
s_mul_i32 s52,s52,18
s_add_u32 s52,s52,s54
s_mul_i32 s52,s52,9
s_add_u32 s52,s52,s53
s_lshl_b32 s52,s52,10
s_add_u32 s72,s52,s77
s_add_u32 s53,s76,1
s_cmp_eq_u32 s98,8
s_cselect_b32 s52,1,s50
s_cselect_b32 s53,8,s53
s_lshr_b32 s54,s49,2
s_sub_u32 s54,s54,s52
s_and_b32 s54,s54,3
s_add_u32 s60,s54,s55
s_cmp_eq_u32 s54,0
s_cselect_b32 s54,s56,s60
s_cmp_lt_u32 s49,16
s_cselect_b32 s54,s54,s49
s_add_u32 s52,s52,s48
s_mul_i32 s52,s52,18
s_add_u32 s52,s52,s54
s_mul_i32 s52,s52,9
s_add_u32 s52,s52,s53
s_lshl_b32 s52,s52,10
s_add_u32 s73,s52,s77
s_add_u32 s53,s76,2
s_cmp_eq_u32 s98,8
s_cselect_b32 s52,2,s50
s_cselect_b32 s53,8,s53
s_lshr_b32 s54,s49,2
s_sub_u32 s54,s54,s52
s_and_b32 s54,s54,3
s_add_u32 s60,s54,s55
s_cmp_eq_u32 s54,0
s_cselect_b32 s54,s56,s60
s_cmp_lt_u32 s49,16
s_cselect_b32 s54,s54,s49
s_add_u32 s52,s52,s48
s_mul_i32 s52,s52,18
s_add_u32 s52,s52,s54
s_mul_i32 s52,s52,9
s_add_u32 s52,s52,s53
s_lshl_b32 s52,s52,10
s_add_u32 s74,s52,s77
s_add_u32 s53,s76,3
s_cmp_eq_u32 s98,8
s_cselect_b32 s52,3,s50
s_cselect_b32 s53,8,s53
s_lshr_b32 s54,s49,2
s_sub_u32 s54,s54,s52
s_and_b32 s54,s54,3
s_add_u32 s60,s54,s55
s_cmp_eq_u32 s54,0
s_cselect_b32 s54,s56,s60
s_cmp_lt_u32 s49,16
s_cselect_b32 s54,s54,s49
s_add_u32 s52,s52,s48
s_mul_i32 s52,s52,18
s_add_u32 s52,s52,s54
s_mul_i32 s52,s52,9
s_add_u32 s52,s52,s53
s_lshl_b32 s52,s52,10
s_add_u32 s75,s52,s77
s_mul_i32 s50,s26,3
s_add_u32 s50,s50,s24
s_lshl_b32 s48,s50,5
v_lshrrev_b32 v10,2,v4
v_lshlrev_b32 v10,3,v10
v_and_b32 v11,3,v4
v_add3_u32 v10,v10,v11,s48
v_cmp_eq_u32 vcc,0,v10
s_sub_u32 s51,16,s30
s_and_b32 s51,s51,15
s_cmp_ge_u32 s26,3
s_cselect_b32 s48,-16,16
s_cselect_b32 s49,9200,-16
s_cselect_b32 s51,s51,s30
v_mul_lo_u32 v10,v10,s48
v_add_u32 v10,s49,v10
v_mul_u32_u24 v11,4608,v5
v_add_u32 v10,v10,v11
s_lshl_b32 s48,s48,2
v_add_u32 v11,s48,v10
v_mov_b32 v12,0x7ff00000
v_cndmask_b32 v10,v10,v12,vcc
s_mul_i32 s51,s51,147456
s_mul_i32 s85,s25,72
s_add_u32 s85,s85,s50
s_lshl_b32 s86,s85,7
s_add_u32 s86,s86,4718592
s_lshl_b32 s85,s85,10
s_add_u32 s85,s85,2359296
v_mul_u32_u24 v24,2304,v5
v_lshl_add_u32 v24,v4,3,v24
s_waitcnt lgkmcnt(0)
s_barrier
buffer_load_dwordx4 a[128:131],v10,s[20:23],s51 offen
buffer_load_dwordx4 a[132:135],v11,s[20:23],s51 offen
s_add_u32 s51,s51,18432
buffer_load_dwordx4 a[136:139],v10,s[20:23],s51 offen
buffer_load_dwordx4 a[140:143],v11,s[20:23],s51 offen
s_add_u32 s51,s51,18432
buffer_load_dwordx4 a[144:147],v10,s[20:23],s51 offen
buffer_load_dwordx4 a[148:151],v11,s[20:23],s51 offen
s_add_u32 s51,s51,18432
buffer_load_dwordx4 a[152:155],v10,s[20:23],s51 offen
buffer_load_dwordx4 a[156:159],v11,s[20:23],s51 offen
s_add_u32 s51,s51,18432
buffer_load_dwordx4 a[160:163],v10,s[20:23],s51 offen
buffer_load_dwordx4 a[164:167],v11,s[20:23],s51 offen
s_add_u32 s51,s51,18432
buffer_load_dwordx4 a[168:171],v10,s[20:23],s51 offen
buffer_load_dwordx4 a[172:175],v11,s[20:23],s51 offen
s_waitcnt vmcnt(10)
mf v[36:39],a[128:131],a[0:3],v[36:39]
mf v[40:43],a[132:135],a[0:3],v[40:43]
mf v[44:47],a[128:131],a[32:35],v[44:47]
s_add_u32 s51,s51,18432
buffer_load_dwordx4 a[176:179],v10,s[20:23],s51 offen
mf v[48:51],a[132:135],a[32:35],v[48:51]
mf v[52:55],a[128:131],a[64:67],v[52:55]
mf v[56:59],a[132:135],a[64:67],v[56:59]
buffer_load_dwordx4 a[180:183],v11,s[20:23],s51 offen
mf v[60:63],a[128:131],a[96:99],v[60:63]
mf v[64:67],a[132:135],a[96:99],v[64:67]
s_waitcnt vmcnt(10)
mf v[36:39],a[136:139],a[4:7],v[36:39]
s_add_u32 s51,s51,18432
buffer_load_dwordx4 a[184:187],v10,s[20:23],s51 offen
mf v[40:43],a[140:143],a[4:7],v[40:43]
mf v[44:47],a[136:139],a[36:39],v[44:47]
mf v[48:51],a[140:143],a[36:39],v[48:51]
buffer_load_dwordx4 a[188:191],v11,s[20:23],s51 offen
s_barrier
mf v[52:55],a[136:139],a[68:71],v[52:55]
mf v[56:59],a[140:143],a[68:71],v[56:59]
mf v[60:63],a[136:139],a[100:103],v[60:63]
mf v[64:67],a[140:143],a[100:103],v[64:67]
s_waitcnt vmcnt(10)
mf v[36:39],a[144:147],a[8:11],v[36:39]
mf v[40:43],a[148:151],a[8:11],v[40:43]
mf v[44:47],a[144:147],a[40:43],v[44:47]
mf v[48:51],a[148:151],a[40:43],v[48:51]
mf v[52:55],a[144:147],a[72:75],v[52:55]
mf v[56:59],a[148:151],a[72:75],v[56:59]
mf v[60:63],a[144:147],a[104:107],v[60:63]
mf v[64:67],a[148:151],a[104:107],v[64:67]
s_waitcnt vmcnt(8)
mf v[36:39],a[152:155],a[12:15],v[36:39]
mf v[40:43],a[156:159],a[12:15],v[40:43]
mf v[44:47],a[152:155],a[44:47],v[44:47]
mf v[48:51],a[156:159],a[44:47],v[48:51]
mf v[52:55],a[152:155],a[76:79],v[52:55]
mf v[56:59],a[156:159],a[76:79],v[56:59]
mf v[60:63],a[152:155],a[108:111],v[60:63]
mf v[64:67],a[156:159],a[108:111],v[64:67]
s_waitcnt vmcnt(6)
mf v[36:39],a[160:163],a[16:19],v[36:39]
mf v[40:43],a[164:167],a[16:19],v[40:43]
mf v[44:47],a[160:163],a[48:51],v[44:47]
mf v[48:51],a[164:167],a[48:51],v[48:51]
mf v[52:55],a[160:163],a[80:83],v[52:55]
mf v[56:59],a[164:167],a[80:83],v[56:59]
mf v[60:63],a[160:163],a[112:115],v[60:63]
mf v[64:67],a[164:167],a[112:115],v[64:67]
s_waitcnt vmcnt(4)
mf v[36:39],a[168:171],a[20:23],v[36:39]
mf v[40:43],a[172:175],a[20:23],v[40:43]
mf v[44:47],a[168:171],a[52:55],v[44:47]
mf v[48:51],a[172:175],a[52:55],v[48:51]
mf v[52:55],a[168:171],a[84:87],v[52:55]
mf v[56:59],a[172:175],a[84:87],v[56:59]
mf v[60:63],a[168:171],a[116:119],v[60:63]
mf v[64:67],a[172:175],a[116:119],v[64:67]
s_waitcnt vmcnt(2)
mf v[36:39],a[176:179],a[24:27],v[36:39]
mf v[40:43],a[180:183],a[24:27],v[40:43]
mf v[44:47],a[176:179],a[56:59],v[44:47]
mf v[48:51],a[180:183],a[56:59],v[48:51]
mf v[52:55],a[176:179],a[88:91],v[52:55]
mf v[56:59],a[180:183],a[88:91],v[56:59]
mf v[60:63],a[176:179],a[120:123],v[60:63]
mf v[64:67],a[180:183],a[120:123],v[64:67]
s_waitcnt vmcnt(0)
mf v[36:39],a[184:187],a[28:31],v[36:39]
mf v[40:43],a[188:191],a[28:31],v[40:43]
mf v[44:47],a[184:187],a[60:63],v[44:47]
mf v[48:51],a[188:191],a[60:63],v[48:51]
mf v[52:55],a[184:187],a[92:95],v[52:55]
mf v[56:59],a[188:191],a[92:95],v[56:59]
mf v[60:63],a[184:187],a[124:127],v[60:63]
mf v[64:67],a[188:191],a[124:127],v[64:67]
s_nop 0
s_nop 0
v_cvt_pk_bf16_f32 v100,v36,v37
v_cvt_pk_bf16_f32 v101,v38,v39
v_cvt_pk_bf16_f32 v102,v40,v41
v_cvt_pk_bf16_f32 v103,v42,v43
buffer_store_dwordx4 v[100:103],v1,s[20:23],s85 offen sc1
s_add_u32 s85,s85,18432
v_cvt_pk_bf16_f32 v104,v44,v45
v_cvt_pk_bf16_f32 v105,v46,v47
v_cvt_pk_bf16_f32 v106,v48,v49
v_cvt_pk_bf16_f32 v107,v50,v51
buffer_store_dwordx4 v[104:107],v1,s[20:23],s85 offen sc1
s_add_u32 s85,s85,18432
v_cvt_pk_bf16_f32 v108,v52,v53
v_cvt_pk_bf16_f32 v109,v54,v55
v_cvt_pk_bf16_f32 v110,v56,v57
v_cvt_pk_bf16_f32 v111,v58,v59
buffer_store_dwordx4 v[108:111],v1,s[20:23],s85 offen sc1
s_add_u32 s85,s85,18432
v_cvt_pk_bf16_f32 v112,v60,v61
v_cvt_pk_bf16_f32 v113,v62,v63
v_cvt_pk_bf16_f32 v114,v64,v65
v_cvt_pk_bf16_f32 v115,v66,v67
buffer_store_dwordx4 v[112:115],v1,s[20:23],s85 offen sc1
v_pk_add_f32 v[20:21],v[36:37],v[38:39]
v_pk_mul_f32 v[22:23],v[36:37],v[36:37]
v_pk_add_f32 v[20:21],v[20:21],v[40:41]
v_pk_fma_f32 v[22:23],v[38:39],v[38:39],v[22:23]
v_pk_add_f32 v[20:21],v[20:21],v[42:43]
v_pk_fma_f32 v[22:23],v[40:41],v[40:41],v[22:23]
v_add_f32 v12,v20,v21
v_pk_fma_f32 v[22:23],v[42:43],v[42:43],v[22:23]
v_add_f32 v13,v22,v23
v_pk_add_f32 v[20:21],v[44:45],v[46:47]
v_pk_mul_f32 v[22:23],v[44:45],v[44:45]
v_pk_add_f32 v[20:21],v[20:21],v[48:49]
v_pk_fma_f32 v[22:23],v[46:47],v[46:47],v[22:23]
v_pk_add_f32 v[20:21],v[20:21],v[50:51]
v_pk_fma_f32 v[22:23],v[48:49],v[48:49],v[22:23]
v_add_f32 v14,v20,v21
v_pk_fma_f32 v[22:23],v[50:51],v[50:51],v[22:23]
v_add_f32 v15,v22,v23
v_pk_add_f32 v[20:21],v[52:53],v[54:55]
v_pk_mul_f32 v[22:23],v[52:53],v[52:53]
v_pk_add_f32 v[20:21],v[20:21],v[56:57]
v_pk_fma_f32 v[22:23],v[54:55],v[54:55],v[22:23]
v_pk_add_f32 v[20:21],v[20:21],v[58:59]
v_pk_fma_f32 v[22:23],v[56:57],v[56:57],v[22:23]
v_add_f32 v16,v20,v21
v_pk_fma_f32 v[22:23],v[58:59],v[58:59],v[22:23]
v_add_f32 v17,v22,v23
v_pk_add_f32 v[20:21],v[60:61],v[62:63]
v_pk_mul_f32 v[22:23],v[60:61],v[60:61]
v_pk_add_f32 v[20:21],v[20:21],v[64:65]
v_pk_fma_f32 v[22:23],v[62:63],v[62:63],v[22:23]
v_pk_add_f32 v[20:21],v[20:21],v[66:67]
v_pk_fma_f32 v[22:23],v[64:65],v[64:65],v[22:23]
v_add_f32 v18,v20,v21
v_pk_fma_f32 v[22:23],v[66:67],v[66:67],v[22:23]
v_add_f32 v19,v22,v23
v_permlane32_swap_b32 v12,v16
v_permlane32_swap_b32 v14,v18
v_add_f32 v12,v12,v16
v_add_f32 v14,v14,v18
s_nop 1
v_permlane16_swap_b32 v12,v14
v_add_f32 v12,v12,v14
v_permlane32_swap_b32 v13,v17
v_permlane32_swap_b32 v15,v19
v_add_f32 v13,v13,v17
v_add_f32 v15,v15,v19
s_nop 1
v_permlane16_swap_b32 v13,v15
v_add_f32 v13,v13,v15
buffer_store_dwordx2 v[12:13],v24,s[20:23],s86 offen sc1
buffer_store_dwordx4 v[220:223],v1,s[4:7],s72 offen sc1
buffer_store_dwordx4 v[224:227],v1,s[4:7],s73 offen sc1
buffer_store_dwordx4 v[228:231],v1,s[4:7],s74 offen sc1
buffer_store_dwordx4 v[232:235],v1,s[4:7],s75 offen sc1
v_and_b32 v25,7,v0
v_bfe_u32 v26,v0,3,1
v_lshlrev_b32 v25,4,v25
v_lshl_add_u32 v25,v5,8,v25
v_lshl_add_u32 v25,v26,12,v25
s_lshr_b32 s48,s28,1
s_lshl_b32 s49,0,2
s_add_u32 s48,s48,s49
s_lshr_b32 s49,s48,1
s_lshl_b32 s50,s27,2
s_add_u32 s49,s49,s50
s_lshl_b32 s49,s49,17
s_and_b32 s48,s48,1
s_lshl_b32 s48,s48,10
s_add_u32 s49,s49,s48
s_and_b32 s48,s28,1
s_lshl_b32 s48,s48,7
s_add_u32 s49,s49,s48
s_lshr_b32 s48,s24,1
s_lshl_b32 s48,s48,11
s_add_u32 s49,s49,s48
s_add_u32 s49,s49,6291456
s_and_b32 s48,s24,1
s_lshl_b32 s48,s48,3
s_add_u32 s50,s48,0
s_cmp_lt_u32 s50,s27
s_addc_u32 s51,s50,0
s_cmp_eq_u32 s50,s27
s_cselect_b32 s50,0,s51
s_lshl_b32 s50,s50,13
s_add_u32 s80,s50,s49
s_add_u32 s50,s48,1
s_cmp_lt_u32 s50,s27
s_addc_u32 s51,s50,0
s_cmp_eq_u32 s50,s27
s_cselect_b32 s50,0,s51
s_lshl_b32 s50,s50,13
s_add_u32 s81,s50,s49
s_add_u32 s50,s48,2
s_cmp_lt_u32 s50,s27
s_addc_u32 s51,s50,0
s_cmp_eq_u32 s50,s27
s_cselect_b32 s50,0,s51
s_lshl_b32 s50,s50,13
s_add_u32 s82,s50,s49
s_add_u32 s50,s48,3
s_cmp_lt_u32 s50,s27
s_addc_u32 s51,s50,0
s_cmp_eq_u32 s50,s27
s_cselect_b32 s50,0,s51
s_lshl_b32 s50,s50,13
s_add_u32 s83,s50,s49
s_add_u32 s50,s48,4
s_cmp_lt_u32 s50,s27
s_addc_u32 s51,s50,0
s_cmp_eq_u32 s50,s27
s_cselect_b32 s50,0,s51
s_lshl_b32 s50,s50,13
s_add_u32 s84,s50,s49
s_add_u32 s50,s48,5
s_cmp_lt_u32 s50,s27
s_addc_u32 s51,s50,0
s_cmp_eq_u32 s50,s27
s_cselect_b32 s50,0,s51
s_lshl_b32 s50,s50,13
s_add_u32 s85,s50,s49
s_add_u32 s50,s48,6
s_cmp_lt_u32 s50,s27
s_addc_u32 s51,s50,0
s_cmp_eq_u32 s50,s27
s_cselect_b32 s50,0,s51
s_lshl_b32 s50,s50,13
s_add_u32 s86,s50,s49
s_add_u32 s50,s48,7
s_cmp_lt_u32 s50,s27
s_addc_u32 s51,s50,0
s_cmp_eq_u32 s50,s27
s_cselect_b32 s50,0,s51
s_lshl_b32 s50,s50,13
s_add_u32 s87,s50,s49
s_mul_i32 s89,s27,1024
s_add_u32 s89,s89,5521408
s_and_b32 s90,s28,3
s_mul_i32 s90,s90,256
s_add_u32 s90,s90,s89
s_waitcnt vmcnt(5)
s_branch Lae9
Lst5:
s_mov_b32 s52,s42
s_mov_b32 s53,s43
s_mov_b32 s54,256
s_mov_b32 s55,0x20000
v_mov_b32 v100,0x3f803f80
v_mov_b32 v101,0x3f803f80
v_mov_b32 v102,0x3f803f80
v_mov_b32 v103,0x3f803f80
v_mov_b32 v105,0
v_and_b32 v10,3,v0
v_cmp_eq_u32 s[66:67],1,v10
v_cmp_eq_u32 s[68:69],2,v10
v_cmp_eq_u32 s[70:71],3,v10
v_lshlrev_b32 v10,2,v4
v_add_u32 v10,148736,v10
s_lshl_b32 s72,s2,10
s_add_u32 s72,s72,5013504
s_add_u32 s73,s72,34603008
v_mov_b32 v108,-1
v_mov_b32 v109,-1
v_mov_b32 v110,-1
v_mov_b32 v111,-1
s_waitcnt vmcnt(5)
s_barrier
ds_read_b128 a[0:3],v21
ds_read_b128 a[4:7],v21 offset:1024
ds_read_b128 a[8:11],v21 offset:2048
ds_read_b128 a[12:15],v21 offset:3072
ds_read_b128 a[16:19],v21 offset:4096
ds_read_b128 a[20:23],v21 offset:5120
s_waitcnt lgkmcnt(4)
mf v[36:39],v[100:103],a[0:3],0
ds_read_b128 a[24:27],v21 offset:6144
s_add_u32 s87,s87,192
mf v[40:43],a[0:3],a[0:3],0
s_cmp_eq_u32 s87,s91
s_cselect_b32 s87,s89,s87
s_add_u32 m0,s90,110592
mf v[44:47],v[100:103],a[4:7],0
buffer_load_dwordx4 v23,s[8:11],s87 offen lds
mf v[48:51],a[4:7],a[4:7],0
ds_read_b128 a[28:31],v21 offset:7168
s_waitcnt lgkmcnt(4)
mf v[52:55],v[100:103],a[8:11],0
ds_read_b128 a[0:3],v21 offset:8192
s_add_u32 m0,s90,114624
mf v[56:59],a[8:11],a[8:11],0
mf v[60:63],v[100:103],a[12:15],0
buffer_load_dwordx4 v23,s[8:11],s87 offen offset:64 lds
mf v[64:67],a[12:15],a[12:15],0
ds_read_b128 a[4:7],v21 offset:9216
s_waitcnt lgkmcnt(4)
mf v[36:39],v[100:103],a[16:19],v[36:39]
ds_read_b128 a[8:11],v21 offset:10240
s_add_u32 m0,s90,118656
mf v[40:43],a[16:19],a[16:19],v[40:43]
mf v[44:47],v[100:103],a[20:23],v[44:47]
buffer_load_dwordx4 v23,s[8:11],s87 offen offset:128 lds
mf v[48:51],a[20:23],a[20:23],v[48:51]
ds_read_b128 a[12:15],v21 offset:11264
s_waitcnt lgkmcnt(4)
mf v[52:55],v[100:103],a[24:27],v[52:55]
ds_read_b128 a[16:19],v21 offset:12288
s_add_u32 s87,s87,192
mf v[56:59],a[24:27],a[24:27],v[56:59]
s_cmp_eq_u32 s87,s91
s_cselect_b32 s87,s89,s87
s_add_u32 m0,s90,122880
mf v[60:63],v[100:103],a[28:31],v[60:63]
buffer_load_dwordx4 v23,s[8:11],s87 offen lds
mf v[64:67],a[28:31],a[28:31],v[64:67]
ds_read_b128 a[20:23],v21 offset:13312
s_waitcnt lgkmcnt(4)
mf v[36:39],v[100:103],a[0:3],v[36:39]
ds_read_b128 a[24:27],v21 offset:14336
s_add_u32 m0,s90,126912
mf v[40:43],a[0:3],a[0:3],v[40:43]
mf v[44:47],v[100:103],a[4:7],v[44:47]
buffer_load_dwordx4 v23,s[8:11],s87 offen offset:64 lds
mf v[48:51],a[4:7],a[4:7],v[48:51]
ds_read_b128 a[28:31],v21 offset:15360
s_waitcnt lgkmcnt(4)
mf v[52:55],v[100:103],a[8:11],v[52:55]
s_waitcnt vmcnt(4)
s_barrier
ds_read_b128 a[0:3],v21 offset:16384
s_add_u32 m0,s90,130944
mf v[56:59],a[8:11],a[8:11],v[56:59]
mf v[60:63],v[100:103],a[12:15],v[60:63]
buffer_load_dwordx4 v23,s[8:11],s87 offen offset:128 lds
mf v[64:67],a[12:15],a[12:15],v[64:67]
ds_read_b128 a[4:7],v21 offset:17408
s_waitcnt lgkmcnt(4)
mf v[36:39],v[100:103],a[16:19],v[36:39]
ds_read_b128 a[8:11],v21 offset:18432
s_add_u32 s87,s87,192
mf v[40:43],a[16:19],a[16:19],v[40:43]
s_cmp_eq_u32 s87,s91
s_cselect_b32 s87,s89,s87
s_add_u32 m0,s90,135168
mf v[44:47],v[100:103],a[20:23],v[44:47]
buffer_load_dwordx4 v23,s[8:11],s87 offen lds
mf v[48:51],a[20:23],a[20:23],v[48:51]
ds_read_b128 a[12:15],v21 offset:19456
s_waitcnt lgkmcnt(4)
mf v[52:55],v[100:103],a[24:27],v[52:55]
ds_read_b128 a[16:19],v21 offset:20480
s_add_u32 m0,s90,139200
mf v[56:59],a[24:27],a[24:27],v[56:59]
mf v[60:63],v[100:103],a[28:31],v[60:63]
buffer_load_dwordx4 v23,s[8:11],s87 offen offset:64 lds
mf v[64:67],a[28:31],a[28:31],v[64:67]
ds_read_b128 a[20:23],v21 offset:21504
s_waitcnt lgkmcnt(4)
mf v[36:39],v[100:103],a[0:3],v[36:39]
ds_read_b128 a[24:27],v21 offset:22528
s_add_u32 m0,s90,143232
mf v[40:43],a[0:3],a[0:3],v[40:43]
mf v[44:47],v[100:103],a[4:7],v[44:47]
buffer_load_dwordx4 v23,s[8:11],s87 offen offset:128 lds
mf v[48:51],a[4:7],a[4:7],v[48:51]
ds_read_b128 a[28:31],v21 offset:23552
s_waitcnt lgkmcnt(4)
mf v[52:55],v[100:103],a[8:11],v[52:55]
ds_read_b128 a[0:3],v21 offset:24576
mf v[56:59],a[8:11],a[8:11],v[56:59]
mf v[60:63],v[100:103],a[12:15],v[60:63]
buffer_load_dword v104,v105,s[52:55],0 offen sc1
mf v[64:67],a[12:15],a[12:15],v[64:67]
ds_read_b128 a[4:7],v21 offset:25600
s_waitcnt lgkmcnt(4)
mf v[36:39],v[100:103],a[16:19],v[36:39]
ds_read_b128 a[8:11],v21 offset:26624
mf v[40:43],a[16:19],a[16:19],v[40:43]
mf v[44:47],v[100:103],a[20:23],v[44:47]
buffer_store_dwordx4 v[108:111],v1,s[20:23],s72 offen sc1
mf v[48:51],a[20:23],a[20:23],v[48:51]
ds_read_b128 a[12:15],v21 offset:27648
s_waitcnt lgkmcnt(4)
mf v[52:55],v[100:103],a[24:27],v[52:55]
ds_read_b128 a[16:19],v21 offset:28672
mf v[56:59],a[24:27],a[24:27],v[56:59]
mf v[60:63],v[100:103],a[28:31],v[60:63]
buffer_store_dwordx4 v[108:111],v1,s[20:23],s73 offen sc1
mf v[64:67],a[28:31],a[28:31],v[64:67]
ds_read_b128 a[20:23],v21 offset:29696
s_waitcnt lgkmcnt(4)
mf v[36:39],v[100:103],a[0:3],v[36:39]
ds_read_b128 a[24:27],v21 offset:30720
s_add_u32 m0,s95,0
mf v[40:43],a[0:3],a[0:3],v[40:43]
mf v[44:47],v[100:103],a[4:7],v[44:47]
buffer_load_dwordx4 v1,s[16:19],s94 offen lds
mf v[48:51],a[4:7],a[4:7],v[48:51]
ds_read_b128 a[28:31],v21 offset:31744
s_waitcnt lgkmcnt(4)
mf v[52:55],v[100:103],a[8:11],v[52:55]
ds_read_b128 a[0:3],v21 offset:32768
s_add_u32 m0,s95,7424
mf v[56:59],a[8:11],a[8:11],v[56:59]
mf v[60:63],v[100:103],a[12:15],v[60:63]
buffer_load_dwordx4 v1,s[16:19],s94 offen offset:1024 lds
mf v[64:67],a[12:15],a[12:15],v[64:67]
ds_read_b128 a[4:7],v21 offset:33792
s_waitcnt lgkmcnt(4)
mf v[36:39],v[100:103],a[16:19],v[36:39]
ds_read_b128 a[8:11],v21 offset:34816
s_add_u32 m0,s95,14848
mf v[40:43],a[16:19],a[16:19],v[40:43]
mf v[44:47],v[100:103],a[20:23],v[44:47]
buffer_load_dwordx4 v1,s[16:19],s94 offen offset:2048 lds
mf v[48:51],a[20:23],a[20:23],v[48:51]
ds_read_b128 a[12:15],v21 offset:35840
s_waitcnt lgkmcnt(4)
mf v[52:55],v[100:103],a[24:27],v[52:55]
ds_read_b128 a[16:19],v22
s_add_u32 m0,s95,22272
mf v[56:59],a[24:27],a[24:27],v[56:59]
mf v[60:63],v[100:103],a[28:31],v[60:63]
buffer_load_dwordx4 v1,s[16:19],s94 offen offset:3072 lds
mf v[64:67],a[28:31],a[28:31],v[64:67]
ds_read_b128 a[20:23],v22 offset:1024
s_waitcnt lgkmcnt(4)
mf v[36:39],v[100:103],a[0:3],v[36:39]
ds_read_b128 a[24:27],v22 offset:2048
s_add_u32 s94,s94,524288
mf v[40:43],a[0:3],a[0:3],v[40:43]
s_add_u32 m0,s95,1040
mf v[44:47],v[100:103],a[4:7],v[44:47]
buffer_load_dwordx4 v1,s[16:19],s94 offen lds
mf v[48:51],a[4:7],a[4:7],v[48:51]
ds_read_b128 a[28:31],v22 offset:3072
s_waitcnt lgkmcnt(4)
mf v[52:55],v[100:103],a[8:11],v[52:55]
s_waitcnt vmcnt(8)
s_barrier
ds_read_b128 a[0:3],v22 offset:4096
s_add_u32 m0,s95,8464
mf v[56:59],a[8:11],a[8:11],v[56:59]
mf v[60:63],v[100:103],a[12:15],v[60:63]
buffer_load_dwordx4 v1,s[16:19],s94 offen offset:1024 lds
mf v[64:67],a[12:15],a[12:15],v[64:67]
ds_read_b128 a[4:7],v22 offset:5120
s_waitcnt lgkmcnt(4)
mf v[36:39],v[100:103],a[16:19],v[36:39]
ds_read_b128 a[8:11],v22 offset:6144
s_add_u32 m0,s95,15888
mf v[40:43],a[16:19],a[16:19],v[40:43]
mf v[44:47],v[100:103],a[20:23],v[44:47]
buffer_load_dwordx4 v1,s[16:19],s94 offen offset:2048 lds
mf v[48:51],a[20:23],a[20:23],v[48:51]
ds_read_b128 a[12:15],v22 offset:7168
s_waitcnt lgkmcnt(4)
mf v[52:55],v[100:103],a[24:27],v[52:55]
ds_read_b128 a[16:19],v22 offset:8192
s_add_u32 m0,s95,23312
mf v[56:59],a[24:27],a[24:27],v[56:59]
mf v[60:63],v[100:103],a[28:31],v[60:63]
buffer_load_dwordx4 v1,s[16:19],s94 offen offset:3072 lds
mf v[64:67],a[28:31],a[28:31],v[64:67]
ds_read_b128 a[20:23],v22 offset:9216
s_waitcnt lgkmcnt(4)
mf v[36:39],v[100:103],a[0:3],v[36:39]
ds_read_b128 a[24:27],v22 offset:10240
mf v[40:43],a[0:3],a[0:3],v[40:43]
mf v[44:47],v[100:103],a[4:7],v[44:47]
ds_read_b128 a[28:31],v22 offset:11264
mf v[48:51],a[4:7],a[4:7],v[48:51]
s_waitcnt lgkmcnt(4)
mf v[52:55],v[100:103],a[8:11],v[52:55]
ds_read_b128 a[0:3],v22 offset:12288
mf v[56:59],a[8:11],a[8:11],v[56:59]
mf v[60:63],v[100:103],a[12:15],v[60:63]
ds_read_b128 a[4:7],v22 offset:13312
mf v[64:67],a[12:15],a[12:15],v[64:67]
s_waitcnt lgkmcnt(4)
mf v[36:39],v[100:103],a[16:19],v[36:39]
ds_read_b128 a[8:11],v22 offset:14336
mf v[40:43],a[16:19],a[16:19],v[40:43]
mf v[44:47],v[100:103],a[20:23],v[44:47]
ds_read_b128 a[12:15],v22 offset:15360
mf v[48:51],a[20:23],a[20:23],v[48:51]
s_waitcnt lgkmcnt(4)
mf v[52:55],v[100:103],a[24:27],v[52:55]
ds_read_b128 a[16:19],v22 offset:16384
mf v[56:59],a[24:27],a[24:27],v[56:59]
mf v[60:63],v[100:103],a[28:31],v[60:63]
ds_read_b128 a[20:23],v22 offset:17408
mf v[64:67],a[28:31],a[28:31],v[64:67]
s_waitcnt lgkmcnt(4)
mf v[36:39],v[100:103],a[0:3],v[36:39]
ds_read_b128 a[24:27],v22 offset:18432
mf v[40:43],a[0:3],a[0:3],v[40:43]
mf v[44:47],v[100:103],a[4:7],v[44:47]
ds_read_b128 a[28:31],v22 offset:19456
mf v[48:51],a[4:7],a[4:7],v[48:51]
s_waitcnt lgkmcnt(4)
mf v[52:55],v[100:103],a[8:11],v[52:55]
ds_read_b128 a[0:3],v22 offset:20480
mf v[56:59],a[8:11],a[8:11],v[56:59]
mf v[60:63],v[100:103],a[12:15],v[60:63]
ds_read_b128 a[4:7],v22 offset:21504
mf v[64:67],a[12:15],a[12:15],v[64:67]
s_waitcnt lgkmcnt(4)
mf v[36:39],v[100:103],a[16:19],v[36:39]
ds_read_b128 a[8:11],v22 offset:22528
mf v[40:43],a[16:19],a[16:19],v[40:43]
mf v[44:47],v[100:103],a[20:23],v[44:47]
ds_read_b128 a[12:15],v22 offset:23552
mf v[48:51],a[20:23],a[20:23],v[48:51]
s_waitcnt lgkmcnt(4)
mf v[52:55],v[100:103],a[24:27],v[52:55]
ds_read_b128 a[16:19],v22 offset:24576
mf v[56:59],a[24:27],a[24:27],v[56:59]
mf v[60:63],v[100:103],a[28:31],v[60:63]
ds_read_b128 a[20:23],v22 offset:25600
mf v[64:67],a[28:31],a[28:31],v[64:67]
s_waitcnt lgkmcnt(4)
mf v[36:39],v[100:103],a[0:3],v[36:39]
ds_read_b128 a[24:27],v22 offset:26624
mf v[40:43],a[0:3],a[0:3],v[40:43]
mf v[44:47],v[100:103],a[4:7],v[44:47]
ds_read_b128 a[28:31],v22 offset:27648
mf v[48:51],a[4:7],a[4:7],v[48:51]
s_waitcnt lgkmcnt(4)
mf v[52:55],v[100:103],a[8:11],v[52:55]
ds_read_b128 a[0:3],v22 offset:28672
mf v[56:59],a[8:11],a[8:11],v[56:59]
mf v[60:63],v[100:103],a[12:15],v[60:63]
ds_read_b128 a[4:7],v22 offset:29696
mf v[64:67],a[12:15],a[12:15],v[64:67]
s_waitcnt lgkmcnt(4)
mf v[36:39],v[100:103],a[16:19],v[36:39]
ds_read_b128 a[8:11],v22 offset:30720
mf v[40:43],a[16:19],a[16:19],v[40:43]
mf v[44:47],v[100:103],a[20:23],v[44:47]
ds_read_b128 a[12:15],v22 offset:31744
mf v[48:51],a[20:23],a[20:23],v[48:51]
s_waitcnt lgkmcnt(4)
mf v[52:55],v[100:103],a[24:27],v[52:55]
ds_read_b128 a[16:19],v22 offset:32768
mf v[56:59],a[24:27],a[24:27],v[56:59]
mf v[60:63],v[100:103],a[28:31],v[60:63]
ds_read_b128 a[20:23],v22 offset:33792
mf v[64:67],a[28:31],a[28:31],v[64:67]
s_waitcnt lgkmcnt(4)
mf v[36:39],v[100:103],a[0:3],v[36:39]
ds_read_b128 a[24:27],v22 offset:34816
mf v[40:43],a[0:3],a[0:3],v[40:43]
mf v[44:47],v[100:103],a[4:7],v[44:47]
ds_read_b128 a[28:31],v22 offset:35840
mf v[48:51],a[4:7],a[4:7],v[48:51]
s_waitcnt lgkmcnt(4)
mf v[52:55],v[100:103],a[8:11],v[52:55]
mf v[56:59],a[8:11],a[8:11],v[56:59]
mf v[60:63],v[100:103],a[12:15],v[60:63]
mf v[64:67],a[12:15],a[12:15],v[64:67]
s_waitcnt lgkmcnt(2)
mf v[36:39],v[100:103],a[16:19],v[36:39]
mf v[40:43],a[16:19],a[16:19],v[40:43]
mf v[44:47],v[100:103],a[20:23],v[44:47]
mf v[48:51],a[20:23],a[20:23],v[48:51]
s_waitcnt lgkmcnt(0)
mf v[52:55],v[100:103],a[24:27],v[52:55]
mf v[56:59],a[24:27],a[24:27],v[56:59]
mf v[60:63],v[100:103],a[28:31],v[60:63]
mf v[64:67],a[28:31],a[28:31],v[64:67]
s_nop 0
v_mul_f32 v28,0xbae38e39,v36
v_cndmask_b32 v16,v40,v41,s[66:67]
v_cndmask_b32 v16,v16,v42,s[68:69]
v_cndmask_b32 v16,v16,v43,s[70:71]
v_fma_f32 v12,-v28,v28,s63
v_fmamk_f32 v16,v16,0x3ae38e39,v12
v_max_f32 v16,s63,v16
v_rsq_f32 v16,v16
v_mul_f32 v29,0xbae38e39,v44
v_cndmask_b32 v17,v48,v49,s[66:67]
v_cndmask_b32 v17,v17,v50,s[68:69]
v_cndmask_b32 v17,v17,v51,s[70:71]
v_fma_f32 v13,-v29,v29,s63
v_fmamk_f32 v17,v17,0x3ae38e39,v13
v_max_f32 v17,s63,v17
v_rsq_f32 v17,v17
v_mul_f32 v30,0xbae38e39,v52
v_cndmask_b32 v18,v56,v57,s[66:67]
v_cndmask_b32 v18,v18,v58,s[68:69]
v_cndmask_b32 v18,v18,v59,s[70:71]
v_fma_f32 v14,-v30,v30,s63
v_fmamk_f32 v18,v18,0x3ae38e39,v14
v_max_f32 v18,s63,v18
v_rsq_f32 v18,v18
v_mul_f32 v31,0xbae38e39,v60
v_cndmask_b32 v19,v64,v65,s[66:67]
v_cndmask_b32 v19,v19,v66,s[68:69]
v_cndmask_b32 v19,v19,v67,s[70:71]
v_fma_f32 v15,-v31,v31,s63
v_fmamk_f32 v19,v19,0x3ae38e39,v15
v_max_f32 v19,s63,v19
v_rsq_f32 v19,v19
s_mov_b32 exec_lo,0x00f0000f
s_mov_b32 exec_hi,0xf0000f00
ds_write2_b32 v10,v16,v28 offset0:0 offset1:64
ds_write2_b32 v10,v17,v29 offset0:16 offset1:80
ds_write2_b32 v10,v18,v30 offset0:32 offset1:96
ds_write2_b32 v10,v19,v31 offset0:48 offset1:112
s_mov_b64 exec,-1
s_waitcnt lgkmcnt(0)
s_barrier
s_lshl_b32 s48,s24,13
v_add_u32_e64 v10,s48,v8
ds_write_b128 v10,v[68:71]
ds_write_b128 v10,v[72:75] offset:1024
ds_write_b128 v10,v[76:79] offset:2048
ds_write_b128 v10,v[80:83] offset:3072
ds_write_b128 v10,v[84:87] offset:4096
ds_write_b128 v10,v[88:91] offset:5120
ds_write_b128 v10,v[92:95] offset:6144
ds_write_b128 v10,v[96:99] offset:7168
s_lshl_b32 s48,s26,1
s_lshr_b32 s49,s25,4
s_add_u32 s48,s48,s49
s_mul_i32 s48,s48,256
s_add_u32 s78,s48,5275648
v_mul_u32_u24 v12,3072,v0
s_lshl_b32 s48,s26,2
s_lshr_b32 s49,0x024310,s48
s_and_b32 s49,s49,15
s_lshr_b32 s50,0x444664,s48
s_and_b32 s50,s50,15
s_bfm_b64 s[66:67],s50,0
s_lshl_b32 s49,s49,1
s_mul_i32 s50,s30,12
s_add_u32 s49,s49,s50
s_mul_i32 s49,s49,256
s_add_u32 s79,s49,5275648
v_mul_u32_u24 v13,256,v0
v_perm_b32 v220,v206,v204,s64
v_perm_b32 v221,v210,v208,s64
v_perm_b32 v222,v214,v212,s64
v_perm_b32 v223,v218,v216,s64
v_perm_b32 v224,v206,v204,s65
v_perm_b32 v225,v210,v208,s65
v_perm_b32 v226,v214,v212,s65
v_perm_b32 v227,v218,v216,s65
v_perm_b32 v228,v207,v205,s64
v_perm_b32 v229,v211,v209,s64
v_perm_b32 v230,v215,v213,s64
v_perm_b32 v231,v219,v217,s64
v_perm_b32 v232,v207,v205,s65
v_perm_b32 v233,v211,v209,s65
v_perm_b32 v234,v215,v213,s65
v_perm_b32 v235,v219,v217,s65
s_cmp_lg_u32 s98,8
s_cbranch_scc1 Lo10
v_lshrrev_b32 v241,2,v240
v_lshlrev_b32 v241,10,v241
v_and_b32_e64 v242,3,v240
v_lshl_add_u32 v241,v242,6,v241
v_lshl_add_u32 v241,v5,8,v241
v_add_u32 v241,150336,v241
v_add_u32 v242,150336,v1
ds_write_b128 v241,v[220:223]
ds_write_b128 v241,v[224:227] offset:16
ds_write_b128 v241,v[228:231] offset:32
ds_write_b128 v241,v[232:235] offset:48
ds_read_b128 v[220:223],v242
ds_read_b128 v[224:227],v242 offset:1024
ds_read_b128 v[228:231],v242 offset:2048
ds_read_b128 v[232:235],v242 offset:3072
s_waitcnt lgkmcnt(0)
Lo10:
s_mul_i32 s48,s97,3641
s_lshr_b32 s48,s48,16
s_mul_i32 s49,s48,18
s_sub_u32 s49,s97,s49
s_lshl_b32 s48,s48,2
s_lshr_b32 s50,s98,1
s_and_b32 s76,s98,1
s_lshl_b32 s76,s76,2
s_mov_b32 s77,14680064
s_cmp_lt_u32 s96,648
s_cselect_b32 s77,s77,23068672
s_and_b32 s56,s49,3
s_mul_i32 s55,s56,3
s_add_u32 s55,s55,3
s_add_u32 s53,s76,0
s_cmp_eq_u32 s98,8
s_cselect_b32 s52,0,s50
s_cselect_b32 s53,8,s53
s_lshr_b32 s54,s49,2
s_sub_u32 s54,s54,s52
s_and_b32 s54,s54,3
s_add_u32 s60,s54,s55
s_cmp_eq_u32 s54,0
s_cselect_b32 s54,s56,s60
s_cmp_lt_u32 s49,16
s_cselect_b32 s54,s54,s49
s_add_u32 s52,s52,s48
s_mul_i32 s52,s52,18
s_add_u32 s52,s52,s54
s_mul_i32 s52,s52,9
s_add_u32 s52,s52,s53
s_lshl_b32 s52,s52,10
s_add_u32 s72,s52,s77
s_add_u32 s53,s76,1
s_cmp_eq_u32 s98,8
s_cselect_b32 s52,1,s50
s_cselect_b32 s53,8,s53
s_lshr_b32 s54,s49,2
s_sub_u32 s54,s54,s52
s_and_b32 s54,s54,3
s_add_u32 s60,s54,s55
s_cmp_eq_u32 s54,0
s_cselect_b32 s54,s56,s60
s_cmp_lt_u32 s49,16
s_cselect_b32 s54,s54,s49
s_add_u32 s52,s52,s48
s_mul_i32 s52,s52,18
s_add_u32 s52,s52,s54
s_mul_i32 s52,s52,9
s_add_u32 s52,s52,s53
s_lshl_b32 s52,s52,10
s_add_u32 s73,s52,s77
s_add_u32 s53,s76,2
s_cmp_eq_u32 s98,8
s_cselect_b32 s52,2,s50
s_cselect_b32 s53,8,s53
s_lshr_b32 s54,s49,2
s_sub_u32 s54,s54,s52
s_and_b32 s54,s54,3
s_add_u32 s60,s54,s55
s_cmp_eq_u32 s54,0
s_cselect_b32 s54,s56,s60
s_cmp_lt_u32 s49,16
s_cselect_b32 s54,s54,s49
s_add_u32 s52,s52,s48
s_mul_i32 s52,s52,18
s_add_u32 s52,s52,s54
s_mul_i32 s52,s52,9
s_add_u32 s52,s52,s53
s_lshl_b32 s52,s52,10
s_add_u32 s74,s52,s77
s_add_u32 s53,s76,3
s_cmp_eq_u32 s98,8
s_cselect_b32 s52,3,s50
s_cselect_b32 s53,8,s53
s_lshr_b32 s54,s49,2
s_sub_u32 s54,s54,s52
s_and_b32 s54,s54,3
s_add_u32 s60,s54,s55
s_cmp_eq_u32 s54,0
s_cselect_b32 s54,s56,s60
s_cmp_lt_u32 s49,16
s_cselect_b32 s54,s54,s49
s_add_u32 s52,s52,s48
s_mul_i32 s52,s52,18
s_add_u32 s52,s52,s54
s_mul_i32 s52,s52,9
s_add_u32 s52,s52,s53
s_lshl_b32 s52,s52,10
s_add_u32 s75,s52,s77
s_waitcnt vmcnt(0)
v_readfirstlane_b32 s48,v104
s_nop 0
s_cmp_eq_u32 s48,1
s_cbranch_scc1 Lg11
s_mov_b32 s16,s42
s_mov_b32 s17,s43
s_mov_b32 s18,256
s_mov_b32 s19,0x20000
s_mov_b64 exec,1
s_mov_b32 s56,0
v_mov_b32 v14,0
Lg12:
buffer_load_dword v11,v14,s[16:19],0 offen sc1
s_add_u32 s56,s56,1
s_waitcnt vmcnt(0)
v_cmp_ne_u32 vcc,1,v11
s_nop 0
s_cbranch_vccz Lgd13
s_cmp_lt_u32 s56,0x40000
s_cbranch_scc1 Lg12
Lgd13:
s_mov_b64 exec,-1
Lg11:
v_mov_b32 v33,v13
s_and_b32 s94,s2,15
s_mul_i32 s94,s94,1024
s_add_u32 s94,s94,5324800
s_waitcnt lgkmcnt(0)
s_barrier
s_mov_b64 exec,65535
v_mov_b32 v11,1
buffer_atomic_add v11,v12,s[20:23],s78 offen sc1
s_mov_b64 exec,-1
s_mov_b64 exec,s[66:67]
s_mov_b32 s56,0
v_mov_b32 v28,0
buffer_atomic_add v28,v33,s[20:23],s79 offen sc0 sc1
s_mov_b64 exec,-1
v_and_b32_e64 v25,7,v0
v_bfe_u32 v26,v0,3,1
v_mul_u32_u24 v24,1040,v25
v_mul_u32_u24 v27,8448,v5
v_lshl_add_u32 v24,v26,7,v24
s_lshr_b32 s48,s24,1
s_lshl_b32 s48,s48,6
s_and_b32 s49,s24,1
s_lshl_b32 s49,s49,4
s_add_u32 s48,s48,s49
s_add_u32 s48,s48,0
v_add3_u32 v24,v24,v27,s48
ds_read_b128 v[68:71],v24
ds_read_b128 v[84:87],v24 offset:32
ds_read_b128 v[72:75],v24 offset:256
ds_read_b128 v[88:91],v24 offset:288
ds_read_b128 v[76:79],v24 offset:512
ds_read_b128 v[92:95],v24 offset:544
ds_read_b128 v[80:83],v24 offset:768
ds_read_b128 v[96:99],v24 offset:800
s_waitcnt lgkmcnt(0)
s_nop 0
v_perm_b32 v12,v72,v68,s64
v_perm_b32 v13,v80,v76,s64
v_perm_b32 v14,v88,v84,s64
v_perm_b32 v15,v96,v92,s64
v_accvgpr_write_b32 a192,v12
v_accvgpr_write_b32 a193,v13
v_accvgpr_write_b32 a194,v14
v_accvgpr_write_b32 a195,v15
v_perm_b32 v16,v72,v68,s65
v_perm_b32 v17,v80,v76,s65
v_perm_b32 v18,v88,v84,s65
v_perm_b32 v19,v96,v92,s65
v_accvgpr_write_b32 a196,v16
v_accvgpr_write_b32 a197,v17
v_accvgpr_write_b32 a198,v18
v_accvgpr_write_b32 a199,v19
v_perm_b32 v12,v73,v69,s64
v_perm_b32 v13,v81,v77,s64
v_perm_b32 v14,v89,v85,s64
v_perm_b32 v15,v97,v93,s64
v_accvgpr_write_b32 a200,v12
v_accvgpr_write_b32 a201,v13
v_accvgpr_write_b32 a202,v14
v_accvgpr_write_b32 a203,v15
v_perm_b32 v16,v73,v69,s65
v_perm_b32 v17,v81,v77,s65
v_perm_b32 v18,v89,v85,s65
v_perm_b32 v19,v97,v93,s65
v_accvgpr_write_b32 a204,v16
v_accvgpr_write_b32 a205,v17
v_accvgpr_write_b32 a206,v18
v_accvgpr_write_b32 a207,v19
v_perm_b32 v12,v74,v70,s64
v_perm_b32 v13,v82,v78,s64
v_perm_b32 v14,v90,v86,s64
v_perm_b32 v15,v98,v94,s64
v_accvgpr_write_b32 a208,v12
v_accvgpr_write_b32 a209,v13
v_accvgpr_write_b32 a210,v14
v_accvgpr_write_b32 a211,v15
v_perm_b32 v16,v74,v70,s65
v_perm_b32 v17,v82,v78,s65
v_perm_b32 v18,v90,v86,s65
v_perm_b32 v19,v98,v94,s65
v_accvgpr_write_b32 a212,v16
v_accvgpr_write_b32 a213,v17
v_accvgpr_write_b32 a214,v18
v_accvgpr_write_b32 a215,v19
v_perm_b32 v12,v75,v71,s64
v_perm_b32 v13,v83,v79,s64
v_perm_b32 v14,v91,v87,s64
v_perm_b32 v15,v99,v95,s64
v_accvgpr_write_b32 a216,v12
v_accvgpr_write_b32 a217,v13
v_accvgpr_write_b32 a218,v14
v_accvgpr_write_b32 a219,v15
v_perm_b32 v16,v75,v71,s65
v_perm_b32 v17,v83,v79,s65
v_perm_b32 v18,v91,v87,s65
v_perm_b32 v19,v99,v95,s65
v_accvgpr_write_b32 a220,v16
v_accvgpr_write_b32 a221,v17
v_accvgpr_write_b32 a222,v18
v_accvgpr_write_b32 a223,v19
s_mov_b64 exec,s[66:67]
Lp14:
v_mov_b32 v29,0
buffer_atomic_add v29,v33,s[20:23],s79 offen sc0 sc1
s_waitcnt vmcnt(1)
v_cmp_ne_u32 vcc,16,v28
s_nop 0
s_cbranch_vccz Lpd15
v_mov_b32 v28,0
buffer_atomic_add v28,v33,s[20:23],s79 offen sc0 sc1
s_waitcnt vmcnt(1)
v_cmp_ne_u32 vcc,16,v29
s_nop 0
s_cbranch_vccz Lpd15
s_add_u32 s56,s56,1
s_cmp_lt_u32 s56,0x40000
s_cbranch_scc1 Lp14
Lpd15:
s_mov_b64 exec,-1
s_mov_b64 exec,15
v_mov_b32 v34,0
buffer_atomic_add v34,v33,s[20:23],s94 offen sc0 sc1
s_mov_b64 exec,-1
s_barrier
v_and_b32 v25,7,v0
v_bfe_u32 v26,v0,3,1
v_lshlrev_b32 v25,4,v25
v_lshl_add_u32 v25,v5,8,v25
v_lshl_add_u32 v25,v26,12,v25
s_lshr_b32 s48,s28,1
s_lshl_b32 s49,0,2
s_add_u32 s48,s48,s49
s_lshr_b32 s49,s48,1
s_lshl_b32 s50,s27,2
s_add_u32 s49,s49,s50
s_lshl_b32 s49,s49,17
s_and_b32 s48,s48,1
s_lshl_b32 s48,s48,10
s_add_u32 s49,s49,s48
s_and_b32 s48,s28,1
s_lshl_b32 s48,s48,7
s_add_u32 s49,s49,s48
s_lshr_b32 s48,s24,1
s_lshl_b32 s48,s48,11
s_add_u32 s49,s49,s48
s_add_u32 s49,s49,6291456
s_and_b32 s48,s24,1
s_lshl_b32 s48,s48,3
s_add_u32 s50,s48,0
s_cmp_lt_u32 s50,s27
s_addc_u32 s51,s50,0
s_cmp_eq_u32 s50,s27
s_cselect_b32 s50,0,s51
s_lshl_b32 s50,s50,13
s_add_u32 s80,s50,s49
s_add_u32 s50,s48,1
s_cmp_lt_u32 s50,s27
s_addc_u32 s51,s50,0
s_cmp_eq_u32 s50,s27
s_cselect_b32 s50,0,s51
s_lshl_b32 s50,s50,13
s_add_u32 s81,s50,s49
s_add_u32 s50,s48,2
s_cmp_lt_u32 s50,s27
s_addc_u32 s51,s50,0
s_cmp_eq_u32 s50,s27
s_cselect_b32 s50,0,s51
s_lshl_b32 s50,s50,13
s_add_u32 s82,s50,s49
s_add_u32 s50,s48,3
s_cmp_lt_u32 s50,s27
s_addc_u32 s51,s50,0
s_cmp_eq_u32 s50,s27
s_cselect_b32 s50,0,s51
s_lshl_b32 s50,s50,13
s_add_u32 s83,s50,s49
s_add_u32 s50,s48,4
s_cmp_lt_u32 s50,s27
s_addc_u32 s51,s50,0
s_cmp_eq_u32 s50,s27
s_cselect_b32 s50,0,s51
s_lshl_b32 s50,s50,13
s_add_u32 s84,s50,s49
s_add_u32 s50,s48,5
s_cmp_lt_u32 s50,s27
s_addc_u32 s51,s50,0
s_cmp_eq_u32 s50,s27
s_cselect_b32 s50,0,s51
s_lshl_b32 s50,s50,13
s_add_u32 s85,s50,s49
s_add_u32 s50,s48,6
s_cmp_lt_u32 s50,s27
s_addc_u32 s51,s50,0
s_cmp_eq_u32 s50,s27
s_cselect_b32 s50,0,s51
s_lshl_b32 s50,s50,13
s_add_u32 s86,s50,s49
s_add_u32 s50,s48,7
s_cmp_lt_u32 s50,s27
s_addc_u32 s51,s50,0
s_cmp_eq_u32 s50,s27
s_cselect_b32 s50,0,s51
s_lshl_b32 s50,s50,13
s_add_u32 s87,s50,s49
s_mul_i32 s89,s27,1024
s_add_u32 s89,s89,5521408
s_and_b32 s90,s28,3
s_mul_i32 s90,s90,256
s_add_u32 s90,s90,s89
s_barrier
s_waitcnt vmcnt(0)
s_mov_b64 exec,15
v_cmp_ne_u32 vcc,32,v34
s_mov_b64 exec,-1
s_cbranch_vccz Lw16
s_mov_b64 exec,15
s_mov_b32 s56,0
Lp17:
v_mov_b32 v34,0
buffer_atomic_add v34,v33,s[20:23],s94 offen sc0 sc1
s_waitcnt vmcnt(0)
v_cmp_ne_u32 vcc,32,v34
s_nop 0
s_cbranch_vccz Lpd18
s_add_u32 s56,s56,1
s_cmp_lt_u32 s56,0x40000
s_cbranch_scc1 Lp17
Lpd18:
s_mov_b64 exec,-1
Lw16:
s_mul_i32 s48,s28,576
s_add_u32 s48,s48,5317632
s_bfm_b64 exec,36,0
buffer_load_dwordx4 v[100:103],v1,s[4:7],s48 offen sc1
s_add_u32 s48,s48,18432
buffer_load_dwordx4 v[104:107],v1,s[4:7],s48 offen sc1
s_add_u32 s48,s48,18432
buffer_load_dwordx4 v[108:111],v1,s[4:7],s48 offen sc1
s_add_u32 s48,s48,18432
buffer_load_dwordx4 v[112:115],v1,s[4:7],s48 offen sc1
s_add_u32 s48,s48,18432
buffer_load_dwordx4 v[116:119],v1,s[4:7],s48 offen sc1
s_add_u32 s48,s48,18432
buffer_load_dwordx4 v[120:123],v1,s[4:7],s48 offen sc1
s_add_u32 s48,s48,18432
buffer_load_dwordx4 v[124:127],v1,s[4:7],s48 offen sc1
s_mov_b64 exec,-1
s_add_u32 s60,s62,0
s_mov_b32 m0,0
s_nop 0
buffer_load_dwordx4 v1,s[4:7],s60 offen lds
buffer_load_dwordx4 v1,s[4:7],s60 offen offset:1024 lds
buffer_load_dwordx4 v1,s[4:7],s60 offen offset:2048 lds
buffer_load_dwordx4 v1,s[4:7],s60 offen offset:3072 lds
s_mov_b32 m0,4096
s_nop 0
buffer_load_dwordx4 v2,s[4:7],s60 offen lds
buffer_load_dwordx4 v2,s[4:7],s60 offen offset:1024 lds
buffer_load_dwordx4 v2,s[4:7],s60 offen offset:2048 lds
buffer_load_dwordx4 v2,s[4:7],s60 offen offset:3072 lds
s_mov_b32 m0,8192
s_nop 0
buffer_load_dwordx4 v3,s[4:7],s60 offen lds
buffer_load_dwordx4 v3,s[4:7],s60 offen offset:1024 lds
buffer_load_dwordx4 v3,s[4:7],s60 offen offset:2048 lds
buffer_load_dwordx4 v3,s[4:7],s60 offen offset:3072 lds
s_add_u32 s60,s62,12288
s_mov_b32 m0,12288
s_nop 0
buffer_load_dwordx4 v1,s[4:7],s60 offen lds
buffer_load_dwordx4 v1,s[4:7],s60 offen offset:1024 lds
buffer_load_dwordx4 v1,s[4:7],s60 offen offset:2048 lds
buffer_load_dwordx4 v1,s[4:7],s60 offen offset:3072 lds
s_mov_b32 m0,16384
s_nop 0
buffer_load_dwordx4 v2,s[4:7],s60 offen lds
buffer_load_dwordx4 v2,s[4:7],s60 offen offset:1024 lds
buffer_load_dwordx4 v2,s[4:7],s60 offen offset:2048 lds
buffer_load_dwordx4 v2,s[4:7],s60 offen offset:3072 lds
s_mov_b32 m0,20480
s_nop 0
buffer_load_dwordx4 v3,s[4:7],s60 offen lds
buffer_load_dwordx4 v3,s[4:7],s60 offen offset:1024 lds
buffer_load_dwordx4 v3,s[4:7],s60 offen offset:2048 lds
buffer_load_dwordx4 v3,s[4:7],s60 offen offset:3072 lds
s_add_u32 s60,s62,24576
s_mov_b32 m0,24576
s_nop 0
buffer_load_dwordx4 v1,s[4:7],s60 offen lds
buffer_load_dwordx4 v1,s[4:7],s60 offen offset:1024 lds
buffer_load_dwordx4 v1,s[4:7],s60 offen offset:2048 lds
buffer_load_dwordx4 v1,s[4:7],s60 offen offset:3072 lds
s_mov_b32 m0,28672
s_nop 0
buffer_load_dwordx4 v2,s[4:7],s60 offen lds
buffer_load_dwordx4 v2,s[4:7],s60 offen offset:1024 lds
buffer_load_dwordx4 v2,s[4:7],s60 offen offset:2048 lds
buffer_load_dwordx4 v2,s[4:7],s60 offen offset:3072 lds
s_mov_b32 m0,32768
s_nop 0
buffer_load_dwordx4 v3,s[4:7],s60 offen lds
buffer_load_dwordx4 v3,s[4:7],s60 offen offset:1024 lds
buffer_load_dwordx4 v3,s[4:7],s60 offen offset:2048 lds
buffer_load_dwordx4 v3,s[4:7],s60 offen offset:3072 lds
s_add_u32 s60,s62,36864
s_mov_b32 m0,36864
s_nop 0
buffer_load_dwordx4 v1,s[4:7],s60 offen lds
buffer_load_dwordx4 v1,s[4:7],s60 offen offset:1024 lds
buffer_load_dwordx4 v1,s[4:7],s60 offen offset:2048 lds
buffer_load_dwordx4 v1,s[4:7],s60 offen offset:3072 lds
s_mov_b32 m0,40960
s_nop 0
buffer_load_dwordx4 v2,s[4:7],s60 offen lds
buffer_load_dwordx4 v2,s[4:7],s60 offen offset:1024 lds
buffer_load_dwordx4 v2,s[4:7],s60 offen offset:2048 lds
buffer_load_dwordx4 v2,s[4:7],s60 offen offset:3072 lds
s_mov_b32 m0,45056
s_nop 0
buffer_load_dwordx4 v3,s[4:7],s60 offen lds
buffer_load_dwordx4 v3,s[4:7],s60 offen offset:1024 lds
buffer_load_dwordx4 v3,s[4:7],s60 offen offset:2048 lds
buffer_load_dwordx4 v3,s[4:7],s60 offen offset:3072 lds
s_add_u32 s60,s62,49152
s_mov_b32 m0,49152
s_nop 0
buffer_load_dwordx4 v1,s[4:7],s60 offen lds
buffer_load_dwordx4 v1,s[4:7],s60 offen offset:1024 lds
buffer_load_dwordx4 v1,s[4:7],s60 offen offset:2048 lds
buffer_load_dwordx4 v1,s[4:7],s60 offen offset:3072 lds
s_mov_b32 m0,53248
s_nop 0
buffer_load_dwordx4 v2,s[4:7],s60 offen lds
buffer_load_dwordx4 v2,s[4:7],s60 offen offset:1024 lds
buffer_load_dwordx4 v2,s[4:7],s60 offen offset:2048 lds
buffer_load_dwordx4 v2,s[4:7],s60 offen offset:3072 lds
s_mov_b32 m0,57344
s_nop 0
buffer_load_dwordx4 v3,s[4:7],s60 offen lds
buffer_load_dwordx4 v3,s[4:7],s60 offen offset:1024 lds
buffer_load_dwordx4 v3,s[4:7],s60 offen offset:2048 lds
buffer_load_dwordx4 v3,s[4:7],s60 offen offset:3072 lds
s_add_u32 s60,s62,61440
s_mov_b32 m0,61440
s_nop 0
buffer_load_dwordx4 v1,s[4:7],s60 offen lds
buffer_load_dwordx4 v1,s[4:7],s60 offen offset:1024 lds
buffer_load_dwordx4 v1,s[4:7],s60 offen offset:2048 lds
buffer_load_dwordx4 v1,s[4:7],s60 offen offset:3072 lds
s_mov_b32 m0,65536
s_nop 0
buffer_load_dwordx4 v2,s[4:7],s60 offen lds
buffer_load_dwordx4 v2,s[4:7],s60 offen offset:1024 lds
buffer_load_dwordx4 v2,s[4:7],s60 offen offset:2048 lds
buffer_load_dwordx4 v2,s[4:7],s60 offen offset:3072 lds
s_mov_b32 m0,69632
s_nop 0
buffer_load_dwordx4 v3,s[4:7],s60 offen lds
buffer_load_dwordx4 v3,s[4:7],s60 offen offset:1024 lds
buffer_load_dwordx4 v3,s[4:7],s60 offen offset:2048 lds
buffer_load_dwordx4 v3,s[4:7],s60 offen offset:3072 lds
s_add_u32 s60,s62,73728
s_mov_b32 m0,73728
s_nop 0
buffer_load_dwordx4 v1,s[4:7],s60 offen lds
buffer_load_dwordx4 v1,s[4:7],s60 offen offset:1024 lds
buffer_load_dwordx4 v1,s[4:7],s60 offen offset:2048 lds
buffer_load_dwordx4 v1,s[4:7],s60 offen offset:3072 lds
s_mov_b32 m0,77824
s_nop 0
buffer_load_dwordx4 v2,s[4:7],s60 offen lds
buffer_load_dwordx4 v2,s[4:7],s60 offen offset:1024 lds
buffer_load_dwordx4 v2,s[4:7],s60 offen offset:2048 lds
buffer_load_dwordx4 v2,s[4:7],s60 offen offset:3072 lds
s_mov_b32 m0,81920
s_nop 0
buffer_load_dwordx4 v3,s[4:7],s60 offen lds
buffer_load_dwordx4 v3,s[4:7],s60 offen offset:1024 lds
buffer_load_dwordx4 v3,s[4:7],s60 offen offset:2048 lds
buffer_load_dwordx4 v3,s[4:7],s60 offen offset:3072 lds
buffer_store_dwordx4 v[220:223],v1,s[4:7],s72 offen sc1
buffer_store_dwordx4 v[224:227],v1,s[4:7],s73 offen sc1
buffer_store_dwordx4 v[228:231],v1,s[4:7],s74 offen sc1
buffer_store_dwordx4 v[232:235],v1,s[4:7],s75 offen sc1
s_waitcnt vmcnt(62)
v_pk_add_f32 v[100:101],v[100:101],v[104:105]
v_pk_add_f32 v[102:103],v[102:103],v[106:107]
v_pk_add_f32 v[100:101],v[100:101],v[108:109]
v_pk_add_f32 v[102:103],v[102:103],v[110:111]
v_pk_add_f32 v[100:101],v[100:101],v[112:113]
v_pk_add_f32 v[102:103],v[102:103],v[114:115]
v_pk_add_f32 v[100:101],v[100:101],v[116:117]
v_pk_add_f32 v[102:103],v[102:103],v[118:119]
v_pk_add_f32 v[100:101],v[100:101],v[120:121]
v_pk_add_f32 v[102:103],v[102:103],v[122:123]
v_pk_add_f32 v[100:101],v[100:101],v[124:125]
v_pk_add_f32 v[102:103],v[102:103],v[126:127]
v_add_u32 v10,147456,v1
s_bfm_b64 exec,36,0
ds_write_b128 v10,v[100:103]
s_mov_b64 exec,-1
Lae9:
s_barrier
s_cmp_lg_u32 s24,0
s_cbranch_scc1 Lj19
s_mul_i32 s48,s30,1024
s_add_u32 s48,s48,5357568
v_mul_u32_u24 v10,256,v0
s_mov_b64 exec,15
v_mov_b32 v11,2
buffer_atomic_add v11,v10,s[20:23],s48 offen sc1
s_mov_b64 exec,-1
Lj19:
s_cmp_eq_u32 s24,0
s_cbranch_scc1 Lj20
s_mul_i32 s48,s24,20480
s_add_u32 s49,s62,s48
s_add_u32 s60,s49,65536
s_add_u32 m0,s48,65536
s_nop 0
buffer_load_dwordx4 v1,s[4:7],s60 offen lds
buffer_load_dwordx4 v1,s[4:7],s60 offen offset:1024 lds
buffer_load_dwordx4 v1,s[4:7],s60 offen offset:2048 lds
buffer_load_dwordx4 v1,s[4:7],s60 offen offset:3072 lds
s_add_u32 m0,s48,69632
s_nop 0
buffer_load_dwordx4 v2,s[4:7],s60 offen lds
buffer_load_dwordx4 v2,s[4:7],s60 offen offset:1024 lds
buffer_load_dwordx4 v2,s[4:7],s60 offen offset:2048 lds
buffer_load_dwordx4 v2,s[4:7],s60 offen offset:3072 lds
s_add_u32 m0,s48,73728
s_nop 0
buffer_load_dwordx4 v3,s[4:7],s60 offen lds
buffer_load_dwordx4 v3,s[4:7],s60 offen offset:1024 lds
buffer_load_dwordx4 v3,s[4:7],s60 offen offset:2048 lds
buffer_load_dwordx4 v3,s[4:7],s60 offen offset:3072 lds
s_add_u32 s60,s49,77824
s_add_u32 m0,s48,77824
s_nop 0
buffer_load_dwordx4 v1,s[4:7],s60 offen lds
buffer_load_dwordx4 v1,s[4:7],s60 offen offset:1024 lds
buffer_load_dwordx4 v1,s[4:7],s60 offen offset:2048 lds
buffer_load_dwordx4 v1,s[4:7],s60 offen offset:3072 lds
s_add_u32 m0,s48,81920
s_nop 0
buffer_load_dwordx4 v2,s[4:7],s60 offen lds
buffer_load_dwordx4 v2,s[4:7],s60 offen offset:1024 lds
buffer_load_dwordx4 v2,s[4:7],s60 offen offset:2048 lds
buffer_load_dwordx4 v2,s[4:7],s60 offen offset:3072 lds
Lj20:
s_waitcnt vmcnt(20)
s_branch Ljoin0
Lprep:
s_cmp_lg_u32 s2,255
s_cbranch_scc1 Lq21
s_cmp_lg_u32 s24,3
s_cbranch_scc1 Lq21
v_mul_u32_u24 v10,256,v0
v_mov_b32 v11,0
s_mov_b32 s48,5275648
buffer_store_dword v11,v10,s[20:23],s48 offen sc1
s_mov_b32 s48,5292032
buffer_store_dword v11,v10,s[20:23],s48 offen sc1
s_mov_b32 s48,5308416
buffer_store_dword v11,v10,s[20:23],s48 offen sc1
s_mov_b32 s48,5324800
buffer_store_dword v11,v10,s[20:23],s48 offen sc1
s_mov_b32 s48,5341184
buffer_store_dword v11,v10,s[20:23],s48 offen sc1
s_mov_b32 s48,5357568
buffer_store_dword v11,v10,s[20:23],s48 offen sc1
s_mov_b32 s16,s42
s_mov_b32 s17,s43
s_mov_b32 s18,256
s_mov_b32 s19,0x20000
v_mov_b32 v12,1
s_waitcnt vmcnt(0)
s_mov_b64 exec,1
buffer_store_dword v12,v11,s[16:19],0 offen sc1
s_mov_b64 exec,-1
Lq21:
s_lshl_b32 s66,s25,1
s_add_u32 s66,s66,s26
s_sub_u32 s66,s66,6
s_and_b32 s78,s24,1
s_lshl_b32 s67,s78,6
s_add_u32 s67,s67,s66
s_cmp_lt_u32 s24,2
s_cbranch_scc1 Lq22
s_xor_b32 s67,s67,63
s_cmp_lg_u32 s24,2
s_cbranch_scc1 Lwp26
s_lshr_b32 s48,s2,6
s_lshl_b32 s48,s48,1
s_and_b32 s49,s26,1
s_add_u32 s48,s48,s49
s_lshl_b32 s48,s48,20
s_add_u32 s48,s48,0x80000
v_lshlrev_b32 v10,23,v0
v_mov_b32 v11,0
s_mov_b64 exec,0x1ff
buffer_atomic_add v11,v10,s[20:23],s48 offen sc1
s_mov_b64 exec,7
buffer_atomic_add v11,v10,s[4:7],s48 offen sc1
s_mov_b32 s16,s40
s_mov_b32 s17,s41
s_mov_b32 s18,2359296
s_mov_b32 s19,0x20000
s_mov_b64 exec,1
s_sub_u32 s48,s48,0x80000
buffer_store_dword v11,v10,s[16:19],s48 offen sc1
s_mov_b64 exec,-1
s_mov_b32 s16,s36
s_mov_b32 s17,s37
s_mov_b32 s18,4096
s_mov_b32 s19,0x20000
v_lshlrev_b32 v10,7,v0
buffer_load_dword v11,v10,s[16:19],0 offen
Lwp26:
s_cmp_lg_u32 s24,3
s_cbranch_scc1 Lq27
s_lshr_b32 s48,0xff81ffff,s66
s_cmp_lt_u32 s66,33
s_cselect_b32 s48,s48,0
s_bitcmp1_b32 s48,0
s_cbranch_scc0 Lq27
s_mul_i32 s48,s66,16384
s_mov_b32 s49,39878656
s_cmp_lt_u32 s66,17
s_cselect_b32 s49,s49,4997120
s_add_u32 s48,s48,s49
v_mul_u32_u24 v10,256,v0
v_mov_b32 v11,0
buffer_store_dword v11,v10,s[20:23],s48 offen sc1
Lq27:
s_barrier
s_mov_b32 s16,s34
s_mov_b32 s17,s35
s_mov_b32 s18,8388608
s_mov_b32 s19,0x20000
s_cmp_lt_u32 s28,16
s_cselect_b32 s18,s18,0
s_lshr_b32 s94,s28,1
s_lshl_b32 s49,0,2
s_add_u32 s94,s94,s49
s_lshl_b32 s94,s94,4
s_add_u32 s94,s94,s27
s_lshl_b32 s94,s94,12
s_and_b32 s49,s28,1
s_lshl_b32 s49,s49,22
s_add_u32 s94,s94,s49
s_mul_i32 s49,s78,2097152
s_add_u32 s94,s94,s49
s_mul_i32 s95,s78,4160
s_add_u32 m0,s95,110592
s_nop 0
buffer_load_dwordx4 v1,s[16:19],s94 offen lds
s_add_u32 m0,s95,118016
s_nop 0
buffer_load_dwordx4 v1,s[16:19],s94 offen offset:1024 lds
s_add_u32 m0,s95,125440
s_nop 0
buffer_load_dwordx4 v1,s[16:19],s94 offen offset:2048 lds
s_add_u32 m0,s95,132864
s_nop 0
buffer_load_dwordx4 v1,s[16:19],s94 offen offset:3072 lds
s_add_u32 s94,s94,524288
s_add_u32 m0,s95,111632
s_nop 0
buffer_load_dwordx4 v1,s[16:19],s94 offen lds
s_add_u32 m0,s95,119056
s_nop 0
buffer_load_dwordx4 v1,s[16:19],s94 offen offset:1024 lds
s_add_u32 m0,s95,126480
s_nop 0
buffer_load_dwordx4 v1,s[16:19],s94 offen offset:2048 lds
s_add_u32 m0,s95,133904
s_nop 0
buffer_load_dwordx4 v1,s[16:19],s94 offen offset:3072 lds
s_add_u32 s94,s94,524288
s_add_u32 m0,s95,112672
s_nop 0
buffer_load_dwordx4 v1,s[16:19],s94 offen lds
s_add_u32 m0,s95,120096
s_nop 0
buffer_load_dwordx4 v1,s[16:19],s94 offen offset:1024 lds
s_add_u32 m0,s95,127520
s_nop 0
buffer_load_dwordx4 v1,s[16:19],s94 offen offset:2048 lds
s_add_u32 m0,s95,134944
s_nop 0
buffer_load_dwordx4 v1,s[16:19],s94 offen offset:3072 lds
s_add_u32 s94,s94,524288
s_add_u32 m0,s95,113712
s_nop 0
buffer_load_dwordx4 v1,s[16:19],s94 offen lds
s_add_u32 m0,s95,121136
s_nop 0
buffer_load_dwordx4 v1,s[16:19],s94 offen offset:1024 lds
s_add_u32 m0,s95,128560
s_nop 0
buffer_load_dwordx4 v1,s[16:19],s94 offen offset:2048 lds
s_add_u32 m0,s95,135984
s_nop 0
buffer_load_dwordx4 v1,s[16:19],s94 offen offset:3072 lds
Lq22:
s_cmp_ge_u32 s67,126
s_cbranch_scc1 Lq23
s_mov_b32 s16,s32
s_mov_b32 s17,s33
s_mov_b32 s18,5308416
s_mov_b32 s19,0x20000
s_mul_i32 s68,s67,3641
s_lshr_b32 s68,s68,16
s_mul_i32 s48,s68,18
s_sub_u32 s53,s67,s48
s_cmp_lt_u32 s24,2
s_cselect_b32 s69,18,0
s_add_u32 s69,s69,s53
s_mul_i32 s55,s68,3
s_lshl_b32 s48,s68,1
s_add_u32 s48,s48,4
s_min_u32 s55,s55,s48
s_mul_i32 s48,s55,294912
s_lshl_b32 s49,s69,8
s_add_u32 s48,s48,s49
v_mul_u32_u24 v10,73728,v5
v_lshl_add_u32 v10,v4,4,v10
s_add_u32 s49,s48,0
buffer_load_dwordx4 v[100:103],v10,s[16:19],s49 offen
s_add_u32 s49,s48,9216
buffer_load_dwordx4 v[104:107],v10,s[16:19],s49 offen
s_add_u32 s49,s48,18432
buffer_load_dwordx4 v[108:111],v10,s[16:19],s49 offen
s_add_u32 s49,s48,27648
buffer_load_dwordx4 v[112:115],v10,s[16:19],s49 offen
s_add_u32 s49,s48,36864
buffer_load_dwordx4 v[116:119],v10,s[16:19],s49 offen
s_add_u32 s49,s48,46080
buffer_load_dwordx4 v[120:123],v10,s[16:19],s49 offen
s_add_u32 s49,s48,55296
buffer_load_dwordx4 v[124:127],v10,s[16:19],s49 offen
s_add_u32 s49,s48,64512
buffer_load_dwordx4 v[128:131],v10,s[16:19],s49 offen
s_add_u32 s49,s48,294912
buffer_load_dwordx4 v[132:135],v10,s[16:19],s49 offen
s_add_u32 s49,s48,304128
buffer_load_dwordx4 v[136:139],v10,s[16:19],s49 offen
s_add_u32 s49,s48,313344
buffer_load_dwordx4 v[140:143],v10,s[16:19],s49 offen
s_add_u32 s49,s48,322560
buffer_load_dwordx4 v[144:147],v10,s[16:19],s49 offen
s_add_u32 s49,s48,331776
buffer_load_dwordx4 v[148:151],v10,s[16:19],s49 offen
s_add_u32 s49,s48,340992
buffer_load_dwordx4 v[152:155],v10,s[16:19],s49 offen
s_add_u32 s49,s48,350208
buffer_load_dwordx4 v[156:159],v10,s[16:19],s49 offen
s_add_u32 s49,s48,359424
buffer_load_dwordx4 v[160:163],v10,s[16:19],s49 offen
s_cmp_lt_u32 s68,4
s_cselect_b32 s18,s18,0
s_add_u32 s49,s48,589824
buffer_load_dwordx4 v[164:167],v10,s[16:19],s49 offen
s_add_u32 s49,s48,599040
buffer_load_dwordx4 v[168:171],v10,s[16:19],s49 offen
s_add_u32 s49,s48,608256
buffer_load_dwordx4 v[172:175],v10,s[16:19],s49 offen
s_add_u32 s49,s48,617472
buffer_load_dwordx4 v[176:179],v10,s[16:19],s49 offen
s_add_u32 s49,s48,626688
buffer_load_dwordx4 v[180:183],v10,s[16:19],s49 offen
s_add_u32 s49,s48,635904
buffer_load_dwordx4 v[184:187],v10,s[16:19],s49 offen
s_add_u32 s49,s48,645120
buffer_load_dwordx4 v[188:191],v10,s[16:19],s49 offen
s_add_u32 s49,s48,654336
buffer_load_dwordx4 v[192:195],v10,s[16:19],s49 offen
s_cmp_lt_u32 s24,2
s_cbranch_scc1 Lq28
s_waitcnt vmcnt(24)
s_barrier
v_and_b32_e64 v25,7,v0
v_bfe_u32 v26,v0,3,1
v_mul_u32_u24 v24,1040,v25
v_mul_u32_u24 v27,8448,v5
v_lshl_add_u32 v24,v26,7,v24
s_lshr_b32 s48,s24,1
s_lshl_b32 s48,s48,6
s_and_b32 s49,s24,1
s_lshl_b32 s49,s49,4
s_add_u32 s48,s48,s49
s_add_u32 s48,s48,110592
v_add3_u32 v24,v24,v27,s48
ds_read_b128 v[68:71],v24
ds_read_b128 v[84:87],v24 offset:32
ds_read_b128 v[72:75],v24 offset:256
ds_read_b128 v[88:91],v24 offset:288
ds_read_b128 v[76:79],v24 offset:512
ds_read_b128 v[92:95],v24 offset:544
ds_read_b128 v[80:83],v24 offset:768
ds_read_b128 v[96:99],v24 offset:800
s_waitcnt lgkmcnt(0)
v_perm_b32 v12,v72,v68,s64
v_perm_b32 v13,v80,v76,s64
v_perm_b32 v14,v88,v84,s64
v_perm_b32 v15,v96,v92,s64
v_accvgpr_write_b32 a192,v12
v_accvgpr_write_b32 a193,v13
v_accvgpr_write_b32 a194,v14
v_accvgpr_write_b32 a195,v15
v_perm_b32 v16,v72,v68,s65
v_perm_b32 v17,v80,v76,s65
v_perm_b32 v18,v88,v84,s65
v_perm_b32 v19,v96,v92,s65
v_accvgpr_write_b32 a196,v16
v_accvgpr_write_b32 a197,v17
v_accvgpr_write_b32 a198,v18
v_accvgpr_write_b32 a199,v19
v_perm_b32 v12,v73,v69,s64
v_perm_b32 v13,v81,v77,s64
v_perm_b32 v14,v89,v85,s64
v_perm_b32 v15,v97,v93,s64
v_accvgpr_write_b32 a200,v12
v_accvgpr_write_b32 a201,v13
v_accvgpr_write_b32 a202,v14
v_accvgpr_write_b32 a203,v15
v_perm_b32 v16,v73,v69,s65
v_perm_b32 v17,v81,v77,s65
v_perm_b32 v18,v89,v85,s65
v_perm_b32 v19,v97,v93,s65
v_accvgpr_write_b32 a204,v16
v_accvgpr_write_b32 a205,v17
v_accvgpr_write_b32 a206,v18
v_accvgpr_write_b32 a207,v19
v_perm_b32 v12,v74,v70,s64
v_perm_b32 v13,v82,v78,s64
v_perm_b32 v14,v90,v86,s64
v_perm_b32 v15,v98,v94,s64
v_accvgpr_write_b32 a208,v12
v_accvgpr_write_b32 a209,v13
v_accvgpr_write_b32 a210,v14
v_accvgpr_write_b32 a211,v15
v_perm_b32 v16,v74,v70,s65
v_perm_b32 v17,v82,v78,s65
v_perm_b32 v18,v90,v86,s65
v_perm_b32 v19,v98,v94,s65
v_accvgpr_write_b32 a212,v16
v_accvgpr_write_b32 a213,v17
v_accvgpr_write_b32 a214,v18
v_accvgpr_write_b32 a215,v19
v_perm_b32 v12,v75,v71,s64
v_perm_b32 v13,v83,v79,s64
v_perm_b32 v14,v91,v87,s64
v_perm_b32 v15,v99,v95,s64
v_accvgpr_write_b32 a216,v12
v_accvgpr_write_b32 a217,v13
v_accvgpr_write_b32 a218,v14
v_accvgpr_write_b32 a219,v15
v_perm_b32 v16,v75,v71,s65
v_perm_b32 v17,v83,v79,s65
v_perm_b32 v18,v91,v87,s65
v_perm_b32 v19,v99,v95,s65
v_accvgpr_write_b32 a220,v16
v_accvgpr_write_b32 a221,v17
v_accvgpr_write_b32 a222,v18
v_accvgpr_write_b32 a223,v19
Lq28:
s_mov_b32 s50,9216
s_cmp_lt_u32 s24,2
s_cselect_b32 s50,9216,s50
s_cselect_b32 s51,0,165888
s_mov_b32 s52,156672
s_lshl_b32 s53,s53,3
s_sub_u32 s54,9216,s50
s_add_u32 s48,s53,0
s_mul_i32 s49,s48,57
s_lshr_b32 s49,s49,9
s_mul_i32 s56,s49,9
s_sub_u32 s48,s48,s56
s_lshl_b32 s48,s48,10
s_mul_i32 s49,s49,331776
s_add_u32 s49,s49,s48
s_cmp_lt_u32 s48,s50
s_cselect_b32 s80,s50,s54
s_cselect_b32 s48,s51,s52
s_add_u32 s49,s49,s48
s_mul_i32 s48,s55,s80
s_add_u32 s70,s49,s48
s_add_u32 s48,s53,1
s_mul_i32 s49,s48,57
s_lshr_b32 s49,s49,9
s_mul_i32 s56,s49,9
s_sub_u32 s48,s48,s56
s_lshl_b32 s48,s48,10
s_mul_i32 s49,s49,331776
s_add_u32 s49,s49,s48
s_cmp_lt_u32 s48,s50
s_cselect_b32 s81,s50,s54
s_cselect_b32 s48,s51,s52
s_add_u32 s49,s49,s48
s_mul_i32 s48,s55,s81
s_add_u32 s71,s49,s48
s_add_u32 s48,s53,2
s_mul_i32 s49,s48,57
s_lshr_b32 s49,s49,9
s_mul_i32 s56,s49,9
s_sub_u32 s48,s48,s56
s_lshl_b32 s48,s48,10
s_mul_i32 s49,s49,331776
s_add_u32 s49,s49,s48
s_cmp_lt_u32 s48,s50
s_cselect_b32 s82,s50,s54
s_cselect_b32 s48,s51,s52
s_add_u32 s49,s49,s48
s_mul_i32 s48,s55,s82
s_add_u32 s72,s49,s48
s_add_u32 s48,s53,3
s_mul_i32 s49,s48,57
s_lshr_b32 s49,s49,9
s_mul_i32 s56,s49,9
s_sub_u32 s48,s48,s56
s_lshl_b32 s48,s48,10
s_mul_i32 s49,s49,331776
s_add_u32 s49,s49,s48
s_cmp_lt_u32 s48,s50
s_cselect_b32 s83,s50,s54
s_cselect_b32 s48,s51,s52
s_add_u32 s49,s49,s48
s_mul_i32 s48,s55,s83
s_add_u32 s73,s49,s48
s_add_u32 s48,s53,4
s_mul_i32 s49,s48,57
s_lshr_b32 s49,s49,9
s_mul_i32 s56,s49,9
s_sub_u32 s48,s48,s56
s_lshl_b32 s48,s48,10
s_mul_i32 s49,s49,331776
s_add_u32 s49,s49,s48
s_cmp_lt_u32 s48,s50
s_cselect_b32 s84,s50,s54
s_cselect_b32 s48,s51,s52
s_add_u32 s49,s49,s48
s_mul_i32 s48,s55,s84
s_add_u32 s74,s49,s48
s_add_u32 s48,s53,5
s_mul_i32 s49,s48,57
s_lshr_b32 s49,s49,9
s_mul_i32 s56,s49,9
s_sub_u32 s48,s48,s56
s_lshl_b32 s48,s48,10
s_mul_i32 s49,s49,331776
s_add_u32 s49,s49,s48
s_cmp_lt_u32 s48,s50
s_cselect_b32 s85,s50,s54
s_cselect_b32 s48,s51,s52
s_add_u32 s49,s49,s48
s_mul_i32 s48,s55,s85
s_add_u32 s75,s49,s48
s_add_u32 s48,s53,6
s_mul_i32 s49,s48,57
s_lshr_b32 s49,s49,9
s_mul_i32 s56,s49,9
s_sub_u32 s48,s48,s56
s_lshl_b32 s48,s48,10
s_mul_i32 s49,s49,331776
s_add_u32 s49,s49,s48
s_cmp_lt_u32 s48,s50
s_cselect_b32 s86,s50,s54
s_cselect_b32 s48,s51,s52
s_add_u32 s49,s49,s48
s_mul_i32 s48,s55,s86
s_add_u32 s76,s49,s48
s_add_u32 s48,s53,7
s_mul_i32 s49,s48,57
s_lshr_b32 s49,s49,9
s_mul_i32 s56,s49,9
s_sub_u32 s48,s48,s56
s_lshl_b32 s48,s48,10
s_mul_i32 s49,s49,331776
s_add_u32 s49,s49,s48
s_cmp_lt_u32 s48,s50
s_cselect_b32 s87,s50,s54
s_cselect_b32 s48,s51,s52
s_add_u32 s49,s49,s48
s_mul_i32 s48,s55,s87
s_add_u32 s77,s49,s48
s_mov_b32 s48,0x3f803f80
v_mov_b32 v20,0
v_mov_b32 v21,0
v_mov_b32 v22,0
v_mov_b32 v23,0
v_mov_b32 v24,0
v_mov_b32 v25,0
v_mov_b32 v26,0
v_mov_b32_e64 v27,0
s_waitcnt vmcnt(16)
v_perm_b32 v12,v104,v100,s64
v_perm_b32 v13,v112,v108,s64
v_perm_b32 v14,v120,v116,s64
v_perm_b32 v15,v128,v124,s64
buffer_store_dwordx4 v[12:15],v1,s[4:7],s70 offen sc1
v_dot2c_f32_bf16 v20,s48,v12
v_dot2c_f32_bf16 v20,s48,v13
v_dot2c_f32_bf16 v20,s48,v14
v_dot2c_f32_bf16 v20,s48,v15
s_add_u32 s70,s70,s80
s_nop 0
v_perm_b32 v16,v104,v100,s65
v_perm_b32 v17,v112,v108,s65
v_perm_b32 v18,v120,v116,s65
v_perm_b32 v19,v128,v124,s65
buffer_store_dwordx4 v[16:19],v1,s[4:7],s71 offen sc1
v_dot2c_f32_bf16 v21,s48,v16
v_dot2c_f32_bf16 v21,s48,v17
v_dot2c_f32_bf16 v21,s48,v18
v_dot2c_f32_bf16 v21,s48,v19
s_add_u32 s71,s71,s81
s_nop 0
v_perm_b32 v12,v105,v101,s64
v_perm_b32 v13,v113,v109,s64
v_perm_b32 v14,v121,v117,s64
v_perm_b32 v15,v129,v125,s64
buffer_store_dwordx4 v[12:15],v1,s[4:7],s72 offen sc1
v_dot2c_f32_bf16 v22,s48,v12
v_dot2c_f32_bf16 v22,s48,v13
v_dot2c_f32_bf16 v22,s48,v14
v_dot2c_f32_bf16 v22,s48,v15
s_add_u32 s72,s72,s82
s_nop 0
v_perm_b32 v16,v105,v101,s65
v_perm_b32 v17,v113,v109,s65
v_perm_b32 v18,v121,v117,s65
v_perm_b32 v19,v129,v125,s65
buffer_store_dwordx4 v[16:19],v1,s[4:7],s73 offen sc1
v_dot2c_f32_bf16 v23,s48,v16
v_dot2c_f32_bf16 v23,s48,v17
v_dot2c_f32_bf16 v23,s48,v18
v_dot2c_f32_bf16 v23,s48,v19
s_add_u32 s73,s73,s83
s_nop 0
v_perm_b32 v12,v106,v102,s64
v_perm_b32 v13,v114,v110,s64
v_perm_b32 v14,v122,v118,s64
v_perm_b32 v15,v130,v126,s64
buffer_store_dwordx4 v[12:15],v1,s[4:7],s74 offen sc1
v_dot2c_f32_bf16 v24,s48,v12
v_dot2c_f32_bf16 v24,s48,v13
v_dot2c_f32_bf16 v24,s48,v14
v_dot2c_f32_bf16 v24,s48,v15
s_add_u32 s74,s74,s84
s_nop 0
v_perm_b32 v16,v106,v102,s65
v_perm_b32 v17,v114,v110,s65
v_perm_b32 v18,v122,v118,s65
v_perm_b32 v19,v130,v126,s65
buffer_store_dwordx4 v[16:19],v1,s[4:7],s75 offen sc1
v_dot2c_f32_bf16 v25,s48,v16
v_dot2c_f32_bf16 v25,s48,v17
v_dot2c_f32_bf16 v25,s48,v18
v_dot2c_f32_bf16 v25,s48,v19
s_add_u32 s75,s75,s85
s_nop 0
v_perm_b32 v12,v107,v103,s64
v_perm_b32 v13,v115,v111,s64
v_perm_b32 v14,v123,v119,s64
v_perm_b32 v15,v131,v127,s64
buffer_store_dwordx4 v[12:15],v1,s[4:7],s76 offen sc1
v_dot2c_f32_bf16 v26,s48,v12
v_dot2c_f32_bf16 v26,s48,v13
v_dot2c_f32_bf16 v26,s48,v14
v_dot2c_f32_bf16 v26,s48,v15
s_add_u32 s76,s76,s86
s_nop 0
v_perm_b32 v16,v107,v103,s65
v_perm_b32 v17,v115,v111,s65
v_perm_b32 v18,v123,v119,s65
v_perm_b32 v19,v131,v127,s65
buffer_store_dwordx4 v[16:19],v1,s[4:7],s77 offen sc1
v_dot2c_f32_bf16 v27,s48,v16
v_dot2c_f32_bf16 v27,s48,v17
v_dot2c_f32_bf16 v27,s48,v18
v_dot2c_f32_bf16 v27,s48,v19
s_add_u32 s77,s77,s87
s_waitcnt vmcnt(16)
v_perm_b32 v12,v136,v132,s64
v_perm_b32 v13,v144,v140,s64
v_perm_b32 v14,v152,v148,s64
v_perm_b32 v15,v160,v156,s64
buffer_store_dwordx4 v[12:15],v1,s[4:7],s70 offen sc1
v_dot2c_f32_bf16 v20,s48,v12
v_dot2c_f32_bf16 v20,s48,v13
v_dot2c_f32_bf16 v20,s48,v14
v_dot2c_f32_bf16 v20,s48,v15
s_add_u32 s70,s70,s80
s_nop 0
v_perm_b32 v16,v136,v132,s65
v_perm_b32 v17,v144,v140,s65
v_perm_b32 v18,v152,v148,s65
v_perm_b32 v19,v160,v156,s65
buffer_store_dwordx4 v[16:19],v1,s[4:7],s71 offen sc1
v_dot2c_f32_bf16 v21,s48,v16
v_dot2c_f32_bf16 v21,s48,v17
v_dot2c_f32_bf16 v21,s48,v18
v_dot2c_f32_bf16 v21,s48,v19
s_add_u32 s71,s71,s81
s_nop 0
v_perm_b32 v12,v137,v133,s64
v_perm_b32 v13,v145,v141,s64
v_perm_b32 v14,v153,v149,s64
v_perm_b32 v15,v161,v157,s64
buffer_store_dwordx4 v[12:15],v1,s[4:7],s72 offen sc1
v_dot2c_f32_bf16 v22,s48,v12
v_dot2c_f32_bf16 v22,s48,v13
v_dot2c_f32_bf16 v22,s48,v14
v_dot2c_f32_bf16 v22,s48,v15
s_add_u32 s72,s72,s82
s_nop 0
v_perm_b32 v16,v137,v133,s65
v_perm_b32 v17,v145,v141,s65
v_perm_b32 v18,v153,v149,s65
v_perm_b32 v19,v161,v157,s65
buffer_store_dwordx4 v[16:19],v1,s[4:7],s73 offen sc1
v_dot2c_f32_bf16 v23,s48,v16
v_dot2c_f32_bf16 v23,s48,v17
v_dot2c_f32_bf16 v23,s48,v18
v_dot2c_f32_bf16 v23,s48,v19
s_add_u32 s73,s73,s83
s_nop 0
v_perm_b32 v12,v138,v134,s64
v_perm_b32 v13,v146,v142,s64
v_perm_b32 v14,v154,v150,s64
v_perm_b32 v15,v162,v158,s64
buffer_store_dwordx4 v[12:15],v1,s[4:7],s74 offen sc1
v_dot2c_f32_bf16 v24,s48,v12
v_dot2c_f32_bf16 v24,s48,v13
v_dot2c_f32_bf16 v24,s48,v14
v_dot2c_f32_bf16 v24,s48,v15
s_add_u32 s74,s74,s84
s_nop 0
v_perm_b32 v16,v138,v134,s65
v_perm_b32 v17,v146,v142,s65
v_perm_b32 v18,v154,v150,s65
v_perm_b32 v19,v162,v158,s65
buffer_store_dwordx4 v[16:19],v1,s[4:7],s75 offen sc1
v_dot2c_f32_bf16 v25,s48,v16
v_dot2c_f32_bf16 v25,s48,v17
v_dot2c_f32_bf16 v25,s48,v18
v_dot2c_f32_bf16 v25,s48,v19
s_add_u32 s75,s75,s85
s_nop 0
v_perm_b32 v12,v139,v135,s64
v_perm_b32 v13,v147,v143,s64
v_perm_b32 v14,v155,v151,s64
v_perm_b32 v15,v163,v159,s64
buffer_store_dwordx4 v[12:15],v1,s[4:7],s76 offen sc1
v_dot2c_f32_bf16 v26,s48,v12
v_dot2c_f32_bf16 v26,s48,v13
v_dot2c_f32_bf16 v26,s48,v14
v_dot2c_f32_bf16 v26,s48,v15
s_add_u32 s76,s76,s86
s_nop 0
v_perm_b32 v16,v139,v135,s65
v_perm_b32 v17,v147,v143,s65
v_perm_b32 v18,v155,v151,s65
v_perm_b32 v19,v163,v159,s65
buffer_store_dwordx4 v[16:19],v1,s[4:7],s77 offen sc1
v_dot2c_f32_bf16 v27,s48,v16
v_dot2c_f32_bf16 v27,s48,v17
v_dot2c_f32_bf16 v27,s48,v18
v_dot2c_f32_bf16 v27,s48,v19
s_add_u32 s77,s77,s87
s_cmp_ge_u32 s68,4
s_cbranch_scc1 Lq29
s_waitcnt vmcnt(16)
v_perm_b32 v12,v168,v164,s64
v_perm_b32 v13,v176,v172,s64
v_perm_b32 v14,v184,v180,s64
v_perm_b32 v15,v192,v188,s64
buffer_store_dwordx4 v[12:15],v1,s[4:7],s70 offen sc1
v_dot2c_f32_bf16 v20,s48,v12
v_dot2c_f32_bf16 v20,s48,v13
v_dot2c_f32_bf16 v20,s48,v14
v_dot2c_f32_bf16 v20,s48,v15
v_perm_b32 v16,v168,v164,s65
v_perm_b32 v17,v176,v172,s65
v_perm_b32 v18,v184,v180,s65
v_perm_b32 v19,v192,v188,s65
buffer_store_dwordx4 v[16:19],v1,s[4:7],s71 offen sc1
v_dot2c_f32_bf16 v21,s48,v16
v_dot2c_f32_bf16 v21,s48,v17
v_dot2c_f32_bf16 v21,s48,v18
v_dot2c_f32_bf16 v21,s48,v19
v_perm_b32 v12,v169,v165,s64
v_perm_b32 v13,v177,v173,s64
v_perm_b32 v14,v185,v181,s64
v_perm_b32 v15,v193,v189,s64
buffer_store_dwordx4 v[12:15],v1,s[4:7],s72 offen sc1
v_dot2c_f32_bf16 v22,s48,v12
v_dot2c_f32_bf16 v22,s48,v13
v_dot2c_f32_bf16 v22,s48,v14
v_dot2c_f32_bf16 v22,s48,v15
v_perm_b32 v16,v169,v165,s65
v_perm_b32 v17,v177,v173,s65
v_perm_b32 v18,v185,v181,s65
v_perm_b32 v19,v193,v189,s65
buffer_store_dwordx4 v[16:19],v1,s[4:7],s73 offen sc1
v_dot2c_f32_bf16 v23,s48,v16
v_dot2c_f32_bf16 v23,s48,v17
v_dot2c_f32_bf16 v23,s48,v18
v_dot2c_f32_bf16 v23,s48,v19
v_perm_b32 v12,v170,v166,s64
v_perm_b32 v13,v178,v174,s64
v_perm_b32 v14,v186,v182,s64
v_perm_b32 v15,v194,v190,s64
buffer_store_dwordx4 v[12:15],v1,s[4:7],s74 offen sc1
v_dot2c_f32_bf16 v24,s48,v12
v_dot2c_f32_bf16 v24,s48,v13
v_dot2c_f32_bf16 v24,s48,v14
v_dot2c_f32_bf16 v24,s48,v15
v_perm_b32 v16,v170,v166,s65
v_perm_b32 v17,v178,v174,s65
v_perm_b32 v18,v186,v182,s65
v_perm_b32 v19,v194,v190,s65
buffer_store_dwordx4 v[16:19],v1,s[4:7],s75 offen sc1
v_dot2c_f32_bf16 v25,s48,v16
v_dot2c_f32_bf16 v25,s48,v17
v_dot2c_f32_bf16 v25,s48,v18
v_dot2c_f32_bf16 v25,s48,v19
v_perm_b32 v12,v171,v167,s64
v_perm_b32 v13,v179,v175,s64
v_perm_b32 v14,v187,v183,s64
v_perm_b32 v15,v195,v191,s64
buffer_store_dwordx4 v[12:15],v1,s[4:7],s76 offen sc1
v_dot2c_f32_bf16 v26,s48,v12
v_dot2c_f32_bf16 v26,s48,v13
v_dot2c_f32_bf16 v26,s48,v14
v_dot2c_f32_bf16 v26,s48,v15
v_perm_b32 v16,v171,v167,s65
v_perm_b32 v17,v179,v175,s65
v_perm_b32 v18,v187,v183,s65
v_perm_b32 v19,v195,v191,s65
buffer_store_dwordx4 v[16:19],v1,s[4:7],s77 offen sc1
v_dot2c_f32_bf16 v27,s48,v16
v_dot2c_f32_bf16 v27,s48,v17
v_dot2c_f32_bf16 v27,s48,v18
v_dot2c_f32_bf16 v27,s48,v19
Lq29:
v_permlane32_swap_b32 v20,v22
v_permlane32_swap_b32 v21,v23
v_add_f32 v20,v20,v22
v_add_f32 v21,v21,v23
s_nop 1
v_permlane16_swap_b32 v20,v21
v_add_f32 v20,v20,v21
v_permlane32_swap_b32 v24,v26
v_permlane32_swap_b32 v25,v27
v_add_f32 v24,v24,v26
v_add_f32 v25,v25,v27
s_nop 1
v_permlane16_swap_b32 v24,v25
v_add_f32 v24,v24,v25
s_mul_i32 s48,s68,18432
s_lshl_b32 s49,s69,9
s_add_u32 s48,s48,s49
s_add_u32 s48,s48,5308416
v_lshlrev_b32 v10,2,v0
buffer_store_dword v20,v10,s[4:7],s48 offen sc1
buffer_store_dword v24,v10,s[4:7],s48 offen offset:256 sc1
s_branch Lq30
Lq23:
s_cmp_lt_u32 s24,2
s_cbranch_scc1 Lq30
s_waitcnt vmcnt(0)
s_barrier
v_and_b32_e64 v25,7,v0
v_bfe_u32 v26,v0,3,1
v_mul_u32_u24 v24,1040,v25
v_mul_u32_u24 v27,8448,v5
v_lshl_add_u32 v24,v26,7,v24
s_lshr_b32 s48,s24,1
s_lshl_b32 s48,s48,6
s_and_b32 s49,s24,1
s_lshl_b32 s49,s49,4
s_add_u32 s48,s48,s49
s_add_u32 s48,s48,110592
v_add3_u32 v24,v24,v27,s48
ds_read_b128 v[68:71],v24
ds_read_b128 v[84:87],v24 offset:32
ds_read_b128 v[72:75],v24 offset:256
ds_read_b128 v[88:91],v24 offset:288
ds_read_b128 v[76:79],v24 offset:512
ds_read_b128 v[92:95],v24 offset:544
ds_read_b128 v[80:83],v24 offset:768
ds_read_b128 v[96:99],v24 offset:800
s_waitcnt lgkmcnt(0)
v_perm_b32 v12,v72,v68,s64
v_perm_b32 v13,v80,v76,s64
v_perm_b32 v14,v88,v84,s64
v_perm_b32 v15,v96,v92,s64
v_accvgpr_write_b32 a192,v12
v_accvgpr_write_b32 a193,v13
v_accvgpr_write_b32 a194,v14
v_accvgpr_write_b32 a195,v15
v_perm_b32 v16,v72,v68,s65
v_perm_b32 v17,v80,v76,s65
v_perm_b32 v18,v88,v84,s65
v_perm_b32 v19,v96,v92,s65
v_accvgpr_write_b32 a196,v16
v_accvgpr_write_b32 a197,v17
v_accvgpr_write_b32 a198,v18
v_accvgpr_write_b32 a199,v19
v_perm_b32 v12,v73,v69,s64
v_perm_b32 v13,v81,v77,s64
v_perm_b32 v14,v89,v85,s64
v_perm_b32 v15,v97,v93,s64
v_accvgpr_write_b32 a200,v12
v_accvgpr_write_b32 a201,v13
v_accvgpr_write_b32 a202,v14
v_accvgpr_write_b32 a203,v15
v_perm_b32 v16,v73,v69,s65
v_perm_b32 v17,v81,v77,s65
v_perm_b32 v18,v89,v85,s65
v_perm_b32 v19,v97,v93,s65
v_accvgpr_write_b32 a204,v16
v_accvgpr_write_b32 a205,v17
v_accvgpr_write_b32 a206,v18
v_accvgpr_write_b32 a207,v19
v_perm_b32 v12,v74,v70,s64
v_perm_b32 v13,v82,v78,s64
v_perm_b32 v14,v90,v86,s64
v_perm_b32 v15,v98,v94,s64
v_accvgpr_write_b32 a208,v12
v_accvgpr_write_b32 a209,v13
v_accvgpr_write_b32 a210,v14
v_accvgpr_write_b32 a211,v15
v_perm_b32 v16,v74,v70,s65
v_perm_b32 v17,v82,v78,s65
v_perm_b32 v18,v90,v86,s65
v_perm_b32 v19,v98,v94,s65
v_accvgpr_write_b32 a212,v16
v_accvgpr_write_b32 a213,v17
v_accvgpr_write_b32 a214,v18
v_accvgpr_write_b32 a215,v19
v_perm_b32 v12,v75,v71,s64
v_perm_b32 v13,v83,v79,s64
v_perm_b32 v14,v91,v87,s64
v_perm_b32 v15,v99,v95,s64
v_accvgpr_write_b32 a216,v12
v_accvgpr_write_b32 a217,v13
v_accvgpr_write_b32 a218,v14
v_accvgpr_write_b32 a219,v15
v_perm_b32 v16,v75,v71,s65
v_perm_b32 v17,v83,v79,s65
v_perm_b32 v18,v91,v87,s65
v_perm_b32 v19,v99,v95,s65
v_accvgpr_write_b32 a220,v16
v_accvgpr_write_b32 a221,v17
v_accvgpr_write_b32 a222,v18
v_accvgpr_write_b32 a223,v19
Lq30:
s_cmp_ge_u32 s24,2
s_cbranch_scc1 Lpo31
s_mul_i32 s48,s24,34603008
s_lshl_b32 s49,s2,10
s_add_u32 s48,s48,s49
s_add_u32 s48,s48,5013504
v_mov_b32 v12,-1
v_mov_b32 v13,-1
v_mov_b32 v14,-1
v_mov_b32 v15,-1
buffer_store_dwordx4 v[12:15],v1,s[20:23],s48 offen sc1
Lpo31:
s_mov_b32 s16,s42
s_mov_b32 s17,s43
s_mov_b32 s18,256
s_mov_b32 s19,0x20000
s_mov_b64 exec,1
s_mov_b32 s56,0
v_mov_b32 v10,0
Lg32:
buffer_load_dword v11,v10,s[16:19],0 offen sc1
s_add_u32 s56,s56,1
s_waitcnt vmcnt(0)
v_cmp_ne_u32 vcc,1,v11
s_nop 0
s_cbranch_vccz Lgd33
s_cmp_lt_u32 s56,0x40000
s_cbranch_scc1 Lg32
Lgd33:
s_mov_b64 exec,-1
s_and_b32 s48,s66,3
s_lshr_b32 s49,s24,1
s_lshl_b32 s49,s49,6
s_add_u32 s48,s48,s49
s_mul_i32 s48,s48,256
s_add_u32 s48,s48,5324800
v_mul_u32_u24 v10,1024,v0
s_mov_b64 exec,65535
v_mov_b32 v11,1
buffer_atomic_add v11,v10,s[20:23],s48 offen sc1
s_mov_b64 exec,-1
s_cmp_ge_u32 s24,2
s_cbranch_scc1 Lq25
s_barrier
s_barrier
v_and_b32_e64 v25,7,v0
v_bfe_u32 v26,v0,3,1
v_mul_u32_u24 v24,1040,v25
v_mul_u32_u24 v27,8448,v5
v_lshl_add_u32 v24,v26,7,v24
s_lshr_b32 s48,s24,1
s_lshl_b32 s48,s48,6
s_and_b32 s49,s24,1
s_lshl_b32 s49,s49,4
s_add_u32 s48,s48,s49
s_add_u32 s48,s48,110592
v_add3_u32 v24,v24,v27,s48
ds_read_b128 v[68:71],v24
ds_read_b128 v[84:87],v24 offset:32
ds_read_b128 v[72:75],v24 offset:256
ds_read_b128 v[88:91],v24 offset:288
ds_read_b128 v[76:79],v24 offset:512
ds_read_b128 v[92:95],v24 offset:544
ds_read_b128 v[80:83],v24 offset:768
ds_read_b128 v[96:99],v24 offset:800
s_waitcnt lgkmcnt(0)
v_perm_b32 v12,v72,v68,s64
v_perm_b32 v13,v80,v76,s64
v_perm_b32 v14,v88,v84,s64
v_perm_b32 v15,v96,v92,s64
v_accvgpr_write_b32 a192,v12
v_accvgpr_write_b32 a193,v13
v_accvgpr_write_b32 a194,v14
v_accvgpr_write_b32 a195,v15
v_perm_b32 v16,v72,v68,s65
v_perm_b32 v17,v80,v76,s65
v_perm_b32 v18,v88,v84,s65
v_perm_b32 v19,v96,v92,s65
v_accvgpr_write_b32 a196,v16
v_accvgpr_write_b32 a197,v17
v_accvgpr_write_b32 a198,v18
v_accvgpr_write_b32 a199,v19
v_perm_b32 v12,v73,v69,s64
v_perm_b32 v13,v81,v77,s64
v_perm_b32 v14,v89,v85,s64
v_perm_b32 v15,v97,v93,s64
v_accvgpr_write_b32 a200,v12
v_accvgpr_write_b32 a201,v13
v_accvgpr_write_b32 a202,v14
v_accvgpr_write_b32 a203,v15
v_perm_b32 v16,v73,v69,s65
v_perm_b32 v17,v81,v77,s65
v_perm_b32 v18,v89,v85,s65
v_perm_b32 v19,v97,v93,s65
v_accvgpr_write_b32 a204,v16
v_accvgpr_write_b32 a205,v17
v_accvgpr_write_b32 a206,v18
v_accvgpr_write_b32 a207,v19
v_perm_b32 v12,v74,v70,s64
v_perm_b32 v13,v82,v78,s64
v_perm_b32 v14,v90,v86,s64
v_perm_b32 v15,v98,v94,s64
v_accvgpr_write_b32 a208,v12
v_accvgpr_write_b32 a209,v13
v_accvgpr_write_b32 a210,v14
v_accvgpr_write_b32 a211,v15
v_perm_b32 v16,v74,v70,s65
v_perm_b32 v17,v82,v78,s65
v_perm_b32 v18,v90,v86,s65
v_perm_b32 v19,v98,v94,s65
v_accvgpr_write_b32 a212,v16
v_accvgpr_write_b32 a213,v17
v_accvgpr_write_b32 a214,v18
v_accvgpr_write_b32 a215,v19
v_perm_b32 v12,v75,v71,s64
v_perm_b32 v13,v83,v79,s64
v_perm_b32 v14,v91,v87,s64
v_perm_b32 v15,v99,v95,s64
v_accvgpr_write_b32 a216,v12
v_accvgpr_write_b32 a217,v13
v_accvgpr_write_b32 a218,v14
v_accvgpr_write_b32 a219,v15
v_perm_b32 v16,v75,v71,s65
v_perm_b32 v17,v83,v79,s65
v_perm_b32 v18,v91,v87,s65
v_perm_b32 v19,v99,v95,s65
v_accvgpr_write_b32 a220,v16
v_accvgpr_write_b32 a221,v17
v_accvgpr_write_b32 a222,v18
v_accvgpr_write_b32 a223,v19
s_and_b32 s48,s2,15
s_mul_i32 s48,s48,1024
s_add_u32 s48,s48,5324800
v_mul_u32_u24 v10,256,v0
s_mov_b64 exec,15
s_mov_b32 s56,0
Lp34:
v_mov_b32 v11,0
buffer_atomic_add v11,v10,s[20:23],s48 offen sc0 sc1
s_waitcnt vmcnt(0)
v_cmp_ne_u32 vcc,32,v11
s_nop 0
s_cbranch_vccz Lpd35
s_add_u32 s56,s56,1
s_cmp_lt_u32 s56,0x40000
s_cbranch_scc1 Lp34
Lpd35:
s_mov_b64 exec,-1
s_mul_i32 s48,s28,576
s_add_u32 s48,s48,5317632
s_bfm_b64 exec,36,0
buffer_load_dwordx4 v[100:103],v1,s[4:7],s48 offen sc1
s_add_u32 s48,s48,18432
buffer_load_dwordx4 v[104:107],v1,s[4:7],s48 offen sc1
s_add_u32 s48,s48,18432
buffer_load_dwordx4 v[108:111],v1,s[4:7],s48 offen sc1
s_add_u32 s48,s48,18432
buffer_load_dwordx4 v[112:115],v1,s[4:7],s48 offen sc1
s_add_u32 s48,s48,18432
buffer_load_dwordx4 v[116:119],v1,s[4:7],s48 offen sc1
s_add_u32 s48,s48,18432
buffer_load_dwordx4 v[120:123],v1,s[4:7],s48 offen sc1
s_add_u32 s48,s48,18432
buffer_load_dwordx4 v[124:127],v1,s[4:7],s48 offen sc1
s_mov_b64 exec,-1
s_mul_i32 s48,s24,18432
s_add_u32 s49,s62,s48
s_add_u32 s60,s49,0
s_add_u32 m0,s48,0
s_nop 0
buffer_load_dwordx4 v1,s[4:7],s60 offen lds
buffer_load_dwordx4 v1,s[4:7],s60 offen offset:1024 lds
buffer_load_dwordx4 v1,s[4:7],s60 offen offset:2048 lds
buffer_load_dwordx4 v1,s[4:7],s60 offen offset:3072 lds
s_add_u32 m0,s48,4096
s_nop 0
buffer_load_dwordx4 v2,s[4:7],s60 offen lds
buffer_load_dwordx4 v2,s[4:7],s60 offen offset:1024 lds
buffer_load_dwordx4 v2,s[4:7],s60 offen offset:2048 lds
buffer_load_dwordx4 v2,s[4:7],s60 offen offset:3072 lds
s_add_u32 m0,s48,8192
s_nop 0
buffer_load_dwordx4 v3,s[4:7],s60 offen lds
buffer_load_dwordx4 v3,s[4:7],s60 offen offset:1024 lds
buffer_load_dwordx4 v3,s[4:7],s60 offen offset:2048 lds
buffer_load_dwordx4 v3,s[4:7],s60 offen offset:3072 lds
s_add_u32 s60,s49,12288
s_add_u32 m0,s48,12288
s_nop 0
buffer_load_dwordx4 v1,s[4:7],s60 offen lds
buffer_load_dwordx4 v1,s[4:7],s60 offen offset:1024 lds
buffer_load_dwordx4 v1,s[4:7],s60 offen offset:2048 lds
buffer_load_dwordx4 v1,s[4:7],s60 offen offset:3072 lds
s_add_u32 m0,s48,16384
s_nop 0
buffer_load_dwordx4 v2,s[4:7],s60 offen lds
buffer_load_dwordx4 v2,s[4:7],s60 offen offset:1024 lds
s_add_u32 s60,s49,36864
s_add_u32 m0,s48,36864
s_nop 0
buffer_load_dwordx4 v1,s[4:7],s60 offen lds
buffer_load_dwordx4 v1,s[4:7],s60 offen offset:1024 lds
buffer_load_dwordx4 v1,s[4:7],s60 offen offset:2048 lds
buffer_load_dwordx4 v1,s[4:7],s60 offen offset:3072 lds
s_add_u32 m0,s48,40960
s_nop 0
buffer_load_dwordx4 v2,s[4:7],s60 offen lds
buffer_load_dwordx4 v2,s[4:7],s60 offen offset:1024 lds
buffer_load_dwordx4 v2,s[4:7],s60 offen offset:2048 lds
buffer_load_dwordx4 v2,s[4:7],s60 offen offset:3072 lds
s_add_u32 m0,s48,45056
s_nop 0
buffer_load_dwordx4 v3,s[4:7],s60 offen lds
buffer_load_dwordx4 v3,s[4:7],s60 offen offset:1024 lds
buffer_load_dwordx4 v3,s[4:7],s60 offen offset:2048 lds
buffer_load_dwordx4 v3,s[4:7],s60 offen offset:3072 lds
s_add_u32 s60,s49,49152
s_add_u32 m0,s48,49152
s_nop 0
buffer_load_dwordx4 v1,s[4:7],s60 offen lds
buffer_load_dwordx4 v1,s[4:7],s60 offen offset:1024 lds
buffer_load_dwordx4 v1,s[4:7],s60 offen offset:2048 lds
buffer_load_dwordx4 v1,s[4:7],s60 offen offset:3072 lds
s_add_u32 m0,s48,53248
s_nop 0
buffer_load_dwordx4 v2,s[4:7],s60 offen lds
buffer_load_dwordx4 v2,s[4:7],s60 offen offset:1024 lds
s_add_u32 s60,s49,73728
s_add_u32 m0,s48,73728
s_nop 0
buffer_load_dwordx4 v1,s[4:7],s60 offen lds
buffer_load_dwordx4 v1,s[4:7],s60 offen offset:1024 lds
buffer_load_dwordx4 v1,s[4:7],s60 offen offset:2048 lds
buffer_load_dwordx4 v1,s[4:7],s60 offen offset:3072 lds
s_add_u32 m0,s48,77824
s_nop 0
buffer_load_dwordx4 v2,s[4:7],s60 offen lds
buffer_load_dwordx4 v2,s[4:7],s60 offen offset:1024 lds
buffer_load_dwordx4 v2,s[4:7],s60 offen offset:2048 lds
buffer_load_dwordx4 v2,s[4:7],s60 offen offset:3072 lds
s_add_u32 m0,s48,81920
s_nop 0
buffer_load_dwordx4 v3,s[4:7],s60 offen lds
buffer_load_dwordx4 v3,s[4:7],s60 offen offset:1024 lds
buffer_load_dwordx4 v3,s[4:7],s60 offen offset:2048 lds
buffer_load_dwordx4 v3,s[4:7],s60 offen offset:3072 lds
s_add_u32 s60,s49,86016
s_add_u32 m0,s48,86016
s_nop 0
buffer_load_dwordx4 v1,s[4:7],s60 offen lds
buffer_load_dwordx4 v1,s[4:7],s60 offen offset:1024 lds
buffer_load_dwordx4 v1,s[4:7],s60 offen offset:2048 lds
buffer_load_dwordx4 v1,s[4:7],s60 offen offset:3072 lds
s_add_u32 m0,s48,90112
s_nop 0
buffer_load_dwordx4 v2,s[4:7],s60 offen lds
buffer_load_dwordx4 v2,s[4:7],s60 offen offset:1024 lds
s_waitcnt vmcnt(18)
v_pk_add_f32 v[100:101],v[100:101],v[104:105]
v_pk_add_f32 v[102:103],v[102:103],v[106:107]
v_pk_add_f32 v[100:101],v[100:101],v[108:109]
v_pk_add_f32 v[102:103],v[102:103],v[110:111]
v_pk_add_f32 v[100:101],v[100:101],v[112:113]
v_pk_add_f32 v[102:103],v[102:103],v[114:115]
v_pk_add_f32 v[100:101],v[100:101],v[116:117]
v_pk_add_f32 v[102:103],v[102:103],v[118:119]
v_pk_add_f32 v[100:101],v[100:101],v[120:121]
v_pk_add_f32 v[102:103],v[102:103],v[122:123]
v_pk_add_f32 v[100:101],v[100:101],v[124:125]
v_pk_add_f32 v[102:103],v[102:103],v[126:127]
v_add_u32 v10,147456,v1
s_bfm_b64 exec,36,0
ds_write_b128 v10,v[100:103]
s_mov_b64 exec,-1
Lq25:
s_barrier
s_mul_i32 s48,s24,9216
s_add_u32 s49,s62,s48
s_add_u32 s60,s49,110592
s_add_u32 m0,s48,110592
s_nop 0
buffer_load_dwordx4 v1,s[4:7],s60 offen lds
buffer_load_dwordx4 v1,s[4:7],s60 offen offset:1024 lds
buffer_load_dwordx4 v1,s[4:7],s60 offen offset:2048 lds
buffer_load_dwordx4 v1,s[4:7],s60 offen offset:3072 lds
s_add_u32 m0,s48,114688
s_nop 0
buffer_load_dwordx4 v2,s[4:7],s60 offen lds
buffer_load_dwordx4 v2,s[4:7],s60 offen offset:1024 lds
buffer_load_dwordx4 v2,s[4:7],s60 offen offset:2048 lds
buffer_load_dwordx4 v2,s[4:7],s60 offen offset:3072 lds
s_add_u32 m0,s48,118784
s_nop 0
buffer_load_dwordx4 v3,s[4:7],s60 offen lds
v_and_b32 v25,7,v0
v_bfe_u32 v26,v0,3,1
v_lshlrev_b32 v25,4,v25
v_lshl_add_u32 v25,v5,8,v25
v_lshl_add_u32 v25,v26,12,v25
s_lshr_b32 s48,s28,1
s_lshl_b32 s49,0,2
s_add_u32 s48,s48,s49
s_lshr_b32 s49,s48,1
s_lshl_b32 s50,s27,2
s_add_u32 s49,s49,s50
s_lshl_b32 s49,s49,17
s_and_b32 s48,s48,1
s_lshl_b32 s48,s48,10
s_add_u32 s49,s49,s48
s_and_b32 s48,s28,1
s_lshl_b32 s48,s48,7
s_add_u32 s49,s49,s48
s_lshr_b32 s48,s24,1
s_lshl_b32 s48,s48,11
s_add_u32 s49,s49,s48
s_add_u32 s49,s49,6291456
s_and_b32 s48,s24,1
s_lshl_b32 s48,s48,3
s_add_u32 s50,s48,0
s_cmp_lt_u32 s50,s27
s_addc_u32 s51,s50,0
s_cmp_eq_u32 s50,s27
s_cselect_b32 s50,0,s51
s_lshl_b32 s50,s50,13
s_add_u32 s80,s50,s49
s_add_u32 s50,s48,1
s_cmp_lt_u32 s50,s27
s_addc_u32 s51,s50,0
s_cmp_eq_u32 s50,s27
s_cselect_b32 s50,0,s51
s_lshl_b32 s50,s50,13
s_add_u32 s81,s50,s49
s_add_u32 s50,s48,2
s_cmp_lt_u32 s50,s27
s_addc_u32 s51,s50,0
s_cmp_eq_u32 s50,s27
s_cselect_b32 s50,0,s51
s_lshl_b32 s50,s50,13
s_add_u32 s82,s50,s49
s_add_u32 s50,s48,3
s_cmp_lt_u32 s50,s27
s_addc_u32 s51,s50,0
s_cmp_eq_u32 s50,s27
s_cselect_b32 s50,0,s51
s_lshl_b32 s50,s50,13
s_add_u32 s83,s50,s49
s_add_u32 s50,s48,4
s_cmp_lt_u32 s50,s27
s_addc_u32 s51,s50,0
s_cmp_eq_u32 s50,s27
s_cselect_b32 s50,0,s51
s_lshl_b32 s50,s50,13
s_add_u32 s84,s50,s49
s_add_u32 s50,s48,5
s_cmp_lt_u32 s50,s27
s_addc_u32 s51,s50,0
s_cmp_eq_u32 s50,s27
s_cselect_b32 s50,0,s51
s_lshl_b32 s50,s50,13
s_add_u32 s85,s50,s49
s_add_u32 s50,s48,6
s_cmp_lt_u32 s50,s27
s_addc_u32 s51,s50,0
s_cmp_eq_u32 s50,s27
s_cselect_b32 s50,0,s51
s_lshl_b32 s50,s50,13
s_add_u32 s86,s50,s49
s_add_u32 s50,s48,7
s_cmp_lt_u32 s50,s27
s_addc_u32 s51,s50,0
s_cmp_eq_u32 s50,s27
s_cselect_b32 s50,0,s51
s_lshl_b32 s50,s50,13
s_add_u32 s87,s50,s49
s_mul_i32 s89,s27,1024
s_add_u32 s89,s89,5521408
s_and_b32 s90,s28,3
s_mul_i32 s90,s90,256
s_add_u32 s90,s90,s89
Ljoin0:
Ljoin1:
s_mov_b32 s94,0
s_cmp_lg_u32 s24,0
s_cbranch_scc1 Lj36
s_lshl_b32 s48,s27,2
s_and_b32 s49,s28,3
s_add_u32 s48,s48,s49
s_mul_i32 s48,s48,256
s_add_u32 s48,s48,5357568
v_mov_b32 v10,0
s_mov_b64 exec,1
s_mov_b32 s56,0
v_mov_b32 v11,0
buffer_atomic_add v11,v10,s[20:23],s48 offen sc0 sc1
s_mov_b64 exec,-1
s_lshl_b32 s69,s27,3
s_lshl_b32 s49,s24,1
s_add_u32 s69,s69,s49
s_mul_i32 s67,s69,18432
s_add_u32 s67,s67,2359296
s_add_u32 s68,s67,18432
s_sleep 4
s_mov_b64 exec,1
v_mov_b32 v12,0
buffer_atomic_add v12,v10,s[20:23],s48 offen sc0 sc1
s_mov_b64 exec,-1
s_lshl_b32 s69,s27,3
s_lshl_b32 s49,s24,1
s_add_u32 s69,s69,s49
s_mul_i32 s67,s69,18432
s_add_u32 s67,s67,2359296
s_add_u32 s68,s67,18432
s_sleep 4
s_mov_b64 exec,1
Lp38:
v_mov_b32 v13,0
buffer_atomic_add v13,v10,s[20:23],s48 offen sc0 sc1
s_waitcnt vmcnt(2)
v_bfe_u32 v11,v11,0,8
v_cmp_ne_u32 vcc,24,v11
s_nop 0
s_cbranch_vccz Lpd39
v_mov_b32 v11,0
buffer_atomic_add v11,v10,s[20:23],s48 offen sc0 sc1
s_waitcnt vmcnt(2)
v_bfe_u32 v12,v12,0,8
v_cmp_ne_u32 vcc,24,v12
s_nop 0
s_cbranch_vccz Lpd39
v_mov_b32 v12,0
buffer_atomic_add v12,v10,s[20:23],s48 offen sc0 sc1
s_waitcnt vmcnt(2)
v_bfe_u32 v13,v13,0,8
v_cmp_ne_u32 vcc,24,v13
s_nop 0
s_cbranch_vccz Lpd39
s_add_u32 s56,s56,1
s_cmp_lt_u32 s56,0x40000
s_cbranch_scc1 Lp38
Lpd39:
s_mov_b64 exec,-1
s_branch Lj37
Lj36:
s_cmp_lg_u32 s24,3
s_cbranch_scc1 Lwc40
s_getpc_b64 s[16:17]
Lwc40a:
s_mov_b32 s18,Lexit-Lwc40a
s_mov_b32 s19,0x20000
s_lshr_b32 s60,s2,3
s_mul_i32 s60,s60,512
v_lshlrev_b32 v14,7,v0
s_mov_b32 exec_hi,0
s_mov_b32 exec_lo,15
buffer_load_dword v15,v14,s[16:19],s60 offen
s_mov_b64 exec,-1
Lwc40:
s_lshl_b32 s69,s27,3
s_lshl_b32 s49,s24,1
s_add_u32 s69,s69,s49
s_mul_i32 s67,s69,18432
s_add_u32 s67,s67,2359296
s_add_u32 s68,s67,18432
Lj37:
s_waitcnt lgkmcnt(0)
s_barrier
buffer_load_dwordx4 a[0:3],v1,s[20:23],s67 offen sc1
buffer_load_dwordx4 a[4:7],v1,s[20:23],s68 offen sc1
ds_read_b128 v[180:183],v1
ds_read_b128 v[184:187],v1 offset:1024
ds_read_b128 v[188:191],v1 offset:2048
ds_read_b128 v[192:195],v1 offset:3072
ds_read_b128 v[196:199],v1 offset:4096
ds_read_b128 v[200:203],v1 offset:5120
ds_read_b128 v[204:207],v1 offset:6144
ds_read_b128 v[208:211],v1 offset:7168
v_mov_b32 v132,0
v_mov_b32 v133,0
v_mov_b32 v134,0
v_mov_b32 v135,0
v_mov_b32 v136,0
v_mov_b32 v137,0
v_mov_b32 v138,0
v_mov_b32 v139,0
v_mov_b32 v140,0
v_mov_b32 v141,0
v_mov_b32 v142,0
v_mov_b32 v143,0
v_mov_b32 v144,0
v_mov_b32 v145,0
v_mov_b32 v146,0
v_mov_b32 v147,0
buffer_load_dwordx4 a[8:11],v1,s[20:23],s67 offen offset:1024 sc1
buffer_load_dwordx4 a[12:15],v1,s[20:23],s68 offen offset:1024 sc1
v_lshlrev_b32 v21,2,v4
v_add_u32 v21,147456,v21
ds_read_b32 v148,v21
ds_read_b32 v149,v21 offset:64
ds_read_b32 v150,v21 offset:128
ds_read_b32 v151,v21 offset:192
ds_read_b32 v152,v21 offset:256
ds_read_b32 v153,v21 offset:320
ds_read_b32 v154,v21 offset:384
ds_read_b32 v155,v21 offset:448
ds_read_b32 v156,v21 offset:512
s_lshl_b32 s48,s24,8
s_add_u32 s48,s48,149312
v_lshrrev_b32 v21,1,v5
v_lshlrev_b32 v21,6,v21
v_lshl_add_u32 v21,v4,2,v21
v_add_u32 v21,s48,v21
v_lshl_add_u32 v22,v5,4,s48
v_mul_u32_u24 v28,256,v0
s_mul_i32 s63,s29,3
s_add_u32 s63,s63,1
buffer_load_dwordx4 a[16:19],v1,s[20:23],s67 offen offset:2048 sc1
buffer_load_dwordx4 a[20:23],v1,s[20:23],s68 offen offset:2048 sc1
s_mov_b32 s16,s36
s_mov_b32 s17,s37
s_mov_b32 s18,4096
s_mov_b32 s19,0x20000
s_add_u32 s66,s62,s61
s_mul_i32 s69,s69,2304
s_add_u32 s69,s69,4718592
v_mul_u32_u24 v20,1152,v5
v_lshl_add_u32 v20,v4,3,v20
s_lshl_b32 s70,s27,2
s_add_u32 s70,s70,s24
s_lshl_b32 s70,s70,17
s_add_u32 s70,s70,6291456
s_lshl_b32 s48,s24,5
s_add_u32 s48,s48,s27
s_lshl_b32 s48,s48,1
v_lshlrev_b32 v19,8,v4
buffer_load_dwordx4 a[24:27],v1,s[20:23],s67 offen offset:3072 sc1
buffer_load_dwordx4 a[28:31],v1,s[20:23],s68 offen offset:3072 sc1
buffer_load_ushort v18,v19,s[16:19],s48 offen
buffer_load_ushort v19,v19,s[16:19],s48 offen offset:32
s_getpc_b64 s[16:17]
Ljb41:
s_mov_b32 s18,Lexit-Ljb41
s_mov_b32 s19,0x20000
s_lshr_b32 s3,s2,3
s_lshl_b32 s3,s3,2
s_add_u32 s3,s3,s24
s_mul_i32 s3,s3,64
s_waitcnt vmcnt(8)
s_waitcnt lgkmcnt(13)
mf v[36:39],a[0:3],v[180:183],0
buffer_load_dwordx4 a[32:35],v2,s[20:23],s67 offen sc1
mf v[44:47],a[0:3],v[184:187],0
ds_read_b128 v[212:215],v1 offset:8192
ds_read_b128 v[216:219],v1 offset:9216
mf v[48:51],a[4:7],v[184:187],0
mf v[40:43],a[4:7],v[180:183],0
mf v[52:55],a[0:3],v[188:191],0
ds_read_b128 v[180:183],v1 offset:10240
ds_read_b128 v[184:187],v1 offset:11264
mf v[60:63],a[0:3],v[192:195],0
buffer_load_dwordx4 a[36:39],v2,s[20:23],s68 offen sc1
mf v[64:67],a[4:7],v[192:195],0
mf v[56:59],a[4:7],v[188:191],0
s_waitcnt lgkmcnt(13)
mf v[68:71],a[0:3],v[196:199],0
ds_read_b128 v[188:191],v1 offset:12288
ds_read_b128 v[192:195],v1 offset:13312
mf v[76:79],a[0:3],v[200:203],0
s_lshl_b32 s72,s27,2
s_add_u32 s72,s72,s24
mf v[80:83],a[4:7],v[200:203],0
buffer_load_dwordx4 a[40:43],v2,s[20:23],s67 offen offset:1024 sc1
mf v[72:75],a[4:7],v[196:199],0
s_lshl_b32 s72,s72,12
s_add_u32 s72,s72,5013504
mf v[84:87],a[0:3],v[204:207],0
ds_read_b128 v[196:199],v1 offset:14336
ds_read_b128 v[200:203],v1 offset:15360
mf v[92:95],a[0:3],v[208:211],0
s_lshl_b32 s73,s28,8
s_add_u32 s73,s73,s72
mf v[96:99],a[4:7],v[208:211],0
v_lshlrev_b32 v30,2,v0
mf v[88:91],a[4:7],v[204:207],0
s_waitcnt vmcnt(9)
s_waitcnt lgkmcnt(4)
mf v[100:103],a[0:3],v[212:215],0
buffer_load_dwordx4 a[44:47],v2,s[20:23],s68 offen offset:1024 sc1
mf v[36:39],a[8:11],v[216:219],v[36:39]
ds_read_b128 v[204:207],v1 offset:16384
ds_read_b128 v[208:211],v1 offset:17408
mf v[40:43],a[12:15],v[216:219],v[40:43]
mf v[104:107],a[4:7],v[212:215],0
mf v[44:47],a[8:11],v[180:183],v[44:47]
ds_read_b128 v[212:215],v1 offset:18432
ds_read_b128 v[216:219],v1 offset:27648
mf v[52:55],a[8:11],v[184:187],v[52:55]
buffer_load_dwordx4 a[48:51],v2,s[20:23],s67 offen offset:2048 sc1
mf v[56:59],a[12:15],v[184:187],v[56:59]
mf v[48:51],a[12:15],v[180:183],v[48:51]
s_waitcnt lgkmcnt(4)
mf v[60:63],a[8:11],v[188:191],v[60:63]
ds_read_b128 v[180:183],v1 offset:19456
ds_read_b128 v[184:187],v1 offset:28672
mf v[68:71],a[8:11],v[192:195],v[68:71]
mf v[72:75],a[12:15],v[192:195],v[72:75]
buffer_load_dwordx4 a[52:55],v2,s[20:23],s68 offen offset:2048 sc1
mf v[64:67],a[12:15],v[188:191],v[64:67]
mf v[76:79],a[8:11],v[196:199],v[76:79]
ds_read_b128 v[188:191],v1 offset:20480
ds_read_b128 v[192:195],v1 offset:29696
mf v[84:87],a[8:11],v[200:203],v[84:87]
mf v[88:91],a[12:15],v[200:203],v[88:91]
mf v[80:83],a[12:15],v[196:199],v[80:83]
s_waitcnt lgkmcnt(4)
mf v[92:95],a[8:11],v[204:207],v[92:95]
buffer_load_dwordx4 a[56:59],v2,s[20:23],s67 offen offset:3072 sc1
mf v[100:103],a[8:11],v[208:211],v[100:103]
ds_read_b128 v[196:199],v1 offset:21504
ds_read_b128 v[200:203],v1 offset:30720
mf v[104:107],a[12:15],v[208:211],v[104:107]
mf v[96:99],a[12:15],v[204:207],v[96:99]
s_waitcnt vmcnt(9)
mf v[36:39],a[16:19],v[212:215],v[36:39]
ds_read_b128 v[204:207],v1 offset:22528
ds_read_b128 v[208:211],v1 offset:31744
mf v[36:39],a[24:27],v[216:219],v[36:39]
buffer_load_dwordx4 a[60:63],v2,s[20:23],s68 offen offset:3072 sc1
mf v[40:43],a[28:31],v[216:219],v[40:43]
mf v[40:43],a[20:23],v[212:215],v[40:43]
s_waitcnt lgkmcnt(4)
mf v[44:47],a[16:19],v[180:183],v[44:47]
ds_read_b128 v[212:215],v1 offset:23552
ds_read_b128 v[216:219],v1 offset:32768
mf v[44:47],a[24:27],v[184:187],v[44:47]
mf v[48:51],a[28:31],v[184:187],v[48:51]
buffer_load_dwordx4 a[64:67],v3,s[20:23],s67 offen sc1
mf v[48:51],a[20:23],v[180:183],v[48:51]
mf v[52:55],a[16:19],v[188:191],v[52:55]
ds_read_b128 v[180:183],v1 offset:24576
ds_read_b128 v[184:187],v1 offset:33792
mf v[52:55],a[24:27],v[192:195],v[52:55]
mf v[56:59],a[28:31],v[192:195],v[56:59]
mf v[56:59],a[20:23],v[188:191],v[56:59]
s_waitcnt lgkmcnt(4)
mf v[60:63],a[16:19],v[196:199],v[60:63]
buffer_load_dwordx4 a[68:71],v3,s[20:23],s68 offen sc1
mf v[60:63],a[24:27],v[200:203],v[60:63]
ds_read_b128 v[188:191],v1 offset:25600
ds_read_b128 v[192:195],v1 offset:34816
mf v[64:67],a[28:31],v[200:203],v[64:67]
mf v[64:67],a[20:23],v[196:199],v[64:67]
mf v[68:71],a[16:19],v[204:207],v[68:71]
ds_read_b128 v[196:199],v1 offset:26624
ds_read_b128 v[200:203],v1 offset:35840
mf v[68:71],a[24:27],v[208:211],v[68:71]
buffer_load_dwordx4 a[72:75],v3,s[20:23],s67 offen offset:1024 sc1
mf v[72:75],a[28:31],v[208:211],v[72:75]
mf v[72:75],a[20:23],v[204:207],v[72:75]
s_waitcnt lgkmcnt(4)
mf v[76:79],a[16:19],v[212:215],v[76:79]
ds_read_b128 v[204:207],v6
ds_read_b128 v[208:211],v6 offset:9216
mf v[76:79],a[24:27],v[216:219],v[76:79]
mf v[80:83],a[28:31],v[216:219],v[80:83]
buffer_load_dwordx4 a[76:79],v3,s[20:23],s68 offen offset:1024 sc1
mf v[80:83],a[20:23],v[212:215],v[80:83]
mf v[84:87],a[16:19],v[180:183],v[84:87]
ds_read_b128 v[212:215],v6 offset:1024
ds_read_b128 v[216:219],v6 offset:10240
mf v[84:87],a[24:27],v[184:187],v[84:87]
mf v[88:91],a[28:31],v[184:187],v[88:91]
mf v[88:91],a[20:23],v[180:183],v[88:91]
s_waitcnt lgkmcnt(4)
mf v[92:95],a[16:19],v[188:191],v[92:95]
buffer_load_dwordx4 a[80:83],v3,s[20:23],s67 offen offset:2048 sc1
mf v[92:95],a[24:27],v[192:195],v[92:95]
ds_read_b128 v[180:183],v6 offset:2048
ds_read_b128 v[184:187],v6 offset:11264
mf v[96:99],a[28:31],v[192:195],v[96:99]
mf v[96:99],a[20:23],v[188:191],v[96:99]
mf v[100:103],a[16:19],v[196:199],v[100:103]
ds_read_b128 v[188:191],v6 offset:3072
ds_read_b128 v[192:195],v6 offset:12288
mf v[100:103],a[24:27],v[200:203],v[100:103]
buffer_load_dwordx4 a[84:87],v3,s[20:23],s68 offen offset:2048 sc1
mf v[104:107],a[28:31],v[200:203],v[104:107]
mf v[104:107],a[20:23],v[196:199],v[104:107]
s_cmp_eq_u32 s24,s63
s_cbranch_scc1 Lx42
Lx43:
s_waitcnt vmcnt(10)
s_waitcnt lgkmcnt(4)
mf v[36:39],a[32:35],v[204:207],v[36:39]
ds_read_b128 v[196:199],v6 offset:4096
ds_read_b128 v[200:203],v6 offset:13312
mf v[36:39],a[40:43],v[208:211],v[36:39]
mf v[40:43],a[44:47],v[208:211],v[40:43]
buffer_load_dwordx4 a[88:91],v3,s[20:23],s67 offen offset:3072 sc1
mf v[40:43],a[36:39],v[204:207],v[40:43]
mf v[44:47],a[32:35],v[212:215],v[44:47]
ds_read_b128 v[204:207],v6 offset:5120
ds_read_b128 v[208:211],v6 offset:14336
mf v[44:47],a[40:43],v[216:219],v[44:47]
mf v[48:51],a[44:47],v[216:219],v[48:51]
mf v[48:51],a[36:39],v[212:215],v[48:51]
s_waitcnt lgkmcnt(4)
mf v[52:55],a[32:35],v[180:183],v[52:55]
buffer_load_dwordx4 a[92:95],v3,s[20:23],s68 offen offset:3072 sc1
mf v[52:55],a[40:43],v[184:187],v[52:55]
ds_read_b128 v[212:215],v6 offset:6144
ds_read_b128 v[216:219],v6 offset:15360
mf v[56:59],a[44:47],v[184:187],v[56:59]
s_cmp_eq_u32 s29,0
s_cbranch_scc1 Lx44
Lx45:
mf v[56:59],a[36:39],v[180:183],v[56:59]
mf v[60:63],a[32:35],v[188:191],v[60:63]
ds_read_b128 v[180:183],v6 offset:7168
ds_read_b128 v[184:187],v6 offset:16384
mf v[60:63],a[40:43],v[192:195],v[60:63]
s_add_u32 s67,s67,12288
buffer_load_dwordx4 a[96:99],v1,s[20:23],s67 offen sc1
mf v[64:67],a[44:47],v[192:195],v[64:67]
mf v[64:67],a[36:39],v[188:191],v[64:67]
s_waitcnt lgkmcnt(4)
mf v[68:71],a[32:35],v[196:199],v[68:71]
ds_read_b128 v[188:191],v6 offset:8192
ds_read_b128 v[192:195],v6 offset:17408
mf v[68:71],a[40:43],v[200:203],v[68:71]
mf v[72:75],a[44:47],v[200:203],v[72:75]
s_add_u32 s68,s68,12288
buffer_load_dwordx4 a[100:103],v1,s[20:23],s68 offen sc1
mf v[72:75],a[36:39],v[196:199],v[72:75]
mf v[76:79],a[32:35],v[204:207],v[76:79]
ds_read_b128 v[196:199],v6 offset:18432
ds_read_b128 v[200:203],v6 offset:27648
mf v[76:79],a[40:43],v[208:211],v[76:79]
mf v[80:83],a[44:47],v[208:211],v[80:83]
mf v[80:83],a[36:39],v[204:207],v[80:83]
s_waitcnt lgkmcnt(4)
mf v[84:87],a[32:35],v[212:215],v[84:87]
buffer_load_dwordx4 a[104:107],v1,s[20:23],s67 offen offset:1024 sc1
mf v[84:87],a[40:43],v[216:219],v[84:87]
ds_read_b128 v[204:207],v6 offset:19456
ds_read_b128 v[208:211],v6 offset:28672
mf v[88:91],a[44:47],v[216:219],v[88:91]
s_cmp_eq_u32 s29,0
s_cbranch_scc1 Lx46
Lx47:
mf v[88:91],a[36:39],v[212:215],v[88:91]
mf v[92:95],a[32:35],v[180:183],v[92:95]
ds_read_b128 v[212:215],v6 offset:20480
ds_read_b128 v[216:219],v6 offset:29696
mf v[92:95],a[40:43],v[184:187],v[92:95]
buffer_load_dwordx4 a[108:111],v1,s[20:23],s68 offen offset:1024 sc1
mf v[96:99],a[44:47],v[184:187],v[96:99]
mf v[96:99],a[36:39],v[180:183],v[96:99]
s_waitcnt lgkmcnt(4)
mf v[100:103],a[32:35],v[188:191],v[100:103]
ds_read_b128 v[180:183],v6 offset:21504
ds_read_b128 v[184:187],v6 offset:30720
mf v[100:103],a[40:43],v[192:195],v[100:103]
mf v[104:107],a[44:47],v[192:195],v[104:107]
mf v[104:107],a[36:39],v[188:191],v[104:107]
s_waitcnt vmcnt(12)
mf v[36:39],a[48:51],v[196:199],v[36:39]
buffer_load_dwordx4 a[112:115],v1,s[20:23],s67 offen offset:2048 sc1
mf v[36:39],a[56:59],v[200:203],v[36:39]
ds_read_b128 v[188:191],v6 offset:22528
ds_read_b128 v[192:195],v6 offset:31744
mf v[40:43],a[60:63],v[200:203],v[40:43]
buffer_load_dwordx2 v[220:221],v20,s[20:23],s69 offen sc1
mf v[40:43],a[52:55],v[196:199],v[40:43]
s_waitcnt lgkmcnt(4)
mf v[44:47],a[48:51],v[204:207],v[44:47]
ds_read_b128 v[196:199],v6 offset:23552
ds_read_b128 v[200:203],v6 offset:32768
mf v[44:47],a[56:59],v[208:211],v[44:47]
buffer_load_dwordx4 a[116:119],v1,s[20:23],s68 offen offset:2048 sc1
mf v[48:51],a[60:63],v[208:211],v[48:51]
s_cmp_eq_u32 s29,0
s_cbranch_scc1 Lx48
Lx49:
mf v[48:51],a[52:55],v[204:207],v[48:51]
mf v[52:55],a[48:51],v[212:215],v[52:55]
ds_read_b128 v[204:207],v6 offset:24576
ds_read_b128 v[208:211],v6 offset:33792
mf v[52:55],a[56:59],v[216:219],v[52:55]
buffer_load_dwordx2 v[222:223],v20,s[20:23],s69 offen offset:128 sc1
mf v[56:59],a[60:63],v[216:219],v[56:59]
buffer_load_dwordx4 a[120:123],v1,s[20:23],s67 offen offset:3072 sc1
mf v[56:59],a[52:55],v[212:215],v[56:59]
s_waitcnt lgkmcnt(4)
mf v[60:63],a[48:51],v[180:183],v[60:63]
ds_read_b128 v[212:215],v6 offset:25600
ds_read_b128 v[216:219],v6 offset:34816
mf v[60:63],a[56:59],v[184:187],v[60:63]
mf v[64:67],a[60:63],v[184:187],v[64:67]
mf v[64:67],a[52:55],v[180:183],v[64:67]
buffer_load_dwordx4 a[124:127],v1,s[20:23],s68 offen offset:3072 sc1
mf v[68:71],a[48:51],v[188:191],v[68:71]
ds_read_b128 v[180:183],v6 offset:26624
ds_read_b128 v[184:187],v6 offset:35840
mf v[68:71],a[56:59],v[192:195],v[68:71]
buffer_load_dwordx2 v[224:225],v20,s[20:23],s69 offen offset:256 sc1
mf v[72:75],a[60:63],v[192:195],v[72:75]
mf v[72:75],a[52:55],v[188:191],v[72:75]
s_waitcnt lgkmcnt(4)
mf v[76:79],a[48:51],v[196:199],v[76:79]
s_cmp_eq_u32 s24,s63
s_cbranch_scc1 Lx50
Lx51:
s_barrier
ds_read_b128 v[188:191],v7
ds_read_b128 v[192:195],v7 offset:9216
mf v[76:79],a[56:59],v[200:203],v[76:79]
s_add_u32 s60,s66,147456
s_add_u32 m0,s61,0
mf v[80:83],a[60:63],v[200:203],v[80:83]
buffer_load_dwordx4 v1,s[4:7],s60 offen lds
mf v[80:83],a[52:55],v[196:199],v[80:83]
s_cmp_eq_u32 s29,0
s_cbranch_scc1 Lx55
Lx56:
mf v[84:87],a[48:51],v[204:207],v[84:87]
ds_read_b128 v[196:199],v7 offset:1024
ds_read_b128 v[200:203],v7 offset:10240
mf v[84:87],a[56:59],v[208:211],v[84:87]
buffer_load_dwordx2 v[226:227],v20,s[20:23],s69 offen offset:384 sc1
mf v[88:91],a[60:63],v[208:211],v[88:91]
mf v[88:91],a[52:55],v[204:207],v[88:91]
s_waitcnt lgkmcnt(4)
mf v[92:95],a[48:51],v[212:215],v[92:95]
buffer_load_dwordx4 v1,s[4:7],s60 offen offset:1024 lds
mf v[92:95],a[56:59],v[216:219],v[92:95]
ds_read_b128 v[204:207],v7 offset:2048
ds_read_b128 v[208:211],v7 offset:11264
mf v[96:99],a[60:63],v[216:219],v[96:99]
mf v[96:99],a[52:55],v[212:215],v[96:99]
mf v[100:103],a[48:51],v[180:183],v[100:103]
ds_read_b128 v[212:215],v7 offset:3072
ds_read_b128 v[216:219],v7 offset:12288
mf v[100:103],a[56:59],v[184:187],v[100:103]
buffer_load_dwordx4 v1,s[4:7],s60 offen offset:2048 lds
mf v[104:107],a[60:63],v[184:187],v[104:107]
buffer_load_dwordx2 v[228:229],v20,s[20:23],s69 offen offset:512 sc1
mf v[104:107],a[52:55],v[180:183],v[104:107]
s_waitcnt vmcnt(20)
s_waitcnt lgkmcnt(4)
mf v[36:39],a[64:67],v[188:191],v[36:39]
ds_read_b128 v[180:183],v7 offset:4096
ds_read_b128 v[184:187],v7 offset:13312
mf v[36:39],a[72:75],v[192:195],v[36:39]
s_cmp_eq_u32 s29,0
s_cbranch_scc1 Lx57
Lx58:
mf v[40:43],a[76:79],v[192:195],v[40:43]
buffer_load_dwordx4 a[128:131],v2,s[20:23],s67 offen sc1
mf v[40:43],a[68:71],v[188:191],v[40:43]
mf v[44:47],a[64:67],v[196:199],v[44:47]
ds_read_b128 v[188:191],v7 offset:5120
ds_read_b128 v[192:195],v7 offset:14336
mf v[44:47],a[72:75],v[200:203],v[44:47]
buffer_load_dwordx2 v[230:231],v20,s[20:23],s69 offen offset:640 sc1
mf v[48:51],a[76:79],v[200:203],v[48:51]
mf v[48:51],a[68:71],v[196:199],v[48:51]
s_waitcnt lgkmcnt(4)
mf v[52:55],a[64:67],v[204:207],v[52:55]
buffer_load_dwordx4 a[132:135],v2,s[20:23],s68 offen sc1
mf v[52:55],a[72:75],v[208:211],v[52:55]
ds_read_b128 v[196:199],v7 offset:6144
ds_read_b128 v[200:203],v7 offset:15360
mf v[56:59],a[76:79],v[208:211],v[56:59]
mf v[56:59],a[68:71],v[204:207],v[56:59]
mf v[60:63],a[64:67],v[212:215],v[60:63]
ds_read_b128 v[204:207],v7 offset:7168
ds_read_b128 v[208:211],v7 offset:16384
mf v[60:63],a[72:75],v[216:219],v[60:63]
buffer_load_dwordx4 a[136:139],v2,s[20:23],s67 offen offset:1024 sc1
mf v[64:67],a[76:79],v[216:219],v[64:67]
buffer_load_dwordx2 v[232:233],v20,s[20:23],s69 offen offset:768 sc1
mf v[64:67],a[68:71],v[212:215],v[64:67]
s_waitcnt lgkmcnt(4)
mf v[68:71],a[64:67],v[180:183],v[68:71]
ds_read_b128 v[212:215],v7 offset:8192
ds_read_b128 v[216:219],v7 offset:17408
mf v[68:71],a[72:75],v[184:187],v[68:71]
s_cmp_eq_u32 s29,0
s_cbranch_scc1 Lx59
Lx60:
mf v[72:75],a[76:79],v[184:187],v[72:75]
buffer_load_dwordx4 a[140:143],v2,s[20:23],s68 offen offset:1024 sc1
mf v[72:75],a[68:71],v[180:183],v[72:75]
mf v[76:79],a[64:67],v[188:191],v[76:79]
ds_read_b128 v[180:183],v7 offset:18432
ds_read_b128 v[184:187],v7 offset:27648
mf v[76:79],a[72:75],v[192:195],v[76:79]
buffer_load_dwordx2 v[234:235],v20,s[20:23],s69 offen offset:896 sc1
mf v[80:83],a[76:79],v[192:195],v[80:83]
mf v[80:83],a[68:71],v[188:191],v[80:83]
s_waitcnt lgkmcnt(4)
mf v[84:87],a[64:67],v[196:199],v[84:87]
buffer_load_dwordx4 v1,s[4:7],s60 offen offset:3072 lds
mf v[84:87],a[72:75],v[200:203],v[84:87]
ds_read_b128 v[188:191],v7 offset:19456
ds_read_b128 v[192:195],v7 offset:28672
mf v[88:91],a[76:79],v[200:203],v[88:91]
s_add_u32 m0,s61,4096
mf v[88:91],a[68:71],v[196:199],v[88:91]
mf v[92:95],a[64:67],v[204:207],v[92:95]
ds_read_b128 v[196:199],v7 offset:20480
ds_read_b128 v[200:203],v7 offset:29696
mf v[92:95],a[72:75],v[208:211],v[92:95]
buffer_load_dwordx4 v2,s[4:7],s60 offen lds
mf v[96:99],a[76:79],v[208:211],v[96:99]
buffer_load_dwordx2 v[236:237],v20,s[20:23],s69 offen offset:1024 sc1
mf v[96:99],a[68:71],v[204:207],v[96:99]
s_waitcnt lgkmcnt(4)
mf v[100:103],a[64:67],v[212:215],v[100:103]
ds_read_b128 v[204:207],v7 offset:21504
ds_read_b128 v[208:211],v7 offset:30720
mf v[100:103],a[72:75],v[216:219],v[100:103]
s_cmp_eq_u32 s29,0
s_cbranch_scc1 Lx61
Lx62:
mf v[104:107],a[76:79],v[216:219],v[104:107]
buffer_load_dwordx4 v2,s[4:7],s60 offen offset:1024 lds
mf v[104:107],a[68:71],v[212:215],v[104:107]
s_waitcnt vmcnt(27)
mf v[36:39],a[80:83],v[180:183],v[36:39]
ds_read_b128 v[212:215],v7 offset:22528
ds_read_b128 v[216:219],v7 offset:31744
mf v[36:39],a[88:91],v[184:187],v[36:39]
Ljt63:
s_add_u32 s101,s3,Ljt63-Ljb41+1536
mf v[40:43],a[92:95],v[184:187],v[40:43]
mf v[40:43],a[84:87],v[180:183],v[40:43]
s_waitcnt lgkmcnt(4)
mf v[44:47],a[80:83],v[188:191],v[44:47]
buffer_load_dword v9,off,s[16:19],s101
mf v[44:47],a[88:91],v[192:195],v[44:47]
ds_read_b128 v[180:183],v7 offset:23552
ds_read_b128 v[184:187],v7 offset:32768
mf v[48:51],a[92:95],v[192:195],v[48:51]
mf v[48:51],a[84:87],v[188:191],v[48:51]
mf v[52:55],a[80:83],v[196:199],v[52:55]
ds_read_b128 v[188:191],v7 offset:24576
ds_read_b128 v[192:195],v7 offset:33792
mf v[52:55],a[88:91],v[200:203],v[52:55]
buffer_load_dwordx4 v2,s[4:7],s60 offen offset:2048 lds
mf v[56:59],a[92:95],v[200:203],v[56:59]
mf v[56:59],a[84:87],v[196:199],v[56:59]
s_waitcnt lgkmcnt(4)
mf v[60:63],a[80:83],v[204:207],v[60:63]
ds_read_b128 v[196:199],v7 offset:25600
ds_read_b128 v[200:203],v7 offset:34816
mf v[60:63],a[88:91],v[208:211],v[60:63]
s_cmp_eq_u32 s29,0
s_cbranch_scc1 Lx64
Lx65:
mf v[64:67],a[92:95],v[208:211],v[64:67]
buffer_load_dwordx4 v2,s[4:7],s60 offen offset:3072 lds
mf v[64:67],a[84:87],v[204:207],v[64:67]
s_add_u32 m0,s61,8192
mf v[68:71],a[80:83],v[212:215],v[68:71]
ds_read_b128 v[204:207],v7 offset:26624
ds_read_b128 v[208:211],v7 offset:35840
mf v[68:71],a[88:91],v[216:219],v[68:71]
mf v[72:75],a[92:95],v[216:219],v[72:75]
mf v[72:75],a[84:87],v[212:215],v[72:75]
s_waitcnt lgkmcnt(4)
mf v[76:79],a[80:83],v[180:183],v[76:79]
buffer_load_dwordx4 v3,s[4:7],s60 offen lds
mf v[76:79],a[88:91],v[184:187],v[76:79]
s_barrier
ds_read_b128 v[212:215],v8
ds_read_b128 v[216:219],v8 offset:9216
mf v[80:83],a[92:95],v[184:187],v[80:83]
s_add_u32 s60,s66,184320
s_add_u32 m0,s61,36864
mf v[80:83],a[84:87],v[180:183],v[80:83]
mf v[84:87],a[80:83],v[188:191],v[84:87]
ds_read_b128 v[180:183],v8 offset:1024
ds_read_b128 v[184:187],v8 offset:10240
mf v[84:87],a[88:91],v[192:195],v[84:87]
buffer_load_dwordx4 v1,s[4:7],s60 offen lds
mf v[88:91],a[92:95],v[192:195],v[88:91]
mf v[88:91],a[84:87],v[188:191],v[88:91]
s_waitcnt lgkmcnt(4)
mf v[92:95],a[80:83],v[196:199],v[92:95]
ds_read_b128 v[188:191],v8 offset:2048
ds_read_b128 v[192:195],v8 offset:11264
mf v[92:95],a[88:91],v[200:203],v[92:95]
mf v[96:99],a[92:95],v[200:203],v[96:99]
buffer_load_dwordx4 v1,s[4:7],s60 offen offset:1024 lds
mf v[96:99],a[84:87],v[196:199],v[96:99]
mf v[100:103],a[80:83],v[204:207],v[100:103]
ds_read_b128 v[196:199],v8 offset:3072
ds_read_b128 v[200:203],v8 offset:12288
mf v[100:103],a[88:91],v[208:211],v[100:103]
mf v[104:107],a[92:95],v[208:211],v[104:107]
mf v[104:107],a[84:87],v[204:207],v[104:107]
s_waitcnt vmcnt(29)
s_waitcnt lgkmcnt(4)
mf v[36:39],a[96:99],v[212:215],v[36:39]
buffer_load_dwordx4 v1,s[4:7],s60 offen offset:2048 lds
mf v[36:39],a[104:107],v[216:219],v[36:39]
ds_read_b128 v[204:207],v8 offset:4096
ds_read_b128 v[208:211],v8 offset:13312
mf v[40:43],a[108:111],v[216:219],v[40:43]
mf v[40:43],a[100:103],v[212:215],v[40:43]
mf v[44:47],a[96:99],v[180:183],v[44:47]
ds_read_b128 v[212:215],v8 offset:5120
ds_read_b128 v[216:219],v8 offset:14336
mf v[44:47],a[104:107],v[184:187],v[44:47]
buffer_load_dwordx4 v1,s[4:7],s60 offen offset:3072 lds
mf v[48:51],a[108:111],v[184:187],v[48:51]
s_add_u32 m0,s61,40960
mf v[48:51],a[100:103],v[180:183],v[48:51]
s_waitcnt lgkmcnt(4)
mf v[52:55],a[96:99],v[188:191],v[52:55]
ds_read_b128 v[180:183],v8 offset:6144
ds_read_b128 v[184:187],v8 offset:15360
mf v[52:55],a[104:107],v[192:195],v[52:55]
mf v[56:59],a[108:111],v[192:195],v[56:59]
buffer_load_dwordx4 v2,s[4:7],s60 offen lds
mf v[56:59],a[100:103],v[188:191],v[56:59]
mf v[60:63],a[96:99],v[196:199],v[60:63]
ds_read_b128 v[188:191],v8 offset:7168
ds_read_b128 v[192:195],v8 offset:16384
mf v[60:63],a[104:107],v[200:203],v[60:63]
mf v[64:67],a[108:111],v[200:203],v[64:67]
mf v[64:67],a[100:103],v[196:199],v[64:67]
s_waitcnt lgkmcnt(4)
mf v[68:71],a[96:99],v[204:207],v[68:71]
buffer_load_dwordx4 v2,s[4:7],s60 offen offset:1024 lds
mf v[68:71],a[104:107],v[208:211],v[68:71]
ds_read_b128 v[196:199],v8 offset:8192
ds_read_b128 v[200:203],v8 offset:17408
mf v[72:75],a[108:111],v[208:211],v[72:75]
mf v[72:75],a[100:103],v[204:207],v[72:75]
mf v[76:79],a[96:99],v[212:215],v[76:79]
ds_read_b128 v[204:207],v8 offset:18432
ds_read_b128 v[208:211],v8 offset:27648
mf v[76:79],a[104:107],v[216:219],v[76:79]
buffer_load_dwordx4 v2,s[4:7],s60 offen offset:2048 lds
mf v[80:83],a[108:111],v[216:219],v[80:83]
mf v[80:83],a[100:103],v[212:215],v[80:83]
s_waitcnt lgkmcnt(4)
mf v[84:87],a[96:99],v[180:183],v[84:87]
ds_read_b128 v[212:215],v8 offset:19456
ds_read_b128 v[216:219],v8 offset:28672
mf v[84:87],a[104:107],v[184:187],v[84:87]
s_waitcnt vmcnt(12)
v_max3_u32 v24,v221,v223,v225
mf v[88:91],a[108:111],v[184:187],v[88:91]
buffer_load_dwordx4 v2,s[4:7],s60 offen offset:3072 lds
mf v[88:91],a[100:103],v[180:183],v[88:91]
s_add_u32 m0,s61,45056
v_max3_u32 v24,v24,v227,v229
mf v[92:95],a[96:99],v[188:191],v[92:95]
ds_read_b128 v[180:183],v8 offset:20480
ds_read_b128 v[184:187],v8 offset:29696
mf v[92:95],a[104:107],v[192:195],v[92:95]
v_max3_u32 v24,v24,v231,v233
v_max3_u32 v24,v24,v235,v237
mf v[96:99],a[108:111],v[192:195],v[96:99]
v_cmp_eq_u32 vcc,-1,v24
s_nop 0
s_cmp_lg_u64 vcc,0
s_cbranch_scc1 Lx66
Lx67:
mf v[96:99],a[100:103],v[188:191],v[96:99]
v_lshlrev_b32 v18,16,v18
s_waitcnt lgkmcnt(4)
mf v[100:103],a[96:99],v[196:199],v[100:103]
buffer_load_dwordx4 v3,s[4:7],s60 offen lds
mf v[100:103],a[104:107],v[200:203],v[100:103]
ds_read_b128 v[188:191],v8 offset:21504
ds_read_b128 v[192:195],v8 offset:30720
mf v[104:107],a[108:111],v[200:203],v[104:107]
v_lshlrev_b32 v19,16,v19
v_add_f32 v220,v220,v222
mf v[104:107],a[100:103],v[196:199],v[104:107]
v_add_f32 v221,v221,v223
mf v[36:39],a[112:115],v[204:207],v[36:39]
ds_read_b128 v[196:199],v8 offset:22528
ds_read_b128 v[200:203],v8 offset:31744
mf v[36:39],a[120:123],v[208:211],v[36:39]
v_add_f32 v220,v220,v224
v_add_f32 v221,v221,v225
mf v[40:43],a[124:127],v[208:211],v[40:43]
v_add_f32 v220,v220,v226
v_add_f32 v221,v221,v227
mf v[40:43],a[116:119],v[204:207],v[40:43]
v_add_f32 v220,v220,v228
s_cmp_eq_u32 s29,0
s_cbranch_scc1 Lx70
Lx71:
s_waitcnt lgkmcnt(4)
mf v[44:47],a[112:115],v[212:215],v[44:47]
ds_read_b128 v[204:207],v8 offset:23552
ds_read_b128 v[208:211],v8 offset:32768
mf v[44:47],a[120:123],v[216:219],v[44:47]
v_add_f32 v221,v221,v229
v_add_f32 v220,v220,v230
mf v[48:51],a[124:127],v[216:219],v[48:51]
v_add_f32 v221,v221,v231
v_add_f32 v220,v220,v232
mf v[48:51],a[116:119],v[212:215],v[48:51]
v_add_f32 v221,v221,v233
v_add_f32 v220,v220,v234
mf v[52:55],a[112:115],v[180:183],v[52:55]
ds_read_b128 v[212:215],v8 offset:24576
ds_read_b128 v[216:219],v8 offset:33792
mf v[52:55],a[120:123],v[184:187],v[52:55]
v_add_f32 v221,v221,v235
v_add_f32 v220,v220,v236
mf v[56:59],a[124:127],v[184:187],v[56:59]
v_add_f32 v221,v221,v237
v_mov_b32 v222,v220
mf v[56:59],a[116:119],v[180:183],v[56:59]
v_mov_b32 v223,v221
s_waitcnt lgkmcnt(4)
mf v[60:63],a[112:115],v[188:191],v[60:63]
ds_read_b128 v[180:183],v8 offset:25600
ds_read_b128 v[184:187],v8 offset:34816
mf v[60:63],a[120:123],v[192:195],v[60:63]
s_nop 0
v_permlane16_swap_b32 v220,v222
mf v[64:67],a[124:127],v[192:195],v[64:67]
v_permlane16_swap_b32 v221,v223
v_add_f32 v220,v220,v222
mf v[64:67],a[116:119],v[188:191],v[64:67]
v_add_f32 v221,v221,v223
v_mul_f32 v10,0xbae38e39,v220
mf v[68:71],a[112:115],v[196:199],v[68:71]
ds_read_b128 v[188:191],v8 offset:26624
ds_read_b128 v[192:195],v8 offset:35840
mf v[68:71],a[120:123],v[200:203],v[68:71]
v_mul_f32 v16,0x3ae38e39,v221
v_fma_f32 v16,-v10,v10,v16
mf v[72:75],a[124:127],v[200:203],v[72:75]
v_max_f32 v16,0,v16
v_add_f32 v16,0x3727c5ac,v16
mf v[72:75],a[116:119],v[196:199],v[72:75]
s_waitcnt lgkmcnt(4)
mf v[76:79],a[112:115],v[204:207],v[76:79]
s_waitcnt vmcnt(9)
s_barrier
ds_read_b128 v[196:199],v1
ds_read_b128 v[200:203],v1 offset:9216
mf v[76:79],a[120:123],v[208:211],v[76:79]
s_add_u32 s60,s66,221184
s_add_u32 m0,s61,73728
mf v[80:83],a[124:127],v[208:211],v[80:83]
buffer_load_dwordx4 v1,s[4:7],s60 offen lds
mf v[80:83],a[116:119],v[204:207],v[80:83]
v_rsq_f32 v16,v16
mf v[84:87],a[112:115],v[212:215],v[84:87]
ds_read_b128 v[204:207],v1 offset:1024
ds_read_b128 v[208:211],v1 offset:10240
mf v[84:87],a[120:123],v[216:219],v[84:87]
v_mov_b32 v11,v10
mf v[88:91],a[124:127],v[216:219],v[88:91]
s_cmp_eq_u32 s24,s63
s_cbranch_scc1 Lx73
Lx74:
mf v[88:91],a[116:119],v[212:215],v[88:91]
ds_write_b32 v21,v10
s_waitcnt lgkmcnt(5)
mf v[92:95],a[112:115],v[180:183],v[92:95]
buffer_load_dwordx4 v1,s[4:7],s60 offen offset:1024 lds
mf v[92:95],a[120:123],v[184:187],v[92:95]
ds_read_b128 v[212:215],v1 offset:2048
ds_read_b128 v[216:219],v1 offset:11264
mf v[96:99],a[124:127],v[184:187],v[96:99]
ds_write_b32 v21,v16 offset:128
v_mov_b32 v17,v16
mf v[96:99],a[116:119],v[180:183],v[96:99]
ds_read_b128 v[108:111],v22
ds_read_b128 v[116:119],v22 offset:128
mf v[100:103],a[112:115],v[188:191],v[100:103]
ds_read_b128 v[180:183],v1 offset:3072
ds_read_b128 v[184:187],v1 offset:12288
mf v[100:103],a[120:123],v[192:195],v[100:103]
buffer_load_dwordx4 v1,s[4:7],s60 offen offset:2048 lds
mf v[104:107],a[124:127],v[192:195],v[104:107]
ds_read_b128 v[112:115],v22 offset:64
ds_read_b128 v[120:123],v22 offset:192
mf v[104:107],a[116:119],v[188:191],v[104:107]
s_waitcnt lgkmcnt(10)
mf v[36:39],a[128:131],v[196:199],v[36:39]
ds_read_b128 v[188:191],v1 offset:4096
ds_read_b128 v[192:195],v1 offset:13312
mf v[36:39],a[136:139],v[200:203],v[36:39]
v_permlane32_swap_b32 v10,v11
v_permlane32_swap_b32 v16,v17
mf v[40:43],a[140:143],v[200:203],v[40:43]
buffer_load_dwordx4 v1,s[4:7],s60 offen offset:3072 lds
mf v[40:43],a[132:135],v[196:199],v[40:43]
s_add_u32 m0,s61,77824
v_mul_f32 v12,0xc0135761,v16
mf v[44:47],a[128:131],v[204:207],v[44:47]
ds_read_b128 v[196:199],v1 offset:5120
ds_read_b128 v[200:203],v1 offset:14336
mf v[44:47],a[136:139],v[208:211],v[44:47]
v_mul_f32 v14,v16,v16
mf v[48:51],a[140:143],v[208:211],v[48:51]
v_rcp_f32 v16,v16
mf v[48:51],a[132:135],v[204:207],v[48:51]
v_mul_f32 v14,v14,v12
s_waitcnt lgkmcnt(6)
mf v[52:55],a[128:131],v[212:215],v[52:55]
buffer_load_dwordx4 v2,s[4:7],s60 offen lds
mf v[52:55],a[136:139],v[216:219],v[52:55]
ds_read_b128 v[204:207],v1 offset:6144
ds_read_b128 v[208:211],v1 offset:15360
mf v[56:59],a[140:143],v[216:219],v[56:59]
v_mul_f32 v14,0x3d372713,v14
v_mul_f32 v13,0xc0135761,v17
mf v[56:59],a[132:135],v[212:215],v[56:59]
v_mul_f32 v15,v17,v17
mf v[60:63],a[128:131],v[180:183],v[60:63]
ds_read_b128 v[212:215],v1 offset:7168
ds_read_b128 v[216:219],v1 offset:16384
mf v[60:63],a[136:139],v[184:187],v[60:63]
buffer_load_dwordx4 v2,s[4:7],s60 offen offset:1024 lds
mf v[64:67],a[140:143],v[184:187],v[64:67]
v_rcp_f32 v17,v17
mf v[64:67],a[132:135],v[180:183],v[64:67]
v_mul_f32 v15,v15,v13
s_cmp_eq_u32 s24,s63
s_cbranch_scc1 Lx75
Lx76:
s_waitcnt lgkmcnt(4)
mf v[68:71],a[128:131],v[188:191],v[68:71]
ds_read_b128 v[180:183],v1 offset:8192
ds_read_b128 v[184:187],v1 offset:17408
mf v[68:71],a[136:139],v[192:195],v[68:71]
v_mul_f32 v15,0x3d372713,v15
mf v[72:75],a[140:143],v[192:195],v[72:75]
buffer_load_dwordx4 v2,s[4:7],s60 offen offset:2048 lds
mf v[72:75],a[132:135],v[188:191],v[72:75]
v_mul_f32 v124,v116,v116
v_mul_f32 v116,0xc0135761,v116
mf v[76:79],a[128:131],v[196:199],v[76:79]
ds_read_b128 v[188:191],v1 offset:18432
ds_read_b128 v[192:195],v1 offset:27648
mf v[76:79],a[136:139],v[200:203],v[76:79]
v_mul_f32 v124,0x3d372713,v124
v_mul_f32 v124,v124,v116
mf v[80:83],a[140:143],v[200:203],v[80:83]
v_mul_f32 v125,v117,v117
v_mul_f32 v117,0xc0135761,v117
mf v[80:83],a[132:135],v[196:199],v[80:83]
v_mul_f32 v125,0x3d372713,v125
s_waitcnt lgkmcnt(4)
mf v[84:87],a[128:131],v[204:207],v[84:87]
buffer_load_dwordx4 v2,s[4:7],s60 offen offset:3072 lds
mf v[84:87],a[136:139],v[208:211],v[84:87]
ds_read_b128 v[196:199],v1 offset:19456
ds_read_b128 v[200:203],v1 offset:28672
mf v[88:91],a[140:143],v[208:211],v[88:91]
s_add_u32 m0,s61,81920
v_mul_f32 v125,v125,v117
mf v[88:91],a[132:135],v[204:207],v[88:91]
v_mul_f32 v126,v118,v118
v_mul_f32 v118,0xc0135761,v118
mf v[92:95],a[128:131],v[212:215],v[92:95]
ds_read_b128 v[204:207],v1 offset:20480
ds_read_b128 v[208:211],v1 offset:29696
mf v[92:95],a[136:139],v[216:219],v[92:95]
buffer_load_dwordx4 v3,s[4:7],s60 offen lds
mf v[96:99],a[140:143],v[216:219],v[96:99]
v_mul_f32 v126,0x3d372713,v126
v_mul_f32 v126,v126,v118
mf v[96:99],a[132:135],v[212:215],v[96:99]
v_mul_f32 v127,v119,v119
s_waitcnt lgkmcnt(4)
mf v[100:103],a[128:131],v[180:183],v[100:103]
ds_read_b128 v[212:215],v1 offset:21504
ds_read_b128 v[216:219],v1 offset:30720
mf v[100:103],a[136:139],v[184:187],v[100:103]
v_mul_f32 v119,0xc0135761,v119
v_mul_f32 v127,0x3d372713,v127
mf v[104:107],a[140:143],v[184:187],v[104:107]
v_mul_f32 v127,v127,v119
v_mul_f32 v128,v120,v120
mf v[104:107],a[132:135],v[180:183],v[104:107]
v_mul_f32 v120,0xc0135761,v120
v_mul_f32 v128,0x3d372713,v128
s_cmp_eq_u32 s24,s63
s_cbranch_scc1 Lx78
Lx79:
v_mul_f32 v128,v128,v120
v_mul_f32 v129,v121,v121
v_mul_f32 v121,0xc0135761,v121
v_mul_f32 v129,0x3d372713,v129
v_mul_f32 v129,v129,v121
v_mul_f32 v130,v122,v122
v_mul_f32 v122,0xc0135761,v122
v_mul_f32 v130,0x3d372713,v130
v_mul_f32 v130,v130,v122
v_mul_f32 v131,v123,v123
v_mul_f32 v123,0xc0135761,v123
v_mul_f32 v131,0x3d372713,v131
v_mul_f32 v131,v131,v123
s_cmp_lg_u32 s29,0
s_cbranch_scc1 Lg80
v_pk_fma_f32 v[36:37],v[108:109],v[148:149],v[36:37] op_sel_hi:[1,0,1]
v_pk_fma_f32 v[38:39],v[110:111],v[148:149],v[38:39] op_sel_hi:[1,0,1]
v_pk_fma_f32 v[40:41],v[112:113],v[148:149],v[40:41] op_sel_hi:[1,0,1]
v_pk_fma_f32 v[42:43],v[114:115],v[148:149],v[42:43] op_sel_hi:[1,0,1]
v_pk_mul_f32 v[160:161],v[36:37],v[36:37]
v_pk_mul_f32 v[162:163],v[38:39],v[38:39]
v_pk_mul_f32 v[164:165],v[40:41],v[40:41]
v_pk_mul_f32 v[166:167],v[42:43],v[42:43]
v_pk_fma_f32 v[160:161],v[160:161],v[124:125],v[116:117]
v_pk_fma_f32 v[162:163],v[162:163],v[126:127],v[118:119]
v_pk_fma_f32 v[164:165],v[164:165],v[128:129],v[120:121]
v_pk_fma_f32 v[166:167],v[166:167],v[130:131],v[122:123]
Ljt77a:
s_add_u32 s101,s3,Ljt77a-Ljb41+1536
buffer_load_dword v9,off,s[16:19],s101
v_pk_mul_f32 v[160:161],v[36:37],v[160:161]
v_pk_mul_f32 v[162:163],v[38:39],v[162:163]
v_pk_mul_f32 v[164:165],v[40:41],v[164:165]
v_pk_mul_f32 v[166:167],v[42:43],v[166:167]
v_exp_f32 v160,v160
v_exp_f32 v161,v161
v_exp_f32 v162,v162
v_exp_f32 v163,v163
v_exp_f32 v164,v164
v_exp_f32 v165,v165
v_exp_f32 v166,v166
v_exp_f32 v167,v167
s_lshl_b32 s48,s2,2
s_add_u32 s48,s48,s24
s_mul_i32 s48,s48,2304
s_add_u32 s48,s48,34603008
v_mov_b32 v32,-1
v_mov_b32 v33,-1
v_mov_b32 v34,-1
v_mov_b32 v35,-1
buffer_store_dwordx4 v[32:35],v1,s[20:23],s48 offen sc1
v_pk_add_f32 v[160:161],v[160:161],1.0 op_sel_hi:[1,0]
v_pk_add_f32 v[162:163],v[162:163],1.0 op_sel_hi:[1,0]
v_pk_add_f32 v[164:165],v[164:165],1.0 op_sel_hi:[1,0]
v_pk_add_f32 v[166:167],v[166:167],1.0 op_sel_hi:[1,0]
v_rcp_f32 v160,v160
v_rcp_f32 v161,v161
v_rcp_f32 v162,v162
v_rcp_f32 v163,v163
v_rcp_f32 v164,v164
v_rcp_f32 v165,v165
v_rcp_f32 v166,v166
v_rcp_f32 v167,v167
s_sub_u32 s49,s48,34603008
buffer_store_dwordx4 v[32:35],v1,s[12:15],s49 offen sc1
v_pk_mul_f32 v[36:37],v[36:37],v[160:161]
v_pk_mul_f32 v[38:39],v[38:39],v[162:163]
v_pk_mul_f32 v[40:41],v[40:41],v[164:165]
v_pk_mul_f32 v[42:43],v[42:43],v[166:167]
v_pk_add_f32 v[132:133],v[132:133],v[36:37]
v_pk_add_f32 v[134:135],v[134:135],v[38:39]
v_pk_add_f32 v[136:137],v[136:137],v[40:41]
v_pk_add_f32 v[138:139],v[138:139],v[42:43]
buffer_store_dwordx4 v[32:35],v1,s[20:23],s48 offen offset:1024 sc1
v_pk_fma_f32 v[140:141],v[36:37],v[36:37],v[140:141]
v_pk_fma_f32 v[142:143],v[38:39],v[38:39],v[142:143]
v_pk_fma_f32 v[144:145],v[40:41],v[40:41],v[144:145]
v_pk_fma_f32 v[146:147],v[42:43],v[42:43],v[146:147]
v_pk_fma_f32 v[44:45],v[108:109],v[148:149],v[44:45] op_sel:[0,1,0]
v_pk_fma_f32 v[46:47],v[110:111],v[148:149],v[46:47] op_sel:[0,1,0]
v_pk_fma_f32 v[48:49],v[112:113],v[148:149],v[48:49] op_sel:[0,1,0]
v_pk_fma_f32 v[50:51],v[114:115],v[148:149],v[50:51] op_sel:[0,1,0]
v_pk_mul_f32 v[160:161],v[44:45],v[44:45]
v_pk_mul_f32 v[162:163],v[46:47],v[46:47]
v_pk_mul_f32 v[164:165],v[48:49],v[48:49]
v_pk_mul_f32 v[166:167],v[50:51],v[50:51]
v_pk_fma_f32 v[160:161],v[160:161],v[124:125],v[116:117]
v_pk_fma_f32 v[162:163],v[162:163],v[126:127],v[118:119]
v_pk_fma_f32 v[164:165],v[164:165],v[128:129],v[120:121]
v_pk_fma_f32 v[166:167],v[166:167],v[130:131],v[122:123]
s_sub_u32 s49,s48,34603008
buffer_store_dwordx4 v[32:35],v1,s[12:15],s49 offen offset:1024 sc1
v_pk_mul_f32 v[160:161],v[44:45],v[160:161]
v_pk_mul_f32 v[162:163],v[46:47],v[162:163]
v_pk_mul_f32 v[164:165],v[48:49],v[164:165]
v_pk_mul_f32 v[166:167],v[50:51],v[166:167]
v_exp_f32 v160,v160
v_exp_f32 v161,v161
v_exp_f32 v162,v162
v_exp_f32 v163,v163
v_exp_f32 v164,v164
v_exp_f32 v165,v165
v_exp_f32 v166,v166
v_exp_f32 v167,v167
buffer_store_dword v32,v30,s[20:23],s48 offen offset:2048 sc1
v_pk_add_f32 v[160:161],v[160:161],1.0 op_sel_hi:[1,0]
v_pk_add_f32 v[162:163],v[162:163],1.0 op_sel_hi:[1,0]
v_pk_add_f32 v[164:165],v[164:165],1.0 op_sel_hi:[1,0]
v_pk_add_f32 v[166:167],v[166:167],1.0 op_sel_hi:[1,0]
v_rcp_f32 v160,v160
v_rcp_f32 v161,v161
v_rcp_f32 v162,v162
v_rcp_f32 v163,v163
v_rcp_f32 v164,v164
v_rcp_f32 v165,v165
v_rcp_f32 v166,v166
v_rcp_f32 v167,v167
s_sub_u32 s49,s48,34603008
buffer_store_dword v32,v30,s[12:15],s49 offen offset:2048 sc1
v_pk_mul_f32 v[44:45],v[44:45],v[160:161]
v_pk_mul_f32 v[46:47],v[46:47],v[162:163]
v_pk_mul_f32 v[48:49],v[48:49],v[164:165]
v_pk_mul_f32 v[50:51],v[50:51],v[166:167]
v_pk_add_f32 v[132:133],v[132:133],v[44:45]
v_pk_add_f32 v[134:135],v[134:135],v[46:47]
v_pk_add_f32 v[136:137],v[136:137],v[48:49]
v_pk_add_f32 v[138:139],v[138:139],v[50:51]
s_add_u32 s71,s70,0
s_cmp_lg_u32 s24,s63
s_cbranch_scc1 Lj82
s_waitcnt vmcnt(10)
v_readfirstlane_b32 s56,v27
s_nop 0
s_cmp_eq_u32 s56,16
s_cbranch_scc1 Lj82
s_mov_b64 exec,1
s_mov_b32 s56,0
Lp83:
v_mov_b32_e64 v27,0
buffer_atomic_add v27,v28,s[20:23],s90 offen sc0 sc1
s_waitcnt vmcnt(0)
v_cmp_ne_u32 vcc,16,v27
s_nop 0
s_cbranch_vccz Lpd84
s_add_u32 s56,s56,1
s_cmp_lt_u32 s56,0x40000
s_cbranch_scc1 Lp83
Lpd84:
s_mov_b64 exec,-1
Lj82:
s_barrier
buffer_load_dwordx4 a[144:147],v1,s[4:7],s71 offen
v_pk_fma_f32 v[140:141],v[44:45],v[44:45],v[140:141]
v_pk_fma_f32 v[142:143],v[46:47],v[46:47],v[142:143]
v_pk_fma_f32 v[144:145],v[48:49],v[48:49],v[144:145]
v_pk_fma_f32 v[146:147],v[50:51],v[50:51],v[146:147]
v_pk_fma_f32 v[52:53],v[108:109],v[150:151],v[52:53] op_sel_hi:[1,0,1]
v_pk_fma_f32 v[54:55],v[110:111],v[150:151],v[54:55] op_sel_hi:[1,0,1]
v_pk_fma_f32 v[56:57],v[112:113],v[150:151],v[56:57] op_sel_hi:[1,0,1]
v_pk_fma_f32 v[58:59],v[114:115],v[150:151],v[58:59] op_sel_hi:[1,0,1]
v_pk_mul_f32 v[160:161],v[52:53],v[52:53]
v_pk_mul_f32 v[162:163],v[54:55],v[54:55]
v_pk_mul_f32 v[164:165],v[56:57],v[56:57]
v_pk_mul_f32 v[166:167],v[58:59],v[58:59]
v_pk_fma_f32 v[160:161],v[160:161],v[124:125],v[116:117]
v_pk_fma_f32 v[162:163],v[162:163],v[126:127],v[118:119]
v_pk_fma_f32 v[164:165],v[164:165],v[128:129],v[120:121]
v_pk_fma_f32 v[166:167],v[166:167],v[130:131],v[122:123]
buffer_load_dwordx4 a[148:151],v1,s[4:7],s71 offen offset:1024
v_pk_mul_f32 v[160:161],v[52:53],v[160:161]
v_pk_mul_f32 v[162:163],v[54:55],v[162:163]
v_pk_mul_f32 v[164:165],v[56:57],v[164:165]
v_pk_mul_f32 v[166:167],v[58:59],v[166:167]
v_exp_f32 v160,v160
v_exp_f32 v161,v161
v_exp_f32 v162,v162
v_exp_f32 v163,v163
v_exp_f32 v164,v164
v_exp_f32 v165,v165
v_exp_f32 v166,v166
v_exp_f32 v167,v167
buffer_load_dwordx4 a[152:155],v1,s[4:7],s71 offen offset:2048
v_pk_add_f32 v[160:161],v[160:161],1.0 op_sel_hi:[1,0]
v_pk_add_f32 v[162:163],v[162:163],1.0 op_sel_hi:[1,0]
v_pk_add_f32 v[164:165],v[164:165],1.0 op_sel_hi:[1,0]
v_pk_add_f32 v[166:167],v[166:167],1.0 op_sel_hi:[1,0]
v_rcp_f32 v160,v160
v_rcp_f32 v161,v161
v_rcp_f32 v162,v162
v_rcp_f32 v163,v163
v_rcp_f32 v164,v164
v_rcp_f32 v165,v165
v_rcp_f32 v166,v166
v_rcp_f32 v167,v167
buffer_load_dwordx4 a[156:159],v1,s[4:7],s71 offen offset:3072
v_pk_mul_f32 v[52:53],v[52:53],v[160:161]
v_pk_mul_f32 v[54:55],v[54:55],v[162:163]
v_pk_mul_f32 v[56:57],v[56:57],v[164:165]
v_pk_mul_f32 v[58:59],v[58:59],v[166:167]
v_pk_add_f32 v[132:133],v[132:133],v[52:53]
v_pk_add_f32 v[134:135],v[134:135],v[54:55]
v_pk_add_f32 v[136:137],v[136:137],v[56:57]
v_pk_add_f32 v[138:139],v[138:139],v[58:59]
buffer_load_dwordx4 a[160:163],v2,s[4:7],s71 offen
v_pk_fma_f32 v[140:141],v[52:53],v[52:53],v[140:141]
v_pk_fma_f32 v[142:143],v[54:55],v[54:55],v[142:143]
v_pk_fma_f32 v[144:145],v[56:57],v[56:57],v[144:145]
v_pk_fma_f32 v[146:147],v[58:59],v[58:59],v[146:147]
v_pk_fma_f32 v[60:61],v[108:109],v[150:151],v[60:61] op_sel:[0,1,0]
v_pk_fma_f32 v[62:63],v[110:111],v[150:151],v[62:63] op_sel:[0,1,0]
v_pk_fma_f32 v[64:65],v[112:113],v[150:151],v[64:65] op_sel:[0,1,0]
v_pk_fma_f32 v[66:67],v[114:115],v[150:151],v[66:67] op_sel:[0,1,0]
v_pk_mul_f32 v[160:161],v[60:61],v[60:61]
v_pk_mul_f32 v[162:163],v[62:63],v[62:63]
v_pk_mul_f32 v[164:165],v[64:65],v[64:65]
v_pk_mul_f32 v[166:167],v[66:67],v[66:67]
v_pk_fma_f32 v[160:161],v[160:161],v[124:125],v[116:117]
v_pk_fma_f32 v[162:163],v[162:163],v[126:127],v[118:119]
v_pk_fma_f32 v[164:165],v[164:165],v[128:129],v[120:121]
v_pk_fma_f32 v[166:167],v[166:167],v[130:131],v[122:123]
buffer_load_dwordx4 a[164:167],v2,s[4:7],s71 offen offset:1024
v_pk_mul_f32 v[160:161],v[60:61],v[160:161]
v_pk_mul_f32 v[162:163],v[62:63],v[162:163]
v_pk_mul_f32 v[164:165],v[64:65],v[164:165]
v_pk_mul_f32 v[166:167],v[66:67],v[166:167]
v_exp_f32 v160,v160
v_exp_f32 v161,v161
v_exp_f32 v162,v162
v_exp_f32 v163,v163
v_exp_f32 v164,v164
v_exp_f32 v165,v165
v_exp_f32 v166,v166
v_exp_f32 v167,v167
buffer_load_dwordx4 a[168:171],v2,s[4:7],s71 offen offset:2048
v_pk_add_f32 v[160:161],v[160:161],1.0 op_sel_hi:[1,0]
v_pk_add_f32 v[162:163],v[162:163],1.0 op_sel_hi:[1,0]
v_pk_add_f32 v[164:165],v[164:165],1.0 op_sel_hi:[1,0]
v_pk_add_f32 v[166:167],v[166:167],1.0 op_sel_hi:[1,0]
v_rcp_f32 v160,v160
v_rcp_f32 v161,v161
v_rcp_f32 v162,v162
v_rcp_f32 v163,v163
v_rcp_f32 v164,v164
v_rcp_f32 v165,v165
v_rcp_f32 v166,v166
v_rcp_f32 v167,v167
buffer_load_dwordx4 a[172:175],v2,s[4:7],s71 offen offset:3072
v_pk_mul_f32 v[60:61],v[60:61],v[160:161]
v_pk_mul_f32 v[62:63],v[62:63],v[162:163]
v_pk_mul_f32 v[64:65],v[64:65],v[164:165]
v_pk_mul_f32 v[66:67],v[66:67],v[166:167]
v_pk_add_f32 v[132:133],v[132:133],v[60:61]
v_pk_add_f32 v[134:135],v[134:135],v[62:63]
v_pk_add_f32 v[136:137],v[136:137],v[64:65]
v_pk_add_f32 v[138:139],v[138:139],v[66:67]
buffer_load_dwordx4 a[176:179],v3,s[4:7],s71 offen
v_pk_fma_f32 v[140:141],v[60:61],v[60:61],v[140:141]
v_pk_fma_f32 v[142:143],v[62:63],v[62:63],v[142:143]
v_pk_fma_f32 v[144:145],v[64:65],v[64:65],v[144:145]
v_pk_fma_f32 v[146:147],v[66:67],v[66:67],v[146:147]
v_pk_fma_f32 v[68:69],v[108:109],v[152:153],v[68:69] op_sel_hi:[1,0,1]
v_pk_fma_f32 v[70:71],v[110:111],v[152:153],v[70:71] op_sel_hi:[1,0,1]
v_pk_fma_f32 v[72:73],v[112:113],v[152:153],v[72:73] op_sel_hi:[1,0,1]
v_pk_fma_f32 v[74:75],v[114:115],v[152:153],v[74:75] op_sel_hi:[1,0,1]
v_pk_mul_f32 v[160:161],v[68:69],v[68:69]
v_pk_mul_f32 v[162:163],v[70:71],v[70:71]
v_pk_mul_f32 v[164:165],v[72:73],v[72:73]
v_pk_mul_f32 v[166:167],v[74:75],v[74:75]
v_pk_fma_f32 v[160:161],v[160:161],v[124:125],v[116:117]
v_pk_fma_f32 v[162:163],v[162:163],v[126:127],v[118:119]
v_pk_fma_f32 v[164:165],v[164:165],v[128:129],v[120:121]
v_pk_fma_f32 v[166:167],v[166:167],v[130:131],v[122:123]
buffer_load_dwordx4 a[180:183],v3,s[4:7],s71 offen offset:1024
v_pk_mul_f32 v[160:161],v[68:69],v[160:161]
v_pk_mul_f32 v[162:163],v[70:71],v[162:163]
v_pk_mul_f32 v[164:165],v[72:73],v[164:165]
v_pk_mul_f32 v[166:167],v[74:75],v[166:167]
v_exp_f32 v160,v160
v_exp_f32 v161,v161
v_exp_f32 v162,v162
v_exp_f32 v163,v163
v_exp_f32 v164,v164
v_exp_f32 v165,v165
v_exp_f32 v166,v166
v_exp_f32 v167,v167
buffer_load_dwordx4 a[184:187],v3,s[4:7],s71 offen offset:2048
v_pk_add_f32 v[160:161],v[160:161],1.0 op_sel_hi:[1,0]
v_pk_add_f32 v[162:163],v[162:163],1.0 op_sel_hi:[1,0]
v_pk_add_f32 v[164:165],v[164:165],1.0 op_sel_hi:[1,0]
v_pk_add_f32 v[166:167],v[166:167],1.0 op_sel_hi:[1,0]
v_rcp_f32 v160,v160
v_rcp_f32 v161,v161
v_rcp_f32 v162,v162
v_rcp_f32 v163,v163
v_rcp_f32 v164,v164
v_rcp_f32 v165,v165
v_rcp_f32 v166,v166
v_rcp_f32 v167,v167
buffer_load_dwordx4 a[188:191],v3,s[4:7],s71 offen offset:3072
v_pk_mul_f32 v[68:69],v[68:69],v[160:161]
v_pk_mul_f32 v[70:71],v[70:71],v[162:163]
v_pk_mul_f32 v[72:73],v[72:73],v[164:165]
v_pk_mul_f32 v[74:75],v[74:75],v[166:167]
v_pk_add_f32 v[132:133],v[132:133],v[68:69]
v_pk_add_f32 v[134:135],v[134:135],v[70:71]
v_pk_add_f32 v[136:137],v[136:137],v[72:73]
v_pk_add_f32 v[138:139],v[138:139],v[74:75]
s_add_u32 s71,s70,12288
buffer_load_dwordx4 a[192:195],v1,s[4:7],s71 offen
v_pk_fma_f32 v[140:141],v[68:69],v[68:69],v[140:141]
v_pk_fma_f32 v[142:143],v[70:71],v[70:71],v[142:143]
v_pk_fma_f32 v[144:145],v[72:73],v[72:73],v[144:145]
v_pk_fma_f32 v[146:147],v[74:75],v[74:75],v[146:147]
v_pk_fma_f32 v[76:77],v[108:109],v[152:153],v[76:77] op_sel:[0,1,0]
v_pk_fma_f32 v[78:79],v[110:111],v[152:153],v[78:79] op_sel:[0,1,0]
v_pk_fma_f32 v[80:81],v[112:113],v[152:153],v[80:81] op_sel:[0,1,0]
v_pk_fma_f32 v[82:83],v[114:115],v[152:153],v[82:83] op_sel:[0,1,0]
v_pk_mul_f32 v[160:161],v[76:77],v[76:77]
v_pk_mul_f32 v[162:163],v[78:79],v[78:79]
v_pk_mul_f32 v[164:165],v[80:81],v[80:81]
v_pk_mul_f32 v[166:167],v[82:83],v[82:83]
v_pk_fma_f32 v[160:161],v[160:161],v[124:125],v[116:117]
v_pk_fma_f32 v[162:163],v[162:163],v[126:127],v[118:119]
v_pk_fma_f32 v[164:165],v[164:165],v[128:129],v[120:121]
v_pk_fma_f32 v[166:167],v[166:167],v[130:131],v[122:123]
buffer_load_dwordx4 a[196:199],v1,s[4:7],s71 offen offset:1024
v_pk_mul_f32 v[160:161],v[76:77],v[160:161]
v_pk_mul_f32 v[162:163],v[78:79],v[162:163]
v_pk_mul_f32 v[164:165],v[80:81],v[164:165]
v_pk_mul_f32 v[166:167],v[82:83],v[166:167]
v_exp_f32 v160,v160
v_exp_f32 v161,v161
v_exp_f32 v162,v162
v_exp_f32 v163,v163
v_exp_f32 v164,v164
v_exp_f32 v165,v165
v_exp_f32 v166,v166
v_exp_f32 v167,v167
buffer_load_dwordx4 a[200:203],v1,s[4:7],s71 offen offset:2048
v_pk_add_f32 v[160:161],v[160:161],1.0 op_sel_hi:[1,0]
v_pk_add_f32 v[162:163],v[162:163],1.0 op_sel_hi:[1,0]
v_pk_add_f32 v[164:165],v[164:165],1.0 op_sel_hi:[1,0]
v_pk_add_f32 v[166:167],v[166:167],1.0 op_sel_hi:[1,0]
v_rcp_f32 v160,v160
v_rcp_f32 v161,v161
v_rcp_f32 v162,v162
v_rcp_f32 v163,v163
v_rcp_f32 v164,v164
v_rcp_f32 v165,v165
v_rcp_f32 v166,v166
v_rcp_f32 v167,v167
buffer_load_dwordx4 a[204:207],v1,s[4:7],s71 offen offset:3072
v_pk_mul_f32 v[76:77],v[76:77],v[160:161]
v_pk_mul_f32 v[78:79],v[78:79],v[162:163]
v_pk_mul_f32 v[80:81],v[80:81],v[164:165]
v_pk_mul_f32 v[82:83],v[82:83],v[166:167]
v_pk_add_f32 v[132:133],v[132:133],v[76:77]
v_pk_add_f32 v[134:135],v[134:135],v[78:79]
v_pk_add_f32 v[136:137],v[136:137],v[80:81]
v_pk_add_f32 v[138:139],v[138:139],v[82:83]
buffer_load_dwordx4 a[208:211],v2,s[4:7],s71 offen
v_pk_fma_f32 v[140:141],v[76:77],v[76:77],v[140:141]
v_pk_fma_f32 v[142:143],v[78:79],v[78:79],v[142:143]
v_pk_fma_f32 v[144:145],v[80:81],v[80:81],v[144:145]
v_pk_fma_f32 v[146:147],v[82:83],v[82:83],v[146:147]
v_pk_fma_f32 v[84:85],v[108:109],v[154:155],v[84:85] op_sel_hi:[1,0,1]
v_pk_fma_f32 v[86:87],v[110:111],v[154:155],v[86:87] op_sel_hi:[1,0,1]
v_pk_fma_f32 v[88:89],v[112:113],v[154:155],v[88:89] op_sel_hi:[1,0,1]
v_pk_fma_f32 v[90:91],v[114:115],v[154:155],v[90:91] op_sel_hi:[1,0,1]
v_pk_mul_f32 v[160:161],v[84:85],v[84:85]
v_pk_mul_f32 v[162:163],v[86:87],v[86:87]
v_pk_mul_f32 v[164:165],v[88:89],v[88:89]
v_pk_mul_f32 v[166:167],v[90:91],v[90:91]
v_pk_fma_f32 v[160:161],v[160:161],v[124:125],v[116:117]
v_pk_fma_f32 v[162:163],v[162:163],v[126:127],v[118:119]
v_pk_fma_f32 v[164:165],v[164:165],v[128:129],v[120:121]
v_pk_fma_f32 v[166:167],v[166:167],v[130:131],v[122:123]
buffer_load_dwordx4 a[212:215],v2,s[4:7],s71 offen offset:1024
v_pk_mul_f32 v[160:161],v[84:85],v[160:161]
v_pk_mul_f32 v[162:163],v[86:87],v[162:163]
v_pk_mul_f32 v[164:165],v[88:89],v[164:165]
v_pk_mul_f32 v[166:167],v[90:91],v[166:167]
v_exp_f32 v160,v160
v_exp_f32 v161,v161
v_exp_f32 v162,v162
v_exp_f32 v163,v163
v_exp_f32 v164,v164
v_exp_f32 v165,v165
v_exp_f32 v166,v166
v_exp_f32 v167,v167
buffer_load_dwordx4 a[216:219],v2,s[4:7],s71 offen offset:2048
v_pk_add_f32 v[160:161],v[160:161],1.0 op_sel_hi:[1,0]
v_pk_add_f32 v[162:163],v[162:163],1.0 op_sel_hi:[1,0]
v_pk_add_f32 v[164:165],v[164:165],1.0 op_sel_hi:[1,0]
v_pk_add_f32 v[166:167],v[166:167],1.0 op_sel_hi:[1,0]
v_rcp_f32 v160,v160
v_rcp_f32 v161,v161
v_rcp_f32 v162,v162
v_rcp_f32 v163,v163
v_rcp_f32 v164,v164
v_rcp_f32 v165,v165
v_rcp_f32 v166,v166
v_rcp_f32 v167,v167
buffer_load_dwordx4 a[220:223],v2,s[4:7],s71 offen offset:3072
v_pk_mul_f32 v[84:85],v[84:85],v[160:161]
v_pk_mul_f32 v[86:87],v[86:87],v[162:163]
v_pk_mul_f32 v[88:89],v[88:89],v[164:165]
v_pk_mul_f32 v[90:91],v[90:91],v[166:167]
v_pk_add_f32 v[132:133],v[132:133],v[84:85]
v_pk_add_f32 v[134:135],v[134:135],v[86:87]
v_pk_add_f32 v[136:137],v[136:137],v[88:89]
v_pk_add_f32 v[138:139],v[138:139],v[90:91]
buffer_load_dwordx4 a[224:227],v3,s[4:7],s71 offen
v_pk_fma_f32 v[140:141],v[84:85],v[84:85],v[140:141]
v_pk_fma_f32 v[142:143],v[86:87],v[86:87],v[142:143]
v_pk_fma_f32 v[144:145],v[88:89],v[88:89],v[144:145]
v_pk_fma_f32 v[146:147],v[90:91],v[90:91],v[146:147]
v_pk_fma_f32 v[92:93],v[108:109],v[154:155],v[92:93] op_sel:[0,1,0]
v_pk_fma_f32 v[94:95],v[110:111],v[154:155],v[94:95] op_sel:[0,1,0]
v_pk_fma_f32 v[96:97],v[112:113],v[154:155],v[96:97] op_sel:[0,1,0]
v_pk_fma_f32 v[98:99],v[114:115],v[154:155],v[98:99] op_sel:[0,1,0]
v_pk_mul_f32 v[160:161],v[92:93],v[92:93]
v_pk_mul_f32 v[162:163],v[94:95],v[94:95]
v_pk_mul_f32 v[164:165],v[96:97],v[96:97]
v_pk_mul_f32 v[166:167],v[98:99],v[98:99]
v_pk_fma_f32 v[160:161],v[160:161],v[124:125],v[116:117]
v_pk_fma_f32 v[162:163],v[162:163],v[126:127],v[118:119]
v_pk_fma_f32 v[164:165],v[164:165],v[128:129],v[120:121]
v_pk_fma_f32 v[166:167],v[166:167],v[130:131],v[122:123]
buffer_load_dwordx4 a[228:231],v3,s[4:7],s71 offen offset:1024
v_pk_mul_f32 v[160:161],v[92:93],v[160:161]
v_pk_mul_f32 v[162:163],v[94:95],v[162:163]
v_pk_mul_f32 v[164:165],v[96:97],v[164:165]
v_pk_mul_f32 v[166:167],v[98:99],v[166:167]
v_exp_f32 v160,v160
v_exp_f32 v161,v161
v_exp_f32 v162,v162
v_exp_f32 v163,v163
v_exp_f32 v164,v164
v_exp_f32 v165,v165
v_exp_f32 v166,v166
v_exp_f32 v167,v167
buffer_load_dwordx4 a[232:235],v3,s[4:7],s71 offen offset:2048
v_pk_add_f32 v[160:161],v[160:161],1.0 op_sel_hi:[1,0]
v_pk_add_f32 v[162:163],v[162:163],1.0 op_sel_hi:[1,0]
v_pk_add_f32 v[164:165],v[164:165],1.0 op_sel_hi:[1,0]
v_pk_add_f32 v[166:167],v[166:167],1.0 op_sel_hi:[1,0]
v_rcp_f32 v160,v160
v_rcp_f32 v161,v161
v_rcp_f32 v162,v162
v_rcp_f32 v163,v163
v_rcp_f32 v164,v164
v_rcp_f32 v165,v165
v_rcp_f32 v166,v166
v_rcp_f32 v167,v167
buffer_load_dwordx4 a[236:239],v3,s[4:7],s71 offen offset:3072
v_pk_mul_f32 v[92:93],v[92:93],v[160:161]
v_pk_mul_f32 v[94:95],v[94:95],v[162:163]
v_pk_mul_f32 v[96:97],v[96:97],v[164:165]
v_pk_mul_f32 v[98:99],v[98:99],v[166:167]
v_pk_add_f32 v[132:133],v[132:133],v[92:93]
v_pk_add_f32 v[134:135],v[134:135],v[94:95]
v_pk_add_f32 v[136:137],v[136:137],v[96:97]
v_pk_add_f32 v[138:139],v[138:139],v[98:99]
s_add_u32 s71,s70,24576
buffer_load_dwordx4 a[240:243],v1,s[4:7],s71 offen
v_pk_fma_f32 v[140:141],v[92:93],v[92:93],v[140:141]
v_pk_fma_f32 v[142:143],v[94:95],v[94:95],v[142:143]
v_pk_fma_f32 v[144:145],v[96:97],v[96:97],v[144:145]
v_pk_fma_f32 v[146:147],v[98:99],v[98:99],v[146:147]
v_pk_fma_f32 v[100:101],v[108:109],v[156:157],v[100:101] op_sel_hi:[1,0,1]
v_pk_fma_f32 v[102:103],v[110:111],v[156:157],v[102:103] op_sel_hi:[1,0,1]
v_pk_fma_f32 v[104:105],v[112:113],v[156:157],v[104:105] op_sel_hi:[1,0,1]
v_pk_fma_f32 v[106:107],v[114:115],v[156:157],v[106:107] op_sel_hi:[1,0,1]
v_pk_mul_f32 v[160:161],v[100:101],v[100:101]
v_pk_mul_f32 v[162:163],v[102:103],v[102:103]
v_pk_mul_f32 v[164:165],v[104:105],v[104:105]
v_pk_mul_f32 v[166:167],v[106:107],v[106:107]
v_pk_fma_f32 v[160:161],v[160:161],v[124:125],v[116:117]
v_pk_fma_f32 v[162:163],v[162:163],v[126:127],v[118:119]
v_pk_fma_f32 v[164:165],v[164:165],v[128:129],v[120:121]
v_pk_fma_f32 v[166:167],v[166:167],v[130:131],v[122:123]
v_pk_mul_f32 v[160:161],v[100:101],v[160:161]
v_pk_mul_f32 v[162:163],v[102:103],v[162:163]
v_pk_mul_f32 v[164:165],v[104:105],v[164:165]
v_pk_mul_f32 v[166:167],v[106:107],v[166:167]
v_exp_f32 v160,v160
v_exp_f32 v161,v161
v_exp_f32 v162,v162
v_exp_f32 v163,v163
v_exp_f32 v164,v164
v_exp_f32 v165,v165
v_exp_f32 v166,v166
v_exp_f32 v167,v167
v_pk_add_f32 v[160:161],v[160:161],1.0 op_sel_hi:[1,0]
v_pk_add_f32 v[162:163],v[162:163],1.0 op_sel_hi:[1,0]
v_pk_add_f32 v[164:165],v[164:165],1.0 op_sel_hi:[1,0]
v_pk_add_f32 v[166:167],v[166:167],1.0 op_sel_hi:[1,0]
v_rcp_f32 v160,v160
v_rcp_f32 v161,v161
v_rcp_f32 v162,v162
v_rcp_f32 v163,v163
v_rcp_f32 v164,v164
v_rcp_f32 v165,v165
v_rcp_f32 v166,v166
v_rcp_f32 v167,v167
v_pk_mul_f32 v[100:101],v[100:101],v[160:161]
v_pk_mul_f32 v[102:103],v[102:103],v[162:163]
v_pk_mul_f32 v[104:105],v[104:105],v[164:165]
v_pk_mul_f32 v[106:107],v[106:107],v[166:167]
v_pk_add_f32 v[132:133],v[132:133],v[100:101]
v_pk_add_f32 v[134:135],v[134:135],v[102:103]
v_pk_add_f32 v[136:137],v[136:137],v[104:105]
v_pk_add_f32 v[138:139],v[138:139],v[106:107]
v_pk_fma_f32 v[140:141],v[100:101],v[100:101],v[140:141]
v_pk_fma_f32 v[142:143],v[102:103],v[102:103],v[142:143]
v_pk_fma_f32 v[144:145],v[104:105],v[104:105],v[144:145]
v_pk_fma_f32 v[146:147],v[106:107],v[106:107],v[146:147]
s_branch Lg81
Lx42:
s_and_b32 s79,s2,15
s_mul_i32 s79,s79,1024
s_add_u32 s79,s79,5341184
v_mov_b32 v29,0
s_mov_b64 exec,15
buffer_atomic_add v29,v28,s[20:23],s79 offen sc0 sc1
s_mov_b64 exec,-1
s_nop 1
s_branch Lx43
Lx44:
buffer_store_dwordx4 a[192:195],v25,s[4:7],s80 offen sc1
s_nop 1
s_branch Lx45
Lx46:
buffer_store_dwordx4 a[196:199],v25,s[4:7],s81 offen sc1
s_nop 1
s_branch Lx47
Lx48:
buffer_store_dwordx4 a[200:203],v25,s[4:7],s82 offen sc1
s_nop 1
s_branch Lx49
Lx50:
s_waitcnt vmcnt(13)
s_mov_b64 exec,15
v_cmp_ne_u32 vcc,32,v29
s_mov_b64 exec,-1
s_cbranch_vccz Lj52
s_mov_b64 exec,15
s_mov_b32 s56,0
Lp53:
v_mov_b32 v29,0
buffer_atomic_add v29,v28,s[20:23],s79 offen sc0 sc1
s_waitcnt vmcnt(0)
v_cmp_ne_u32 vcc,32,v29
s_nop 0
s_cbranch_vccz Lpd54
s_add_u32 s56,s56,1
s_cmp_lt_u32 s56,0x40000
s_cbranch_scc1 Lp53
Lpd54:
s_mov_b64 exec,-1
Lj52:
s_nop 1
s_branch Lx51
Lx55:
buffer_store_dwordx4 a[204:207],v25,s[4:7],s83 offen sc1
s_nop 1
s_branch Lx56
Lx57:
buffer_store_dwordx4 a[208:211],v25,s[4:7],s84 offen sc1
s_nop 1
s_branch Lx58
Lx59:
buffer_store_dwordx4 a[212:215],v25,s[4:7],s85 offen sc1
s_nop 1
s_branch Lx60
Lx61:
buffer_store_dwordx4 a[216:219],v25,s[4:7],s86 offen sc1
s_nop 1
s_branch Lx62
Lx64:
buffer_store_dwordx4 a[220:223],v25,s[4:7],s87 offen sc1
s_nop 1
s_branch Lx65
Lx66:
s_mov_b32 s56,0
Ly68:
buffer_load_dwordx2 v[220:221],v20,s[20:23],s69 offen sc1
buffer_load_dwordx2 v[222:223],v20,s[20:23],s69 offen offset:128 sc1
buffer_load_dwordx2 v[224:225],v20,s[20:23],s69 offen offset:256 sc1
buffer_load_dwordx2 v[226:227],v20,s[20:23],s69 offen offset:384 sc1
buffer_load_dwordx2 v[228:229],v20,s[20:23],s69 offen offset:512 sc1
buffer_load_dwordx2 v[230:231],v20,s[20:23],s69 offen offset:640 sc1
buffer_load_dwordx2 v[232:233],v20,s[20:23],s69 offen offset:768 sc1
buffer_load_dwordx2 v[234:235],v20,s[20:23],s69 offen offset:896 sc1
buffer_load_dwordx2 v[236:237],v20,s[20:23],s69 offen offset:1024 sc1
s_waitcnt vmcnt(0)
v_max3_u32 v24,v221,v223,v225
v_max3_u32 v24,v24,v227,v229
v_max3_u32 v24,v24,v231,v233
v_max3_u32 v24,v24,v235,v237
v_cmp_eq_u32 vcc,-1,v24
s_nop 0
s_cbranch_vccz Ly69
s_add_u32 s56,s56,1
s_cmp_lt_u32 s56,0x40000
s_cbranch_scc1 Ly68
Ly69:
s_nop 1
s_branch Lx67
Lx70:
s_waitcnt vmcnt(11)
s_barrier
s_cmp_lg_u32 s24,s63
s_cbranch_scc1 Lj72
s_mov_b64 exec,15
v_mov_b32 v26,1
buffer_atomic_add v26,v28,s[20:23],s89 offen sc1
s_mov_b64 exec,-1
Lj72:
s_nop 1
s_branch Lx71
Lx73:
s_mul_i32 s48,s28,576
s_add_u32 s48,s48,5308416
s_bfm_b64 exec,36,0
buffer_load_dwordx4 v[224:227],v1,s[4:7],s48 offen sc1
s_add_u32 s48,s48,18432
buffer_load_dwordx4 v[228:231],v1,s[4:7],s48 offen sc1
s_add_u32 s48,s48,18432
buffer_load_dwordx4 v[232:235],v1,s[4:7],s48 offen sc1
s_add_u32 s48,s48,18432
buffer_load_dwordx4 v[236:239],v1,s[4:7],s48 offen sc1
s_add_u32 s48,s48,18432
buffer_load_dwordx4 v[240:243],v1,s[4:7],s48 offen sc1
s_add_u32 s48,s48,18432
buffer_load_dwordx4 v[244:247],v1,s[4:7],s48 offen sc1
s_add_u32 s48,s48,18432
buffer_load_dwordx4 v[248:251],v1,s[4:7],s48 offen sc1
s_mov_b64 exec,-1
s_nop 1
s_branch Lx74
Lx75:
v_mov_b32 v27,0
s_mov_b64 exec,1
buffer_atomic_add v27,v28,s[20:23],s90 offen sc0 sc1
s_mov_b64 exec,-1
s_nop 1
s_branch Lx76
Lx78:
s_waitcnt vmcnt(8)
v_pk_add_f32 v[224:225],v[224:225],v[228:229]
v_pk_add_f32 v[226:227],v[226:227],v[230:231]
v_pk_add_f32 v[224:225],v[224:225],v[232:233]
v_pk_add_f32 v[226:227],v[226:227],v[234:235]
v_pk_add_f32 v[224:225],v[224:225],v[236:237]
v_pk_add_f32 v[226:227],v[226:227],v[238:239]
v_pk_add_f32 v[224:225],v[224:225],v[240:241]
v_pk_add_f32 v[226:227],v[226:227],v[242:243]
v_pk_add_f32 v[224:225],v[224:225],v[244:245]
v_pk_add_f32 v[226:227],v[226:227],v[246:247]
v_pk_add_f32 v[224:225],v[224:225],v[248:249]
v_pk_add_f32 v[226:227],v[226:227],v[250:251]
v_add_u32 v31,148032,v1
s_bfm_b64 exec,36,0
ds_write_b128 v31,v[224:227]
s_mov_b64 exec,-1
s_nop 1
s_branch Lx79
Lg80:
v_pk_fma_f32 v[36:37],v[108:109],v[148:149],v[36:37] op_sel_hi:[1,0,1]
v_pk_fma_f32 v[38:39],v[110:111],v[148:149],v[38:39] op_sel_hi:[1,0,1]
v_pk_fma_f32 v[40:41],v[112:113],v[148:149],v[40:41] op_sel_hi:[1,0,1]
v_pk_fma_f32 v[42:43],v[114:115],v[148:149],v[42:43] op_sel_hi:[1,0,1]
v_pk_mul_f32 v[160:161],v[36:37],v[36:37]
v_pk_mul_f32 v[162:163],v[38:39],v[38:39]
v_pk_mul_f32 v[164:165],v[40:41],v[40:41]
v_pk_mul_f32 v[166:167],v[42:43],v[42:43]
v_pk_fma_f32 v[160:161],v[160:161],v[124:125],v[116:117]
v_pk_fma_f32 v[162:163],v[162:163],v[126:127],v[118:119]
v_pk_fma_f32 v[164:165],v[164:165],v[128:129],v[120:121]
v_pk_fma_f32 v[166:167],v[166:167],v[130:131],v[122:123]
Ljt77:
s_add_u32 s101,s3,Ljt77-Ljb41+1536
buffer_load_dword v9,off,s[16:19],s101
v_pk_mul_f32 v[160:161],v[36:37],v[160:161]
v_pk_mul_f32 v[162:163],v[38:39],v[162:163]
v_pk_mul_f32 v[164:165],v[40:41],v[164:165]
v_pk_mul_f32 v[166:167],v[42:43],v[166:167]
v_exp_f32 v160,v160
v_exp_f32 v161,v161
v_exp_f32 v162,v162
v_exp_f32 v163,v163
v_exp_f32 v164,v164
v_exp_f32 v165,v165
v_exp_f32 v166,v166
v_exp_f32 v167,v167
v_pk_add_f32 v[160:161],v[160:161],1.0 op_sel_hi:[1,0]
v_pk_add_f32 v[162:163],v[162:163],1.0 op_sel_hi:[1,0]
v_pk_add_f32 v[164:165],v[164:165],1.0 op_sel_hi:[1,0]
v_pk_add_f32 v[166:167],v[166:167],1.0 op_sel_hi:[1,0]
v_rcp_f32 v160,v160
v_rcp_f32 v161,v161
v_rcp_f32 v162,v162
v_rcp_f32 v163,v163
v_rcp_f32 v164,v164
v_rcp_f32 v165,v165
v_rcp_f32 v166,v166
v_rcp_f32 v167,v167
v_pk_mul_f32 v[36:37],v[36:37],v[160:161]
v_pk_mul_f32 v[38:39],v[38:39],v[162:163]
v_pk_mul_f32 v[40:41],v[40:41],v[164:165]
v_pk_mul_f32 v[42:43],v[42:43],v[166:167]
v_pk_add_f32 v[132:133],v[132:133],v[36:37]
v_pk_add_f32 v[134:135],v[134:135],v[38:39]
v_pk_add_f32 v[136:137],v[136:137],v[40:41]
v_pk_add_f32 v[138:139],v[138:139],v[42:43]
v_pk_fma_f32 v[140:141],v[36:37],v[36:37],v[140:141]
v_pk_fma_f32 v[142:143],v[38:39],v[38:39],v[142:143]
v_pk_fma_f32 v[144:145],v[40:41],v[40:41],v[144:145]
v_pk_fma_f32 v[146:147],v[42:43],v[42:43],v[146:147]
v_pk_fma_f32 v[44:45],v[108:109],v[148:149],v[44:45] op_sel:[0,1,0]
v_pk_fma_f32 v[46:47],v[110:111],v[148:149],v[46:47] op_sel:[0,1,0]
v_pk_fma_f32 v[48:49],v[112:113],v[148:149],v[48:49] op_sel:[0,1,0]
v_pk_fma_f32 v[50:51],v[114:115],v[148:149],v[50:51] op_sel:[0,1,0]
v_pk_mul_f32 v[160:161],v[44:45],v[44:45]
v_pk_mul_f32 v[162:163],v[46:47],v[46:47]
v_pk_mul_f32 v[164:165],v[48:49],v[48:49]
v_pk_mul_f32 v[166:167],v[50:51],v[50:51]
v_pk_fma_f32 v[160:161],v[160:161],v[124:125],v[116:117]
v_pk_fma_f32 v[162:163],v[162:163],v[126:127],v[118:119]
v_pk_fma_f32 v[164:165],v[164:165],v[128:129],v[120:121]
v_pk_fma_f32 v[166:167],v[166:167],v[130:131],v[122:123]
v_pk_mul_f32 v[160:161],v[44:45],v[160:161]
v_pk_mul_f32 v[162:163],v[46:47],v[162:163]
v_pk_mul_f32 v[164:165],v[48:49],v[164:165]
v_pk_mul_f32 v[166:167],v[50:51],v[166:167]
v_exp_f32 v160,v160
v_exp_f32 v161,v161
v_exp_f32 v162,v162
v_exp_f32 v163,v163
v_exp_f32 v164,v164
v_exp_f32 v165,v165
v_exp_f32 v166,v166
v_exp_f32 v167,v167
v_pk_add_f32 v[160:161],v[160:161],1.0 op_sel_hi:[1,0]
v_pk_add_f32 v[162:163],v[162:163],1.0 op_sel_hi:[1,0]
v_pk_add_f32 v[164:165],v[164:165],1.0 op_sel_hi:[1,0]
v_pk_add_f32 v[166:167],v[166:167],1.0 op_sel_hi:[1,0]
v_rcp_f32 v160,v160
v_rcp_f32 v161,v161
v_rcp_f32 v162,v162
v_rcp_f32 v163,v163
v_rcp_f32 v164,v164
v_rcp_f32 v165,v165
v_rcp_f32 v166,v166
v_rcp_f32 v167,v167
v_pk_mul_f32 v[44:45],v[44:45],v[160:161]
v_pk_mul_f32 v[46:47],v[46:47],v[162:163]
v_pk_mul_f32 v[48:49],v[48:49],v[164:165]
v_pk_mul_f32 v[50:51],v[50:51],v[166:167]
v_pk_add_f32 v[132:133],v[132:133],v[44:45]
v_pk_add_f32 v[134:135],v[134:135],v[46:47]
v_pk_add_f32 v[136:137],v[136:137],v[48:49]
v_pk_add_f32 v[138:139],v[138:139],v[50:51]
v_pk_fma_f32 v[140:141],v[44:45],v[44:45],v[140:141]
v_pk_fma_f32 v[142:143],v[46:47],v[46:47],v[142:143]
v_pk_fma_f32 v[144:145],v[48:49],v[48:49],v[144:145]
v_pk_fma_f32 v[146:147],v[50:51],v[50:51],v[146:147]
v_pk_fma_f32 v[52:53],v[108:109],v[150:151],v[52:53] op_sel_hi:[1,0,1]
v_pk_fma_f32 v[54:55],v[110:111],v[150:151],v[54:55] op_sel_hi:[1,0,1]
v_pk_fma_f32 v[56:57],v[112:113],v[150:151],v[56:57] op_sel_hi:[1,0,1]
v_pk_fma_f32 v[58:59],v[114:115],v[150:151],v[58:59] op_sel_hi:[1,0,1]
v_pk_mul_f32 v[160:161],v[52:53],v[52:53]
v_pk_mul_f32 v[162:163],v[54:55],v[54:55]
v_pk_mul_f32 v[164:165],v[56:57],v[56:57]
v_pk_mul_f32 v[166:167],v[58:59],v[58:59]
v_pk_fma_f32 v[160:161],v[160:161],v[124:125],v[116:117]
v_pk_fma_f32 v[162:163],v[162:163],v[126:127],v[118:119]
v_pk_fma_f32 v[164:165],v[164:165],v[128:129],v[120:121]
v_pk_fma_f32 v[166:167],v[166:167],v[130:131],v[122:123]
v_pk_mul_f32 v[160:161],v[52:53],v[160:161]
v_pk_mul_f32 v[162:163],v[54:55],v[162:163]
v_pk_mul_f32 v[164:165],v[56:57],v[164:165]
v_pk_mul_f32 v[166:167],v[58:59],v[166:167]
v_exp_f32 v160,v160
v_exp_f32 v161,v161
v_exp_f32 v162,v162
v_exp_f32 v163,v163
v_exp_f32 v164,v164
v_exp_f32 v165,v165
v_exp_f32 v166,v166
v_exp_f32 v167,v167
v_pk_add_f32 v[160:161],v[160:161],1.0 op_sel_hi:[1,0]
v_pk_add_f32 v[162:163],v[162:163],1.0 op_sel_hi:[1,0]
v_pk_add_f32 v[164:165],v[164:165],1.0 op_sel_hi:[1,0]
v_pk_add_f32 v[166:167],v[166:167],1.0 op_sel_hi:[1,0]
v_rcp_f32 v160,v160
v_rcp_f32 v161,v161
v_rcp_f32 v162,v162
v_rcp_f32 v163,v163
v_rcp_f32 v164,v164
v_rcp_f32 v165,v165
v_rcp_f32 v166,v166
v_rcp_f32 v167,v167
v_pk_mul_f32 v[52:53],v[52:53],v[160:161]
v_pk_mul_f32 v[54:55],v[54:55],v[162:163]
v_pk_mul_f32 v[56:57],v[56:57],v[164:165]
v_pk_mul_f32 v[58:59],v[58:59],v[166:167]
v_pk_add_f32 v[132:133],v[132:133],v[52:53]
v_pk_add_f32 v[134:135],v[134:135],v[54:55]
v_pk_add_f32 v[136:137],v[136:137],v[56:57]
v_pk_add_f32 v[138:139],v[138:139],v[58:59]
v_pk_fma_f32 v[140:141],v[52:53],v[52:53],v[140:141]
v_pk_fma_f32 v[142:143],v[54:55],v[54:55],v[142:143]
v_pk_fma_f32 v[144:145],v[56:57],v[56:57],v[144:145]
v_pk_fma_f32 v[146:147],v[58:59],v[58:59],v[146:147]
v_pk_fma_f32 v[60:61],v[108:109],v[150:151],v[60:61] op_sel:[0,1,0]
v_pk_fma_f32 v[62:63],v[110:111],v[150:151],v[62:63] op_sel:[0,1,0]
v_pk_fma_f32 v[64:65],v[112:113],v[150:151],v[64:65] op_sel:[0,1,0]
v_pk_fma_f32 v[66:67],v[114:115],v[150:151],v[66:67] op_sel:[0,1,0]
v_pk_mul_f32 v[160:161],v[60:61],v[60:61]
v_pk_mul_f32 v[162:163],v[62:63],v[62:63]
v_pk_mul_f32 v[164:165],v[64:65],v[64:65]
v_pk_mul_f32 v[166:167],v[66:67],v[66:67]
v_pk_fma_f32 v[160:161],v[160:161],v[124:125],v[116:117]
v_pk_fma_f32 v[162:163],v[162:163],v[126:127],v[118:119]
v_pk_fma_f32 v[164:165],v[164:165],v[128:129],v[120:121]
v_pk_fma_f32 v[166:167],v[166:167],v[130:131],v[122:123]
v_pk_mul_f32 v[160:161],v[60:61],v[160:161]
v_pk_mul_f32 v[162:163],v[62:63],v[162:163]
v_pk_mul_f32 v[164:165],v[64:65],v[164:165]
v_pk_mul_f32 v[166:167],v[66:67],v[166:167]
v_exp_f32 v160,v160
v_exp_f32 v161,v161
v_exp_f32 v162,v162
v_exp_f32 v163,v163
v_exp_f32 v164,v164
v_exp_f32 v165,v165
v_exp_f32 v166,v166
v_exp_f32 v167,v167
v_pk_add_f32 v[160:161],v[160:161],1.0 op_sel_hi:[1,0]
v_pk_add_f32 v[162:163],v[162:163],1.0 op_sel_hi:[1,0]
v_pk_add_f32 v[164:165],v[164:165],1.0 op_sel_hi:[1,0]
v_pk_add_f32 v[166:167],v[166:167],1.0 op_sel_hi:[1,0]
v_rcp_f32 v160,v160
v_rcp_f32 v161,v161
v_rcp_f32 v162,v162
v_rcp_f32 v163,v163
v_rcp_f32 v164,v164
v_rcp_f32 v165,v165
v_rcp_f32 v166,v166
v_rcp_f32 v167,v167
v_pk_mul_f32 v[60:61],v[60:61],v[160:161]
v_pk_mul_f32 v[62:63],v[62:63],v[162:163]
v_pk_mul_f32 v[64:65],v[64:65],v[164:165]
v_pk_mul_f32 v[66:67],v[66:67],v[166:167]
v_pk_add_f32 v[132:133],v[132:133],v[60:61]
v_pk_add_f32 v[134:135],v[134:135],v[62:63]
v_pk_add_f32 v[136:137],v[136:137],v[64:65]
v_pk_add_f32 v[138:139],v[138:139],v[66:67]
v_pk_fma_f32 v[140:141],v[60:61],v[60:61],v[140:141]
v_pk_fma_f32 v[142:143],v[62:63],v[62:63],v[142:143]
v_pk_fma_f32 v[144:145],v[64:65],v[64:65],v[144:145]
v_pk_fma_f32 v[146:147],v[66:67],v[66:67],v[146:147]
v_pk_fma_f32 v[68:69],v[108:109],v[152:153],v[68:69] op_sel_hi:[1,0,1]
v_pk_fma_f32 v[70:71],v[110:111],v[152:153],v[70:71] op_sel_hi:[1,0,1]
v_pk_fma_f32 v[72:73],v[112:113],v[152:153],v[72:73] op_sel_hi:[1,0,1]
v_pk_fma_f32 v[74:75],v[114:115],v[152:153],v[74:75] op_sel_hi:[1,0,1]
v_pk_mul_f32 v[160:161],v[68:69],v[68:69]
v_pk_mul_f32 v[162:163],v[70:71],v[70:71]
v_pk_mul_f32 v[164:165],v[72:73],v[72:73]
v_pk_mul_f32 v[166:167],v[74:75],v[74:75]
v_pk_fma_f32 v[160:161],v[160:161],v[124:125],v[116:117]
v_pk_fma_f32 v[162:163],v[162:163],v[126:127],v[118:119]
v_pk_fma_f32 v[164:165],v[164:165],v[128:129],v[120:121]
v_pk_fma_f32 v[166:167],v[166:167],v[130:131],v[122:123]
v_pk_mul_f32 v[160:161],v[68:69],v[160:161]
v_pk_mul_f32 v[162:163],v[70:71],v[162:163]
v_pk_mul_f32 v[164:165],v[72:73],v[164:165]
v_pk_mul_f32 v[166:167],v[74:75],v[166:167]
v_exp_f32 v160,v160
v_exp_f32 v161,v161
v_exp_f32 v162,v162
v_exp_f32 v163,v163
v_exp_f32 v164,v164
v_exp_f32 v165,v165
v_exp_f32 v166,v166
v_exp_f32 v167,v167
v_pk_add_f32 v[160:161],v[160:161],1.0 op_sel_hi:[1,0]
v_pk_add_f32 v[162:163],v[162:163],1.0 op_sel_hi:[1,0]
v_pk_add_f32 v[164:165],v[164:165],1.0 op_sel_hi:[1,0]
v_pk_add_f32 v[166:167],v[166:167],1.0 op_sel_hi:[1,0]
v_rcp_f32 v160,v160
v_rcp_f32 v161,v161
v_rcp_f32 v162,v162
v_rcp_f32 v163,v163
v_rcp_f32 v164,v164
v_rcp_f32 v165,v165
v_rcp_f32 v166,v166
v_rcp_f32 v167,v167
v_pk_mul_f32 v[68:69],v[68:69],v[160:161]
v_pk_mul_f32 v[70:71],v[70:71],v[162:163]
v_pk_mul_f32 v[72:73],v[72:73],v[164:165]
v_pk_mul_f32 v[74:75],v[74:75],v[166:167]
v_pk_add_f32 v[132:133],v[132:133],v[68:69]
v_pk_add_f32 v[134:135],v[134:135],v[70:71]
v_pk_add_f32 v[136:137],v[136:137],v[72:73]
v_pk_add_f32 v[138:139],v[138:139],v[74:75]
v_pk_fma_f32 v[140:141],v[68:69],v[68:69],v[140:141]
v_pk_fma_f32 v[142:143],v[70:71],v[70:71],v[142:143]
v_pk_fma_f32 v[144:145],v[72:73],v[72:73],v[144:145]
v_pk_fma_f32 v[146:147],v[74:75],v[74:75],v[146:147]
v_pk_fma_f32 v[76:77],v[108:109],v[152:153],v[76:77] op_sel:[0,1,0]
v_pk_fma_f32 v[78:79],v[110:111],v[152:153],v[78:79] op_sel:[0,1,0]
v_pk_fma_f32 v[80:81],v[112:113],v[152:153],v[80:81] op_sel:[0,1,0]
v_pk_fma_f32 v[82:83],v[114:115],v[152:153],v[82:83] op_sel:[0,1,0]
v_pk_mul_f32 v[160:161],v[76:77],v[76:77]
v_pk_mul_f32 v[162:163],v[78:79],v[78:79]
v_pk_mul_f32 v[164:165],v[80:81],v[80:81]
v_pk_mul_f32 v[166:167],v[82:83],v[82:83]
v_pk_fma_f32 v[160:161],v[160:161],v[124:125],v[116:117]
v_pk_fma_f32 v[162:163],v[162:163],v[126:127],v[118:119]
v_pk_fma_f32 v[164:165],v[164:165],v[128:129],v[120:121]
v_pk_fma_f32 v[166:167],v[166:167],v[130:131],v[122:123]
v_pk_mul_f32 v[160:161],v[76:77],v[160:161]
v_pk_mul_f32 v[162:163],v[78:79],v[162:163]
v_pk_mul_f32 v[164:165],v[80:81],v[164:165]
v_pk_mul_f32 v[166:167],v[82:83],v[166:167]
v_exp_f32 v160,v160
v_exp_f32 v161,v161
v_exp_f32 v162,v162
v_exp_f32 v163,v163
v_exp_f32 v164,v164
v_exp_f32 v165,v165
v_exp_f32 v166,v166
v_exp_f32 v167,v167
v_pk_add_f32 v[160:161],v[160:161],1.0 op_sel_hi:[1,0]
v_pk_add_f32 v[162:163],v[162:163],1.0 op_sel_hi:[1,0]
v_pk_add_f32 v[164:165],v[164:165],1.0 op_sel_hi:[1,0]
v_pk_add_f32 v[166:167],v[166:167],1.0 op_sel_hi:[1,0]
v_rcp_f32 v160,v160
v_rcp_f32 v161,v161
v_rcp_f32 v162,v162
v_rcp_f32 v163,v163
v_rcp_f32 v164,v164
v_rcp_f32 v165,v165
v_rcp_f32 v166,v166
v_rcp_f32 v167,v167
v_pk_mul_f32 v[76:77],v[76:77],v[160:161]
v_pk_mul_f32 v[78:79],v[78:79],v[162:163]
v_pk_mul_f32 v[80:81],v[80:81],v[164:165]
v_pk_mul_f32 v[82:83],v[82:83],v[166:167]
v_pk_add_f32 v[132:133],v[132:133],v[76:77]
v_pk_add_f32 v[134:135],v[134:135],v[78:79]
v_pk_add_f32 v[136:137],v[136:137],v[80:81]
v_pk_add_f32 v[138:139],v[138:139],v[82:83]
v_pk_fma_f32 v[140:141],v[76:77],v[76:77],v[140:141]
v_pk_fma_f32 v[142:143],v[78:79],v[78:79],v[142:143]
v_pk_fma_f32 v[144:145],v[80:81],v[80:81],v[144:145]
v_pk_fma_f32 v[146:147],v[82:83],v[82:83],v[146:147]
v_pk_fma_f32 v[84:85],v[108:109],v[154:155],v[84:85] op_sel_hi:[1,0,1]
v_pk_fma_f32 v[86:87],v[110:111],v[154:155],v[86:87] op_sel_hi:[1,0,1]
v_pk_fma_f32 v[88:89],v[112:113],v[154:155],v[88:89] op_sel_hi:[1,0,1]
v_pk_fma_f32 v[90:91],v[114:115],v[154:155],v[90:91] op_sel_hi:[1,0,1]
v_pk_mul_f32 v[160:161],v[84:85],v[84:85]
v_pk_mul_f32 v[162:163],v[86:87],v[86:87]
v_pk_mul_f32 v[164:165],v[88:89],v[88:89]
v_pk_mul_f32 v[166:167],v[90:91],v[90:91]
v_pk_fma_f32 v[160:161],v[160:161],v[124:125],v[116:117]
v_pk_fma_f32 v[162:163],v[162:163],v[126:127],v[118:119]
v_pk_fma_f32 v[164:165],v[164:165],v[128:129],v[120:121]
v_pk_fma_f32 v[166:167],v[166:167],v[130:131],v[122:123]
v_pk_mul_f32 v[160:161],v[84:85],v[160:161]
v_pk_mul_f32 v[162:163],v[86:87],v[162:163]
v_pk_mul_f32 v[164:165],v[88:89],v[164:165]
v_pk_mul_f32 v[166:167],v[90:91],v[166:167]
v_exp_f32 v160,v160
v_exp_f32 v161,v161
v_exp_f32 v162,v162
v_exp_f32 v163,v163
v_exp_f32 v164,v164
v_exp_f32 v165,v165
v_exp_f32 v166,v166
v_exp_f32 v167,v167
v_pk_add_f32 v[160:161],v[160:161],1.0 op_sel_hi:[1,0]
v_pk_add_f32 v[162:163],v[162:163],1.0 op_sel_hi:[1,0]
v_pk_add_f32 v[164:165],v[164:165],1.0 op_sel_hi:[1,0]
v_pk_add_f32 v[166:167],v[166:167],1.0 op_sel_hi:[1,0]
v_rcp_f32 v160,v160
v_rcp_f32 v161,v161
v_rcp_f32 v162,v162
v_rcp_f32 v163,v163
v_rcp_f32 v164,v164
v_rcp_f32 v165,v165
v_rcp_f32 v166,v166
v_rcp_f32 v167,v167
v_pk_mul_f32 v[84:85],v[84:85],v[160:161]
v_pk_mul_f32 v[86:87],v[86:87],v[162:163]
v_pk_mul_f32 v[88:89],v[88:89],v[164:165]
v_pk_mul_f32 v[90:91],v[90:91],v[166:167]
v_pk_add_f32 v[132:133],v[132:133],v[84:85]
v_pk_add_f32 v[134:135],v[134:135],v[86:87]
v_pk_add_f32 v[136:137],v[136:137],v[88:89]
v_pk_add_f32 v[138:139],v[138:139],v[90:91]
v_pk_fma_f32 v[140:141],v[84:85],v[84:85],v[140:141]
v_pk_fma_f32 v[142:143],v[86:87],v[86:87],v[142:143]
v_pk_fma_f32 v[144:145],v[88:89],v[88:89],v[144:145]
v_pk_fma_f32 v[146:147],v[90:91],v[90:91],v[146:147]
v_pk_fma_f32 v[92:93],v[108:109],v[154:155],v[92:93] op_sel:[0,1,0]
v_pk_fma_f32 v[94:95],v[110:111],v[154:155],v[94:95] op_sel:[0,1,0]
v_pk_fma_f32 v[96:97],v[112:113],v[154:155],v[96:97] op_sel:[0,1,0]
v_pk_fma_f32 v[98:99],v[114:115],v[154:155],v[98:99] op_sel:[0,1,0]
v_pk_mul_f32 v[160:161],v[92:93],v[92:93]
v_pk_mul_f32 v[162:163],v[94:95],v[94:95]
v_pk_mul_f32 v[164:165],v[96:97],v[96:97]
v_pk_mul_f32 v[166:167],v[98:99],v[98:99]
v_pk_fma_f32 v[160:161],v[160:161],v[124:125],v[116:117]
v_pk_fma_f32 v[162:163],v[162:163],v[126:127],v[118:119]
v_pk_fma_f32 v[164:165],v[164:165],v[128:129],v[120:121]
v_pk_fma_f32 v[166:167],v[166:167],v[130:131],v[122:123]
v_pk_mul_f32 v[160:161],v[92:93],v[160:161]
v_pk_mul_f32 v[162:163],v[94:95],v[162:163]
v_pk_mul_f32 v[164:165],v[96:97],v[164:165]
v_pk_mul_f32 v[166:167],v[98:99],v[166:167]
v_exp_f32 v160,v160
v_exp_f32 v161,v161
v_exp_f32 v162,v162
v_exp_f32 v163,v163
v_exp_f32 v164,v164
v_exp_f32 v165,v165
v_exp_f32 v166,v166
v_exp_f32 v167,v167
v_pk_add_f32 v[160:161],v[160:161],1.0 op_sel_hi:[1,0]
v_pk_add_f32 v[162:163],v[162:163],1.0 op_sel_hi:[1,0]
v_pk_add_f32 v[164:165],v[164:165],1.0 op_sel_hi:[1,0]
v_pk_add_f32 v[166:167],v[166:167],1.0 op_sel_hi:[1,0]
v_rcp_f32 v160,v160
v_rcp_f32 v161,v161
v_rcp_f32 v162,v162
v_rcp_f32 v163,v163
v_rcp_f32 v164,v164
v_rcp_f32 v165,v165
v_rcp_f32 v166,v166
v_rcp_f32 v167,v167
v_pk_mul_f32 v[92:93],v[92:93],v[160:161]
v_pk_mul_f32 v[94:95],v[94:95],v[162:163]
v_pk_mul_f32 v[96:97],v[96:97],v[164:165]
v_pk_mul_f32 v[98:99],v[98:99],v[166:167]
v_pk_add_f32 v[132:133],v[132:133],v[92:93]
v_pk_add_f32 v[134:135],v[134:135],v[94:95]
v_pk_add_f32 v[136:137],v[136:137],v[96:97]
v_pk_add_f32 v[138:139],v[138:139],v[98:99]
v_pk_fma_f32 v[140:141],v[92:93],v[92:93],v[140:141]
v_pk_fma_f32 v[142:143],v[94:95],v[94:95],v[142:143]
v_pk_fma_f32 v[144:145],v[96:97],v[96:97],v[144:145]
v_pk_fma_f32 v[146:147],v[98:99],v[98:99],v[146:147]
v_pk_fma_f32 v[100:101],v[108:109],v[156:157],v[100:101] op_sel_hi:[1,0,1]
v_pk_fma_f32 v[102:103],v[110:111],v[156:157],v[102:103] op_sel_hi:[1,0,1]
v_pk_fma_f32 v[104:105],v[112:113],v[156:157],v[104:105] op_sel_hi:[1,0,1]
v_pk_fma_f32 v[106:107],v[114:115],v[156:157],v[106:107] op_sel_hi:[1,0,1]
v_pk_mul_f32 v[160:161],v[100:101],v[100:101]
v_pk_mul_f32 v[162:163],v[102:103],v[102:103]
v_pk_mul_f32 v[164:165],v[104:105],v[104:105]
v_pk_mul_f32 v[166:167],v[106:107],v[106:107]
v_pk_fma_f32 v[160:161],v[160:161],v[124:125],v[116:117]
v_pk_fma_f32 v[162:163],v[162:163],v[126:127],v[118:119]
v_pk_fma_f32 v[164:165],v[164:165],v[128:129],v[120:121]
v_pk_fma_f32 v[166:167],v[166:167],v[130:131],v[122:123]
v_pk_mul_f32 v[160:161],v[100:101],v[160:161]
v_pk_mul_f32 v[162:163],v[102:103],v[162:163]
v_pk_mul_f32 v[164:165],v[104:105],v[164:165]
v_pk_mul_f32 v[166:167],v[106:107],v[166:167]
v_exp_f32 v160,v160
v_exp_f32 v161,v161
v_exp_f32 v162,v162
v_exp_f32 v163,v163
v_exp_f32 v164,v164
v_exp_f32 v165,v165
v_exp_f32 v166,v166
v_exp_f32 v167,v167
v_pk_add_f32 v[160:161],v[160:161],1.0 op_sel_hi:[1,0]
v_pk_add_f32 v[162:163],v[162:163],1.0 op_sel_hi:[1,0]
v_pk_add_f32 v[164:165],v[164:165],1.0 op_sel_hi:[1,0]
v_pk_add_f32 v[166:167],v[166:167],1.0 op_sel_hi:[1,0]
v_rcp_f32 v160,v160
v_rcp_f32 v161,v161
v_rcp_f32 v162,v162
v_rcp_f32 v163,v163
v_rcp_f32 v164,v164
v_rcp_f32 v165,v165
v_rcp_f32 v166,v166
v_rcp_f32 v167,v167
v_pk_mul_f32 v[100:101],v[100:101],v[160:161]
v_pk_mul_f32 v[102:103],v[102:103],v[162:163]
v_pk_mul_f32 v[104:105],v[104:105],v[164:165]
v_pk_mul_f32 v[106:107],v[106:107],v[166:167]
v_pk_add_f32 v[132:133],v[132:133],v[100:101]
v_pk_add_f32 v[134:135],v[134:135],v[102:103]
v_pk_add_f32 v[136:137],v[136:137],v[104:105]
v_pk_add_f32 v[138:139],v[138:139],v[106:107]
v_pk_fma_f32 v[140:141],v[100:101],v[100:101],v[140:141]
v_pk_fma_f32 v[142:143],v[102:103],v[102:103],v[142:143]
v_pk_fma_f32 v[144:145],v[104:105],v[104:105],v[144:145]
v_pk_fma_f32 v[146:147],v[106:107],v[106:107],v[146:147]
Lg81:
v_add_f32_dpp v160,v132,v132 row_ror:8 row_mask:0xf bank_mask:0x3
v_add_f32_dpp v162,v133,v133 row_ror:8 row_mask:0xf bank_mask:0x3
v_add_f32_dpp v164,v134,v134 row_ror:8 row_mask:0xf bank_mask:0x3
v_add_f32_dpp v166,v135,v135 row_ror:8 row_mask:0xf bank_mask:0x3
v_add_f32_dpp v160,v136,v136 row_ror:8 row_mask:0xf bank_mask:0xc
v_add_f32_dpp v162,v137,v137 row_ror:8 row_mask:0xf bank_mask:0xc
v_add_f32_dpp v164,v138,v138 row_ror:8 row_mask:0xf bank_mask:0xc
v_add_f32_dpp v166,v139,v139 row_ror:8 row_mask:0xf bank_mask:0xc
v_add_f32_dpp v161,v140,v140 row_ror:8 row_mask:0xf bank_mask:0x3
v_add_f32_dpp v163,v141,v141 row_ror:8 row_mask:0xf bank_mask:0x3
v_add_f32_dpp v165,v142,v142 row_ror:8 row_mask:0xf bank_mask:0x3
v_add_f32_dpp v167,v143,v143 row_ror:8 row_mask:0xf bank_mask:0x3
v_add_f32_dpp v161,v144,v144 row_ror:8 row_mask:0xf bank_mask:0xc
v_add_f32_dpp v163,v145,v145 row_ror:8 row_mask:0xf bank_mask:0xc
v_add_f32_dpp v165,v146,v146 row_ror:8 row_mask:0xf bank_mask:0xc
v_add_f32_dpp v167,v147,v147 row_ror:8 row_mask:0xf bank_mask:0xc
v_add_f32_dpp v168,v160,v160 row_shl:4 row_mask:0xf bank_mask:0x5
v_add_f32_dpp v169,v161,v161 row_shl:4 row_mask:0xf bank_mask:0x5
v_add_f32_dpp v170,v162,v162 row_shl:4 row_mask:0xf bank_mask:0x5
v_add_f32_dpp v171,v163,v163 row_shl:4 row_mask:0xf bank_mask:0x5
v_add_f32_dpp v168,v164,v164 row_shr:4 row_mask:0xf bank_mask:0xa
v_add_f32_dpp v169,v165,v165 row_shr:4 row_mask:0xf bank_mask:0xa
v_add_f32_dpp v170,v166,v166 row_shr:4 row_mask:0xf bank_mask:0xa
v_add_f32_dpp v171,v167,v167 row_shr:4 row_mask:0xf bank_mask:0xa
v_add_f32_dpp v168,v168,v168 quad_perm:[1,0,3,2] row_mask:0xf bank_mask:0xf
v_add_f32_dpp v169,v169,v169 quad_perm:[1,0,3,2] row_mask:0xf bank_mask:0xf
v_add_f32_dpp v170,v170,v170 quad_perm:[1,0,3,2] row_mask:0xf bank_mask:0xf
v_add_f32_dpp v171,v171,v171 quad_perm:[1,0,3,2] row_mask:0xf bank_mask:0xf
v_add_f32_dpp v168,v168,v168 quad_perm:[2,3,0,1] row_mask:0xf bank_mask:0xf
v_add_f32_dpp v169,v169,v169 quad_perm:[2,3,0,1] row_mask:0xf bank_mask:0xf
v_add_f32_dpp v170,v170,v170 quad_perm:[2,3,0,1] row_mask:0xf bank_mask:0xf
v_add_f32_dpp v171,v171,v171 quad_perm:[2,3,0,1] row_mask:0xf bank_mask:0xf
s_mov_b32 exec_lo,0x11111111
s_mov_b32 exec_hi,0x11111111
buffer_store_dwordx4 v[168:171],v30,s[20:23],s73 offen sc1
s_mov_b64 exec,-1
mf v[108:111],v[188:191],a[0:3],0
ds_read_b128 v[180:183],v1 offset:22528
ds_read_b128 v[184:187],v1 offset:31744
mf v[108:111],v[192:195],a[8:11],v[108:111]
v_lshrrev_b32 v23,2,v4
v_lshlrev_b32 v23,8,v23
mf v[112:115],v[192:195],a[12:15],0
v_lshl_add_u32 v23,v5,6,v23
v_and_b32 v24,3,v4
mf v[112:115],v[188:191],a[4:7],v[112:115]
v_lshl_add_u32 v23,v24,4,v23
s_waitcnt lgkmcnt(4)
mf v[116:119],v[196:199],a[0:3],0
s_add_u32 s71,s70,24576
buffer_load_dwordx4 a[244:247],v1,s[4:7],s71 offen offset:1024
mf v[116:119],v[200:203],a[8:11],v[116:119]
ds_read_b128 v[188:191],v1 offset:23552
ds_read_b128 v[192:195],v1 offset:32768
mf v[120:123],v[200:203],a[12:15],0
v_and_b32 v24,1,v4
v_lshl_add_u32 v24,v24,3,v22
mf v[120:123],v[196:199],a[4:7],v[120:123]
v_and_b32 v25,2,v4
v_lshl_add_u32 v24,v25,5,v24
mf v[124:127],v[204:207],a[0:3],0
buffer_load_dwordx4 a[248:251],v1,s[4:7],s71 offen offset:2048
mf v[124:127],v[208:211],a[8:11],v[124:127]
ds_read_b128 v[196:199],v1 offset:24576
ds_read_b128 v[200:203],v1 offset:33792
mf v[128:131],v[208:211],a[12:15],0
ds_read_b64 v[26:27],v24 offset:128
s_lshl_b32 s73,s28,4
mf v[128:131],v[204:207],a[4:7],v[128:131]
s_add_u32 s73,s73,s27
s_waitcnt lgkmcnt(5)
mf v[132:135],v[212:215],a[0:3],0
buffer_load_dwordx4 a[252:255],v1,s[4:7],s71 offen offset:3072
mf v[132:135],v[216:219],a[8:11],v[132:135]
ds_read_b128 v[204:207],v1 offset:25600
ds_read_b128 v[208:211],v1 offset:34816
mf v[136:139],v[216:219],a[12:15],0
s_mul_i32 s73,s73,36864
s_add_u32 s73,s73,s61
mf v[136:139],v[212:215],a[4:7],v[136:139]
s_add_u32 s79,s73,5570560
v_add_u32 v21,s61,v6
mf v[140:143],v[180:183],a[0:3],0
ds_read_b128 v[212:215],v1 offset:26624
ds_read_b128 v[216:219],v1 offset:35840
mf v[140:143],v[184:187],a[8:11],v[140:143]
s_mul_i32 s74,s28,1024
s_add_u32 s74,s74,5373952
mf v[144:147],v[184:187],a[12:15],0
s_and_b32 s98,s27,3
s_mul_i32 s98,s98,256
mf v[144:147],v[180:183],a[4:7],v[144:147]
s_add_u32 s98,s98,s74
s_waitcnt lgkmcnt(5)
mf v[148:151],v[188:191],a[0:3],0
s_waitcnt vmcnt(14)
s_barrier
ds_read_b128 v[180:183],v6
ds_read_b128 v[184:187],v6 offset:9216
mf v[148:151],v[192:195],a[8:11],v[148:151]
s_add_u32 s60,s66,258048
s_add_u32 m0,s61,110592
mf v[152:155],v[192:195],a[12:15],0
buffer_load_dwordx4 v1,s[4:7],s60 offen lds
mf v[152:155],v[188:191],a[4:7],v[152:155]
s_mov_b32 s56,0
s_waitcnt lgkmcnt(6)
mf v[156:159],v[196:199],a[0:3],0
ds_read_b128 v[188:191],v6 offset:1024
ds_read_b128 v[192:195],v6 offset:10240
mf v[156:159],v[200:203],a[8:11],v[156:159]
v_mul_f32 v26,v26,v26
v_mul_f32 v27,v27,v27
mf v[160:163],v[200:203],a[12:15],0
buffer_load_dwordx4 v1,s[4:7],s60 offen offset:1024 lds
mf v[160:163],v[196:199],a[4:7],v[160:163]
s_waitcnt lgkmcnt(4)
mf v[164:167],v[204:207],a[0:3],0
ds_read_b128 v[196:199],v6 offset:2048
ds_read_b128 v[200:203],v6 offset:11264
mf v[164:167],v[208:211],a[8:11],v[164:167]
v_rcp_f32 v26,v26
mf v[168:171],v[208:211],a[12:15],0
buffer_load_dwordx4 v1,s[4:7],s60 offen offset:2048 lds
mf v[168:171],v[204:207],a[4:7],v[168:171]
v_rcp_f32 v27,v27
mf v[172:175],v[212:215],a[0:3],0
ds_read_b128 v[204:207],v6 offset:3072
ds_read_b128 v[208:211],v6 offset:12288
mf v[172:175],v[216:219],a[8:11],v[172:175]
mf v[176:179],v[216:219],a[12:15],0
buffer_load_dwordx4 v1,s[4:7],s60 offen offset:3072 lds
mf v[176:179],v[212:215],a[4:7],v[176:179]
s_add_u32 m0,s61,114688
s_barrier
s_waitcnt lgkmcnt(4)
mf v[108:111],v[180:183],a[16:19],v[108:111]
ds_read_b128 v[212:215],v6 offset:4096
ds_read_b128 v[216:219],v6 offset:13312
mf v[108:111],v[184:187],a[24:27],v[108:111]
mf v[112:115],v[184:187],a[28:31],v[112:115]
buffer_load_dwordx4 v2,s[4:7],s60 offen lds
mf v[112:115],v[180:183],a[20:23],v[112:115]
mf v[116:119],v[188:191],a[16:19],v[116:119]
ds_read_b128 v[180:183],v6 offset:5120
ds_read_b128 v[184:187],v6 offset:14336
mf v[116:119],v[192:195],a[24:27],v[116:119]
mf v[120:123],v[192:195],a[28:31],v[120:123]
buffer_load_dwordx4 v2,s[4:7],s60 offen offset:1024 lds
mf v[120:123],v[188:191],a[20:23],v[120:123]
s_waitcnt lgkmcnt(4)
mf v[124:127],v[196:199],a[16:19],v[124:127]
ds_read_b128 v[188:191],v6 offset:6144
ds_read_b128 v[192:195],v6 offset:15360
mf v[124:127],v[200:203],a[24:27],v[124:127]
mf v[128:131],v[200:203],a[28:31],v[128:131]
buffer_load_dwordx4 v[236:239],v23,s[20:23],s72 offen sc1
mf v[128:131],v[196:199],a[20:23],v[128:131]
mf v[132:135],v[204:207],a[16:19],v[132:135]
ds_read_b128 v[196:199],v6 offset:7168
ds_read_b128 v[200:203],v6 offset:16384
mf v[132:135],v[208:211],a[24:27],v[132:135]
mf v[136:139],v[208:211],a[28:31],v[136:139]
buffer_load_dwordx4 v[240:243],v23,s[20:23],s72 offen offset:1024 sc1
mf v[136:139],v[204:207],a[20:23],v[136:139]
s_waitcnt lgkmcnt(4)
mf v[140:143],v[212:215],a[16:19],v[140:143]
ds_read_b128 v[204:207],v6 offset:8192
ds_read_b128 v[208:211],v6 offset:17408
mf v[140:143],v[216:219],a[24:27],v[140:143]
mf v[144:147],v[216:219],a[28:31],v[144:147]
buffer_load_dwordx4 v[244:247],v23,s[20:23],s72 offen offset:2048 sc1
mf v[144:147],v[212:215],a[20:23],v[144:147]
mf v[148:151],v[180:183],a[16:19],v[148:151]
ds_read_b128 v[212:215],v6 offset:18432
ds_read_b128 v[216:219],v6 offset:27648
mf v[148:151],v[184:187],a[24:27],v[148:151]
mf v[152:155],v[184:187],a[28:31],v[152:155]
buffer_load_dwordx4 v[248:251],v23,s[20:23],s72 offen offset:3072 sc1
mf v[152:155],v[180:183],a[20:23],v[152:155]
s_waitcnt lgkmcnt(4)
mf v[156:159],v[188:191],a[16:19],v[156:159]
ds_read_b128 v[180:183],v6 offset:19456
ds_read_b128 v[184:187],v6 offset:28672
mf v[156:159],v[192:195],a[24:27],v[156:159]
mf v[160:163],v[192:195],a[28:31],v[160:163]
buffer_load_dwordx4 v2,s[4:7],s60 offen offset:2048 lds
mf v[160:163],v[188:191],a[20:23],v[160:163]
mf v[164:167],v[196:199],a[16:19],v[164:167]
ds_read_b128 v[188:191],v6 offset:20480
ds_read_b128 v[192:195],v6 offset:29696
mf v[164:167],v[200:203],a[24:27],v[164:167]
mf v[168:171],v[200:203],a[28:31],v[168:171]
buffer_load_dwordx4 v2,s[4:7],s60 offen offset:3072 lds
mf v[168:171],v[196:199],a[20:23],v[168:171]
s_add_u32 m0,s61,118784
s_waitcnt lgkmcnt(4)
mf v[172:175],v[204:207],a[16:19],v[172:175]
ds_read_b128 v[196:199],v6 offset:21504
ds_read_b128 v[200:203],v6 offset:30720
mf v[172:175],v[208:211],a[24:27],v[172:175]
mf v[176:179],v[208:211],a[28:31],v[176:179]
buffer_load_dwordx4 v3,s[4:7],s60 offen lds
mf v[176:179],v[204:207],a[20:23],v[176:179]
s_add_u32 s60,s66,294912
s_add_u32 m0,s61,0
mf v[108:111],v[212:215],a[32:35],v[108:111]
ds_read_b128 v[204:207],v6 offset:22528
ds_read_b128 v[208:211],v6 offset:31744
mf v[108:111],v[216:219],a[40:43],v[108:111]
mf v[112:115],v[216:219],a[44:47],v[112:115]
buffer_load_dwordx4 v1,s[4:7],s60 offen lds
mf v[112:115],v[212:215],a[36:39],v[112:115]
s_waitcnt lgkmcnt(4)
mf v[116:119],v[180:183],a[32:35],v[116:119]
ds_read_b128 v[212:215],v6 offset:23552
ds_read_b128 v[216:219],v6 offset:32768
mf v[116:119],v[184:187],a[40:43],v[116:119]
mf v[120:123],v[184:187],a[44:47],v[120:123]
buffer_load_dwordx4 v1,s[4:7],s60 offen offset:1024 lds
mf v[120:123],v[180:183],a[36:39],v[120:123]
mf v[124:127],v[188:191],a[32:35],v[124:127]
ds_read_b128 v[180:183],v6 offset:24576
ds_read_b128 v[184:187],v6 offset:33792
mf v[124:127],v[192:195],a[40:43],v[124:127]
mf v[128:131],v[192:195],a[44:47],v[128:131]
buffer_load_dwordx4 v1,s[4:7],s60 offen offset:2048 lds
mf v[128:131],v[188:191],a[36:39],v[128:131]
s_waitcnt lgkmcnt(4)
mf v[132:135],v[196:199],a[32:35],v[132:135]
ds_read_b128 v[188:191],v6 offset:25600
ds_read_b128 v[192:195],v6 offset:34816
mf v[132:135],v[200:203],a[40:43],v[132:135]
mf v[136:139],v[200:203],a[44:47],v[136:139]
buffer_load_dwordx4 v1,s[4:7],s60 offen offset:3072 lds
mf v[136:139],v[196:199],a[36:39],v[136:139]
s_add_u32 m0,s61,4096
mf v[140:143],v[204:207],a[32:35],v[140:143]
ds_read_b128 v[196:199],v6 offset:26624
ds_read_b128 v[200:203],v6 offset:35840
mf v[140:143],v[208:211],a[40:43],v[140:143]
mf v[144:147],v[208:211],a[44:47],v[144:147]
buffer_load_dwordx4 v2,s[4:7],s60 offen lds
mf v[144:147],v[204:207],a[36:39],v[144:147]
s_waitcnt lgkmcnt(4)
mf v[148:151],v[212:215],a[32:35],v[148:151]
s_waitcnt vmcnt(23)
s_barrier
ds_read_b128 v[204:207],v7
ds_read_b128 v[208:211],v7 offset:9216
mf v[148:151],v[216:219],a[40:43],v[148:151]
mf v[152:155],v[216:219],a[44:47],v[152:155]
buffer_load_dwordx4 v2,s[4:7],s60 offen offset:1024 lds
mf v[152:155],v[212:215],a[36:39],v[152:155]
s_waitcnt vmcnt(9)
Lz85:
v_max3_u32 v25,v237,v239,v241
v_max3_u32 v25,v25,v243,v245
v_max3_u32 v25,v25,v247,v249
v_max_u32_e64 v25,v25,v251
v_cmp_eq_u32 vcc,-1,v25
s_nop 0
s_cbranch_vccz Lz86
s_add_u32 s56,s56,1
s_cmp_gt_u32 s56,0x40000
s_cbranch_scc1 Lz86
buffer_load_dwordx4 v[236:239],v23,s[20:23],s72 offen sc1
buffer_load_dwordx4 v[240:243],v23,s[20:23],s72 offen offset:1024 sc1
buffer_load_dwordx4 v[244:247],v23,s[20:23],s72 offen offset:2048 sc1
buffer_load_dwordx4 v[248:251],v23,s[20:23],s72 offen offset:3072 sc1
s_waitcnt vmcnt(0)
s_branch Lz85
Lz86:
v_pk_add_f32 v[236:237],v[236:237],v[240:241]
v_pk_add_f32 v[244:245],v[244:245],v[248:249]
v_pk_add_f32 v[238:239],v[238:239],v[242:243]
v_pk_add_f32 v[246:247],v[246:247],v[250:251]
v_pk_add_f32 v[236:237],v[236:237],v[244:245]
v_pk_add_f32 v[238:239],v[238:239],v[246:247]
s_nop 0
s_nop 0
v_add_f32_dpp v236,v236,v236 row_ror:4 row_mask:0xf bank_mask:0xf
v_add_f32_dpp v237,v237,v237 row_ror:4 row_mask:0xf bank_mask:0xf
v_add_f32_dpp v238,v238,v238 row_ror:4 row_mask:0xf bank_mask:0xf
v_add_f32_dpp v239,v239,v239 row_ror:4 row_mask:0xf bank_mask:0xf
v_add_f32_dpp v236,v236,v236 row_ror:8 row_mask:0xf bank_mask:0xf
v_add_f32_dpp v237,v237,v237 row_ror:8 row_mask:0xf bank_mask:0xf
v_add_f32_dpp v238,v238,v238 row_ror:8 row_mask:0xf bank_mask:0xf
v_add_f32_dpp v239,v239,v239 row_ror:8 row_mask:0xf bank_mask:0xf
v_mul_f32 v236,0xb9e38e39,v236
v_mul_f32 v237,0x39e38e39,v237
v_mul_f32 v238,0xb9e38e39,v238
v_mul_f32 v239,0x39e38e39,v239
v_fma_f32 v237,-v236,v236,v237
v_fma_f32 v239,-v238,v238,v239
v_max_f32 v237,0,v237
v_max_f32 v239,0,v239
v_fmamk_f32 v237,v26,0x3727c5ac,v237
v_fmamk_f32 v239,v27,0x3727c5ac,v239
v_rsq_f32 v237,v237
v_rsq_f32 v239,v239
v_mul_f32 v236,v236,v237
v_mul_f32 v238,v238,v239
v_mov_b32_dpp v220,v237 quad_perm:[0,0,0,0] row_mask:0xf bank_mask:0xf
v_mov_b32_dpp v221,v239 quad_perm:[0,0,0,0] row_mask:0xf bank_mask:0xf
v_mov_b32_dpp v222,v237 quad_perm:[1,1,1,1] row_mask:0xf bank_mask:0xf
v_mov_b32_dpp v223,v239 quad_perm:[1,1,1,1] row_mask:0xf bank_mask:0xf
v_mov_b32_dpp v224,v237 quad_perm:[2,2,2,2] row_mask:0xf bank_mask:0xf
v_mov_b32_dpp v225,v239 quad_perm:[2,2,2,2] row_mask:0xf bank_mask:0xf
v_mov_b32_dpp v226,v237 quad_perm:[3,3,3,3] row_mask:0xf bank_mask:0xf
v_mov_b32_dpp v227,v239 quad_perm:[3,3,3,3] row_mask:0xf bank_mask:0xf
v_mov_b32_dpp v228,v236 quad_perm:[0,0,0,0] row_mask:0xf bank_mask:0xf
v_mov_b32_dpp v229,v238 quad_perm:[0,0,0,0] row_mask:0xf bank_mask:0xf
v_mov_b32_dpp v230,v236 quad_perm:[1,1,1,1] row_mask:0xf bank_mask:0xf
v_mov_b32_dpp v231,v238 quad_perm:[1,1,1,1] row_mask:0xf bank_mask:0xf
v_mov_b32_dpp v232,v236 quad_perm:[2,2,2,2] row_mask:0xf bank_mask:0xf
v_mov_b32_dpp v233,v238 quad_perm:[2,2,2,2] row_mask:0xf bank_mask:0xf
v_mov_b32_dpp v234,v236 quad_perm:[3,3,3,3] row_mask:0xf bank_mask:0xf
v_mov_b32_dpp v235,v238 quad_perm:[3,3,3,3] row_mask:0xf bank_mask:0xf
mf v[156:159],v[180:183],a[32:35],v[156:159]
ds_read_b128 v[212:215],v7 offset:1024
ds_read_b128 v[216:219],v7 offset:10240
v_fma_f32 v36,v36,v220,v228
mf v[156:159],v[184:187],a[40:43],v[156:159]
v_fma_f32 v37,v37,v221,v229
v_fma_f32 v38,v38,v222,v230
v_fma_f32 v39,v39,v223,v231
mf v[160:163],v[184:187],a[44:47],v[160:163]
buffer_load_dwordx4 v2,s[4:7],s60 offen offset:2048 lds
mf v[160:163],v[180:183],a[36:39],v[160:163]
v_fma_f32 v40,v40,v224,v232
v_fma_f32 v41,v41,v225,v233
s_waitcnt lgkmcnt(4)
mf v[164:167],v[188:191],a[32:35],v[164:167]
ds_read_b128 v[180:183],v7 offset:2048
ds_read_b128 v[184:187],v7 offset:11264
v_fma_f32 v42,v42,v226,v234
mf v[164:167],v[192:195],a[40:43],v[164:167]
v_fma_f32 v43,v43,v227,v235
v_cvt_pk_bf16_f32 v36,v36,v37
v_cvt_pk_bf16_f32 v37,v38,v39
mf v[168:171],v[192:195],a[44:47],v[168:171]
buffer_load_dwordx4 v2,s[4:7],s60 offen offset:3072 lds
mf v[168:171],v[188:191],a[36:39],v[168:171]
s_add_u32 m0,s61,8192
v_cvt_pk_bf16_f32 v38,v40,v41
v_cvt_pk_bf16_f32 v39,v42,v43
mf v[172:175],v[196:199],a[32:35],v[172:175]
ds_read_b128 v[188:191],v7 offset:3072
ds_read_b128 v[192:195],v7 offset:12288
v_fma_f32 v44,v44,v220,v228
mf v[172:175],v[200:203],a[40:43],v[172:175]
buffer_store_dwordx4 v[36:39],v1,s[20:23],s79 offen sc1
mf v[176:179],v[200:203],a[44:47],v[176:179]
v_fma_f32 v45,v45,v221,v229
v_fma_f32 v46,v46,v222,v230
v_fma_f32 v47,v47,v223,v231
mf v[176:179],v[196:199],a[36:39],v[176:179]
v_fma_f32 v48,v48,v224,v232
v_fma_f32 v49,v49,v225,v233
s_waitcnt lgkmcnt(4)
mf v[108:111],v[204:207],a[48:51],v[108:111]
buffer_load_dwordx4 v3,s[4:7],s60 offen lds
mf v[108:111],v[208:211],a[56:59],v[108:111]
ds_read_b128 v[196:199],v7 offset:4096
ds_read_b128 v[200:203],v7 offset:13312
v_fma_f32 v50,v50,v226,v234
mf v[112:115],v[208:211],a[60:63],v[112:115]
v_fma_f32 v51,v51,v227,v235
v_cvt_pk_bf16_f32 v44,v44,v45
v_cvt_pk_bf16_f32 v45,v46,v47
mf v[112:115],v[204:207],a[52:55],v[112:115]
v_cvt_pk_bf16_f32 v46,v48,v49
v_cvt_pk_bf16_f32 v47,v50,v51
v_fma_f32 v52,v52,v220,v228
mf v[116:119],v[212:215],a[48:51],v[116:119]
ds_read_b128 v[204:207],v7 offset:5120
ds_read_b128 v[208:211],v7 offset:14336
v_fma_f32 v53,v53,v221,v229
mf v[116:119],v[216:219],a[56:59],v[116:119]
buffer_store_dwordx4 v[44:47],v1,s[20:23],s79 offen offset:1024 sc1
mf v[120:123],v[216:219],a[60:63],v[120:123]
v_fma_f32 v54,v54,v222,v230
v_fma_f32 v55,v55,v223,v231
v_fma_f32 v56,v56,v224,v232
mf v[120:123],v[212:215],a[52:55],v[120:123]
v_fma_f32 v57,v57,v225,v233
v_fma_f32 v58,v58,v226,v234
s_waitcnt lgkmcnt(4)
mf v[124:127],v[180:183],a[48:51],v[124:127]
ds_read_b128 v[212:215],v7 offset:6144
ds_read_b128 v[216:219],v7 offset:15360
v_fma_f32 v59,v59,v227,v235
mf v[124:127],v[184:187],a[56:59],v[124:127]
v_cvt_pk_bf16_f32 v52,v52,v53
v_cvt_pk_bf16_f32 v53,v54,v55
v_cvt_pk_bf16_f32 v54,v56,v57
mf v[128:131],v[184:187],a[60:63],v[128:131]
v_cvt_pk_bf16_f32 v55,v58,v59
v_fma_f32 v60,v60,v220,v228
v_fma_f32 v61,v61,v221,v229
mf v[128:131],v[180:183],a[52:55],v[128:131]
v_fma_f32 v62,v62,v222,v230
v_fma_f32 v63,v63,v223,v231
v_fma_f32 v64,v64,v224,v232
mf v[132:135],v[188:191],a[48:51],v[132:135]
ds_read_b128 v[180:183],v7 offset:7168
ds_read_b128 v[184:187],v7 offset:16384
v_fma_f32 v65,v65,v225,v233
mf v[132:135],v[192:195],a[56:59],v[132:135]
buffer_store_dwordx4 v[52:55],v1,s[20:23],s79 offen offset:2048 sc1
mf v[136:139],v[192:195],a[60:63],v[136:139]
v_fma_f32 v66,v66,v226,v234
v_fma_f32 v67,v67,v227,v235
v_cvt_pk_bf16_f32 v60,v60,v61
mf v[136:139],v[188:191],a[52:55],v[136:139]
v_cvt_pk_bf16_f32 v61,v62,v63
v_cvt_pk_bf16_f32 v62,v64,v65
s_waitcnt lgkmcnt(4)
mf v[140:143],v[196:199],a[48:51],v[140:143]
ds_read_b128 v[188:191],v7 offset:8192
ds_read_b128 v[192:195],v7 offset:17408
v_cvt_pk_bf16_f32 v63,v66,v67
mf v[140:143],v[200:203],a[56:59],v[140:143]
v_fma_f32 v68,v68,v220,v228
v_fma_f32 v69,v69,v221,v229
v_fma_f32 v70,v70,v222,v230
mf v[144:147],v[200:203],a[60:63],v[144:147]
v_fma_f32 v71,v71,v223,v231
v_fma_f32 v72,v72,v224,v232
v_fma_f32 v73,v73,v225,v233
mf v[144:147],v[196:199],a[52:55],v[144:147]
v_fma_f32 v74,v74,v226,v234
v_fma_f32 v75,v75,v227,v235
v_cvt_pk_bf16_f32 v68,v68,v69
mf v[148:151],v[204:207],a[48:51],v[148:151]
ds_read_b128 v[196:199],v7 offset:18432
ds_read_b128 v[200:203],v7 offset:27648
v_cvt_pk_bf16_f32 v69,v70,v71
mf v[148:151],v[208:211],a[56:59],v[148:151]
buffer_store_dwordx4 v[60:63],v1,s[20:23],s79 offen offset:3072 sc1
mf v[152:155],v[208:211],a[60:63],v[152:155]
v_cvt_pk_bf16_f32 v70,v72,v73
v_cvt_pk_bf16_f32 v71,v74,v75
v_fma_f32 v76,v76,v220,v228
mf v[152:155],v[204:207],a[52:55],v[152:155]
v_fma_f32 v77,v77,v221,v229
v_fma_f32 v78,v78,v222,v230
s_waitcnt lgkmcnt(4)
mf v[156:159],v[212:215],a[48:51],v[156:159]
ds_read_b128 v[204:207],v7 offset:19456
ds_read_b128 v[208:211],v7 offset:28672
v_fma_f32 v79,v79,v223,v231
mf v[156:159],v[216:219],a[56:59],v[156:159]
v_fma_f32 v80,v80,v224,v232
v_fma_f32 v81,v81,v225,v233
v_fma_f32 v82,v82,v226,v234
mf v[160:163],v[216:219],a[60:63],v[160:163]
v_fma_f32 v83,v83,v227,v235
v_cvt_pk_bf16_f32 v76,v76,v77
v_cvt_pk_bf16_f32 v77,v78,v79
mf v[160:163],v[212:215],a[52:55],v[160:163]
v_cvt_pk_bf16_f32 v78,v80,v81
v_cvt_pk_bf16_f32 v79,v82,v83
v_fma_f32 v84,v84,v220,v228
mf v[164:167],v[180:183],a[48:51],v[164:167]
ds_read_b128 v[212:215],v7 offset:20480
ds_read_b128 v[216:219],v7 offset:29696
v_fma_f32 v85,v85,v221,v229
mf v[164:167],v[184:187],a[56:59],v[164:167]
buffer_store_dwordx4 v[68:71],v2,s[20:23],s79 offen sc1
mf v[168:171],v[184:187],a[60:63],v[168:171]
v_fma_f32 v86,v86,v222,v230
v_fma_f32 v87,v87,v223,v231
v_fma_f32 v88,v88,v224,v232
mf v[168:171],v[180:183],a[52:55],v[168:171]
v_fma_f32 v89,v89,v225,v233
v_fma_f32 v90,v90,v226,v234
s_waitcnt lgkmcnt(4)
mf v[172:175],v[188:191],a[48:51],v[172:175]
ds_read_b128 v[180:183],v7 offset:21504
ds_read_b128 v[184:187],v7 offset:30720
v_fma_f32 v91,v91,v227,v235
mf v[172:175],v[192:195],a[56:59],v[172:175]
v_cvt_pk_bf16_f32 v84,v84,v85
v_cvt_pk_bf16_f32 v85,v86,v87
v_cvt_pk_bf16_f32 v86,v88,v89
mf v[176:179],v[192:195],a[60:63],v[176:179]
v_cvt_pk_bf16_f32 v87,v90,v91
v_fma_f32 v92,v92,v220,v228
v_fma_f32 v93,v93,v221,v229
mf v[176:179],v[188:191],a[52:55],v[176:179]
v_fma_f32 v94,v94,v222,v230
v_fma_f32 v95,v95,v223,v231
v_fma_f32 v96,v96,v224,v232
mf v[108:111],v[196:199],a[64:67],v[108:111]
ds_read_b128 v[188:191],v7 offset:22528
ds_read_b128 v[192:195],v7 offset:31744
v_fma_f32 v97,v97,v225,v233
mf v[108:111],v[200:203],a[72:75],v[108:111]
buffer_store_dwordx4 v[76:79],v2,s[20:23],s79 offen offset:1024 sc1
mf v[112:115],v[200:203],a[76:79],v[112:115]
v_fma_f32 v98,v98,v226,v234
v_fma_f32 v99,v99,v227,v235
v_cvt_pk_bf16_f32 v92,v92,v93
mf v[112:115],v[196:199],a[68:71],v[112:115]
v_cvt_pk_bf16_f32 v93,v94,v95
v_cvt_pk_bf16_f32 v94,v96,v97
s_waitcnt lgkmcnt(4)
mf v[116:119],v[204:207],a[64:67],v[116:119]
ds_read_b128 v[196:199],v7 offset:23552
ds_read_b128 v[200:203],v7 offset:32768
v_cvt_pk_bf16_f32 v95,v98,v99
mf v[116:119],v[208:211],a[72:75],v[116:119]
v_fma_f32 v100,v100,v220,v228
v_fma_f32 v101,v101,v221,v229
v_fma_f32 v102,v102,v222,v230
mf v[120:123],v[208:211],a[76:79],v[120:123]
v_fma_f32 v103,v103,v223,v231
v_fma_f32 v104,v104,v224,v232
v_fma_f32 v105,v105,v225,v233
mf v[120:123],v[204:207],a[68:71],v[120:123]
v_fma_f32 v106,v106,v226,v234
v_fma_f32 v107,v107,v227,v235
v_cvt_pk_bf16_f32 v100,v100,v101
mf v[124:127],v[212:215],a[64:67],v[124:127]
ds_read_b128 v[204:207],v7 offset:24576
ds_read_b128 v[208:211],v7 offset:33792
v_cvt_pk_bf16_f32 v101,v102,v103
mf v[124:127],v[216:219],a[72:75],v[124:127]
buffer_store_dwordx4 v[84:87],v2,s[20:23],s79 offen offset:2048 sc1
mf v[128:131],v[216:219],a[76:79],v[128:131]
v_cvt_pk_bf16_f32 v102,v104,v105
v_cvt_pk_bf16_f32 v103,v106,v107
v_lshlrev_b32 v22,8,v0
mf v[128:131],v[212:215],a[68:71],v[128:131]
s_mul_i32 s73,s28,589824
s_waitcnt lgkmcnt(4)
mf v[132:135],v[180:183],a[64:67],v[132:135]
ds_read_b128 v[212:215],v7 offset:25600
ds_read_b128 v[216:219],v7 offset:34816
mf v[132:135],v[184:187],a[72:75],v[132:135]
s_add_u32 s73,s73,s61
s_add_u32 s73,s73,5570560
mf v[136:139],v[184:187],a[76:79],v[136:139]
v_lshlrev_b32 v20,4,v5
v_add_u32 v20,148032,v20
mf v[136:139],v[180:183],a[68:71],v[136:139]
v_mov_b32 v244,v18
v_mov_b32 v245,v18
mf v[140:143],v[188:191],a[64:67],v[140:143]
ds_read_b128 v[180:183],v7 offset:26624
ds_read_b128 v[184:187],v7 offset:35840
mf v[140:143],v[192:195],a[72:75],v[140:143]
buffer_store_dwordx4 v[92:95],v2,s[20:23],s79 offen offset:3072 sc1
mf v[144:147],v[192:195],a[76:79],v[144:147]
v_mov_b32 v246,v18
v_mov_b32 v247,v18
mf v[144:147],v[188:191],a[68:71],v[144:147]
v_mov_b32 v248,v19
s_waitcnt lgkmcnt(4)
mf v[148:151],v[196:199],a[64:67],v[148:151]
s_waitcnt vmcnt(17)
s_barrier
ds_read_b128 v[188:191],v8
ds_read_b128 v[192:195],v8 offset:9216
mf v[148:151],v[200:203],a[72:75],v[148:151]
v_mov_b32 v249,v19
v_mov_b32 v250,v19
mf v[152:155],v[200:203],a[76:79],v[152:155]
v_mov_b32 v251,v19
s_lshl_b32 s48,s27,3
mf v[152:155],v[196:199],a[68:71],v[152:155]
s_lshl_b32 s49,s24,1
s_add_u32 s48,s48,s49
mf v[156:159],v[204:207],a[64:67],v[156:159]
ds_read_b128 v[196:199],v8 offset:1024
ds_read_b128 v[200:203],v8 offset:10240
mf v[156:159],v[208:211],a[72:75],v[156:159]
buffer_store_dwordx4 v[100:103],v3,s[20:23],s79 offen sc1
mf v[160:163],v[208:211],a[76:79],v[160:163]
s_mul_i32 s48,s48,73728
s_lshr_b32 s49,s28,2
mf v[160:163],v[204:207],a[68:71],v[160:163]
s_mul_i32 s49,s49,18432
s_waitcnt lgkmcnt(4)
mf v[164:167],v[212:215],a[64:67],v[164:167]
ds_read_b128 v[204:207],v8 offset:2048
ds_read_b128 v[208:211],v8 offset:11264
mf v[164:167],v[216:219],a[72:75],v[164:167]
s_add_u32 s48,s48,s49
s_add_u32 s48,s48,15007744
mf v[168:171],v[216:219],a[76:79],v[168:171]
s_and_b32 s49,s28,3
s_lshl_b32 s50,s49,9
mf v[168:171],v[212:215],a[68:71],v[168:171]
s_add_u32 s50,s50,16384
s_add_u32 s50,s50,s48
mf v[172:175],v[180:183],a[64:67],v[172:175]
ds_read_b128 v[212:215],v8 offset:3072
ds_read_b128 v[216:219],v8 offset:12288
mf v[172:175],v[184:187],a[72:75],v[172:175]
s_lshl_b32 s49,s49,12
s_add_u32 s48,s48,s49
mf v[176:179],v[184:187],a[76:79],v[176:179]
s_add_u32 s49,s48,73728
s_add_u32 s51,s50,73728
mf v[176:179],v[180:183],a[68:71],v[176:179]
s_mul_i32 s76,s28,165888
s_waitcnt lgkmcnt(4)
mf v[108:111],v[188:191],a[80:83],v[108:111]
ds_read_b128 v[180:183],v8 offset:4096
ds_read_b128 v[184:187],v8 offset:13312
mf v[108:111],v[192:195],a[88:91],v[108:111]
s_add_u32 s76,s76,14680064
s_add_u32 s75,s76,s61
mf v[112:115],v[192:195],a[92:95],v[112:115]
s_mul_i32 s77,s24,5120
s_min_u32 s77,s77,13312
mf v[112:115],v[188:191],a[84:87],v[112:115]
s_add_u32 s76,s76,s77
s_lshr_b32 s84,s28,2
mf v[116:119],v[196:199],a[80:83],v[116:119]
ds_read_b128 v[188:191],v8 offset:5120
ds_read_b128 v[192:195],v8 offset:14336
mf v[116:119],v[200:203],a[88:91],v[116:119]
s_and_b32 s85,s28,3
s_lshl_b32 s86,s85,12
mf v[120:123],v[200:203],a[92:95],v[120:123]
s_sub_u32 s78,s48,s86
s_lshl_b32 s52,s27,2
mf v[120:123],v[196:199],a[84:87],v[120:123]
s_add_u32 s54,s52,s85
s_waitcnt lgkmcnt(4)
mf v[124:127],v[204:207],a[80:83],v[124:127]
ds_read_b128 v[196:199],v8 offset:6144
ds_read_b128 v[200:203],v8 offset:15360
mf v[124:127],v[208:211],a[88:91],v[124:127]
s_add_u32 s52,s52,s84
s_lshl_b32 s52,s52,2
mf v[128:131],v[208:211],a[92:95],v[128:131]
s_add_u32 s52,s52,s24
s_mul_i32 s52,s52,256
mf v[128:131],v[204:207],a[84:87],v[128:131]
s_add_u32 s52,s52,5390336
s_lshl_b32 s54,s54,2
mf v[132:135],v[212:215],a[80:83],v[132:135]
buffer_load_dwordx4 a[0:3],v2,s[4:7],s71 offen
mf v[132:135],v[216:219],a[88:91],v[132:135]
ds_read_b128 v[204:207],v8 offset:7168
ds_read_b128 v[208:211],v8 offset:16384
mf v[136:139],v[216:219],a[92:95],v[136:139]
s_add_u32 s55,s54,s84
s_add_u32 s54,s54,s24
mf v[136:139],v[212:215],a[84:87],v[136:139]
s_mul_i32 s54,s54,256
s_waitcnt lgkmcnt(4)
mf v[140:143],v[180:183],a[80:83],v[140:143]
buffer_load_dwordx4 a[4:7],v2,s[4:7],s71 offen offset:1024
mf v[140:143],v[184:187],a[88:91],v[140:143]
ds_read_b128 v[212:215],v8 offset:8192
ds_read_b128 v[216:219],v8 offset:17408
mf v[144:147],v[184:187],a[92:95],v[144:147]
s_add_u32 s54,s54,5455872
s_mul_i32 s55,s55,256
mf v[144:147],v[180:183],a[84:87],v[144:147]
s_add_u32 s55,s55,5455872
s_lshl_b32 s80,s27,2
mf v[148:151],v[188:191],a[80:83],v[148:151]
buffer_load_dwordx4 a[8:11],v2,s[4:7],s71 offen offset:2048
mf v[148:151],v[192:195],a[88:91],v[148:151]
ds_read_b128 v[180:183],v8 offset:18432
ds_read_b128 v[184:187],v8 offset:27648
mf v[152:155],v[192:195],a[92:95],v[152:155]
s_add_u32 s82,s80,s84
s_add_u32 s80,s80,s24
mf v[152:155],v[188:191],a[84:87],v[152:155]
s_mul_i32 s80,s80,36864
s_waitcnt lgkmcnt(4)
mf v[156:159],v[196:199],a[80:83],v[156:159]
buffer_load_dwordx4 v[220:223],v2,s[4:7],s71 offen offset:3072
mf v[156:159],v[200:203],a[88:91],v[156:159]
ds_read_b128 v[188:191],v8 offset:19456
ds_read_b128 v[192:195],v8 offset:28672
mf v[160:163],v[200:203],a[92:95],v[160:163]
s_mul_i32 s81,s84,2359296
s_add_u32 s80,s80,s81
mf v[160:163],v[196:199],a[84:87],v[160:163]
s_add_u32 s80,s80,24444928
s_lshl_b32 s87,s85,9
mf v[164:167],v[204:207],a[80:83],v[164:167]
buffer_load_dwordx4 v[224:227],v3,s[4:7],s71 offen
mf v[164:167],v[208:211],a[88:91],v[164:167]
ds_read_b128 v[196:199],v8 offset:20480
ds_read_b128 v[200:203],v8 offset:29696
mf v[168:171],v[208:211],a[92:95],v[168:171]
s_add_u32 s87,s87,16384
s_add_u32 s81,s80,s87
mf v[168:171],v[204:207],a[84:87],v[168:171]
s_add_u32 s80,s80,s86
s_waitcnt lgkmcnt(4)
mf v[172:175],v[212:215],a[80:83],v[172:175]
buffer_load_dwordx4 v[228:231],v3,s[4:7],s71 offen offset:1024
mf v[172:175],v[216:219],a[88:91],v[172:175]
ds_read_b128 v[204:207],v8 offset:21504
ds_read_b128 v[208:211],v8 offset:30720
mf v[176:179],v[216:219],a[92:95],v[176:179]
s_add_u32 s53,s80,18432
s_lshl_b32 s82,s82,1
mf v[176:179],v[212:215],a[84:87],v[176:179]
s_lshr_b32 s83,s24,1
s_add_u32 s89,s82,s83
mf v[108:111],v[180:183],a[96:99],v[108:111]
ds_read_b128 v[212:215],v8 offset:22528
ds_read_b128 v[216:219],v8 offset:31744
mf v[108:111],v[184:187],a[104:107],v[108:111]
Ljt87:
s_add_u32 s101,s3,Ljt87-Ljb41+1536
s_mul_i32 s82,s89,18432
mf v[112:115],v[184:187],a[108:111],v[112:115]
buffer_load_dword v9,off,s[16:19],s101
mf v[112:115],v[180:183],a[100:103],v[112:115]
s_and_b32 s90,s24,1
s_waitcnt lgkmcnt(4)
mf v[116:119],v[188:191],a[96:99],v[116:119]
ds_read_b128 v[180:183],v8 offset:23552
ds_read_b128 v[184:187],v8 offset:32768
mf v[116:119],v[192:195],a[104:107],v[116:119]
s_lshl_b32 s83,s90,7
s_add_u32 s83,s83,s87
mf v[120:123],v[192:195],a[108:111],v[120:123]
buffer_load_dwordx4 v[232:235],v3,s[4:7],s71 offen offset:2048
mf v[120:123],v[188:191],a[100:103],v[120:123]
s_add_u32 s83,s83,s82
s_add_u32 s82,s82,s86
s_waitcnt vmcnt(8)
s_barrier
s_cmp_lg_u32 s24,0
s_cbranch_scc1 Ls88
s_mov_b64 exec,15
v_mov_b32 v25,1
buffer_atomic_add v25,v22,s[20:23],s74 offen sc1
s_mov_b64 exec,-1
Ls88:
mf v[124:127],v[196:199],a[96:99],v[124:127]
ds_read_b128 v[188:191],v8 offset:24576
ds_read_b128 v[192:195],v8 offset:33792
mf v[124:127],v[200:203],a[104:107],v[124:127]
s_lshl_b32 s87,s90,10
s_add_u32 s82,s82,s87
mf v[128:131],v[200:203],a[108:111],v[128:131]
buffer_load_dwordx4 v[236:239],v3,s[4:7],s71 offen offset:3072
mf v[128:131],v[196:199],a[100:103],v[128:131]
s_add_u32 s67,s86,4096
s_waitcnt lgkmcnt(4)
mf v[132:135],v[204:207],a[96:99],v[132:135]
ds_read_b128 v[196:199],v8 offset:25600
ds_read_b128 v[200:203],v8 offset:34816
mf v[132:135],v[208:211],a[104:107],v[132:135]
s_and_b32 s67,s67,16383
s_add_u32 s67,s67,s78
mf v[136:139],v[208:211],a[108:111],v[136:139]
s_add_u32 s71,s70,36864
buffer_load_dwordx4 v[240:243],v1,s[4:7],s71 offen
mf v[136:139],v[204:207],a[100:103],v[136:139]
s_add_u32 s68,s67,73728
s_xor_b32 s69,s86,8192
mf v[140:143],v[212:215],a[96:99],v[140:143]
ds_read_b128 v[204:207],v8 offset:26624
ds_read_b128 v[208:211],v8 offset:35840
mf v[140:143],v[216:219],a[104:107],v[140:143]
s_add_u32 s69,s69,s78
s_add_u32 s72,s69,73728
mf v[144:147],v[216:219],a[108:111],v[144:147]
buffer_load_dwordx4 v[252:255],v1,s[4:7],s71 offen offset:1024
mf v[144:147],v[212:215],a[100:103],v[144:147]
s_add_u32 s94,s86,12288
s_waitcnt lgkmcnt(4)
mf v[148:151],v[180:183],a[96:99],v[148:151]
s_barrier
ds_read_b128 v[212:215],v1
ds_read_b128 v[216:219],v1 offset:9216
mf v[148:151],v[184:187],a[104:107],v[148:151]
s_and_b32 s94,s94,16383
s_add_u32 s94,s94,s78
mf v[152:155],v[184:187],a[108:111],v[152:155]
buffer_load_dwordx4 a[12:15],v1,s[4:7],s71 offen offset:2048
mf v[152:155],v[180:183],a[100:103],v[152:155]
s_add_u32 s95,s94,73728
s_add_u32 s96,s78,16384
mf v[156:159],v[188:191],a[96:99],v[156:159]
ds_read_b128 v[180:183],v1 offset:1024
ds_read_b128 v[184:187],v1 offset:10240
mf v[156:159],v[192:195],a[104:107],v[156:159]
s_add_u32 s97,s96,73728
mf v[160:163],v[192:195],a[108:111],v[160:163]
buffer_load_dwordx4 a[16:19],v1,s[4:7],s71 offen offset:3072
mf v[160:163],v[188:191],a[100:103],v[160:163]
s_waitcnt lgkmcnt(4)
mf v[164:167],v[196:199],a[96:99],v[164:167]
ds_read_b128 v[188:191],v1 offset:2048
ds_read_b128 v[192:195],v1 offset:11264
mf v[164:167],v[200:203],a[104:107],v[164:167]
ds_write_b128 v21,v[36:39]
mf v[168:171],v[200:203],a[108:111],v[168:171]
buffer_load_dwordx4 a[20:23],v2,s[4:7],s71 offen
mf v[168:171],v[196:199],a[100:103],v[168:171]
ds_write_b128 v21,v[44:47] offset:1024
s_cmp_lg_u32 s24,1
s_cbranch_scc1 Ls89
v_mov_b32 v23,0
s_mov_b64 exec,1
buffer_atomic_add v23,v22,s[20:23],s98 offen sc0 sc1
s_mov_b64 exec,-1
Ls89:
mf v[172:175],v[204:207],a[96:99],v[172:175]
ds_read_b128 v[196:199],v1 offset:3072
ds_read_b128 v[200:203],v1 offset:12288
mf v[172:175],v[208:211],a[104:107],v[172:175]
ds_write_b128 v21,v[52:55] offset:2048
mf v[176:179],v[208:211],a[108:111],v[176:179]
buffer_load_dwordx4 a[24:27],v2,s[4:7],s71 offen offset:1024
mf v[176:179],v[204:207],a[100:103],v[176:179]
s_waitcnt lgkmcnt(7)
mf v[108:111],v[212:215],a[112:115],v[108:111]
ds_read_b128 v[204:207],v1 offset:4096
ds_read_b128 v[208:211],v1 offset:13312
mf v[108:111],v[216:219],a[120:123],v[108:111]
ds_write_b128 v21,v[60:63] offset:3072
mf v[112:115],v[216:219],a[124:127],v[112:115]
buffer_load_dwordx4 a[28:31],v2,s[4:7],s71 offen offset:2048
mf v[112:115],v[212:215],a[116:119],v[112:115]
ds_write_b128 v21,v[68:71] offset:4096
mf v[116:119],v[180:183],a[112:115],v[116:119]
ds_read_b128 v[212:215],v1 offset:5120
ds_read_b128 v[216:219],v1 offset:14336
mf v[116:119],v[184:187],a[120:123],v[116:119]
ds_write_b128 v21,v[76:79] offset:5120
mf v[120:123],v[184:187],a[124:127],v[120:123]
buffer_load_dwordx4 a[32:35],v2,s[4:7],s71 offen offset:3072
mf v[120:123],v[180:183],a[116:119],v[120:123]
s_waitcnt lgkmcnt(8)
mf v[124:127],v[188:191],a[112:115],v[124:127]
ds_read_b128 v[180:183],v1 offset:6144
ds_read_b128 v[184:187],v1 offset:15360
mf v[124:127],v[192:195],a[120:123],v[124:127]
ds_write_b128 v21,v[84:87] offset:6144
mf v[128:131],v[192:195],a[124:127],v[128:131]
buffer_load_dwordx4 a[36:39],v3,s[4:7],s71 offen
mf v[128:131],v[188:191],a[116:119],v[128:131]
ds_write_b128 v21,v[92:95] offset:7168
mf v[132:135],v[196:199],a[112:115],v[132:135]
ds_read_b128 v[188:191],v1 offset:7168
ds_read_b128 v[192:195],v1 offset:16384
mf v[132:135],v[200:203],a[120:123],v[132:135]
ds_write_b128 v21,v[100:103] offset:8192
mf v[136:139],v[200:203],a[124:127],v[136:139]
buffer_load_dwordx4 a[40:43],v3,s[4:7],s71 offen offset:1024
mf v[136:139],v[196:199],a[116:119],v[136:139]
s_waitcnt lgkmcnt(8)
mf v[140:143],v[204:207],a[112:115],v[140:143]
ds_read_b128 v[196:199],v1 offset:8192
ds_read_b128 v[200:203],v1 offset:17408
mf v[140:143],v[208:211],a[120:123],v[140:143]
mf v[144:147],v[208:211],a[124:127],v[144:147]
buffer_load_dwordx4 a[44:47],v3,s[4:7],s71 offen offset:2048
mf v[144:147],v[204:207],a[116:119],v[144:147]
mf v[148:151],v[212:215],a[112:115],v[148:151]
ds_read_b128 v[204:207],v1 offset:18432
ds_read_b128 v[208:211],v1 offset:27648
mf v[148:151],v[216:219],a[120:123],v[148:151]
mf v[152:155],v[216:219],a[124:127],v[152:155]
buffer_load_dwordx4 a[48:51],v3,s[4:7],s71 offen offset:3072
mf v[152:155],v[212:215],a[116:119],v[152:155]
s_waitcnt lgkmcnt(5)
mf v[156:159],v[180:183],a[112:115],v[156:159]
ds_read_b128 v[212:215],v1 offset:19456
ds_read_b128 v[216:219],v1 offset:28672
mf v[156:159],v[184:187],a[120:123],v[156:159]
mf v[160:163],v[184:187],a[124:127],v[160:163]
s_add_u32 s71,s70,49152
buffer_load_dwordx4 a[52:55],v1,s[4:7],s71 offen
mf v[160:163],v[180:183],a[116:119],v[160:163]
mf v[164:167],v[188:191],a[112:115],v[164:167]
ds_read_b128 v[180:183],v1 offset:20480
ds_read_b128 v[184:187],v1 offset:29696
mf v[164:167],v[192:195],a[120:123],v[164:167]
mf v[168:171],v[192:195],a[124:127],v[168:171]
buffer_load_dwordx4 a[56:59],v1,s[4:7],s71 offen offset:1024
mf v[168:171],v[188:191],a[116:119],v[168:171]
s_waitcnt lgkmcnt(4)
mf v[172:175],v[196:199],a[112:115],v[172:175]
ds_read_b128 v[188:191],v1 offset:21504
ds_read_b128 v[192:195],v1 offset:30720
mf v[172:175],v[200:203],a[120:123],v[172:175]
mf v[176:179],v[200:203],a[124:127],v[176:179]
buffer_load_dwordx4 a[60:63],v1,s[4:7],s71 offen offset:2048
mf v[176:179],v[196:199],a[116:119],v[176:179]
mf v[108:111],v[204:207],a[128:131],v[108:111]
ds_read_b128 v[196:199],v1 offset:22528
ds_read_b128 v[200:203],v1 offset:31744
mf v[108:111],v[208:211],a[136:139],v[108:111]
mf v[112:115],v[208:211],a[140:143],v[112:115]
buffer_load_dwordx4 a[64:67],v1,s[4:7],s71 offen offset:3072
mf v[112:115],v[204:207],a[132:135],v[112:115]
s_cmp_lg_u32 s24,1
s_cbranch_scc1 Ls90
s_waitcnt vmcnt(11)
v_readfirstlane_b32 s56,v23
s_nop 0
s_cmp_eq_u32 s56,16
s_cbranch_scc1 Ls90
s_mov_b64 exec,1
s_mov_b32 s56,0
Lp91:
v_mov_b32 v23,0
buffer_atomic_add v23,v22,s[20:23],s98 offen sc0 sc1
s_waitcnt vmcnt(0)
v_cmp_ne_u32 vcc,16,v23
s_nop 0
s_cbranch_vccz Lpd92
s_add_u32 s56,s56,1
s_cmp_lt_u32 s56,0x40000
s_cbranch_scc1 Lp91
Lpd92:
s_mov_b64 exec,-1
Ls90:
s_barrier
s_waitcnt lgkmcnt(4)
mf v[116:119],v[212:215],a[128:131],v[116:119]
ds_read_b128 v[204:207],v1 offset:23552
ds_read_b128 v[208:211],v1 offset:32768
mf v[116:119],v[216:219],a[136:139],v[116:119]
s_cmp_gt_u32 s27,0
s_cselect_b32 s74,0,1
s_mul_i32 s74,s74,36864
mf v[120:123],v[216:219],a[140:143],v[120:123]
s_add_u32 s74,s74,s73
s_add_u32 s60,s74,0
mf v[120:123],v[212:215],a[132:135],v[120:123]
s_add_u32 m0,s61,73728
mf v[124:127],v[180:183],a[128:131],v[124:127]
buffer_load_dwordx4 v1,s[20:23],s60 offen sc1 lds
mf v[124:127],v[184:187],a[136:139],v[124:127]
ds_read_b128 v[212:215],v1 offset:24576
ds_read_b128 v[216:219],v1 offset:33792
mf v[128:131],v[184:187],a[140:143],v[128:131]
mf v[128:131],v[180:183],a[132:135],v[128:131]
s_waitcnt lgkmcnt(4)
mf v[132:135],v[188:191],a[128:131],v[132:135]
buffer_load_dwordx4 v1,s[20:23],s60 offen offset:1024 sc1 lds
mf v[132:135],v[192:195],a[136:139],v[132:135]
ds_read_b128 v[180:183],v1 offset:25600
ds_read_b128 v[184:187],v1 offset:34816
mf v[136:139],v[192:195],a[140:143],v[136:139]
mf v[136:139],v[188:191],a[132:135],v[136:139]
mf v[140:143],v[196:199],a[128:131],v[140:143]
buffer_load_dwordx4 v1,s[20:23],s60 offen offset:2048 sc1 lds
mf v[140:143],v[200:203],a[136:139],v[140:143]
ds_read_b128 v[188:191],v1 offset:26624
ds_read_b128 v[192:195],v1 offset:35840
mf v[144:147],v[200:203],a[140:143],v[144:147]
mf v[144:147],v[196:199],a[132:135],v[144:147]
s_waitcnt lgkmcnt(4)
mf v[148:151],v[204:207],a[128:131],v[148:151]
buffer_load_dwordx4 v1,s[20:23],s60 offen offset:3072 sc1 lds
mf v[148:151],v[208:211],a[136:139],v[148:151]
ds_read_b128 v[196:199],v6
ds_read_b128 v[200:203],v6 offset:9216
mf v[152:155],v[208:211],a[140:143],v[152:155]
s_add_u32 m0,s61,77824
mf v[152:155],v[204:207],a[132:135],v[152:155]
mf v[156:159],v[212:215],a[128:131],v[156:159]
buffer_load_dwordx4 v2,s[20:23],s60 offen sc1 lds
mf v[156:159],v[216:219],a[136:139],v[156:159]
ds_read_b128 v[204:207],v6 offset:1024
ds_read_b128 v[208:211],v6 offset:10240
mf v[160:163],v[216:219],a[140:143],v[160:163]
mf v[160:163],v[212:215],a[132:135],v[160:163]
s_waitcnt lgkmcnt(4)
mf v[164:167],v[180:183],a[128:131],v[164:167]
buffer_load_dwordx4 v2,s[20:23],s60 offen offset:1024 sc1 lds
mf v[164:167],v[184:187],a[136:139],v[164:167]
ds_read_b128 v[212:215],v6 offset:2048
ds_read_b128 v[216:219],v6 offset:11264
mf v[168:171],v[184:187],a[140:143],v[168:171]
mf v[168:171],v[180:183],a[132:135],v[168:171]
mf v[172:175],v[188:191],a[128:131],v[172:175]
buffer_load_dwordx4 v2,s[20:23],s60 offen offset:2048 sc1 lds
mf v[172:175],v[192:195],a[136:139],v[172:175]
ds_read_b128 v[180:183],v6 offset:3072
ds_read_b128 v[184:187],v6 offset:12288
mf v[176:179],v[192:195],a[140:143],v[176:179]
mf v[176:179],v[188:191],a[132:135],v[176:179]
ds_read_b128 v[24:27],v20
s_waitcnt lgkmcnt(3)
mf v[36:39],v[196:199],a[144:147],v[244:247]
buffer_load_dwordx4 v2,s[20:23],s60 offen offset:3072 sc1 lds
mf v[36:39],v[200:203],a[152:155],v[36:39]
ds_read_b128 v[188:191],v6 offset:4096
ds_read_b128 v[192:195],v6 offset:13312
mf v[40:43],v[200:203],a[156:159],v[248:251]
s_add_u32 m0,s61,81920
s_waitcnt lgkmcnt(2)
ds_read_b128 v[28:31],v20 offset:64
mf v[40:43],v[196:199],a[148:151],v[40:43]
v_fmac_f32 v108,v10,v24
v_fmac_f32 v109,v10,v25
mf v[44:47],v[204:207],a[144:147],v[244:247]
buffer_load_dwordx4 v3,s[20:23],s60 offen sc1 lds
mf v[44:47],v[208:211],a[152:155],v[44:47]
ds_read_b128 v[196:199],v6 offset:5120
ds_read_b128 v[200:203],v6 offset:14336
mf v[48:51],v[208:211],a[156:159],v[248:251]
s_cmp_gt_u32 s27,1
s_cselect_b32 s74,1,2
s_mul_i32 s74,s74,36864
mf v[48:51],v[204:207],a[148:151],v[48:51]
s_add_u32 s74,s74,s73
s_add_u32 s60,s74,0
mf v[52:55],v[212:215],a[144:147],v[244:247]
ds_read_b128 v[204:207],v6 offset:6144
ds_read_b128 v[208:211],v6 offset:15360
mf v[52:55],v[216:219],a[152:155],v[52:55]
s_add_u32 m0,s61,110592
v_fmac_f32 v110,v10,v26
mf v[56:59],v[216:219],a[156:159],v[248:251]
buffer_load_dwordx4 v1,s[20:23],s60 offen sc1 lds
mf v[56:59],v[212:215],a[148:151],v[56:59]
v_fmac_f32 v111,v10,v27
s_waitcnt lgkmcnt(2)
mf v[60:63],v[180:183],a[144:147],v[244:247]
ds_read_b128 v[212:215],v6 offset:7168
ds_read_b128 v[216:219],v6 offset:16384
mf v[60:63],v[184:187],a[152:155],v[60:63]
v_mul_f32 v32,v108,v108
v_mul_f32 v33,v109,v109
mf v[64:67],v[184:187],a[156:159],v[248:251]
buffer_load_dwordx4 v1,s[20:23],s60 offen offset:1024 sc1 lds
mf v[64:67],v[180:183],a[148:151],v[64:67]
v_mul_f32 v34,v110,v110
v_mul_f32 v35,v111,v111
mf v[68:71],v[188:191],a[144:147],v[244:247]
ds_read_b128 v[180:183],v6 offset:8192
ds_read_b128 v[184:187],v6 offset:17408
mf v[68:71],v[192:195],a[152:155],v[68:71]
v_fma_f32 v32,v32,v14,v12
v_fma_f32 v33,v33,v14,v12
mf v[72:75],v[192:195],a[156:159],v[248:251]
buffer_load_dwordx4 v1,s[20:23],s60 offen offset:2048 sc1 lds
mf v[72:75],v[188:191],a[148:151],v[72:75]
v_fma_f32 v34,v34,v14,v12
v_fma_f32 v35,v35,v14,v12
mf v[76:79],v[196:199],a[144:147],v[244:247]
ds_read_b128 v[188:191],v6 offset:18432
ds_read_b128 v[192:195],v6 offset:27648
mf v[76:79],v[200:203],a[152:155],v[76:79]
v_mul_f32 v32,v108,v32
v_mul_f32 v33,v109,v33
mf v[80:83],v[200:203],a[156:159],v[248:251]
buffer_load_dwordx4 v1,s[20:23],s60 offen offset:3072 sc1 lds
mf v[80:83],v[196:199],a[148:151],v[80:83]
s_add_u32 m0,s61,114688
s_waitcnt lgkmcnt(2)
mf v[84:87],v[204:207],a[144:147],v[244:247]
ds_read_b128 v[196:199],v6 offset:19456
ds_read_b128 v[200:203],v6 offset:28672
mf v[84:87],v[208:211],a[152:155],v[84:87]
v_mul_f32 v34,v110,v34
v_mul_f32 v35,v111,v35
mf v[88:91],v[208:211],a[156:159],v[248:251]
buffer_load_dwordx4 v2,s[20:23],s60 offen sc1 lds
mf v[88:91],v[204:207],a[148:151],v[88:91]
v_exp_f32 v32,v32
mf v[92:95],v[212:215],a[144:147],v[244:247]
ds_read_b128 v[204:207],v6 offset:20480
ds_read_b128 v[208:211],v6 offset:29696
mf v[92:95],v[216:219],a[152:155],v[92:95]
v_exp_f32 v33,v33
mf v[96:99],v[216:219],a[156:159],v[248:251]
buffer_load_dwordx4 v2,s[20:23],s60 offen offset:1024 sc1 lds
mf v[96:99],v[212:215],a[148:151],v[96:99]
v_exp_f32 v34,v34
mf v[100:103],v[180:183],a[144:147],v[244:247]
ds_read_b128 v[212:215],v6 offset:21504
ds_read_b128 v[216:219],v6 offset:30720
mf v[100:103],v[184:187],a[152:155],v[100:103]
v_exp_f32 v35,v35
mf v[104:107],v[184:187],a[156:159],v[248:251]
v_fma_f32 v32,v32,v16,v16
v_fma_f32 v33,v33,v16,v16
mf v[104:107],v[180:183],a[148:151],v[104:107]
s_waitcnt lgkmcnt(2)
mf v[36:39],v[188:191],a[160:163],v[36:39]
buffer_load_dwordx4 v2,s[20:23],s60 offen offset:2048 sc1 lds
mf v[36:39],v[192:195],a[168:171],v[36:39]
ds_read_b128 v[180:183],v6 offset:22528
ds_read_b128 v[184:187],v6 offset:31744
mf v[40:43],v[192:195],a[172:175],v[40:43]
v_fma_f32 v34,v34,v16,v16
v_fma_f32 v35,v35,v16,v16
mf v[40:43],v[188:191],a[164:167],v[40:43]
v_rcp_f32 v32,v32
mf v[44:47],v[196:199],a[160:163],v[44:47]
buffer_load_dwordx4 a[68:71],v2,s[4:7],s71 offen
mf v[44:47],v[200:203],a[168:171],v[44:47]
ds_read_b128 v[188:191],v6 offset:23552
ds_read_b128 v[192:195],v6 offset:32768
mf v[48:51],v[200:203],a[172:175],v[48:51]
v_rcp_f32 v33,v33
mf v[48:51],v[196:199],a[164:167],v[48:51]
v_rcp_f32 v34,v34
mf v[52:55],v[204:207],a[160:163],v[52:55]
buffer_load_dwordx4 v2,s[20:23],s60 offen offset:3072 sc1 lds
mf v[52:55],v[208:211],a[168:171],v[52:55]
ds_read_b128 v[196:199],v6 offset:24576
ds_read_b128 v[200:203],v6 offset:33792
mf v[56:59],v[208:211],a[172:175],v[56:59]
v_rcp_f32 v35,v35
mf v[56:59],v[204:207],a[164:167],v[56:59]
v_mul_f32 v108,v108,v32
s_waitcnt lgkmcnt(2)
mf v[60:63],v[212:215],a[160:163],v[60:63]
buffer_load_dwordx4 a[72:75],v2,s[4:7],s71 offen offset:1024
mf v[60:63],v[216:219],a[168:171],v[60:63]
ds_read_b128 v[204:207],v6 offset:25600
ds_read_b128 v[208:211],v6 offset:34816
mf v[64:67],v[216:219],a[172:175],v[64:67]
s_add_u32 m0,s61,118784
v_mul_f32 v109,v109,v33
mf v[64:67],v[212:215],a[164:167],v[64:67]
v_mul_f32 v110,v110,v34
v_mul_f32 v111,v111,v35
mf v[68:71],v[180:183],a[160:163],v[68:71]
buffer_load_dwordx4 v3,s[20:23],s60 offen sc1 lds
mf v[68:71],v[184:187],a[168:171],v[68:71]
ds_read_b128 v[212:215],v6 offset:26624
ds_read_b128 v[216:219],v6 offset:35840
mf v[72:75],v[184:187],a[172:175],v[72:75]
v_fmac_f32 v112,v11,v24
v_fmac_f32 v113,v11,v25
mf v[72:75],v[180:183],a[164:167],v[72:75]
v_fmac_f32 v114,v11,v26
v_fmac_f32 v115,v11,v27
mf v[76:79],v[188:191],a[160:163],v[76:79]
buffer_load_dwordx4 a[76:79],v2,s[4:7],s71 offen offset:2048
mf v[76:79],v[192:195],a[168:171],v[76:79]
s_waitcnt vmcnt(12)
s_barrier
ds_read_b128 v[180:183],v7
ds_read_b128 v[184:187],v7 offset:9216
mf v[80:83],v[192:195],a[172:175],v[80:83]
v_mul_f32 v32,v112,v112
v_mul_f32 v33,v113,v113
mf v[80:83],v[188:191],a[164:167],v[80:83]
v_mul_f32 v34,v114,v114
s_waitcnt lgkmcnt(2)
mf v[84:87],v[196:199],a[160:163],v[84:87]
buffer_load_dwordx4 v[244:247],v2,s[4:7],s71 offen offset:3072
mf v[84:87],v[200:203],a[168:171],v[84:87]
ds_read_b128 v[188:191],v7 offset:1024
ds_read_b128 v[192:195],v7 offset:10240
mf v[88:91],v[200:203],a[172:175],v[88:91]
v_mul_f32 v35,v115,v115
v_fma_f32 v32,v32,v15,v13
mf v[88:91],v[196:199],a[164:167],v[88:91]
v_fma_f32 v33,v33,v15,v13
v_fma_f32 v34,v34,v15,v13
mf v[92:95],v[204:207],a[160:163],v[92:95]
buffer_load_dwordx4 v[248:251],v3,s[4:7],s71 offen
mf v[92:95],v[208:211],a[168:171],v[92:95]
ds_read_b128 v[196:199],v7 offset:2048
ds_read_b128 v[200:203],v7 offset:11264
mf v[96:99],v[208:211],a[172:175],v[96:99]
v_fma_f32 v35,v35,v15,v13
v_mul_f32 v32,v112,v32
mf v[96:99],v[204:207],a[164:167],v[96:99]
v_mul_f32 v33,v113,v33
v_mul_f32 v34,v114,v34
mf v[100:103],v[212:215],a[160:163],v[100:103]
ds_read_b128 v[204:207],v7 offset:3072
ds_read_b128 v[208:211],v7 offset:12288
mf v[100:103],v[216:219],a[168:171],v[100:103]
v_mul_f32 v35,v115,v35
mf v[104:107],v[216:219],a[172:175],v[104:107]
v_exp_f32 v32,v32
mf v[104:107],v[212:215],a[164:167],v[104:107]
s_barrier
s_waitcnt lgkmcnt(2)
mf v[36:39],v[180:183],a[176:179],v[36:39]
ds_read_b128 v[212:215],v7 offset:4096
ds_read_b128 v[216:219],v7 offset:13312
mf v[36:39],v[184:187],a[184:187],v[36:39]
s_cmp_gt_u32 s27,2
s_cselect_b32 s74,2,3
s_mul_i32 s74,s74,36864
mf v[40:43],v[184:187],a[188:191],v[40:43]
s_add_u32 s74,s74,s73
s_add_u32 s60,s74,0
mf v[40:43],v[180:183],a[180:183],v[40:43]
s_add_u32 m0,s61,0
mf v[44:47],v[188:191],a[176:179],v[44:47]
buffer_load_dwordx4 v1,s[20:23],s60 offen sc1 lds
mf v[44:47],v[192:195],a[184:187],v[44:47]
ds_read_b128 v[180:183],v7 offset:5120
ds_read_b128 v[184:187],v7 offset:14336
mf v[48:51],v[192:195],a[188:191],v[48:51]
v_exp_f32 v33,v33
mf v[48:51],v[188:191],a[180:183],v[48:51]
v_exp_f32 v34,v34
mf v[52:55],v[196:199],a[176:179],v[52:55]
buffer_load_dwordx4 v1,s[20:23],s60 offen offset:1024 sc1 lds
mf v[52:55],v[200:203],a[184:187],v[52:55]
ds_read_b128 v[188:191],v7 offset:6144
ds_read_b128 v[192:195],v7 offset:15360
mf v[56:59],v[200:203],a[188:191],v[56:59]
v_exp_f32 v35,v35
mf v[56:59],v[196:199],a[180:183],v[56:59]
v_fma_f32 v32,v32,v17,v17
s_waitcnt lgkmcnt(2)
mf v[60:63],v[204:207],a[176:179],v[60:63]
buffer_load_dwordx4 v1,s[20:23],s60 offen offset:2048 sc1 lds
mf v[60:63],v[208:211],a[184:187],v[60:63]
ds_read_b128 v[196:199],v7 offset:7168
ds_read_b128 v[200:203],v7 offset:16384
mf v[64:67],v[208:211],a[188:191],v[64:67]
v_fma_f32 v33,v33,v17,v17
v_fma_f32 v34,v34,v17,v17
mf v[64:67],v[204:207],a[180:183],v[64:67]
v_fma_f32 v35,v35,v17,v17
mf v[68:71],v[212:215],a[176:179],v[68:71]
buffer_load_dwordx4 v1,s[20:23],s60 offen offset:3072 sc1 lds
mf v[68:71],v[216:219],a[184:187],v[68:71]
ds_read_b128 v[204:207],v7 offset:8192
ds_read_b128 v[208:211],v7 offset:17408
mf v[72:75],v[216:219],a[188:191],v[72:75]
s_add_u32 m0,s61,4096
mf v[72:75],v[212:215],a[180:183],v[72:75]
v_rcp_f32 v32,v32
mf v[76:79],v[180:183],a[176:179],v[76:79]
buffer_load_dwordx4 v2,s[20:23],s60 offen sc1 lds
mf v[76:79],v[184:187],a[184:187],v[76:79]
ds_read_b128 v[212:215],v7 offset:18432
ds_read_b128 v[216:219],v7 offset:27648
mf v[80:83],v[184:187],a[188:191],v[80:83]
v_rcp_f32 v33,v33
mf v[80:83],v[180:183],a[180:183],v[80:83]
s_waitcnt lgkmcnt(2)
mf v[84:87],v[188:191],a[176:179],v[84:87]
buffer_load_dwordx4 v2,s[20:23],s60 offen offset:1024 sc1 lds
mf v[84:87],v[192:195],a[184:187],v[84:87]
ds_read_b128 v[180:183],v7 offset:19456
ds_read_b128 v[184:187],v7 offset:28672
mf v[88:91],v[192:195],a[188:191],v[88:91]
v_rcp_f32 v34,v34
mf v[88:91],v[188:191],a[180:183],v[88:91]
v_rcp_f32 v35,v35
mf v[92:95],v[196:199],a[176:179],v[92:95]
buffer_load_dwordx4 v2,s[20:23],s60 offen offset:2048 sc1 lds
mf v[92:95],v[200:203],a[184:187],v[92:95]
ds_read_b128 v[188:191],v7 offset:20480
ds_read_b128 v[192:195],v7 offset:29696
mf v[96:99],v[200:203],a[188:191],v[96:99]
v_mul_f32 v112,v112,v32
v_mul_f32 v113,v113,v33
mf v[96:99],v[196:199],a[180:183],v[96:99]
v_mul_f32 v114,v114,v34
v_mul_f32 v115,v115,v35
mf v[100:103],v[204:207],a[176:179],v[100:103]
buffer_load_dwordx4 v2,s[20:23],s60 offen offset:3072 sc1 lds
mf v[100:103],v[208:211],a[184:187],v[100:103]
ds_read_b128 v[196:199],v7 offset:21504
ds_read_b128 v[200:203],v7 offset:30720
mf v[104:107],v[208:211],a[188:191],v[104:107]
Ljt93:
s_add_u32 s101,s3,Ljt93-Ljb41+1536
ds_read_b128 v[24:27],v20 offset:128
mf v[104:107],v[204:207],a[180:183],v[104:107]
s_waitcnt lgkmcnt(3)
mf v[36:39],v[212:215],a[192:195],v[36:39]
buffer_load_dword v9,off,s[16:19],s101
mf v[36:39],v[216:219],a[200:203],v[36:39]
ds_read_b128 v[204:207],v7 offset:22528
ds_read_b128 v[208:211],v7 offset:31744
mf v[40:43],v[216:219],a[204:207],v[40:43]
s_add_u32 m0,s61,8192
v_fmac_f32 v116,v10,v28
mf v[40:43],v[212:215],a[196:199],v[40:43]
v_fmac_f32 v117,v10,v29
v_fmac_f32 v118,v10,v30
mf v[44:47],v[180:183],a[192:195],v[44:47]
buffer_load_dwordx4 v3,s[20:23],s60 offen sc1 lds
mf v[44:47],v[184:187],a[200:203],v[44:47]
ds_read_b128 v[212:215],v7 offset:23552
ds_read_b128 v[216:219],v7 offset:32768
mf v[48:51],v[184:187],a[204:207],v[48:51]
s_cmp_gt_u32 s27,3
s_cselect_b32 s74,3,4
s_mul_i32 s74,s74,36864
mf v[48:51],v[180:183],a[196:199],v[48:51]
s_add_u32 s74,s74,s73
s_add_u32 s60,s74,0
mf v[52:55],v[188:191],a[192:195],v[52:55]
ds_read_b128 v[180:183],v7 offset:24576
ds_read_b128 v[184:187],v7 offset:33792
mf v[52:55],v[192:195],a[200:203],v[52:55]
s_add_u32 m0,s61,36864
v_fmac_f32 v119,v10,v31
mf v[56:59],v[192:195],a[204:207],v[56:59]
buffer_load_dwordx4 v1,s[20:23],s60 offen sc1 lds
mf v[56:59],v[188:191],a[196:199],v[56:59]
v_mul_f32 v32,v116,v116
s_waitcnt lgkmcnt(2)
mf v[60:63],v[196:199],a[192:195],v[60:63]
ds_read_b128 v[188:191],v7 offset:25600
ds_read_b128 v[192:195],v7 offset:34816
mf v[60:63],v[200:203],a[200:203],v[60:63]
v_mul_f32 v33,v117,v117
v_mul_f32 v34,v118,v118
mf v[64:67],v[200:203],a[204:207],v[64:67]
buffer_load_dwordx4 v1,s[20:23],s60 offen offset:1024 sc1 lds
mf v[64:67],v[196:199],a[196:199],v[64:67]
v_mul_f32 v35,v119,v119
v_fma_f32 v32,v32,v14,v12
mf v[68:71],v[204:207],a[192:195],v[68:71]
ds_read_b128 v[196:199],v7 offset:26624
ds_read_b128 v[200:203],v7 offset:35840
mf v[68:71],v[208:211],a[200:203],v[68:71]
v_fma_f32 v33,v33,v14,v12
v_fma_f32 v34,v34,v14,v12
mf v[72:75],v[208:211],a[204:207],v[72:75]
buffer_load_dwordx4 v1,s[20:23],s60 offen offset:2048 sc1 lds
mf v[72:75],v[204:207],a[196:199],v[72:75]
v_fma_f32 v35,v35,v14,v12
v_mul_f32 v32,v116,v32
mf v[76:79],v[212:215],a[192:195],v[76:79]
s_waitcnt vmcnt(16)
s_barrier
ds_read_b128 v[204:207],v8
ds_read_b128 v[208:211],v8 offset:9216
mf v[76:79],v[216:219],a[200:203],v[76:79]
v_mul_f32 v33,v117,v33
v_mul_f32 v34,v118,v34
mf v[80:83],v[216:219],a[204:207],v[80:83]
buffer_load_dwordx4 v1,s[20:23],s60 offen offset:3072 sc1 lds
mf v[80:83],v[212:215],a[196:199],v[80:83]
s_add_u32 m0,s61,40960
s_waitcnt lgkmcnt(2)
mf v[84:87],v[180:183],a[192:195],v[84:87]
ds_read_b128 v[212:215],v8 offset:1024
ds_read_b128 v[216:219],v8 offset:10240
mf v[84:87],v[184:187],a[200:203],v[84:87]
v_mul_f32 v35,v119,v35
mf v[88:91],v[184:187],a[204:207],v[88:91]
buffer_load_dwordx4 v2,s[20:23],s60 offen sc1 lds
mf v[88:91],v[180:183],a[196:199],v[88:91]
v_exp_f32 v32,v32
mf v[92:95],v[188:191],a[192:195],v[92:95]
ds_read_b128 v[180:183],v8 offset:2048
ds_read_b128 v[184:187],v8 offset:11264
mf v[92:95],v[192:195],a[200:203],v[92:95]
v_exp_f32 v33,v33
mf v[96:99],v[192:195],a[204:207],v[96:99]
buffer_load_dwordx4 v2,s[20:23],s60 offen offset:1024 sc1 lds
mf v[96:99],v[188:191],a[196:199],v[96:99]
v_exp_f32 v34,v34
mf v[100:103],v[196:199],a[192:195],v[100:103]
ds_read_b128 v[188:191],v8 offset:3072
ds_read_b128 v[192:195],v8 offset:12288
mf v[100:103],v[200:203],a[200:203],v[100:103]
v_exp_f32 v35,v35
mf v[104:107],v[200:203],a[204:207],v[104:107]
buffer_load_dwordx4 v2,s[20:23],s60 offen offset:2048 sc1 lds
mf v[104:107],v[196:199],a[196:199],v[104:107]
s_barrier
s_waitcnt lgkmcnt(2)
mf v[36:39],v[204:207],a[208:211],v[36:39]
ds_read_b128 v[196:199],v8 offset:4096
ds_read_b128 v[200:203],v8 offset:13312
mf v[36:39],v[208:211],a[216:219],v[36:39]
v_fma_f32 v32,v32,v16,v16
v_fma_f32 v33,v33,v16,v16
mf v[40:43],v[208:211],a[220:223],v[40:43]
buffer_load_dwordx4 v2,s[20:23],s60 offen offset:3072 sc1 lds
mf v[40:43],v[204:207],a[212:215],v[40:43]
v_fma_f32 v34,v34,v16,v16
v_fma_f32 v35,v35,v16,v16
mf v[44:47],v[212:215],a[208:211],v[44:47]
ds_read_b128 v[204:207],v8 offset:5120
ds_read_b128 v[208:211],v8 offset:14336
mf v[44:47],v[216:219],a[216:219],v[44:47]
v_rcp_f32 v32,v32
mf v[48:51],v[216:219],a[220:223],v[48:51]
buffer_load_dwordx4 a[80:83],v3,s[4:7],s71 offen offset:1024
mf v[48:51],v[212:215],a[212:215],v[48:51]
s_add_u32 m0,s61,45056
mf v[52:55],v[180:183],a[208:211],v[52:55]
ds_read_b128 v[212:215],v8 offset:6144
ds_read_b128 v[216:219],v8 offset:15360
mf v[52:55],v[184:187],a[216:219],v[52:55]
v_rcp_f32 v33,v33
mf v[56:59],v[184:187],a[220:223],v[56:59]
buffer_load_dwordx4 v3,s[20:23],s60 offen sc1 lds
mf v[56:59],v[180:183],a[212:215],v[56:59]
s_waitcnt lgkmcnt(2)
mf v[60:63],v[188:191],a[208:211],v[60:63]
ds_read_b128 v[180:183],v8 offset:7168
ds_read_b128 v[184:187],v8 offset:16384
mf v[60:63],v[192:195],a[216:219],v[60:63]
v_rcp_f32 v34,v34
mf v[64:67],v[192:195],a[220:223],v[64:67]
buffer_load_dwordx4 a[84:87],v3,s[4:7],s71 offen offset:2048
mf v[64:67],v[188:191],a[212:215],v[64:67]
s_cmp_gt_u32 s27,4
s_cselect_b32 s74,4,5
s_mul_i32 s74,s74,36864
mf v[68:71],v[196:199],a[208:211],v[68:71]
ds_read_b128 v[188:191],v8 offset:8192
ds_read_b128 v[192:195],v8 offset:17408
mf v[68:71],v[200:203],a[216:219],v[68:71]
s_add_u32 s74,s74,s73
s_add_u32 s60,s74,0
mf v[72:75],v[200:203],a[220:223],v[72:75]
s_add_u32 m0,s61,73728
mf v[72:75],v[196:199],a[212:215],v[72:75]
buffer_load_dwordx4 v1,s[20:23],s60 offen sc1 lds
mf v[76:79],v[204:207],a[208:211],v[76:79]
ds_read_b128 v[196:199],v8 offset:18432
ds_read_b128 v[200:203],v8 offset:27648
mf v[76:79],v[208:211],a[216:219],v[76:79]
v_rcp_f32 v35,v35
mf v[80:83],v[208:211],a[220:223],v[80:83]
v_mul_f32 v116,v116,v32
v_mul_f32 v117,v117,v33
mf v[80:83],v[204:207],a[212:215],v[80:83]
v_mul_f32 v118,v118,v34
s_waitcnt lgkmcnt(2)
mf v[84:87],v[212:215],a[208:211],v[84:87]
buffer_load_dwordx4 a[88:91],v3,s[4:7],s71 offen offset:3072
mf v[84:87],v[216:219],a[216:219],v[84:87]
ds_read_b128 v[204:207],v8 offset:19456
ds_read_b128 v[208:211],v8 offset:28672
mf v[88:91],v[216:219],a[220:223],v[88:91]
v_mul_f32 v119,v119,v35
v_fmac_f32 v120,v11,v28
mf v[88:91],v[212:215],a[212:215],v[88:91]
v_fmac_f32 v121,v11,v29
v_fmac_f32 v122,v11,v30
mf v[92:95],v[180:183],a[208:211],v[92:95]
buffer_load_dwordx4 v1,s[20:23],s60 offen offset:1024 sc1 lds
mf v[92:95],v[184:187],a[216:219],v[92:95]
ds_read_b128 v[212:215],v8 offset:20480
ds_read_b128 v[216:219],v8 offset:29696
mf v[96:99],v[184:187],a[220:223],v[96:99]
v_fmac_f32 v123,v11,v31
v_mul_f32 v32,v120,v120
mf v[96:99],v[180:183],a[212:215],v[96:99]
v_mul_f32 v33,v121,v121
v_mul_f32 v34,v122,v122
mf v[100:103],v[188:191],a[208:211],v[100:103]
buffer_load_dwordx4 v1,s[20:23],s60 offen offset:2048 sc1 lds
mf v[100:103],v[192:195],a[216:219],v[100:103]
ds_read_b128 v[180:183],v8 offset:21504
ds_read_b128 v[184:187],v8 offset:30720
mf v[104:107],v[192:195],a[220:223],v[104:107]
v_mul_f32 v35,v123,v123
v_fma_f32 v32,v32,v15,v13
mf v[104:107],v[188:191],a[212:215],v[104:107]
s_waitcnt lgkmcnt(2)
mf v[36:39],v[196:199],a[224:227],v[36:39]
buffer_load_dwordx4 v1,s[20:23],s60 offen offset:3072 sc1 lds
mf v[36:39],v[200:203],a[232:235],v[36:39]
ds_read_b128 v[188:191],v8 offset:22528
ds_read_b128 v[192:195],v8 offset:31744
mf v[40:43],v[200:203],a[236:239],v[40:43]
s_add_u32 m0,s61,77824
v_fma_f32 v33,v33,v15,v13
mf v[40:43],v[196:199],a[228:231],v[40:43]
v_fma_f32 v34,v34,v15,v13
v_fma_f32 v35,v35,v15,v13
mf v[44:47],v[204:207],a[224:227],v[44:47]
buffer_load_dwordx4 v2,s[20:23],s60 offen sc1 lds
mf v[44:47],v[208:211],a[232:235],v[44:47]
ds_read_b128 v[196:199],v8 offset:23552
ds_read_b128 v[200:203],v8 offset:32768
mf v[48:51],v[208:211],a[236:239],v[48:51]
v_mul_f32 v32,v120,v32
v_mul_f32 v33,v121,v33
mf v[48:51],v[204:207],a[228:231],v[48:51]
v_mul_f32 v34,v122,v34
v_mul_f32 v35,v123,v35
mf v[52:55],v[212:215],a[224:227],v[52:55]
s_add_u32 s71,s70,61440
buffer_load_dwordx4 a[92:95],v1,s[4:7],s71 offen
mf v[52:55],v[216:219],a[232:235],v[52:55]
ds_read_b128 v[204:207],v8 offset:24576
ds_read_b128 v[208:211],v8 offset:33792
mf v[56:59],v[216:219],a[236:239],v[56:59]
v_exp_f32 v32,v32
mf v[56:59],v[212:215],a[228:231],v[56:59]
s_waitcnt lgkmcnt(2)
mf v[60:63],v[180:183],a[224:227],v[60:63]
buffer_load_dwordx4 v2,s[20:23],s60 offen offset:1024 sc1 lds
mf v[60:63],v[184:187],a[232:235],v[60:63]
ds_read_b128 v[212:215],v8 offset:25600
ds_read_b128 v[216:219],v8 offset:34816
mf v[64:67],v[184:187],a[236:239],v[64:67]
v_exp_f32 v33,v33
mf v[64:67],v[180:183],a[228:231],v[64:67]
v_exp_f32 v34,v34
mf v[68:71],v[188:191],a[224:227],v[68:71]
buffer_load_dwordx4 a[96:99],v1,s[4:7],s71 offen offset:1024
mf v[68:71],v[192:195],a[232:235],v[68:71]
ds_read_b128 v[180:183],v8 offset:26624
ds_read_b128 v[184:187],v8 offset:35840
mf v[72:75],v[192:195],a[236:239],v[72:75]
v_exp_f32 v35,v35
mf v[72:75],v[188:191],a[228:231],v[72:75]
v_fma_f32 v32,v32,v17,v17
v_fma_f32 v33,v33,v17,v17
mf v[76:79],v[196:199],a[224:227],v[76:79]
buffer_load_dwordx4 v2,s[20:23],s60 offen offset:2048 sc1 lds
mf v[76:79],v[200:203],a[232:235],v[76:79]
s_waitcnt vmcnt(21)
s_barrier
ds_read_b128 v[188:191],v1
ds_read_b128 v[192:195],v1 offset:9216
mf v[80:83],v[200:203],a[236:239],v[80:83]
v_fma_f32 v34,v34,v17,v17
v_fma_f32 v35,v35,v17,v17
mf v[80:83],v[196:199],a[228:231],v[80:83]
s_waitcnt lgkmcnt(2)
mf v[84:87],v[204:207],a[224:227],v[84:87]
buffer_load_dwordx4 a[100:103],v1,s[4:7],s71 offen offset:2048
mf v[84:87],v[208:211],a[232:235],v[84:87]
ds_read_b128 v[196:199],v1 offset:1024
ds_read_b128 v[200:203],v1 offset:10240
mf v[88:91],v[208:211],a[236:239],v[88:91]
v_rcp_f32 v32,v32
mf v[88:91],v[204:207],a[228:231],v[88:91]
v_rcp_f32 v33,v33
mf v[92:95],v[212:215],a[224:227],v[92:95]
buffer_load_dwordx4 v2,s[20:23],s60 offen offset:3072 sc1 lds
mf v[92:95],v[216:219],a[232:235],v[92:95]
ds_read_b128 v[204:207],v1 offset:2048
ds_read_b128 v[208:211],v1 offset:11264
mf v[96:99],v[216:219],a[236:239],v[96:99]
v_rcp_f32 v34,v34
mf v[96:99],v[212:215],a[228:231],v[96:99]
v_rcp_f32 v35,v35
mf v[100:103],v[180:183],a[224:227],v[100:103]
buffer_load_dwordx4 a[104:107],v1,s[4:7],s71 offen offset:3072
mf v[100:103],v[184:187],a[232:235],v[100:103]
ds_read_b128 v[212:215],v1 offset:3072
ds_read_b128 v[216:219],v1 offset:12288
mf v[104:107],v[184:187],a[236:239],v[104:107]
s_add_u32 m0,s61,81920
v_mul_f32 v120,v120,v32
mf v[104:107],v[180:183],a[228:231],v[104:107]
s_barrier
s_waitcnt lgkmcnt(2)
mf v[36:39],v[188:191],a[240:243],v[36:39]
buffer_load_dwordx4 v3,s[20:23],s60 offen sc1 lds
mf v[36:39],v[192:195],a[248:251],v[36:39]
ds_read_b128 v[180:183],v1 offset:4096
ds_read_b128 v[184:187],v1 offset:13312
mf v[40:43],v[192:195],a[252:255],v[40:43]
s_cmp_gt_u32 s27,5
s_cselect_b32 s74,5,6
s_mul_i32 s74,s74,36864
mf v[40:43],v[188:191],a[244:247],v[40:43]
s_add_u32 s74,s74,s73
s_add_u32 s60,s74,0
mf v[44:47],v[196:199],a[240:243],v[44:47]
ds_read_b128 v[188:191],v1 offset:5120
ds_read_b128 v[192:195],v1 offset:14336
mf v[44:47],v[200:203],a[248:251],v[44:47]
s_add_u32 m0,s61,110592
v_mul_f32 v121,v121,v33
mf v[48:51],v[200:203],a[252:255],v[48:51]
buffer_load_dwordx4 v1,s[20:23],s60 offen sc1 lds
mf v[48:51],v[196:199],a[244:247],v[48:51]
v_mul_f32 v122,v122,v34
v_mul_f32 v123,v123,v35
mf v[52:55],v[204:207],a[240:243],v[52:55]
ds_read_b128 v[196:199],v1 offset:6144
ds_read_b128 v[200:203],v1 offset:15360
mf v[52:55],v[208:211],a[248:251],v[52:55]
ds_read_b128 v[28:31],v20 offset:192
v_fmac_f32 v124,v10,v24
mf v[56:59],v[208:211],a[252:255],v[56:59]
buffer_load_dwordx4 a[108:111],v2,s[4:7],s71 offen
mf v[56:59],v[204:207],a[244:247],v[56:59]
v_fmac_f32 v125,v10,v25
s_waitcnt lgkmcnt(3)
mf v[60:63],v[212:215],a[240:243],v[60:63]
ds_read_b128 v[204:207],v1 offset:7168
ds_read_b128 v[208:211],v1 offset:16384
mf v[60:63],v[216:219],a[248:251],v[60:63]
v_fmac_f32 v126,v10,v26
v_fmac_f32 v127,v10,v27
mf v[64:67],v[216:219],a[252:255],v[64:67]
buffer_load_dwordx4 v1,s[20:23],s60 offen offset:1024 sc1 lds
mf v[64:67],v[212:215],a[244:247],v[64:67]
v_mul_f32 v32,v124,v124
v_mul_f32 v33,v125,v125
mf v[68:71],v[180:183],a[240:243],v[68:71]
ds_read_b128 v[212:215],v1 offset:8192
ds_read_b128 v[216:219],v1 offset:17408
mf v[68:71],v[184:187],a[248:251],v[68:71]
v_mul_f32 v34,v126,v126
v_mul_f32 v35,v127,v127
mf v[72:75],v[184:187],a[252:255],v[72:75]
buffer_load_dwordx4 a[112:115],v2,s[4:7],s71 offen offset:1024
mf v[72:75],v[180:183],a[244:247],v[72:75]
v_fma_f32 v32,v32,v14,v12
v_fma_f32 v33,v33,v14,v12
mf v[76:79],v[188:191],a[240:243],v[76:79]
ds_read_b128 v[180:183],v1 offset:18432
ds_read_b128 v[184:187],v1 offset:27648
mf v[76:79],v[192:195],a[248:251],v[76:79]
v_fma_f32 v34,v34,v14,v12
v_fma_f32 v35,v35,v14,v12
mf v[80:83],v[192:195],a[252:255],v[80:83]
buffer_load_dwordx4 v1,s[20:23],s60 offen offset:2048 sc1 lds
mf v[80:83],v[188:191],a[244:247],v[80:83]
v_mul_f32 v32,v124,v32
s_waitcnt lgkmcnt(2)
mf v[84:87],v[196:199],a[240:243],v[84:87]
ds_read_b128 v[188:191],v1 offset:19456
ds_read_b128 v[192:195],v1 offset:28672
mf v[84:87],v[200:203],a[248:251],v[84:87]
v_mul_f32 v33,v125,v33
v_mul_f32 v34,v126,v34
mf v[88:91],v[200:203],a[252:255],v[88:91]
buffer_load_dwordx4 a[116:119],v2,s[4:7],s71 offen offset:2048
mf v[88:91],v[196:199],a[244:247],v[88:91]
v_mul_f32 v35,v127,v35
mf v[92:95],v[204:207],a[240:243],v[92:95]
ds_read_b128 v[196:199],v1 offset:20480
ds_read_b128 v[200:203],v1 offset:29696
mf v[92:95],v[208:211],a[248:251],v[92:95]
v_exp_f32 v32,v32
mf v[96:99],v[208:211],a[252:255],v[96:99]
buffer_load_dwordx4 v1,s[20:23],s60 offen offset:3072 sc1 lds
mf v[96:99],v[204:207],a[244:247],v[96:99]
v_exp_f32 v33,v33
mf v[100:103],v[212:215],a[240:243],v[100:103]
ds_read_b128 v[204:207],v1 offset:21504
ds_read_b128 v[208:211],v1 offset:30720
mf v[100:103],v[216:219],a[248:251],v[100:103]
v_exp_f32 v34,v34
mf v[104:107],v[216:219],a[252:255],v[104:107]
buffer_load_dwordx4 a[120:123],v2,s[4:7],s71 offen offset:3072
mf v[104:107],v[212:215],a[244:247],v[104:107]
s_waitcnt lgkmcnt(2)
mf v[36:39],v[180:183],a[0:3],v[36:39]
ds_read_b128 v[212:215],v1 offset:22528
ds_read_b128 v[216:219],v1 offset:31744
mf v[36:39],v[184:187],a[8:11],v[36:39]
v_exp_f32 v35,v35
mf v[40:43],v[184:187],v[220:223],v[40:43]
buffer_load_dwordx4 a[124:127],v3,s[4:7],s71 offen
mf v[40:43],v[180:183],a[4:7],v[40:43]
s_add_u32 m0,s61,114688
v_fma_f32 v32,v32,v16,v16
mf v[44:47],v[188:191],a[0:3],v[44:47]
ds_read_b128 v[180:183],v1 offset:23552
ds_read_b128 v[184:187],v1 offset:32768
mf v[44:47],v[192:195],a[8:11],v[44:47]
v_fma_f32 v33,v33,v16,v16
v_fma_f32 v34,v34,v16,v16
mf v[48:51],v[192:195],v[220:223],v[48:51]
buffer_load_dwordx4 v2,s[20:23],s60 offen sc1 lds
mf v[48:51],v[188:191],a[4:7],v[48:51]
v_fma_f32 v35,v35,v16,v16
mf v[52:55],v[196:199],a[0:3],v[52:55]
ds_read_b128 v[188:191],v1 offset:24576
ds_read_b128 v[192:195],v1 offset:33792
mf v[52:55],v[200:203],a[8:11],v[52:55]
v_rcp_f32 v32,v32
mf v[56:59],v[200:203],v[220:223],v[56:59]
buffer_load_dwordx4 a[128:131],v3,s[4:7],s71 offen offset:1024
mf v[56:59],v[196:199],a[4:7],v[56:59]
s_waitcnt lgkmcnt(2)
mf v[60:63],v[204:207],a[0:3],v[60:63]
ds_read_b128 v[196:199],v1 offset:25600
ds_read_b128 v[200:203],v1 offset:34816
mf v[60:63],v[208:211],a[8:11],v[60:63]
v_rcp_f32 v33,v33
mf v[64:67],v[208:211],v[220:223],v[64:67]
buffer_load_dwordx4 v2,s[20:23],s60 offen offset:1024 sc1 lds
mf v[64:67],v[204:207],a[4:7],v[64:67]
v_rcp_f32 v34,v34
mf v[68:71],v[212:215],a[0:3],v[68:71]
ds_read_b128 v[204:207],v1 offset:26624
ds_read_b128 v[208:211],v1 offset:35840
mf v[68:71],v[216:219],a[8:11],v[68:71]
v_rcp_f32 v35,v35
mf v[72:75],v[216:219],v[220:223],v[72:75]
buffer_load_dwordx4 a[132:135],v3,s[4:7],s71 offen offset:2048
mf v[72:75],v[212:215],a[4:7],v[72:75]
v_mul_f32 v124,v124,v32
v_mul_f32 v125,v125,v33
mf v[76:79],v[180:183],a[0:3],v[76:79]
s_waitcnt vmcnt(28)
s_barrier
ds_read_b128 v[212:215],v6
ds_read_b128 v[216:219],v6 offset:9216
mf v[76:79],v[184:187],a[8:11],v[76:79]
v_mul_f32 v126,v126,v34
v_mul_f32 v127,v127,v35
mf v[80:83],v[184:187],v[220:223],v[80:83]
buffer_load_dwordx4 v2,s[20:23],s60 offen offset:2048 sc1 lds
mf v[80:83],v[180:183],a[4:7],v[80:83]
v_fmac_f32 v128,v11,v24
s_waitcnt lgkmcnt(2)
mf v[84:87],v[188:191],a[0:3],v[84:87]
ds_read_b128 v[180:183],v6 offset:1024
ds_read_b128 v[184:187],v6 offset:10240
mf v[84:87],v[192:195],a[8:11],v[84:87]
v_fmac_f32 v129,v11,v25
v_fmac_f32 v130,v11,v26
mf v[88:91],v[192:195],v[220:223],v[88:91]
buffer_load_dwordx4 a[136:139],v3,s[4:7],s71 offen offset:3072
mf v[88:91],v[188:191],a[4:7],v[88:91]
v_fmac_f32 v131,v11,v27
v_mul_f32 v32,v128,v128
mf v[92:95],v[196:199],a[0:3],v[92:95]
ds_read_b128 v[188:191],v6 offset:2048
ds_read_b128 v[192:195],v6 offset:11264
mf v[92:95],v[200:203],a[8:11],v[92:95]
v_mul_f32 v33,v129,v129
v_mul_f32 v34,v130,v130
mf v[96:99],v[200:203],v[220:223],v[96:99]
buffer_load_dwordx4 v2,s[20:23],s60 offen offset:3072 sc1 lds
mf v[96:99],v[196:199],a[4:7],v[96:99]
v_mul_f32 v35,v131,v131
v_fma_f32 v32,v32,v15,v13
mf v[100:103],v[204:207],a[0:3],v[100:103]
ds_read_b128 v[196:199],v6 offset:3072
ds_read_b128 v[200:203],v6 offset:12288
mf v[100:103],v[208:211],a[8:11],v[100:103]
v_fma_f32 v33,v33,v15,v13
v_fma_f32 v34,v34,v15,v13
mf v[104:107],v[208:211],v[220:223],v[104:107]
s_add_u32 s71,s70,73728
buffer_load_dwordx4 a[140:143],v1,s[4:7],s71 offen
mf v[104:107],v[204:207],a[4:7],v[104:107]
s_waitcnt vmcnt(17)
s_barrier
s_waitcnt lgkmcnt(2)
mf v[36:39],v[212:215],v[224:227],v[36:39]
ds_read_b128 v[204:207],v6 offset:4096
ds_read_b128 v[208:211],v6 offset:13312
mf v[36:39],v[216:219],v[232:235],v[36:39]
s_add_u32 m0,s61,118784
v_fma_f32 v35,v35,v15,v13
mf v[40:43],v[216:219],v[236:239],v[40:43]
buffer_load_dwordx4 v3,s[20:23],s60 offen sc1 lds
mf v[40:43],v[212:215],v[228:231],v[40:43]
s_cmp_gt_u32 s27,6
s_cselect_b32 s74,6,7
s_mul_i32 s74,s74,36864
mf v[44:47],v[180:183],v[224:227],v[44:47]
ds_read_b128 v[212:215],v6 offset:5120
ds_read_b128 v[216:219],v6 offset:14336
mf v[44:47],v[184:187],v[232:235],v[44:47]
s_add_u32 s74,s74,s73
s_add_u32 s60,s74,0
mf v[48:51],v[184:187],v[236:239],v[48:51]
s_add_u32 m0,s61,0
v_mul_f32 v32,v128,v32
mf v[48:51],v[180:183],v[228:231],v[48:51]
buffer_load_dwordx4 v1,s[20:23],s60 offen sc1 lds
mf v[52:55],v[188:191],v[224:227],v[52:55]
ds_read_b128 v[180:183],v6 offset:6144
ds_read_b128 v[184:187],v6 offset:15360
mf v[52:55],v[192:195],v[232:235],v[52:55]
v_mul_f32 v33,v129,v33
v_mul_f32 v34,v130,v34
mf v[56:59],v[192:195],v[236:239],v[56:59]
v_mul_f32 v35,v131,v35
mf v[56:59],v[188:191],v[228:231],v[56:59]
s_waitcnt lgkmcnt(2)
mf v[60:63],v[196:199],v[224:227],v[60:63]
buffer_load_dwordx4 v[220:223],v1,s[4:7],s71 offen offset:1024
mf v[60:63],v[200:203],v[232:235],v[60:63]
ds_read_b128 v[188:191],v6 offset:7168
ds_read_b128 v[192:195],v6 offset:16384
mf v[64:67],v[200:203],v[236:239],v[64:67]
v_exp_f32 v32,v32
mf v[64:67],v[196:199],v[228:231],v[64:67]
v_exp_f32 v33,v33
mf v[68:71],v[204:207],v[224:227],v[68:71]
buffer_load_dwordx4 v1,s[20:23],s60 offen offset:1024 sc1 lds
mf v[68:71],v[208:211],v[232:235],v[68:71]
ds_read_b128 v[196:199],v6 offset:8192
ds_read_b128 v[200:203],v6 offset:17408
mf v[72:75],v[208:211],v[236:239],v[72:75]
v_exp_f32 v34,v34
mf v[72:75],v[204:207],v[228:231],v[72:75]
v_exp_f32 v35,v35
mf v[76:79],v[212:215],v[224:227],v[76:79]
buffer_load_dwordx4 a[244:247],v1,s[4:7],s71 offen offset:2048
mf v[76:79],v[216:219],v[232:235],v[76:79]
ds_read_b128 v[204:207],v6 offset:18432
ds_read_b128 v[208:211],v6 offset:27648
mf v[80:83],v[216:219],v[236:239],v[80:83]
v_fma_f32 v32,v32,v17,v17
v_fma_f32 v33,v33,v17,v17
mf v[80:83],v[212:215],v[228:231],v[80:83]
v_fma_f32 v34,v34,v17,v17
s_waitcnt lgkmcnt(2)
mf v[84:87],v[180:183],v[224:227],v[84:87]
buffer_load_dwordx4 v1,s[20:23],s60 offen offset:2048 sc1 lds
mf v[84:87],v[184:187],v[232:235],v[84:87]
ds_read_b128 v[212:215],v6 offset:19456
ds_read_b128 v[216:219],v6 offset:28672
mf v[88:91],v[184:187],v[236:239],v[88:91]
v_fma_f32 v35,v35,v17,v17
mf v[88:91],v[180:183],v[228:231],v[88:91]
v_rcp_f32 v32,v32
mf v[92:95],v[188:191],v[224:227],v[92:95]
buffer_load_dwordx4 a[248:251],v1,s[4:7],s71 offen offset:3072
mf v[92:95],v[192:195],v[232:235],v[92:95]
ds_read_b128 v[180:183],v6 offset:20480
ds_read_b128 v[184:187],v6 offset:29696
mf v[96:99],v[192:195],v[236:239],v[96:99]
v_rcp_f32 v33,v33
mf v[96:99],v[188:191],v[228:231],v[96:99]
v_rcp_f32 v34,v34
mf v[100:103],v[196:199],v[224:227],v[100:103]
buffer_load_dwordx4 v1,s[20:23],s60 offen offset:3072 sc1 lds
mf v[100:103],v[200:203],v[232:235],v[100:103]
ds_read_b128 v[188:191],v6 offset:21504
ds_read_b128 v[192:195],v6 offset:30720
mf v[104:107],v[200:203],v[236:239],v[104:107]
v_rcp_f32 v35,v35
mf v[104:107],v[196:199],v[228:231],v[104:107]
s_waitcnt lgkmcnt(2)
mf v[36:39],v[204:207],v[240:243],v[36:39]
buffer_load_dwordx4 a[252:255],v2,s[4:7],s71 offen
mf v[36:39],v[208:211],a[12:15],v[36:39]
ds_read_b128 v[196:199],v6 offset:22528
ds_read_b128 v[200:203],v6 offset:31744
mf v[40:43],v[208:211],a[16:19],v[40:43]
s_add_u32 m0,s61,4096
v_mul_f32 v128,v128,v32
mf v[40:43],v[204:207],v[252:255],v[40:43]
v_mul_f32 v129,v129,v33
v_mul_f32 v130,v130,v34
mf v[44:47],v[212:215],v[240:243],v[44:47]
buffer_load_dwordx4 v2,s[20:23],s60 offen sc1 lds
mf v[44:47],v[216:219],a[12:15],v[44:47]
ds_read_b128 v[204:207],v6 offset:23552
ds_read_b128 v[208:211],v6 offset:32768
mf v[48:51],v[216:219],a[16:19],v[48:51]
v_mul_f32 v131,v131,v35
ds_read_b128 v[24:27],v20 offset:256
mf v[48:51],v[212:215],v[252:255],v[48:51]
v_fmac_f32 v132,v10,v28
v_fmac_f32 v133,v10,v29
mf v[52:55],v[180:183],v[240:243],v[52:55]
buffer_load_dwordx4 v[224:227],v2,s[4:7],s71 offen offset:1024
mf v[52:55],v[184:187],a[12:15],v[52:55]
ds_read_b128 v[212:215],v6 offset:24576
ds_read_b128 v[216:219],v6 offset:33792
mf v[56:59],v[184:187],a[16:19],v[56:59]
v_fmac_f32 v134,v10,v30
v_fmac_f32 v135,v10,v31
mf v[56:59],v[180:183],v[252:255],v[56:59]
v_mul_f32 v32,v132,v132
s_waitcnt lgkmcnt(3)
mf v[60:63],v[188:191],v[240:243],v[60:63]
buffer_load_dwordx4 v2,s[20:23],s60 offen offset:1024 sc1 lds
mf v[60:63],v[192:195],a[12:15],v[60:63]
ds_read_b128 v[180:183],v6 offset:25600
ds_read_b128 v[184:187],v6 offset:34816
mf v[64:67],v[192:195],a[16:19],v[64:67]
v_mul_f32 v33,v133,v133
v_mul_f32 v34,v134,v134
mf v[64:67],v[188:191],v[252:255],v[64:67]
v_mul_f32 v35,v135,v135
v_fma_f32 v32,v32,v14,v12
mf v[68:71],v[196:199],v[240:243],v[68:71]
buffer_load_dwordx4 v[228:231],v2,s[4:7],s71 offen offset:2048
mf v[68:71],v[200:203],a[12:15],v[68:71]
ds_read_b128 v[188:191],v6 offset:26624
ds_read_b128 v[192:195],v6 offset:35840
mf v[72:75],v[200:203],a[16:19],v[72:75]
v_fma_f32 v33,v33,v14,v12
v_fma_f32 v34,v34,v14,v12
mf v[72:75],v[196:199],v[252:255],v[72:75]
v_fma_f32 v35,v35,v14,v12
v_mul_f32 v32,v132,v32
mf v[76:79],v[204:207],v[240:243],v[76:79]
buffer_load_dwordx4 v2,s[20:23],s60 offen offset:2048 sc1 lds
mf v[76:79],v[208:211],a[12:15],v[76:79]
ds_read_b128 v[196:199],v7
ds_read_b128 v[200:203],v7 offset:9216
mf v[80:83],v[208:211],a[16:19],v[80:83]
v_mul_f32 v33,v133,v33
v_mul_f32 v34,v134,v34
mf v[80:83],v[204:207],v[252:255],v[80:83]
v_mul_f32 v35,v135,v35
s_waitcnt lgkmcnt(2)
mf v[84:87],v[212:215],v[240:243],v[84:87]
buffer_load_dwordx4 v[232:235],v2,s[4:7],s71 offen offset:3072
mf v[84:87],v[216:219],a[12:15],v[84:87]
ds_read_b128 v[204:207],v7 offset:1024
ds_read_b128 v[208:211],v7 offset:10240
mf v[88:91],v[216:219],a[16:19],v[88:91]
v_exp_f32 v32,v32
mf v[88:91],v[212:215],v[252:255],v[88:91]
v_exp_f32 v33,v33
mf v[92:95],v[180:183],v[240:243],v[92:95]
buffer_load_dwordx4 v2,s[20:23],s60 offen offset:3072 sc1 lds
mf v[92:95],v[184:187],a[12:15],v[92:95]
ds_read_b128 v[212:215],v7 offset:2048
ds_read_b128 v[216:219],v7 offset:11264
mf v[96:99],v[184:187],a[16:19],v[96:99]
s_add_u32 m0,s61,8192
mf v[96:99],v[180:183],v[252:255],v[96:99]
v_exp_f32 v34,v34
mf v[100:103],v[188:191],v[240:243],v[100:103]
buffer_load_dwordx4 v3,s[20:23],s60 offen sc1 lds
mf v[100:103],v[192:195],a[12:15],v[100:103]
ds_read_b128 v[180:183],v7 offset:3072
ds_read_b128 v[184:187],v7 offset:12288
mf v[104:107],v[192:195],a[16:19],v[104:107]
v_exp_f32 v35,v35
mf v[104:107],v[188:191],v[252:255],v[104:107]
s_waitcnt vmcnt(16)
s_barrier
s_waitcnt lgkmcnt(2)
mf v[36:39],v[196:199],a[20:23],v[36:39]
ds_read_b128 v[188:191],v7 offset:4096
ds_read_b128 v[192:195],v7 offset:13312
mf v[36:39],v[200:203],a[28:31],v[36:39]
s_cmp_gt_u32 s27,7
s_cselect_b32 s74,7,8
s_mul_i32 s74,s74,36864
mf v[40:43],v[200:203],a[32:35],v[40:43]
s_add_u32 s74,s74,s73
s_add_u32 s60,s74,0
mf v[40:43],v[196:199],a[24:27],v[40:43]
s_add_u32 m0,s61,36864
v_fma_f32 v32,v32,v16,v16
mf v[44:47],v[204:207],a[20:23],v[44:47]
buffer_load_dwordx4 v1,s[20:23],s60 offen sc1 lds
mf v[44:47],v[208:211],a[28:31],v[44:47]
ds_read_b128 v[196:199],v7 offset:5120
ds_read_b128 v[200:203],v7 offset:14336
mf v[48:51],v[208:211],a[32:35],v[48:51]
v_fma_f32 v33,v33,v16,v16
v_fma_f32 v34,v34,v16,v16
mf v[48:51],v[204:207],a[24:27],v[48:51]
v_fma_f32 v35,v35,v16,v16
mf v[52:55],v[212:215],a[20:23],v[52:55]
buffer_load_dwordx4 v[236:239],v3,s[4:7],s71 offen
mf v[52:55],v[216:219],a[28:31],v[52:55]
ds_read_b128 v[204:207],v7 offset:6144
ds_read_b128 v[208:211],v7 offset:15360
mf v[56:59],v[216:219],a[32:35],v[56:59]
v_rcp_f32 v32,v32
mf v[56:59],v[212:215],a[24:27],v[56:59]
s_waitcnt lgkmcnt(2)
mf v[60:63],v[180:183],a[20:23],v[60:63]
buffer_load_dwordx4 v1,s[20:23],s60 offen offset:1024 sc1 lds
mf v[60:63],v[184:187],a[28:31],v[60:63]
ds_read_b128 v[212:215],v7 offset:7168
ds_read_b128 v[216:219],v7 offset:16384
mf v[64:67],v[184:187],a[32:35],v[64:67]
v_rcp_f32 v33,v33
mf v[64:67],v[180:183],a[24:27],v[64:67]
v_rcp_f32 v34,v34
mf v[68:71],v[188:191],a[20:23],v[68:71]
buffer_load_dwordx4 v[240:243],v3,s[4:7],s71 offen offset:1024
mf v[68:71],v[192:195],a[28:31],v[68:71]
ds_read_b128 v[180:183],v7 offset:8192
ds_read_b128 v[184:187],v7 offset:17408
mf v[72:75],v[192:195],a[32:35],v[72:75]
v_rcp_f32 v35,v35
mf v[72:75],v[188:191],a[24:27],v[72:75]
v_mul_f32 v132,v132,v32
v_mul_f32 v133,v133,v33
mf v[76:79],v[196:199],a[20:23],v[76:79]
buffer_load_dwordx4 v1,s[20:23],s60 offen offset:2048 sc1 lds
mf v[76:79],v[200:203],a[28:31],v[76:79]
ds_read_b128 v[188:191],v7 offset:18432
ds_read_b128 v[192:195],v7 offset:27648
mf v[80:83],v[200:203],a[32:35],v[80:83]
v_mul_f32 v134,v134,v34
v_mul_f32 v135,v135,v35
mf v[80:83],v[196:199],a[24:27],v[80:83]
v_fmac_f32 v136,v11,v28
s_waitcnt lgkmcnt(2)
mf v[84:87],v[204:207],a[20:23],v[84:87]
buffer_load_dwordx4 v[252:255],v3,s[4:7],s71 offen offset:2048
mf v[84:87],v[208:211],a[28:31],v[84:87]
ds_read_b128 v[196:199],v7 offset:19456
ds_read_b128 v[200:203],v7 offset:28672
mf v[88:91],v[208:211],a[32:35],v[88:91]
v_fmac_f32 v137,v11,v29
v_fmac_f32 v138,v11,v30
mf v[88:91],v[204:207],a[24:27],v[88:91]
v_fmac_f32 v139,v11,v31
v_mul_f32 v32,v136,v136
mf v[92:95],v[212:215],a[20:23],v[92:95]
buffer_load_dwordx4 v1,s[20:23],s60 offen offset:3072 sc1 lds
mf v[92:95],v[216:219],a[28:31],v[92:95]
ds_read_b128 v[204:207],v7 offset:20480
ds_read_b128 v[208:211],v7 offset:29696
mf v[96:99],v[216:219],a[32:35],v[96:99]
v_mul_f32 v33,v137,v137
v_mul_f32 v34,v138,v138
mf v[96:99],v[212:215],a[24:27],v[96:99]
v_mul_f32 v35,v139,v139
v_fma_f32 v32,v32,v15,v13
mf v[100:103],v[180:183],a[20:23],v[100:103]
buffer_load_dwordx4 a[0:3],v3,s[4:7],s71 offen offset:3072
mf v[100:103],v[184:187],a[28:31],v[100:103]
ds_read_b128 v[212:215],v7 offset:21504
ds_read_b128 v[216:219],v7 offset:30720
mf v[104:107],v[184:187],a[32:35],v[104:107]
Ljt94:
s_add_u32 s101,s3,Ljt94-Ljb41+1536
v_fma_f32 v33,v33,v15,v13
mf v[104:107],v[180:183],a[24:27],v[104:107]
s_waitcnt lgkmcnt(2)
mf v[36:39],v[188:191],a[36:39],v[36:39]
buffer_load_dword v9,off,s[16:19],s101
mf v[36:39],v[192:195],a[44:47],v[36:39]
ds_read_b128 v[180:183],v7 offset:22528
ds_read_b128 v[184:187],v7 offset:31744
mf v[40:43],v[192:195],a[48:51],v[40:43]
s_add_u32 m0,s61,40960
v_fma_f32 v34,v34,v15,v13
mf v[40:43],v[188:191],a[40:43],v[40:43]
v_fma_f32 v35,v35,v15,v13
v_mul_f32 v32,v136,v32
mf v[44:47],v[196:199],a[36:39],v[44:47]
buffer_load_dwordx4 v2,s[20:23],s60 offen sc1 lds
mf v[44:47],v[200:203],a[44:47],v[44:47]
ds_read_b128 v[188:191],v7 offset:23552
ds_read_b128 v[192:195],v7 offset:32768
mf v[48:51],v[200:203],a[48:51],v[48:51]
v_mul_f32 v33,v137,v33
v_mul_f32 v34,v138,v34
mf v[48:51],v[196:199],a[40:43],v[48:51]
v_mul_f32 v35,v139,v35
mf v[52:55],v[204:207],a[36:39],v[52:55]
s_add_u32 s71,s70,86016
buffer_load_dwordx4 a[4:7],v1,s[4:7],s71 offen
mf v[52:55],v[208:211],a[44:47],v[52:55]
ds_read_b128 v[196:199],v7 offset:24576
ds_read_b128 v[200:203],v7 offset:33792
mf v[56:59],v[208:211],a[48:51],v[56:59]
v_exp_f32 v32,v32
mf v[56:59],v[204:207],a[40:43],v[56:59]
s_waitcnt lgkmcnt(2)
mf v[60:63],v[212:215],a[36:39],v[60:63]
buffer_load_dwordx4 v2,s[20:23],s60 offen offset:1024 sc1 lds
mf v[60:63],v[216:219],a[44:47],v[60:63]
ds_read_b128 v[204:207],v7 offset:25600
ds_read_b128 v[208:211],v7 offset:34816
mf v[64:67],v[216:219],a[48:51],v[64:67]
v_exp_f32 v33,v33
mf v[64:67],v[212:215],a[40:43],v[64:67]
v_exp_f32 v34,v34
mf v[68:71],v[180:183],a[36:39],v[68:71]
buffer_load_dwordx4 a[8:11],v1,s[4:7],s71 offen offset:1024
mf v[68:71],v[184:187],a[44:47],v[68:71]
ds_read_b128 v[212:215],v7 offset:26624
ds_read_b128 v[216:219],v7 offset:35840
mf v[72:75],v[184:187],a[48:51],v[72:75]
v_exp_f32 v35,v35
mf v[72:75],v[180:183],a[40:43],v[72:75]
v_fma_f32 v32,v32,v17,v17
v_fma_f32 v33,v33,v17,v17
mf v[76:79],v[188:191],a[36:39],v[76:79]
buffer_load_dwordx4 v2,s[20:23],s60 offen offset:2048 sc1 lds
mf v[76:79],v[192:195],a[44:47],v[76:79]
ds_read_b128 v[180:183],v8
ds_read_b128 v[184:187],v8 offset:9216
mf v[80:83],v[192:195],a[48:51],v[80:83]
v_fma_f32 v34,v34,v17,v17
v_fma_f32 v35,v35,v17,v17
mf v[80:83],v[188:191],a[40:43],v[80:83]
s_waitcnt lgkmcnt(2)
mf v[84:87],v[196:199],a[36:39],v[84:87]
buffer_load_dwordx4 a[12:15],v1,s[4:7],s71 offen offset:2048
mf v[84:87],v[200:203],a[44:47],v[84:87]
ds_read_b128 v[188:191],v8 offset:1024
ds_read_b128 v[192:195],v8 offset:10240
mf v[88:91],v[200:203],a[48:51],v[88:91]
v_rcp_f32 v32,v32
mf v[88:91],v[196:199],a[40:43],v[88:91]
v_rcp_f32 v33,v33
mf v[92:95],v[204:207],a[36:39],v[92:95]
buffer_load_dwordx4 v2,s[20:23],s60 offen offset:3072 sc1 lds
mf v[92:95],v[208:211],a[44:47],v[92:95]
ds_read_b128 v[196:199],v8 offset:2048
ds_read_b128 v[200:203],v8 offset:11264
mf v[96:99],v[208:211],a[48:51],v[96:99]
s_add_u32 m0,s61,45056
mf v[96:99],v[204:207],a[40:43],v[96:99]
v_rcp_f32 v34,v34
mf v[100:103],v[212:215],a[36:39],v[100:103]
buffer_load_dwordx4 v3,s[20:23],s60 offen sc1 lds
mf v[100:103],v[216:219],a[44:47],v[100:103]
ds_read_b128 v[204:207],v8 offset:3072
ds_read_b128 v[208:211],v8 offset:12288
mf v[104:107],v[216:219],a[48:51],v[104:107]
v_rcp_f32 v35,v35
mf v[104:107],v[212:215],a[40:43],v[104:107]
s_waitcnt vmcnt(17)
s_barrier
s_waitcnt lgkmcnt(2)
mf v[36:39],v[180:183],a[52:55],v[36:39]
ds_read_b128 v[212:215],v8 offset:4096
ds_read_b128 v[216:219],v8 offset:13312
mf v[36:39],v[184:187],a[60:63],v[36:39]
s_cmp_gt_u32 s27,8
s_cselect_b32 s74,8,9
s_mul_i32 s74,s74,36864
mf v[40:43],v[184:187],a[64:67],v[40:43]
s_add_u32 s74,s74,s73
s_add_u32 s60,s74,0
mf v[40:43],v[180:183],a[56:59],v[40:43]
s_add_u32 m0,s61,73728
v_mul_f32 v136,v136,v32
mf v[44:47],v[188:191],a[52:55],v[44:47]
buffer_load_dwordx4 v1,s[20:23],s60 offen sc1 lds
mf v[44:47],v[192:195],a[60:63],v[44:47]
ds_read_b128 v[180:183],v8 offset:5120
ds_read_b128 v[184:187],v8 offset:14336
mf v[48:51],v[192:195],a[64:67],v[48:51]
v_mul_f32 v137,v137,v33
v_mul_f32 v138,v138,v34
mf v[48:51],v[188:191],a[56:59],v[48:51]
v_mul_f32 v139,v139,v35
ds_read_b128 v[28:31],v20 offset:320
mf v[52:55],v[196:199],a[52:55],v[52:55]
buffer_load_dwordx4 a[16:19],v1,s[4:7],s71 offen offset:3072
mf v[52:55],v[200:203],a[60:63],v[52:55]
ds_read_b128 v[188:191],v8 offset:6144
ds_read_b128 v[192:195],v8 offset:15360
mf v[56:59],v[200:203],a[64:67],v[56:59]
v_fmac_f32 v140,v10,v24
v_fmac_f32 v141,v10,v25
mf v[56:59],v[196:199],a[56:59],v[56:59]
v_fmac_f32 v142,v10,v26
s_waitcnt lgkmcnt(3)
mf v[60:63],v[204:207],a[52:55],v[60:63]
buffer_load_dwordx4 v1,s[20:23],s60 offen offset:1024 sc1 lds
mf v[60:63],v[208:211],a[60:63],v[60:63]
ds_read_b128 v[196:199],v8 offset:7168
ds_read_b128 v[200:203],v8 offset:16384
mf v[64:67],v[208:211],a[64:67],v[64:67]
v_fmac_f32 v143,v10,v27
v_mul_f32 v32,v140,v140
mf v[64:67],v[204:207],a[56:59],v[64:67]
v_mul_f32 v33,v141,v141
v_mul_f32 v34,v142,v142
mf v[68:71],v[212:215],a[52:55],v[68:71]
buffer_load_dwordx4 a[20:23],v2,s[4:7],s71 offen
mf v[68:71],v[216:219],a[60:63],v[68:71]
ds_read_b128 v[204:207],v8 offset:8192
ds_read_b128 v[208:211],v8 offset:17408
mf v[72:75],v[216:219],a[64:67],v[72:75]
v_mul_f32 v35,v143,v143
v_fma_f32 v32,v32,v14,v12
mf v[72:75],v[212:215],a[56:59],v[72:75]
v_fma_f32 v33,v33,v14,v12
v_fma_f32 v34,v34,v14,v12
mf v[76:79],v[180:183],a[52:55],v[76:79]
buffer_load_dwordx4 v1,s[20:23],s60 offen offset:2048 sc1 lds
mf v[76:79],v[184:187],a[60:63],v[76:79]
ds_read_b128 v[212:215],v8 offset:18432
ds_read_b128 v[216:219],v8 offset:27648
mf v[80:83],v[184:187],a[64:67],v[80:83]
v_fma_f32 v35,v35,v14,v12
v_mul_f32 v32,v140,v32
mf v[80:83],v[180:183],a[56:59],v[80:83]
v_mul_f32 v33,v141,v33
s_waitcnt lgkmcnt(2)
mf v[84:87],v[188:191],a[52:55],v[84:87]
buffer_load_dwordx4 a[24:27],v2,s[4:7],s71 offen offset:1024
mf v[84:87],v[192:195],a[60:63],v[84:87]
ds_read_b128 v[180:183],v8 offset:19456
ds_read_b128 v[184:187],v8 offset:28672
mf v[88:91],v[192:195],a[64:67],v[88:91]
v_mul_f32 v34,v142,v34
v_mul_f32 v35,v143,v35
mf v[88:91],v[188:191],a[56:59],v[88:91]
v_exp_f32 v32,v32
mf v[92:95],v[196:199],a[52:55],v[92:95]
buffer_load_dwordx4 v1,s[20:23],s60 offen offset:3072 sc1 lds
mf v[92:95],v[200:203],a[60:63],v[92:95]
ds_read_b128 v[188:191],v8 offset:20480
ds_read_b128 v[192:195],v8 offset:29696
mf v[96:99],v[200:203],a[64:67],v[96:99]
v_exp_f32 v33,v33
mf v[96:99],v[196:199],a[56:59],v[96:99]
v_exp_f32 v34,v34
mf v[100:103],v[204:207],a[52:55],v[100:103]
buffer_load_dwordx4 a[28:31],v2,s[4:7],s71 offen offset:2048
mf v[100:103],v[208:211],a[60:63],v[100:103]
ds_read_b128 v[196:199],v8 offset:21504
ds_read_b128 v[200:203],v8 offset:30720
mf v[104:107],v[208:211],a[64:67],v[104:107]
v_exp_f32 v35,v35
mf v[104:107],v[204:207],a[56:59],v[104:107]
s_waitcnt lgkmcnt(2)
mf v[36:39],v[212:215],a[68:71],v[36:39]
ds_read_b128 v[204:207],v8 offset:22528
ds_read_b128 v[208:211],v8 offset:31744
mf v[36:39],v[216:219],a[76:79],v[36:39]
s_add_u32 m0,s61,77824
v_fma_f32 v32,v32,v16,v16
mf v[40:43],v[216:219],v[244:247],v[40:43]
buffer_load_dwordx4 v2,s[20:23],s60 offen sc1 lds
mf v[40:43],v[212:215],a[72:75],v[40:43]
v_fma_f32 v33,v33,v16,v16
v_fma_f32 v34,v34,v16,v16
mf v[44:47],v[180:183],a[68:71],v[44:47]
ds_read_b128 v[212:215],v8 offset:23552
ds_read_b128 v[216:219],v8 offset:32768
mf v[44:47],v[184:187],a[76:79],v[44:47]
v_fma_f32 v35,v35,v16,v16
mf v[48:51],v[184:187],v[244:247],v[48:51]
buffer_load_dwordx4 a[32:35],v2,s[4:7],s71 offen offset:3072
mf v[48:51],v[180:183],a[72:75],v[48:51]
v_rcp_f32 v32,v32
mf v[52:55],v[188:191],a[68:71],v[52:55]
ds_read_b128 v[180:183],v8 offset:24576
ds_read_b128 v[184:187],v8 offset:33792
mf v[52:55],v[192:195],a[76:79],v[52:55]
v_rcp_f32 v33,v33
mf v[56:59],v[192:195],v[244:247],v[56:59]
buffer_load_dwordx4 v2,s[20:23],s60 offen offset:1024 sc1 lds
mf v[56:59],v[188:191],a[72:75],v[56:59]
s_waitcnt lgkmcnt(2)
mf v[60:63],v[196:199],a[68:71],v[60:63]
ds_read_b128 v[188:191],v8 offset:25600
ds_read_b128 v[192:195],v8 offset:34816
mf v[60:63],v[200:203],a[76:79],v[60:63]
v_rcp_f32 v34,v34
mf v[64:67],v[200:203],v[244:247],v[64:67]
buffer_load_dwordx4 a[36:39],v3,s[4:7],s71 offen
mf v[64:67],v[196:199],a[72:75],v[64:67]
v_rcp_f32 v35,v35
mf v[68:71],v[204:207],a[68:71],v[68:71]
ds_read_b128 v[196:199],v8 offset:26624
ds_read_b128 v[200:203],v8 offset:35840
mf v[68:71],v[208:211],a[76:79],v[68:71]
v_mul_f32 v140,v140,v32
v_mul_f32 v141,v141,v33
mf v[72:75],v[208:211],v[244:247],v[72:75]
buffer_load_dwordx4 v2,s[20:23],s60 offen offset:2048 sc1 lds
mf v[72:75],v[204:207],a[72:75],v[72:75]
v_mul_f32 v142,v142,v34
v_mul_f32 v143,v143,v35
mf v[76:79],v[212:215],a[68:71],v[76:79]
ds_read_b128 v[204:207],v1
ds_read_b128 v[208:211],v1 offset:9216
mf v[76:79],v[216:219],a[76:79],v[76:79]
v_fmac_f32 v144,v11,v24
v_fmac_f32 v145,v11,v25
mf v[80:83],v[216:219],v[244:247],v[80:83]
buffer_load_dwordx4 a[40:43],v3,s[4:7],s71 offen offset:1024
mf v[80:83],v[212:215],a[72:75],v[80:83]
v_fmac_f32 v146,v11,v26
s_waitcnt lgkmcnt(2)
mf v[84:87],v[180:183],a[68:71],v[84:87]
ds_read_b128 v[212:215],v1 offset:1024
ds_read_b128 v[216:219],v1 offset:10240
mf v[84:87],v[184:187],a[76:79],v[84:87]
v_fmac_f32 v147,v11,v27
v_mul_f32 v32,v144,v144
mf v[88:91],v[184:187],v[244:247],v[88:91]
buffer_load_dwordx4 v2,s[20:23],s60 offen offset:3072 sc1 lds
mf v[88:91],v[180:183],a[72:75],v[88:91]
s_add_u32 m0,s61,81920
v_mul_f32 v33,v145,v145
mf v[92:95],v[188:191],a[68:71],v[92:95]
ds_read_b128 v[180:183],v1 offset:2048
ds_read_b128 v[184:187],v1 offset:11264
mf v[92:95],v[192:195],a[76:79],v[92:95]
v_mul_f32 v34,v146,v146
v_mul_f32 v35,v147,v147
mf v[96:99],v[192:195],v[244:247],v[96:99]
buffer_load_dwordx4 v3,s[20:23],s60 offen sc1 lds
mf v[96:99],v[188:191],a[72:75],v[96:99]
v_fma_f32 v32,v32,v15,v13
v_fma_f32 v33,v33,v15,v13
mf v[100:103],v[196:199],a[68:71],v[100:103]
ds_read_b128 v[188:191],v1 offset:3072
ds_read_b128 v[192:195],v1 offset:12288
mf v[100:103],v[200:203],a[76:79],v[100:103]
v_fma_f32 v34,v34,v15,v13
v_fma_f32 v35,v35,v15,v13
mf v[104:107],v[200:203],v[244:247],v[104:107]
v_mul_f32 v32,v144,v32
v_mul_f32 v33,v145,v33
mf v[104:107],v[196:199],a[72:75],v[104:107]
s_waitcnt vmcnt(16)
s_barrier
s_waitcnt lgkmcnt(2)
mf v[36:39],v[204:207],v[248:251],v[36:39]
ds_read_b128 v[196:199],v1 offset:4096
ds_read_b128 v[200:203],v1 offset:13312
mf v[36:39],v[208:211],a[84:87],v[36:39]
s_cmp_gt_u32 s27,9
s_cselect_b32 s74,9,10
s_mul_i32 s74,s74,36864
mf v[40:43],v[208:211],a[88:91],v[40:43]
s_add_u32 s74,s74,s73
s_add_u32 s60,s74,0
mf v[40:43],v[204:207],a[80:83],v[40:43]
s_add_u32 m0,s61,110592
v_mul_f32 v34,v146,v34
mf v[44:47],v[212:215],v[248:251],v[44:47]
buffer_load_dwordx4 v1,s[20:23],s60 offen sc1 lds
mf v[44:47],v[216:219],a[84:87],v[44:47]
ds_read_b128 v[204:207],v1 offset:5120
ds_read_b128 v[208:211],v1 offset:14336
mf v[48:51],v[216:219],a[88:91],v[48:51]
v_mul_f32 v35,v147,v35
mf v[48:51],v[212:215],a[80:83],v[48:51]
v_exp_f32 v32,v32
mf v[52:55],v[180:183],v[248:251],v[52:55]
buffer_load_dwordx4 v[244:247],v3,s[4:7],s71 offen offset:2048
mf v[52:55],v[184:187],a[84:87],v[52:55]
ds_read_b128 v[212:215],v1 offset:6144
ds_read_b128 v[216:219],v1 offset:15360
mf v[56:59],v[184:187],a[88:91],v[56:59]
v_exp_f32 v33,v33
mf v[56:59],v[180:183],a[80:83],v[56:59]
s_waitcnt lgkmcnt(2)
mf v[60:63],v[188:191],v[248:251],v[60:63]
buffer_load_dwordx4 v1,s[20:23],s60 offen offset:1024 sc1 lds
mf v[60:63],v[192:195],a[84:87],v[60:63]
ds_read_b128 v[180:183],v1 offset:7168
ds_read_b128 v[184:187],v1 offset:16384
mf v[64:67],v[192:195],a[88:91],v[64:67]
v_exp_f32 v34,v34
mf v[64:67],v[188:191],a[80:83],v[64:67]
v_exp_f32 v35,v35
mf v[68:71],v[196:199],v[248:251],v[68:71]
buffer_load_dwordx4 a[44:47],v3,s[4:7],s71 offen offset:3072
mf v[68:71],v[200:203],a[84:87],v[68:71]
ds_read_b128 v[188:191],v1 offset:8192
ds_read_b128 v[192:195],v1 offset:17408
mf v[72:75],v[200:203],a[88:91],v[72:75]
v_fma_f32 v32,v32,v17,v17
v_fma_f32 v33,v33,v17,v17
mf v[72:75],v[196:199],a[80:83],v[72:75]
v_fma_f32 v34,v34,v17,v17
v_fma_f32 v35,v35,v17,v17
mf v[76:79],v[204:207],v[248:251],v[76:79]
buffer_load_dwordx4 v1,s[20:23],s60 offen offset:2048 sc1 lds
mf v[76:79],v[208:211],a[84:87],v[76:79]
ds_read_b128 v[196:199],v1 offset:18432
ds_read_b128 v[200:203],v1 offset:27648
mf v[80:83],v[208:211],a[88:91],v[80:83]
v_rcp_f32 v32,v32
mf v[80:83],v[204:207],a[80:83],v[80:83]
s_waitcnt lgkmcnt(2)
mf v[84:87],v[212:215],v[248:251],v[84:87]
s_add_u32 s71,s70,98304
buffer_load_dwordx4 a[48:51],v1,s[4:7],s71 offen
mf v[84:87],v[216:219],a[84:87],v[84:87]
ds_read_b128 v[204:207],v1 offset:19456
ds_read_b128 v[208:211],v1 offset:28672
mf v[88:91],v[216:219],a[88:91],v[88:91]
v_rcp_f32 v33,v33
mf v[88:91],v[212:215],a[80:83],v[88:91]
v_rcp_f32 v34,v34
mf v[92:95],v[180:183],v[248:251],v[92:95]
buffer_load_dwordx4 v1,s[20:23],s60 offen offset:3072 sc1 lds
mf v[92:95],v[184:187],a[84:87],v[92:95]
ds_read_b128 v[212:215],v1 offset:20480
ds_read_b128 v[216:219],v1 offset:29696
mf v[96:99],v[184:187],a[88:91],v[96:99]
v_rcp_f32 v35,v35
mf v[96:99],v[180:183],a[80:83],v[96:99]
v_mul_f32 v144,v144,v32
v_mul_f32 v145,v145,v33
mf v[100:103],v[188:191],v[248:251],v[100:103]
buffer_load_dwordx4 a[52:55],v1,s[4:7],s71 offen offset:1024
mf v[100:103],v[192:195],a[84:87],v[100:103]
ds_read_b128 v[180:183],v1 offset:21504
ds_read_b128 v[184:187],v1 offset:30720
mf v[104:107],v[192:195],a[88:91],v[104:107]
v_mul_f32 v146,v146,v34
v_mul_f32 v147,v147,v35
mf v[104:107],v[188:191],a[80:83],v[104:107]
s_waitcnt lgkmcnt(2)
mf v[36:39],v[196:199],a[92:95],v[36:39]
ds_read_b128 v[188:191],v1 offset:22528
ds_read_b128 v[192:195],v1 offset:31744
mf v[36:39],v[200:203],a[100:103],v[36:39]
s_add_u32 m0,s61,114688
ds_read_b128 v[24:27],v20 offset:384
mf v[40:43],v[200:203],a[104:107],v[40:43]
buffer_load_dwordx4 v2,s[20:23],s60 offen sc1 lds
mf v[40:43],v[196:199],a[96:99],v[40:43]
v_fmac_f32 v148,v10,v28
v_fmac_f32 v149,v10,v29
mf v[44:47],v[204:207],a[92:95],v[44:47]
ds_read_b128 v[196:199],v1 offset:23552
ds_read_b128 v[200:203],v1 offset:32768
mf v[44:47],v[208:211],a[100:103],v[44:47]
v_fmac_f32 v150,v10,v30
v_fmac_f32 v151,v10,v31
mf v[48:51],v[208:211],a[104:107],v[48:51]
buffer_load_dwordx4 v[248:251],v1,s[4:7],s71 offen offset:2048
mf v[48:51],v[204:207],a[96:99],v[48:51]
v_mul_f32 v32,v148,v148
v_mul_f32 v33,v149,v149
mf v[52:55],v[212:215],a[92:95],v[52:55]
ds_read_b128 v[204:207],v1 offset:24576
ds_read_b128 v[208:211],v1 offset:33792
mf v[52:55],v[216:219],a[100:103],v[52:55]
v_mul_f32 v34,v150,v150
v_mul_f32 v35,v151,v151
mf v[56:59],v[216:219],a[104:107],v[56:59]
buffer_load_dwordx4 v2,s[20:23],s60 offen offset:1024 sc1 lds
mf v[56:59],v[212:215],a[96:99],v[56:59]
v_fma_f32 v32,v32,v14,v12
s_waitcnt lgkmcnt(2)
mf v[60:63],v[180:183],a[92:95],v[60:63]
ds_read_b128 v[212:215],v1 offset:25600
ds_read_b128 v[216:219],v1 offset:34816
mf v[60:63],v[184:187],a[100:103],v[60:63]
v_fma_f32 v33,v33,v14,v12
v_fma_f32 v34,v34,v14,v12
mf v[64:67],v[184:187],a[104:107],v[64:67]
buffer_load_dwordx4 a[56:59],v1,s[4:7],s71 offen offset:3072
mf v[64:67],v[180:183],a[96:99],v[64:67]
v_fma_f32 v35,v35,v14,v12
v_mul_f32 v32,v148,v32
mf v[68:71],v[188:191],a[92:95],v[68:71]
ds_read_b128 v[180:183],v1 offset:26624
ds_read_b128 v[184:187],v1 offset:35840
mf v[68:71],v[192:195],a[100:103],v[68:71]
v_mul_f32 v33,v149,v33
v_mul_f32 v34,v150,v34
mf v[72:75],v[192:195],a[104:107],v[72:75]
buffer_load_dwordx4 v2,s[20:23],s60 offen offset:2048 sc1 lds
mf v[72:75],v[188:191],a[96:99],v[72:75]
v_mul_f32 v35,v151,v35
mf v[76:79],v[196:199],a[92:95],v[76:79]
ds_read_b128 v[188:191],v6
ds_read_b128 v[192:195],v6 offset:9216
mf v[76:79],v[200:203],a[100:103],v[76:79]
v_exp_f32 v32,v32
mf v[80:83],v[200:203],a[104:107],v[80:83]
buffer_load_dwordx4 a[60:63],v2,s[4:7],s71 offen
mf v[80:83],v[196:199],a[96:99],v[80:83]
s_waitcnt lgkmcnt(2)
mf v[84:87],v[204:207],a[92:95],v[84:87]
ds_read_b128 v[196:199],v6 offset:1024
ds_read_b128 v[200:203],v6 offset:10240
mf v[84:87],v[208:211],a[100:103],v[84:87]
v_exp_f32 v33,v33
mf v[88:91],v[208:211],a[104:107],v[88:91]
buffer_load_dwordx4 v2,s[20:23],s60 offen offset:3072 sc1 lds
mf v[88:91],v[204:207],a[96:99],v[88:91]
s_add_u32 m0,s61,118784
mf v[92:95],v[212:215],a[92:95],v[92:95]
ds_read_b128 v[204:207],v6 offset:2048
ds_read_b128 v[208:211],v6 offset:11264
mf v[92:95],v[216:219],a[100:103],v[92:95]
v_exp_f32 v34,v34
mf v[96:99],v[216:219],a[104:107],v[96:99]
buffer_load_dwordx4 v3,s[20:23],s60 offen sc1 lds
mf v[96:99],v[212:215],a[96:99],v[96:99]
v_exp_f32 v35,v35
mf v[100:103],v[180:183],a[92:95],v[100:103]
ds_read_b128 v[212:215],v6 offset:3072
ds_read_b128 v[216:219],v6 offset:12288
mf v[100:103],v[184:187],a[100:103],v[100:103]
v_fma_f32 v32,v32,v16,v16
v_fma_f32 v33,v33,v16,v16
mf v[104:107],v[184:187],a[104:107],v[104:107]
v_fma_f32 v34,v34,v16,v16
v_fma_f32 v35,v35,v16,v16
mf v[104:107],v[180:183],a[96:99],v[104:107]
s_waitcnt vmcnt(16)
s_barrier
s_waitcnt lgkmcnt(2)
mf v[36:39],v[188:191],a[108:111],v[36:39]
ds_read_b128 v[180:183],v6 offset:4096
ds_read_b128 v[184:187],v6 offset:13312
mf v[36:39],v[192:195],a[116:119],v[36:39]
s_cmp_gt_u32 s27,10
s_cselect_b32 s74,10,11
s_mul_i32 s74,s74,36864
mf v[40:43],v[192:195],a[120:123],v[40:43]
s_add_u32 s74,s74,s73
s_add_u32 s60,s74,0
mf v[40:43],v[188:191],a[112:115],v[40:43]
s_add_u32 m0,s61,0
mf v[44:47],v[196:199],a[108:111],v[44:47]
buffer_load_dwordx4 v1,s[20:23],s60 offen sc1 lds
mf v[44:47],v[200:203],a[116:119],v[44:47]
ds_read_b128 v[188:191],v6 offset:5120
ds_read_b128 v[192:195],v6 offset:14336
mf v[48:51],v[200:203],a[120:123],v[48:51]
v_rcp_f32 v32,v32
mf v[48:51],v[196:199],a[112:115],v[48:51]
v_rcp_f32 v33,v33
mf v[52:55],v[204:207],a[108:111],v[52:55]
buffer_load_dwordx4 a[64:67],v2,s[4:7],s71 offen offset:1024
mf v[52:55],v[208:211],a[116:119],v[52:55]
ds_read_b128 v[196:199],v6 offset:6144
ds_read_b128 v[200:203],v6 offset:15360
mf v[56:59],v[208:211],a[120:123],v[56:59]
v_rcp_f32 v34,v34
mf v[56:59],v[204:207],a[112:115],v[56:59]
s_waitcnt lgkmcnt(2)
mf v[60:63],v[212:215],a[108:111],v[60:63]
buffer_load_dwordx4 v1,s[20:23],s60 offen offset:1024 sc1 lds
mf v[60:63],v[216:219],a[116:119],v[60:63]
ds_read_b128 v[204:207],v6 offset:7168
ds_read_b128 v[208:211],v6 offset:16384
mf v[64:67],v[216:219],a[120:123],v[64:67]
v_rcp_f32 v35,v35
mf v[64:67],v[212:215],a[112:115],v[64:67]
v_mul_f32 v148,v148,v32
v_mul_f32 v149,v149,v33
mf v[68:71],v[180:183],a[108:111],v[68:71]
buffer_load_dwordx4 a[68:71],v2,s[4:7],s71 offen offset:2048
mf v[68:71],v[184:187],a[116:119],v[68:71]
ds_read_b128 v[212:215],v6 offset:8192
ds_read_b128 v[216:219],v6 offset:17408
mf v[72:75],v[184:187],a[120:123],v[72:75]
v_mul_f32 v150,v150,v34
v_mul_f32 v151,v151,v35
mf v[72:75],v[180:183],a[112:115],v[72:75]
v_fmac_f32 v152,v11,v28
v_fmac_f32 v153,v11,v29
mf v[76:79],v[188:191],a[108:111],v[76:79]
buffer_load_dwordx4 v1,s[20:23],s60 offen offset:2048 sc1 lds
mf v[76:79],v[192:195],a[116:119],v[76:79]
ds_read_b128 v[180:183],v6 offset:18432
ds_read_b128 v[184:187],v6 offset:27648
mf v[80:83],v[192:195],a[120:123],v[80:83]
v_fmac_f32 v154,v11,v30
v_fmac_f32 v155,v11,v31
mf v[80:83],v[188:191],a[112:115],v[80:83]
v_mul_f32 v32,v152,v152
s_waitcnt lgkmcnt(2)
mf v[84:87],v[196:199],a[108:111],v[84:87]
buffer_load_dwordx4 a[72:75],v2,s[4:7],s71 offen offset:3072
mf v[84:87],v[200:203],a[116:119],v[84:87]
ds_read_b128 v[188:191],v6 offset:19456
ds_read_b128 v[192:195],v6 offset:28672
mf v[88:91],v[200:203],a[120:123],v[88:91]
v_mul_f32 v33,v153,v153
v_mul_f32 v34,v154,v154
mf v[88:91],v[196:199],a[112:115],v[88:91]
v_mul_f32 v35,v155,v155
v_fma_f32 v32,v32,v15,v13
mf v[92:95],v[204:207],a[108:111],v[92:95]
buffer_load_dwordx4 v1,s[20:23],s60 offen offset:3072 sc1 lds
mf v[92:95],v[208:211],a[116:119],v[92:95]
ds_read_b128 v[196:199],v6 offset:20480
ds_read_b128 v[200:203],v6 offset:29696
mf v[96:99],v[208:211],a[120:123],v[96:99]
v_fma_f32 v33,v33,v15,v13
v_fma_f32 v34,v34,v15,v13
mf v[96:99],v[204:207],a[112:115],v[96:99]
v_fma_f32 v35,v35,v15,v13
v_mul_f32 v32,v152,v32
mf v[100:103],v[212:215],a[108:111],v[100:103]
s_add_u32 s91,s75,73728
buffer_load_dwordx4 a[76:79],v1,s[4:7],s91 offen
mf v[100:103],v[216:219],a[116:119],v[100:103]
ds_read_b128 v[204:207],v6 offset:21504
ds_read_b128 v[208:211],v6 offset:30720
mf v[104:107],v[216:219],a[120:123],v[104:107]
v_mul_f32 v33,v153,v33
v_mul_f32 v34,v154,v34
mf v[104:107],v[212:215],a[112:115],v[104:107]
s_waitcnt lgkmcnt(2)
mf v[36:39],v[180:183],a[124:127],v[36:39]
ds_read_b128 v[212:215],v6 offset:22528
ds_read_b128 v[216:219],v6 offset:31744
mf v[36:39],v[184:187],a[132:135],v[36:39]
s_add_u32 m0,s61,4096
v_mul_f32 v35,v155,v35
mf v[40:43],v[184:187],a[136:139],v[40:43]
buffer_load_dwordx4 v2,s[20:23],s60 offen sc1 lds
mf v[40:43],v[180:183],a[128:131],v[40:43]
v_exp_f32 v32,v32
mf v[44:47],v[188:191],a[124:127],v[44:47]
ds_read_b128 v[180:183],v6 offset:23552
ds_read_b128 v[184:187],v6 offset:32768
mf v[44:47],v[192:195],a[132:135],v[44:47]
v_exp_f32 v33,v33
mf v[48:51],v[192:195],a[136:139],v[48:51]
buffer_load_dwordx4 a[80:83],v3,s[4:7],s71 offen
mf v[48:51],v[188:191],a[128:131],v[48:51]
v_exp_f32 v34,v34
mf v[52:55],v[196:199],a[124:127],v[52:55]
ds_read_b128 v[188:191],v6 offset:24576
ds_read_b128 v[192:195],v6 offset:33792
mf v[52:55],v[200:203],a[132:135],v[52:55]
v_exp_f32 v35,v35
mf v[56:59],v[200:203],a[136:139],v[56:59]
buffer_load_dwordx4 v2,s[20:23],s60 offen offset:1024 sc1 lds
mf v[56:59],v[196:199],a[128:131],v[56:59]
v_fma_f32 v32,v32,v17,v17
s_waitcnt lgkmcnt(2)
mf v[60:63],v[204:207],a[124:127],v[60:63]
ds_read_b128 v[196:199],v6 offset:25600
ds_read_b128 v[200:203],v6 offset:34816
mf v[60:63],v[208:211],a[132:135],v[60:63]
v_fma_f32 v33,v33,v17,v17
v_fma_f32 v34,v34,v17,v17
mf v[64:67],v[208:211],a[136:139],v[64:67]
buffer_load_dwordx4 a[84:87],v3,s[4:7],s71 offen offset:1024
mf v[64:67],v[204:207],a[128:131],v[64:67]
v_fma_f32 v35,v35,v17,v17
mf v[68:71],v[212:215],a[124:127],v[68:71]
ds_read_b128 v[204:207],v6 offset:26624
ds_read_b128 v[208:211],v6 offset:35840
mf v[68:71],v[216:219],a[132:135],v[68:71]
v_rcp_f32 v32,v32
mf v[72:75],v[216:219],a[136:139],v[72:75]
buffer_load_dwordx4 v2,s[20:23],s60 offen offset:2048 sc1 lds
mf v[72:75],v[212:215],a[128:131],v[72:75]
v_rcp_f32 v33,v33
mf v[76:79],v[180:183],a[124:127],v[76:79]
ds_read_b128 v[212:215],v7
ds_read_b128 v[216:219],v7 offset:9216
mf v[76:79],v[184:187],a[132:135],v[76:79]
v_rcp_f32 v34,v34
mf v[80:83],v[184:187],a[136:139],v[80:83]
buffer_load_dwordx4 a[88:91],v3,s[4:7],s71 offen offset:2048
mf v[80:83],v[180:183],a[128:131],v[80:83]
s_waitcnt lgkmcnt(2)
mf v[84:87],v[188:191],a[124:127],v[84:87]
ds_read_b128 v[180:183],v7 offset:1024
ds_read_b128 v[184:187],v7 offset:10240
mf v[84:87],v[192:195],a[132:135],v[84:87]
v_rcp_f32 v35,v35
mf v[88:91],v[192:195],a[136:139],v[88:91]
buffer_load_dwordx4 v2,s[20:23],s60 offen offset:3072 sc1 lds
mf v[88:91],v[188:191],a[128:131],v[88:91]
s_add_u32 m0,s61,8192
v_mul_f32 v152,v152,v32
mf v[92:95],v[196:199],a[124:127],v[92:95]
ds_read_b128 v[188:191],v7 offset:2048
ds_read_b128 v[192:195],v7 offset:11264
mf v[92:95],v[200:203],a[132:135],v[92:95]
v_mul_f32 v153,v153,v33
v_mul_f32 v154,v154,v34
mf v[96:99],v[200:203],a[136:139],v[96:99]
buffer_load_dwordx4 v3,s[20:23],s60 offen sc1 lds
mf v[96:99],v[196:199],a[128:131],v[96:99]
v_mul_f32 v155,v155,v35
ds_read_b128 v[28:31],v20 offset:448
mf v[100:103],v[204:207],a[124:127],v[100:103]
ds_read_b128 v[196:199],v7 offset:3072
ds_read_b128 v[200:203],v7 offset:12288
mf v[100:103],v[208:211],a[132:135],v[100:103]
v_fmac_f32 v156,v10,v24
v_fmac_f32 v157,v10,v25
mf v[104:107],v[208:211],a[136:139],v[104:107]
v_fmac_f32 v158,v10,v26
v_fmac_f32 v159,v10,v27
mf v[104:107],v[204:207],a[128:131],v[104:107]
s_waitcnt vmcnt(16)
s_barrier
s_waitcnt lgkmcnt(3)
mf v[36:39],v[212:215],a[140:143],v[36:39]
ds_read_b128 v[204:207],v7 offset:4096
ds_read_b128 v[208:211],v7 offset:13312
mf v[36:39],v[216:219],a[244:247],v[36:39]
s_cmp_gt_u32 s27,11
s_cselect_b32 s74,11,12
s_mul_i32 s74,s74,36864
mf v[40:43],v[216:219],a[248:251],v[40:43]
s_add_u32 s74,s74,s73
s_add_u32 s60,s74,0
mf v[40:43],v[212:215],v[220:223],v[40:43]
s_add_u32 m0,s61,36864
v_mul_f32 v32,v156,v156
mf v[44:47],v[180:183],a[140:143],v[44:47]
buffer_load_dwordx4 v1,s[20:23],s60 offen sc1 lds
mf v[44:47],v[184:187],a[244:247],v[44:47]
ds_read_b128 v[212:215],v7 offset:5120
ds_read_b128 v[216:219],v7 offset:14336
mf v[48:51],v[184:187],a[248:251],v[48:51]
v_mul_f32 v33,v157,v157
v_mul_f32 v34,v158,v158
mf v[48:51],v[180:183],v[220:223],v[48:51]
v_mul_f32 v35,v159,v159
v_fma_f32 v32,v32,v14,v12
mf v[52:55],v[188:191],a[140:143],v[52:55]
buffer_load_dwordx4 a[92:95],v3,s[4:7],s71 offen offset:3072
mf v[52:55],v[192:195],a[244:247],v[52:55]
ds_read_b128 v[180:183],v7 offset:6144
ds_read_b128 v[184:187],v7 offset:15360
mf v[56:59],v[192:195],a[248:251],v[56:59]
v_fma_f32 v33,v33,v14,v12
v_fma_f32 v34,v34,v14,v12
mf v[56:59],v[188:191],v[220:223],v[56:59]
v_fma_f32 v35,v35,v14,v12
s_waitcnt lgkmcnt(2)
mf v[60:63],v[196:199],a[140:143],v[60:63]
buffer_load_dwordx4 v1,s[20:23],s60 offen offset:1024 sc1 lds
mf v[60:63],v[200:203],a[244:247],v[60:63]
ds_read_b128 v[188:191],v7 offset:7168
ds_read_b128 v[192:195],v7 offset:16384
mf v[64:67],v[200:203],a[248:251],v[64:67]
v_mul_f32 v32,v156,v32
v_mul_f32 v33,v157,v33
mf v[64:67],v[196:199],v[220:223],v[64:67]
v_mul_f32 v34,v158,v34
v_mul_f32 v35,v159,v35
mf v[68:71],v[204:207],a[140:143],v[68:71]
s_add_u32 s71,s70,110592
buffer_load_dwordx4 a[96:99],v1,s[4:7],s71 offen
mf v[68:71],v[208:211],a[244:247],v[68:71]
ds_read_b128 v[196:199],v7 offset:8192
ds_read_b128 v[200:203],v7 offset:17408
mf v[72:75],v[208:211],a[248:251],v[72:75]
v_exp_f32 v32,v32
mf v[72:75],v[204:207],v[220:223],v[72:75]
v_exp_f32 v33,v33
mf v[76:79],v[212:215],a[140:143],v[76:79]
buffer_load_dwordx4 v1,s[20:23],s60 offen offset:2048 sc1 lds
mf v[76:79],v[216:219],a[244:247],v[76:79]
ds_read_b128 v[204:207],v7 offset:18432
ds_read_b128 v[208:211],v7 offset:27648
mf v[80:83],v[216:219],a[248:251],v[80:83]
v_exp_f32 v34,v34
mf v[80:83],v[212:215],v[220:223],v[80:83]
s_waitcnt lgkmcnt(2)
mf v[84:87],v[180:183],a[140:143],v[84:87]
buffer_load_dwordx4 a[100:103],v1,s[4:7],s71 offen offset:1024
mf v[84:87],v[184:187],a[244:247],v[84:87]
ds_read_b128 v[212:215],v7 offset:19456
ds_read_b128 v[216:219],v7 offset:28672
mf v[88:91],v[184:187],a[248:251],v[88:91]
v_exp_f32 v35,v35
mf v[88:91],v[180:183],v[220:223],v[88:91]
v_fma_f32 v32,v32,v16,v16
v_fma_f32 v33,v33,v16,v16
mf v[92:95],v[188:191],a[140:143],v[92:95]
buffer_load_dwordx4 v1,s[20:23],s60 offen offset:3072 sc1 lds
mf v[92:95],v[192:195],a[244:247],v[92:95]
ds_read_b128 v[180:183],v7 offset:20480
ds_read_b128 v[184:187],v7 offset:29696
mf v[96:99],v[192:195],a[248:251],v[96:99]
v_fma_f32 v34,v34,v16,v16
v_fma_f32 v35,v35,v16,v16
mf v[96:99],v[188:191],v[220:223],v[96:99]
v_rcp_f32 v32,v32
mf v[100:103],v[196:199],a[140:143],v[100:103]
buffer_load_dwordx4 a[104:107],v1,s[4:7],s91 offen offset:1024
mf v[100:103],v[200:203],a[244:247],v[100:103]
ds_read_b128 v[188:191],v7 offset:21504
ds_read_b128 v[192:195],v7 offset:30720
mf v[104:107],v[200:203],a[248:251],v[104:107]
Ljt95:
s_add_u32 s101,s3,Ljt95-Ljb41+1536
mf v[104:107],v[196:199],v[220:223],v[104:107]
s_waitcnt lgkmcnt(2)
mf v[36:39],v[204:207],a[252:255],v[36:39]
buffer_load_dword v9,off,s[16:19],s101
mf v[36:39],v[208:211],v[228:231],v[36:39]
ds_read_b128 v[196:199],v7 offset:22528
ds_read_b128 v[200:203],v7 offset:31744
mf v[40:43],v[208:211],v[232:235],v[40:43]
s_add_u32 m0,s61,40960
mf v[40:43],v[204:207],v[224:227],v[40:43]
v_rcp_f32 v33,v33
mf v[44:47],v[212:215],a[252:255],v[44:47]
buffer_load_dwordx4 v2,s[20:23],s60 offen sc1 lds
mf v[44:47],v[216:219],v[228:231],v[44:47]
ds_read_b128 v[204:207],v7 offset:23552
ds_read_b128 v[208:211],v7 offset:32768
mf v[48:51],v[216:219],v[232:235],v[48:51]
v_rcp_f32 v34,v34
mf v[48:51],v[212:215],v[224:227],v[48:51]
v_rcp_f32 v35,v35
mf v[52:55],v[180:183],a[252:255],v[52:55]
buffer_load_dwordx4 v[220:223],v1,s[4:7],s71 offen offset:2048
mf v[52:55],v[184:187],v[228:231],v[52:55]
ds_read_b128 v[212:215],v7 offset:24576
ds_read_b128 v[216:219],v7 offset:33792
mf v[56:59],v[184:187],v[232:235],v[56:59]
v_mul_f32 v156,v156,v32
v_mul_f32 v157,v157,v33
mf v[56:59],v[180:183],v[224:227],v[56:59]
v_mul_f32 v158,v158,v34
s_waitcnt lgkmcnt(2)
mf v[60:63],v[188:191],a[252:255],v[60:63]
buffer_load_dwordx4 v2,s[20:23],s60 offen offset:1024 sc1 lds
mf v[60:63],v[192:195],v[228:231],v[60:63]
ds_read_b128 v[180:183],v7 offset:25600
ds_read_b128 v[184:187],v7 offset:34816
mf v[64:67],v[192:195],v[232:235],v[64:67]
v_mul_f32 v159,v159,v35
v_fmac_f32 v160,v11,v24
mf v[64:67],v[188:191],v[224:227],v[64:67]
v_fmac_f32 v161,v11,v25
v_fmac_f32 v162,v11,v26
mf v[68:71],v[196:199],a[252:255],v[68:71]
buffer_load_dwordx4 a[108:111],v1,s[4:7],s71 offen offset:3072
mf v[68:71],v[200:203],v[228:231],v[68:71]
ds_read_b128 v[188:191],v7 offset:26624
ds_read_b128 v[192:195],v7 offset:35840
mf v[72:75],v[200:203],v[232:235],v[72:75]
v_fmac_f32 v163,v11,v27
v_mul_f32 v32,v160,v160
mf v[72:75],v[196:199],v[224:227],v[72:75]
v_mul_f32 v33,v161,v161
v_mul_f32 v34,v162,v162
mf v[76:79],v[204:207],a[252:255],v[76:79]
buffer_load_dwordx4 v2,s[20:23],s60 offen offset:2048 sc1 lds
mf v[76:79],v[208:211],v[228:231],v[76:79]
ds_read_b128 v[196:199],v8
ds_read_b128 v[200:203],v8 offset:9216
mf v[80:83],v[208:211],v[232:235],v[80:83]
v_mul_f32 v35,v163,v163
v_fma_f32 v32,v32,v15,v13
mf v[80:83],v[204:207],v[224:227],v[80:83]
v_fma_f32 v33,v33,v15,v13
s_waitcnt lgkmcnt(2)
mf v[84:87],v[212:215],a[252:255],v[84:87]
buffer_load_dwordx4 a[112:115],v2,s[4:7],s71 offen
mf v[84:87],v[216:219],v[228:231],v[84:87]
ds_read_b128 v[204:207],v8 offset:1024
ds_read_b128 v[208:211],v8 offset:10240
mf v[88:91],v[216:219],v[232:235],v[88:91]
v_fma_f32 v34,v34,v15,v13
v_fma_f32 v35,v35,v15,v13
mf v[88:91],v[212:215],v[224:227],v[88:91]
v_mul_f32 v32,v160,v32
v_mul_f32 v33,v161,v33
mf v[92:95],v[180:183],a[252:255],v[92:95]
buffer_load_dwordx4 v2,s[20:23],s60 offen offset:3072 sc1 lds
mf v[92:95],v[184:187],v[228:231],v[92:95]
ds_read_b128 v[212:215],v8 offset:2048
ds_read_b128 v[216:219],v8 offset:11264
mf v[96:99],v[184:187],v[232:235],v[96:99]
s_add_u32 m0,s61,45056
v_mul_f32 v34,v162,v34
mf v[96:99],v[180:183],v[224:227],v[96:99]
v_mul_f32 v35,v163,v35
mf v[100:103],v[188:191],a[252:255],v[100:103]
buffer_load_dwordx4 v3,s[20:23],s60 offen sc1 lds
mf v[100:103],v[192:195],v[228:231],v[100:103]
ds_read_b128 v[180:183],v8 offset:3072
ds_read_b128 v[184:187],v8 offset:12288
mf v[104:107],v[192:195],v[232:235],v[104:107]
v_exp_f32 v32,v32
mf v[104:107],v[188:191],v[224:227],v[104:107]
s_waitcnt vmcnt(17)
s_barrier
s_waitcnt lgkmcnt(2)
mf v[36:39],v[196:199],v[236:239],v[36:39]
ds_read_b128 v[188:191],v8 offset:4096
ds_read_b128 v[192:195],v8 offset:13312
mf v[36:39],v[200:203],v[252:255],v[36:39]
s_cmp_gt_u32 s27,12
s_cselect_b32 s74,12,13
s_mul_i32 s74,s74,36864
mf v[40:43],v[200:203],a[0:3],v[40:43]
s_add_u32 s74,s74,s73
s_add_u32 s60,s74,0
mf v[40:43],v[196:199],v[240:243],v[40:43]
s_add_u32 m0,s61,73728
mf v[44:47],v[204:207],v[236:239],v[44:47]
buffer_load_dwordx4 v1,s[20:23],s60 offen sc1 lds
mf v[44:47],v[208:211],v[252:255],v[44:47]
ds_read_b128 v[196:199],v8 offset:5120
ds_read_b128 v[200:203],v8 offset:14336
mf v[48:51],v[208:211],a[0:3],v[48:51]
v_exp_f32 v33,v33
mf v[48:51],v[204:207],v[240:243],v[48:51]
v_exp_f32 v34,v34
mf v[52:55],v[212:215],v[236:239],v[52:55]
buffer_load_dwordx4 v[224:227],v2,s[4:7],s71 offen offset:1024
mf v[52:55],v[216:219],v[252:255],v[52:55]
ds_read_b128 v[204:207],v8 offset:6144
ds_read_b128 v[208:211],v8 offset:15360
mf v[56:59],v[216:219],a[0:3],v[56:59]
v_exp_f32 v35,v35
mf v[56:59],v[212:215],v[240:243],v[56:59]
v_fma_f32 v32,v32,v17,v17
s_waitcnt lgkmcnt(2)
mf v[60:63],v[180:183],v[236:239],v[60:63]
buffer_load_dwordx4 v1,s[20:23],s60 offen offset:1024 sc1 lds
mf v[60:63],v[184:187],v[252:255],v[60:63]
ds_read_b128 v[212:215],v8 offset:7168
ds_read_b128 v[216:219],v8 offset:16384
mf v[64:67],v[184:187],a[0:3],v[64:67]
v_fma_f32 v33,v33,v17,v17
v_fma_f32 v34,v34,v17,v17
mf v[64:67],v[180:183],v[240:243],v[64:67]
v_fma_f32 v35,v35,v17,v17
mf v[68:71],v[188:191],v[236:239],v[68:71]
buffer_load_dwordx4 v[228:231],v2,s[4:7],s71 offen offset:2048
mf v[68:71],v[192:195],v[252:255],v[68:71]
ds_read_b128 v[180:183],v8 offset:8192
ds_read_b128 v[184:187],v8 offset:17408
mf v[72:75],v[192:195],a[0:3],v[72:75]
v_rcp_f32 v32,v32
mf v[72:75],v[188:191],v[240:243],v[72:75]
v_rcp_f32 v33,v33
mf v[76:79],v[196:199],v[236:239],v[76:79]
buffer_load_dwordx4 v1,s[20:23],s60 offen offset:2048 sc1 lds
mf v[76:79],v[200:203],v[252:255],v[76:79]
ds_read_b128 v[188:191],v8 offset:18432
ds_read_b128 v[192:195],v8 offset:27648
mf v[80:83],v[200:203],a[0:3],v[80:83]
v_rcp_f32 v34,v34
mf v[80:83],v[196:199],v[240:243],v[80:83]
s_waitcnt lgkmcnt(2)
mf v[84:87],v[204:207],v[236:239],v[84:87]
buffer_load_dwordx4 v[232:235],v2,s[4:7],s71 offen offset:3072
mf v[84:87],v[208:211],v[252:255],v[84:87]
ds_read_b128 v[196:199],v8 offset:19456
ds_read_b128 v[200:203],v8 offset:28672
mf v[88:91],v[208:211],a[0:3],v[88:91]
v_rcp_f32 v35,v35
mf v[88:91],v[204:207],v[240:243],v[88:91]
v_mul_f32 v160,v160,v32
v_mul_f32 v161,v161,v33
mf v[92:95],v[212:215],v[236:239],v[92:95]
buffer_load_dwordx4 v1,s[20:23],s60 offen offset:3072 sc1 lds
mf v[92:95],v[216:219],v[252:255],v[92:95]
ds_read_b128 v[204:207],v8 offset:20480
ds_read_b128 v[208:211],v8 offset:29696
mf v[96:99],v[216:219],a[0:3],v[96:99]
v_mul_f32 v162,v162,v34
v_mul_f32 v163,v163,v35
mf v[96:99],v[212:215],v[240:243],v[96:99]
ds_read_b128 v[24:27],v20 offset:512
v_fmac_f32 v164,v10,v28
mf v[100:103],v[180:183],v[236:239],v[100:103]
buffer_load_dwordx4 a[116:119],v1,s[4:7],s91 offen offset:2048
mf v[100:103],v[184:187],v[252:255],v[100:103]
ds_read_b128 v[212:215],v8 offset:21504
ds_read_b128 v[216:219],v8 offset:30720
mf v[104:107],v[184:187],a[0:3],v[104:107]
v_fmac_f32 v165,v10,v29
v_fmac_f32 v166,v10,v30
mf v[104:107],v[180:183],v[240:243],v[104:107]
s_waitcnt lgkmcnt(3)
mf v[36:39],v[188:191],a[4:7],v[36:39]
ds_read_b128 v[180:183],v8 offset:22528
ds_read_b128 v[184:187],v8 offset:31744
mf v[36:39],v[192:195],a[12:15],v[36:39]
s_add_u32 m0,s61,77824
v_fmac_f32 v167,v10,v31
mf v[40:43],v[192:195],a[16:19],v[40:43]
buffer_load_dwordx4 v2,s[20:23],s60 offen sc1 lds
mf v[40:43],v[188:191],a[8:11],v[40:43]
v_mul_f32 v32,v164,v164
v_mul_f32 v33,v165,v165
mf v[44:47],v[196:199],a[4:7],v[44:47]
ds_read_b128 v[188:191],v8 offset:23552
ds_read_b128 v[192:195],v8 offset:32768
mf v[44:47],v[200:203],a[12:15],v[44:47]
v_mul_f32 v34,v166,v166
v_mul_f32 v35,v167,v167
mf v[48:51],v[200:203],a[16:19],v[48:51]
buffer_load_dwordx4 v[236:239],v3,s[4:7],s71 offen
mf v[48:51],v[196:199],a[8:11],v[48:51]
v_fma_f32 v32,v32,v14,v12
v_fma_f32 v33,v33,v14,v12
mf v[52:55],v[204:207],a[4:7],v[52:55]
ds_read_b128 v[196:199],v8 offset:24576
ds_read_b128 v[200:203],v8 offset:33792
mf v[52:55],v[208:211],a[12:15],v[52:55]
v_fma_f32 v34,v34,v14,v12
v_fma_f32 v35,v35,v14,v12
mf v[56:59],v[208:211],a[16:19],v[56:59]
buffer_load_dwordx4 v2,s[20:23],s60 offen offset:1024 sc1 lds
mf v[56:59],v[204:207],a[8:11],v[56:59]
v_mul_f32 v32,v164,v32
s_waitcnt lgkmcnt(2)
mf v[60:63],v[212:215],a[4:7],v[60:63]
ds_read_b128 v[204:207],v8 offset:25600
ds_read_b128 v[208:211],v8 offset:34816
mf v[60:63],v[216:219],a[12:15],v[60:63]
v_mul_f32 v33,v165,v33
v_mul_f32 v34,v166,v34
mf v[64:67],v[216:219],a[16:19],v[64:67]
buffer_load_dwordx4 v[240:243],v3,s[4:7],s71 offen offset:1024
mf v[64:67],v[212:215],a[8:11],v[64:67]
v_mul_f32 v35,v167,v35
mf v[68:71],v[180:183],a[4:7],v[68:71]
ds_read_b128 v[212:215],v8 offset:26624
ds_read_b128 v[216:219],v8 offset:35840
mf v[68:71],v[184:187],a[12:15],v[68:71]
v_exp_f32 v32,v32
mf v[72:75],v[184:187],a[16:19],v[72:75]
buffer_load_dwordx4 v2,s[20:23],s60 offen offset:2048 sc1 lds
mf v[72:75],v[180:183],a[8:11],v[72:75]
v_exp_f32 v33,v33
mf v[76:79],v[188:191],a[4:7],v[76:79]
ds_read_b128 v[180:183],v1
ds_read_b128 v[184:187],v1 offset:9216
mf v[76:79],v[192:195],a[12:15],v[76:79]
v_exp_f32 v34,v34
mf v[80:83],v[192:195],a[16:19],v[80:83]
buffer_load_dwordx4 v[252:255],v3,s[4:7],s71 offen offset:2048
mf v[80:83],v[188:191],a[8:11],v[80:83]
s_waitcnt lgkmcnt(2)
mf v[84:87],v[196:199],a[4:7],v[84:87]
ds_read_b128 v[188:191],v1 offset:1024
ds_read_b128 v[192:195],v1 offset:10240
mf v[84:87],v[200:203],a[12:15],v[84:87]
v_exp_f32 v35,v35
mf v[88:91],v[200:203],a[16:19],v[88:91]
buffer_load_dwordx4 v2,s[20:23],s60 offen offset:3072 sc1 lds
mf v[88:91],v[196:199],a[8:11],v[88:91]
s_add_u32 m0,s61,81920
v_fma_f32 v32,v32,v16,v16
mf v[92:95],v[204:207],a[4:7],v[92:95]
ds_read_b128 v[196:199],v1 offset:2048
ds_read_b128 v[200:203],v1 offset:11264
mf v[92:95],v[208:211],a[12:15],v[92:95]
v_fma_f32 v33,v33,v16,v16
v_fma_f32 v34,v34,v16,v16
mf v[96:99],v[208:211],a[16:19],v[96:99]
buffer_load_dwordx4 v3,s[20:23],s60 offen sc1 lds
mf v[96:99],v[204:207],a[8:11],v[96:99]
v_fma_f32 v35,v35,v16,v16
mf v[100:103],v[212:215],a[4:7],v[100:103]
ds_read_b128 v[204:207],v1 offset:3072
ds_read_b128 v[208:211],v1 offset:12288
mf v[100:103],v[216:219],a[12:15],v[100:103]
v_rcp_f32 v32,v32
mf v[104:107],v[216:219],a[16:19],v[104:107]
v_rcp_f32 v33,v33
mf v[104:107],v[212:215],a[8:11],v[104:107]
s_waitcnt vmcnt(16)
s_barrier
s_waitcnt lgkmcnt(2)
mf v[36:39],v[180:183],a[20:23],v[36:39]
ds_read_b128 v[212:215],v1 offset:4096
ds_read_b128 v[216:219],v1 offset:13312
mf v[36:39],v[184:187],a[28:31],v[36:39]
s_cmp_gt_u32 s27,13
s_cselect_b32 s74,13,14
s_mul_i32 s74,s74,36864
mf v[40:43],v[184:187],a[32:35],v[40:43]
s_add_u32 s74,s74,s73
s_add_u32 s60,s74,0
mf v[40:43],v[180:183],a[24:27],v[40:43]
s_add_u32 m0,s61,110592
mf v[44:47],v[188:191],a[20:23],v[44:47]
buffer_load_dwordx4 v1,s[20:23],s60 offen sc1 lds
mf v[44:47],v[192:195],a[28:31],v[44:47]
ds_read_b128 v[180:183],v1 offset:5120
ds_read_b128 v[184:187],v1 offset:14336
mf v[48:51],v[192:195],a[32:35],v[48:51]
v_rcp_f32 v34,v34
mf v[48:51],v[188:191],a[24:27],v[48:51]
v_rcp_f32 v35,v35
mf v[52:55],v[196:199],a[20:23],v[52:55]
buffer_load_dwordx4 a[120:123],v3,s[4:7],s71 offen offset:3072
mf v[52:55],v[200:203],a[28:31],v[52:55]
ds_read_b128 v[188:191],v1 offset:6144
ds_read_b128 v[192:195],v1 offset:15360
mf v[56:59],v[200:203],a[32:35],v[56:59]
v_mul_f32 v164,v164,v32
v_mul_f32 v165,v165,v33
mf v[56:59],v[196:199],a[24:27],v[56:59]
v_mul_f32 v166,v166,v34
s_waitcnt lgkmcnt(2)
mf v[60:63],v[204:207],a[20:23],v[60:63]
buffer_load_dwordx4 v1,s[20:23],s60 offen offset:1024 sc1 lds
mf v[60:63],v[208:211],a[28:31],v[60:63]
ds_read_b128 v[196:199],v1 offset:7168
ds_read_b128 v[200:203],v1 offset:16384
mf v[64:67],v[208:211],a[32:35],v[64:67]
v_mul_f32 v167,v167,v35
v_fmac_f32 v168,v11,v28
mf v[64:67],v[204:207],a[24:27],v[64:67]
v_fmac_f32 v169,v11,v29
v_fmac_f32 v170,v11,v30
mf v[68:71],v[212:215],a[20:23],v[68:71]
s_add_u32 s71,s70,122880
buffer_load_dwordx4 a[124:127],v1,s[4:7],s71 offen
mf v[68:71],v[216:219],a[28:31],v[68:71]
ds_read_b128 v[204:207],v1 offset:8192
ds_read_b128 v[208:211],v1 offset:17408
mf v[72:75],v[216:219],a[32:35],v[72:75]
v_fmac_f32 v171,v11,v31
v_mul_f32 v32,v168,v168
mf v[72:75],v[212:215],a[24:27],v[72:75]
v_mul_f32 v33,v169,v169
v_mul_f32 v34,v170,v170
mf v[76:79],v[180:183],a[20:23],v[76:79]
buffer_load_dwordx4 v1,s[20:23],s60 offen offset:2048 sc1 lds
mf v[76:79],v[184:187],a[28:31],v[76:79]
ds_read_b128 v[212:215],v1 offset:18432
ds_read_b128 v[216:219],v1 offset:27648
mf v[80:83],v[184:187],a[32:35],v[80:83]
v_mul_f32 v35,v171,v171
v_fma_f32 v32,v32,v15,v13
mf v[80:83],v[180:183],a[24:27],v[80:83]
v_fma_f32 v33,v33,v15,v13
s_waitcnt lgkmcnt(2)
mf v[84:87],v[188:191],a[20:23],v[84:87]
buffer_load_dwordx4 a[128:131],v1,s[4:7],s71 offen offset:1024
mf v[84:87],v[192:195],a[28:31],v[84:87]
ds_read_b128 v[180:183],v1 offset:19456
ds_read_b128 v[184:187],v1 offset:28672
mf v[88:91],v[192:195],a[32:35],v[88:91]
v_fma_f32 v34,v34,v15,v13
v_fma_f32 v35,v35,v15,v13
mf v[88:91],v[188:191],a[24:27],v[88:91]
v_mul_f32 v32,v168,v32
v_mul_f32 v33,v169,v33
mf v[92:95],v[196:199],a[20:23],v[92:95]
buffer_load_dwordx4 v1,s[20:23],s60 offen offset:3072 sc1 lds
mf v[92:95],v[200:203],a[28:31],v[92:95]
ds_read_b128 v[188:191],v1 offset:20480
ds_read_b128 v[192:195],v1 offset:29696
mf v[96:99],v[200:203],a[32:35],v[96:99]
v_mul_f32 v34,v170,v34
v_mul_f32 v35,v171,v35
mf v[96:99],v[196:199],a[24:27],v[96:99]
v_exp_f32 v32,v32
mf v[100:103],v[204:207],a[20:23],v[100:103]
buffer_load_dwordx4 a[132:135],v1,s[4:7],s91 offen offset:3072
mf v[100:103],v[208:211],a[28:31],v[100:103]
ds_read_b128 v[196:199],v1 offset:21504
ds_read_b128 v[200:203],v1 offset:30720
mf v[104:107],v[208:211],a[32:35],v[104:107]
v_exp_f32 v33,v33
mf v[104:107],v[204:207],a[24:27],v[104:107]
s_waitcnt lgkmcnt(2)
mf v[36:39],v[212:215],a[36:39],v[36:39]
ds_read_b128 v[204:207],v1 offset:22528
ds_read_b128 v[208:211],v1 offset:31744
mf v[36:39],v[216:219],v[244:247],v[36:39]
s_add_u32 m0,s61,114688
mf v[40:43],v[216:219],a[44:47],v[40:43]
buffer_load_dwordx4 v2,s[20:23],s60 offen sc1 lds
mf v[40:43],v[212:215],a[40:43],v[40:43]
v_exp_f32 v34,v34
mf v[44:47],v[180:183],a[36:39],v[44:47]
ds_read_b128 v[212:215],v1 offset:23552
ds_read_b128 v[216:219],v1 offset:32768
mf v[44:47],v[184:187],v[244:247],v[44:47]
v_exp_f32 v35,v35
mf v[48:51],v[184:187],a[44:47],v[48:51]
buffer_load_dwordx4 a[136:139],v1,s[4:7],s71 offen offset:2048
mf v[48:51],v[180:183],a[40:43],v[48:51]
v_fma_f32 v32,v32,v17,v17
v_fma_f32 v33,v33,v17,v17
mf v[52:55],v[188:191],a[36:39],v[52:55]
ds_read_b128 v[180:183],v1 offset:24576
ds_read_b128 v[184:187],v1 offset:33792
mf v[52:55],v[192:195],v[244:247],v[52:55]
v_fma_f32 v34,v34,v17,v17
v_fma_f32 v35,v35,v17,v17
mf v[56:59],v[192:195],a[44:47],v[56:59]
buffer_load_dwordx4 v2,s[20:23],s60 offen offset:1024 sc1 lds
mf v[56:59],v[188:191],a[40:43],v[56:59]
s_waitcnt lgkmcnt(2)
mf v[60:63],v[196:199],a[36:39],v[60:63]
ds_read_b128 v[188:191],v1 offset:25600
ds_read_b128 v[192:195],v1 offset:34816
mf v[60:63],v[200:203],v[244:247],v[60:63]
v_rcp_f32 v32,v32
mf v[64:67],v[200:203],a[44:47],v[64:67]
buffer_load_dwordx4 a[140:143],v1,s[4:7],s71 offen offset:3072
mf v[64:67],v[196:199],a[40:43],v[64:67]
v_rcp_f32 v33,v33
mf v[68:71],v[204:207],a[36:39],v[68:71]
ds_read_b128 v[196:199],v1 offset:26624
ds_read_b128 v[200:203],v1 offset:35840
mf v[68:71],v[208:211],v[244:247],v[68:71]
v_rcp_f32 v34,v34
mf v[72:75],v[208:211],a[44:47],v[72:75]
buffer_load_dwordx4 v2,s[20:23],s60 offen offset:2048 sc1 lds
mf v[72:75],v[204:207],a[40:43],v[72:75]
v_rcp_f32 v35,v35
mf v[76:79],v[212:215],a[36:39],v[76:79]
ds_read_b128 v[204:207],v6
ds_read_b128 v[208:211],v6 offset:9216
mf v[76:79],v[216:219],v[244:247],v[76:79]
v_mul_f32 v168,v168,v32
v_mul_f32 v169,v169,v33
mf v[80:83],v[216:219],a[44:47],v[80:83]
buffer_load_dwordx4 a[244:247],v2,s[4:7],s71 offen
mf v[80:83],v[212:215],a[40:43],v[80:83]
v_mul_f32 v170,v170,v34
s_waitcnt lgkmcnt(2)
mf v[84:87],v[180:183],a[36:39],v[84:87]
ds_read_b128 v[212:215],v6 offset:1024
ds_read_b128 v[216:219],v6 offset:10240
mf v[84:87],v[184:187],v[244:247],v[84:87]
v_mul_f32 v171,v171,v35
v_fmac_f32 v172,v10,v24
mf v[88:91],v[184:187],a[44:47],v[88:91]
buffer_load_dwordx4 v2,s[20:23],s60 offen offset:3072 sc1 lds
mf v[88:91],v[180:183],a[40:43],v[88:91]
s_add_u32 m0,s61,118784
v_fmac_f32 v173,v10,v25
mf v[92:95],v[188:191],a[36:39],v[92:95]
ds_read_b128 v[180:183],v6 offset:2048
ds_read_b128 v[184:187],v6 offset:11264
mf v[92:95],v[192:195],v[244:247],v[92:95]
v_fmac_f32 v174,v10,v26
v_fmac_f32 v175,v10,v27
mf v[96:99],v[192:195],a[44:47],v[96:99]
buffer_load_dwordx4 v3,s[20:23],s60 offen sc1 lds
mf v[96:99],v[188:191],a[40:43],v[96:99]
v_mul_f32 v32,v172,v172
v_mul_f32 v33,v173,v173
mf v[100:103],v[196:199],a[36:39],v[100:103]
ds_read_b128 v[188:191],v6 offset:3072
ds_read_b128 v[192:195],v6 offset:12288
mf v[100:103],v[200:203],v[244:247],v[100:103]
v_mul_f32 v34,v174,v174
v_mul_f32 v35,v175,v175
mf v[104:107],v[200:203],a[44:47],v[104:107]
v_fma_f32 v32,v32,v14,v12
v_fma_f32 v33,v33,v14,v12
mf v[104:107],v[196:199],a[40:43],v[104:107]
s_waitcnt vmcnt(16)
s_barrier
s_waitcnt lgkmcnt(2)
mf v[36:39],v[204:207],a[48:51],v[36:39]
ds_read_b128 v[196:199],v6 offset:4096
ds_read_b128 v[200:203],v6 offset:13312
mf v[36:39],v[208:211],v[248:251],v[36:39]
s_cmp_gt_u32 s27,14
s_cselect_b32 s74,14,15
s_mul_i32 s74,s74,36864
mf v[40:43],v[208:211],a[56:59],v[40:43]
s_add_u32 s74,s74,s73
s_add_u32 s60,s74,0
mf v[40:43],v[204:207],a[52:55],v[40:43]
s_add_u32 m0,s61,0
v_fma_f32 v34,v34,v14,v12
mf v[44:47],v[212:215],a[48:51],v[44:47]
buffer_load_dwordx4 v1,s[20:23],s60 offen sc1 lds
mf v[44:47],v[216:219],v[248:251],v[44:47]
ds_read_b128 v[204:207],v6 offset:5120
ds_read_b128 v[208:211],v6 offset:14336
mf v[48:51],v[216:219],a[56:59],v[48:51]
v_fma_f32 v35,v35,v14,v12
v_mul_f32 v32,v172,v32
mf v[48:51],v[212:215],a[52:55],v[48:51]
v_mul_f32 v33,v173,v33
v_mul_f32 v34,v174,v34
mf v[52:55],v[180:183],a[48:51],v[52:55]
buffer_load_dwordx4 v[244:247],v2,s[4:7],s71 offen offset:1024
mf v[52:55],v[184:187],v[248:251],v[52:55]
ds_read_b128 v[212:215],v6 offset:6144
ds_read_b128 v[216:219],v6 offset:15360
mf v[56:59],v[184:187],a[56:59],v[56:59]
v_mul_f32 v35,v175,v35
mf v[56:59],v[180:183],a[52:55],v[56:59]
s_waitcnt lgkmcnt(2)
mf v[60:63],v[188:191],a[48:51],v[60:63]
buffer_load_dwordx4 v1,s[20:23],s60 offen offset:1024 sc1 lds
mf v[60:63],v[192:195],v[248:251],v[60:63]
ds_read_b128 v[180:183],v6 offset:7168
ds_read_b128 v[184:187],v6 offset:16384
mf v[64:67],v[192:195],a[56:59],v[64:67]
v_exp_f32 v32,v32
mf v[64:67],v[188:191],a[52:55],v[64:67]
v_exp_f32 v33,v33
mf v[68:71],v[196:199],a[48:51],v[68:71]
buffer_load_dwordx4 a[248:251],v2,s[4:7],s71 offen offset:2048
mf v[68:71],v[200:203],v[248:251],v[68:71]
ds_read_b128 v[188:191],v6 offset:8192
ds_read_b128 v[192:195],v6 offset:17408
mf v[72:75],v[200:203],a[56:59],v[72:75]
v_exp_f32 v34,v34
mf v[72:75],v[196:199],a[52:55],v[72:75]
v_exp_f32 v35,v35
mf v[76:79],v[204:207],a[48:51],v[76:79]
buffer_load_dwordx4 v1,s[20:23],s60 offen offset:2048 sc1 lds
mf v[76:79],v[208:211],v[248:251],v[76:79]
ds_read_b128 v[196:199],v6 offset:18432
ds_read_b128 v[200:203],v6 offset:27648
mf v[80:83],v[208:211],a[56:59],v[80:83]
v_fma_f32 v32,v32,v16,v16
v_fma_f32 v33,v33,v16,v16
mf v[80:83],v[204:207],a[52:55],v[80:83]
v_fma_f32 v34,v34,v16,v16
s_waitcnt lgkmcnt(2)
mf v[84:87],v[212:215],a[48:51],v[84:87]
buffer_load_dwordx4 a[252:255],v2,s[4:7],s71 offen offset:3072
mf v[84:87],v[216:219],v[248:251],v[84:87]
ds_read_b128 v[204:207],v6 offset:19456
ds_read_b128 v[208:211],v6 offset:28672
mf v[88:91],v[216:219],a[56:59],v[88:91]
v_fma_f32 v35,v35,v16,v16
mf v[88:91],v[212:215],a[52:55],v[88:91]
v_rcp_f32 v32,v32
mf v[92:95],v[180:183],a[48:51],v[92:95]
buffer_load_dwordx4 v1,s[20:23],s60 offen offset:3072 sc1 lds
mf v[92:95],v[184:187],v[248:251],v[92:95]
ds_read_b128 v[212:215],v6 offset:20480
ds_read_b128 v[216:219],v6 offset:29696
mf v[96:99],v[184:187],a[56:59],v[96:99]
v_rcp_f32 v33,v33
mf v[96:99],v[180:183],a[52:55],v[96:99]
v_rcp_f32 v34,v34
mf v[100:103],v[188:191],a[48:51],v[100:103]
buffer_load_dwordx4 a[0:3],v2,s[4:7],s91 offen
mf v[100:103],v[192:195],v[248:251],v[100:103]
ds_read_b128 v[180:183],v6 offset:21504
ds_read_b128 v[184:187],v6 offset:30720
mf v[104:107],v[192:195],a[56:59],v[104:107]
v_rcp_f32 v35,v35
mf v[104:107],v[188:191],a[52:55],v[104:107]
s_waitcnt lgkmcnt(2)
mf v[36:39],v[196:199],a[60:63],v[36:39]
ds_read_b128 v[188:191],v6 offset:22528
ds_read_b128 v[192:195],v6 offset:31744
mf v[36:39],v[200:203],a[68:71],v[36:39]
s_add_u32 m0,s61,4096
v_mul_f32 v172,v172,v32
mf v[40:43],v[200:203],a[72:75],v[40:43]
buffer_load_dwordx4 v2,s[20:23],s60 offen sc1 lds
mf v[40:43],v[196:199],a[64:67],v[40:43]
v_mul_f32 v173,v173,v33
v_mul_f32 v174,v174,v34
mf v[44:47],v[204:207],a[60:63],v[44:47]
ds_read_b128 v[196:199],v6 offset:23552
ds_read_b128 v[200:203],v6 offset:32768
mf v[44:47],v[208:211],a[68:71],v[44:47]
v_mul_f32 v175,v175,v35
v_fmac_f32 v176,v11,v24
mf v[48:51],v[208:211],a[72:75],v[48:51]
buffer_load_dwordx4 a[4:7],v2,s[4:7],s91 offen offset:1024
mf v[48:51],v[204:207],a[64:67],v[48:51]
v_fmac_f32 v177,v11,v25
v_fmac_f32 v178,v11,v26
mf v[52:55],v[212:215],a[60:63],v[52:55]
ds_read_b128 v[204:207],v6 offset:24576
ds_read_b128 v[208:211],v6 offset:33792
mf v[52:55],v[216:219],a[68:71],v[52:55]
v_fmac_f32 v179,v11,v27
v_mul_f32 v32,v176,v176
mf v[56:59],v[216:219],a[72:75],v[56:59]
buffer_load_dwordx4 v2,s[20:23],s60 offen offset:1024 sc1 lds
mf v[56:59],v[212:215],a[64:67],v[56:59]
v_mul_f32 v33,v177,v177
s_waitcnt lgkmcnt(2)
mf v[60:63],v[180:183],a[60:63],v[60:63]
ds_read_b128 v[212:215],v6 offset:25600
ds_read_b128 v[216:219],v6 offset:34816
mf v[60:63],v[184:187],a[68:71],v[60:63]
v_mul_f32 v34,v178,v178
v_mul_f32 v35,v179,v179
mf v[64:67],v[184:187],a[72:75],v[64:67]
buffer_load_dwordx4 a[8:11],v2,s[4:7],s91 offen offset:2048
mf v[64:67],v[180:183],a[64:67],v[64:67]
v_fma_f32 v32,v32,v15,v13
v_fma_f32 v33,v33,v15,v13
mf v[68:71],v[188:191],a[60:63],v[68:71]
ds_read_b128 v[180:183],v6 offset:26624
ds_read_b128 v[184:187],v6 offset:35840
mf v[68:71],v[192:195],a[68:71],v[68:71]
v_fma_f32 v34,v34,v15,v13
v_fma_f32 v35,v35,v15,v13
mf v[72:75],v[192:195],a[72:75],v[72:75]
buffer_load_dwordx4 v2,s[20:23],s60 offen offset:2048 sc1 lds
mf v[72:75],v[188:191],a[64:67],v[72:75]
v_mul_f32 v32,v176,v32
v_mul_f32 v33,v177,v33
mf v[76:79],v[196:199],a[60:63],v[76:79]
ds_read_b128 v[188:191],v7
ds_read_b128 v[192:195],v7 offset:9216
mf v[76:79],v[200:203],a[68:71],v[76:79]
v_mul_f32 v34,v178,v34
v_mul_f32 v35,v179,v35
mf v[80:83],v[200:203],a[72:75],v[80:83]
buffer_load_dwordx4 a[12:15],v2,s[4:7],s91 offen offset:3072
mf v[80:83],v[196:199],a[64:67],v[80:83]
s_waitcnt lgkmcnt(2)
mf v[84:87],v[204:207],a[60:63],v[84:87]
ds_read_b128 v[196:199],v7 offset:1024
ds_read_b128 v[200:203],v7 offset:10240
mf v[84:87],v[208:211],a[68:71],v[84:87]
v_exp_f32 v32,v32
mf v[88:91],v[208:211],a[72:75],v[88:91]
buffer_load_dwordx4 v2,s[20:23],s60 offen offset:3072 sc1 lds
mf v[88:91],v[204:207],a[64:67],v[88:91]
s_add_u32 m0,s61,8192
mf v[92:95],v[212:215],a[60:63],v[92:95]
ds_read_b128 v[204:207],v7 offset:2048
ds_read_b128 v[208:211],v7 offset:11264
mf v[92:95],v[216:219],a[68:71],v[92:95]
v_exp_f32 v33,v33
mf v[96:99],v[216:219],a[72:75],v[96:99]
buffer_load_dwordx4 v3,s[20:23],s60 offen sc1 lds
mf v[96:99],v[212:215],a[64:67],v[96:99]
v_exp_f32 v34,v34
mf v[100:103],v[180:183],a[60:63],v[100:103]
ds_read_b128 v[212:215],v7 offset:3072
ds_read_b128 v[216:219],v7 offset:12288
mf v[100:103],v[184:187],a[68:71],v[100:103]
v_exp_f32 v35,v35
mf v[104:107],v[184:187],a[72:75],v[104:107]
v_fma_f32 v32,v32,v17,v17
v_fma_f32 v33,v33,v17,v17
mf v[104:107],v[180:183],a[64:67],v[104:107]
s_waitcnt vmcnt(16)
s_barrier
s_waitcnt lgkmcnt(2)
mf v[36:39],v[188:191],a[80:83],v[36:39]
buffer_load_dwordx4 a[16:19],v3,s[4:7],s91 offen
mf v[36:39],v[192:195],a[88:91],v[36:39]
ds_read_b128 v[180:183],v7 offset:4096
ds_read_b128 v[184:187],v7 offset:13312
mf v[40:43],v[192:195],a[92:95],v[40:43]
v_fma_f32 v34,v34,v17,v17
v_fma_f32 v35,v35,v17,v17
mf v[40:43],v[188:191],a[84:87],v[40:43]
v_rcp_f32 v32,v32
mf v[44:47],v[196:199],a[80:83],v[44:47]
s_add_u32 s91,s75,110592
buffer_load_dwordx4 a[20:23],v1,s[4:7],s91 offen
mf v[44:47],v[200:203],a[88:91],v[44:47]
ds_read_b128 v[188:191],v7 offset:5120
ds_read_b128 v[192:195],v7 offset:14336
mf v[48:51],v[200:203],a[92:95],v[48:51]
v_rcp_f32 v33,v33
mf v[48:51],v[196:199],a[84:87],v[48:51]
v_rcp_f32 v34,v34
mf v[52:55],v[204:207],a[80:83],v[52:55]
buffer_load_dwordx4 a[24:27],v1,s[4:7],s91 offen offset:1024
mf v[52:55],v[208:211],a[88:91],v[52:55]
ds_read_b128 v[196:199],v7 offset:6144
ds_read_b128 v[200:203],v7 offset:15360
mf v[56:59],v[208:211],a[92:95],v[56:59]
v_rcp_f32 v35,v35
mf v[56:59],v[204:207],a[84:87],v[56:59]
v_mul_f32 v176,v176,v32
s_waitcnt lgkmcnt(2)
mf v[60:63],v[212:215],a[80:83],v[60:63]
buffer_load_dwordx4 a[28:31],v1,s[4:7],s91 offen offset:2048
mf v[60:63],v[216:219],a[88:91],v[60:63]
ds_read_b128 v[204:207],v7 offset:7168
ds_read_b128 v[208:211],v7 offset:16384
mf v[64:67],v[216:219],a[92:95],v[64:67]
v_mul_f32 v177,v177,v33
v_mul_f32 v178,v178,v34
mf v[64:67],v[212:215],a[84:87],v[64:67]
v_mul_f32 v179,v179,v35
v_lshlrev_b32 v20,3,v0
mf v[68:71],v[180:183],a[80:83],v[68:71]
buffer_load_dwordx4 a[32:35],v1,s[4:7],s91 offen offset:3072
mf v[68:71],v[184:187],a[88:91],v[68:71]
ds_read_b128 v[212:215],v7 offset:8192
ds_read_b128 v[216:219],v7 offset:17408
mf v[72:75],v[184:187],a[92:95],v[72:75]
v_mov_b32 v10,0
v_and_b32 v21,1,v5
mf v[72:75],v[180:183],a[84:87],v[72:75]
v_mul_u32_u24 v21,18432,v21
v_lshrrev_b32 v22,1,v5
mf v[76:79],v[188:191],a[80:83],v[76:79]
buffer_load_dwordx4 a[36:39],v2,s[4:7],s91 offen
mf v[76:79],v[192:195],a[88:91],v[76:79]
ds_read_b128 v[180:183],v7 offset:18432
ds_read_b128 v[184:187],v7 offset:27648
mf v[80:83],v[192:195],a[92:95],v[80:83]
v_lshlrev_b32 v22,8,v22
v_lshl_add_u32 v21,v4,4,v21
mf v[80:83],v[188:191],a[84:87],v[80:83]
v_add_u32 v21,v21,v22
s_waitcnt lgkmcnt(2)
mf v[84:87],v[196:199],a[80:83],v[84:87]
buffer_load_dwordx4 a[40:43],v2,s[4:7],s91 offen offset:1024
mf v[84:87],v[200:203],a[88:91],v[84:87]
ds_read_b128 v[188:191],v7 offset:19456
ds_read_b128 v[192:195],v7 offset:28672
mf v[88:91],v[200:203],a[92:95],v[88:91]
v_and_b32 v23,31,v0
v_lshl_add_u32 v22,v23,2,v22
mf v[88:91],v[196:199],a[84:87],v[88:91]
mf v[92:95],v[204:207],a[80:83],v[92:95]
buffer_load_dwordx4 a[44:47],v2,s[4:7],s91 offen offset:2048
mf v[92:95],v[208:211],a[88:91],v[92:95]
ds_read_b128 v[196:199],v7 offset:20480
ds_read_b128 v[200:203],v7 offset:29696
mf v[96:99],v[208:211],a[92:95],v[96:99]
Ljt96:
s_add_u32 s101,s3,Ljt96-Ljb41+1536
mf v[96:99],v[204:207],a[84:87],v[96:99]
mf v[100:103],v[212:215],a[80:83],v[100:103]
buffer_load_dword v9,off,s[16:19],s101
mf v[100:103],v[216:219],a[88:91],v[100:103]
ds_read_b128 v[204:207],v7 offset:21504
ds_read_b128 v[208:211],v7 offset:30720
mf v[104:107],v[216:219],a[92:95],v[104:107]
mf v[104:107],v[212:215],a[84:87],v[104:107]
s_waitcnt lgkmcnt(2)
mf v[36:39],v[180:183],a[96:99],v[36:39]
ds_read_b128 v[212:215],v7 offset:22528
ds_read_b128 v[216:219],v7 offset:31744
mf v[36:39],v[184:187],v[220:223],v[36:39]
s_add_u32 s60,s75,0
s_add_u32 m0,s61,36864
mf v[40:43],v[184:187],a[108:111],v[40:43]
buffer_load_dwordx4 v1,s[4:7],s60 offen lds
mf v[40:43],v[180:183],a[100:103],v[40:43]
mf v[44:47],v[188:191],a[96:99],v[44:47]
ds_read_b128 v[180:183],v7 offset:23552
ds_read_b128 v[184:187],v7 offset:32768
mf v[44:47],v[192:195],v[220:223],v[44:47]
mf v[48:51],v[192:195],a[108:111],v[48:51]
mf v[48:51],v[188:191],a[100:103],v[48:51]
mf v[52:55],v[196:199],a[96:99],v[52:55]
buffer_load_dwordx4 a[48:51],v2,s[4:7],s91 offen offset:3072
mf v[52:55],v[200:203],v[220:223],v[52:55]
ds_read_b128 v[188:191],v7 offset:24576
ds_read_b128 v[192:195],v7 offset:33792
mf v[56:59],v[200:203],a[108:111],v[56:59]
mf v[56:59],v[196:199],a[100:103],v[56:59]
s_waitcnt lgkmcnt(2)
mf v[60:63],v[204:207],a[96:99],v[60:63]
ds_read_b128 v[196:199],v7 offset:25600
ds_read_b128 v[200:203],v7 offset:34816
mf v[60:63],v[208:211],v[220:223],v[60:63]
mf v[64:67],v[208:211],a[108:111],v[64:67]
buffer_load_dwordx4 v1,s[4:7],s60 offen offset:1024 lds
mf v[64:67],v[204:207],a[100:103],v[64:67]
mf v[68:71],v[212:215],a[96:99],v[68:71]
ds_read_b128 v[204:207],v7 offset:26624
ds_read_b128 v[208:211],v7 offset:35840
mf v[68:71],v[216:219],v[220:223],v[68:71]
mf v[72:75],v[216:219],a[108:111],v[72:75]
mf v[72:75],v[212:215],a[100:103],v[72:75]
mf v[76:79],v[180:183],a[96:99],v[76:79]
buffer_load_dwordx4 a[52:55],v3,s[4:7],s91 offen
mf v[76:79],v[184:187],v[220:223],v[76:79]
ds_read_b128 v[212:215],v8
ds_read_b128 v[216:219],v8 offset:9216
mf v[80:83],v[184:187],a[108:111],v[80:83]
mf v[80:83],v[180:183],a[100:103],v[80:83]
s_waitcnt lgkmcnt(2)
mf v[84:87],v[188:191],a[96:99],v[84:87]
ds_read_b128 v[180:183],v8 offset:18432
ds_read_b128 v[184:187],v8 offset:27648
mf v[84:87],v[192:195],v[220:223],v[84:87]
mf v[88:91],v[192:195],a[108:111],v[88:91]
buffer_load_dwordx4 v1,s[4:7],s60 offen offset:2048 lds
mf v[88:91],v[188:191],a[100:103],v[88:91]
mf v[92:95],v[196:199],a[96:99],v[92:95]
s_waitcnt vmcnt(14)
s_barrier
ds_read_b128 v[188:191],v1
ds_read_b128 v[192:195],v1 offset:9216
mf v[92:95],v[200:203],v[220:223],v[92:95]
mf v[96:99],v[200:203],a[108:111],v[96:99]
mf v[96:99],v[196:199],a[100:103],v[96:99]
mf v[100:103],v[204:207],a[96:99],v[100:103]
buffer_load_dwordx4 v1,s[4:7],s60 offen offset:3072 lds
mf v[100:103],v[208:211],v[220:223],v[100:103]
ds_read_b128 v[196:199],v1 offset:18432
ds_read_b128 v[200:203],v1 offset:27648
mf v[104:107],v[208:211],a[108:111],v[104:107]
mf v[104:107],v[204:207],a[100:103],v[104:107]
s_barrier
s_waitcnt lgkmcnt(2)
mf v[36:39],v[212:215],a[112:115],v[36:39]
ds_read_b128 v[204:207],v8 offset:1024
ds_read_b128 v[208:211],v8 offset:10240
mf v[36:39],v[216:219],v[228:231],v[36:39]
s_add_u32 m0,s61,40960
mf v[40:43],v[216:219],v[232:235],v[40:43]
mf v[40:43],v[212:215],v[224:227],v[40:43]
buffer_load_dwordx4 v2,s[4:7],s60 offen lds
mf v[36:39],v[180:183],v[236:239],v[36:39]
ds_read_b128 v[212:215],v8 offset:19456
ds_read_b128 v[216:219],v8 offset:28672
mf v[36:39],v[184:187],v[252:255],v[36:39]
mf v[40:43],v[184:187],a[120:123],v[40:43]
mf v[40:43],v[180:183],v[240:243],v[40:43]
mf v[36:39],v[188:191],a[124:127],v[36:39]
ds_read_b128 v[180:183],v1 offset:1024
ds_read_b128 v[184:187],v1 offset:10240
mf v[36:39],v[192:195],a[136:139],v[36:39]
mf v[40:43],v[192:195],a[140:143],v[40:43]
buffer_load_dwordx4 v2,s[4:7],s60 offen offset:1024 lds
mf v[40:43],v[188:191],a[128:131],v[40:43]
s_waitcnt lgkmcnt(2)
mf v[36:39],v[196:199],a[244:247],v[36:39]
ds_read_b128 v[188:191],v1 offset:19456
ds_read_b128 v[192:195],v1 offset:28672
mf v[36:39],v[200:203],a[248:251],v[36:39]
mf v[40:43],v[200:203],a[252:255],v[40:43]
mf v[40:43],v[196:199],v[244:247],v[40:43]
mf v[44:47],v[204:207],a[112:115],v[44:47]
ds_read_b128 v[196:199],v8 offset:2048
ds_read_b128 v[200:203],v8 offset:11264
mf v[44:47],v[208:211],v[228:231],v[44:47]
buffer_load_dwordx4 v2,s[4:7],s60 offen offset:2048 lds
mf v[48:51],v[208:211],v[232:235],v[48:51]
v_mul_f32 v36,v36,v108
v_mul_f32 v37,v37,v109
mf v[48:51],v[204:207],v[224:227],v[48:51]
v_mul_f32 v38,v38,v110
v_mul_f32 v39,v39,v111
mf v[44:47],v[212:215],v[236:239],v[44:47]
ds_read_b128 v[204:207],v8 offset:20480
ds_read_b128 v[208:211],v8 offset:29696
mf v[44:47],v[216:219],v[252:255],v[44:47]
v_cvt_pk_bf16_f32 v108,v36,v37
v_cvt_pk_bf16_f32 v109,v38,v39
mf v[48:51],v[216:219],a[120:123],v[48:51]
v_mul_f32 v40,v40,v112
v_mul_f32 v41,v41,v113
mf v[48:51],v[212:215],v[240:243],v[48:51]
v_mul_f32 v42,v42,v114
s_waitcnt lgkmcnt(2)
mf v[44:47],v[180:183],a[124:127],v[44:47]
buffer_load_dwordx4 v2,s[4:7],s60 offen offset:3072 lds
mf v[44:47],v[184:187],a[136:139],v[44:47]
ds_read_b128 v[212:215],v1 offset:2048
ds_read_b128 v[216:219],v1 offset:11264
mf v[48:51],v[184:187],a[140:143],v[48:51]
s_add_u32 m0,s61,45056
v_mul_f32 v43,v43,v115
mf v[48:51],v[180:183],a[128:131],v[48:51]
v_cvt_pk_bf16_f32 v112,v40,v41
v_cvt_pk_bf16_f32 v113,v42,v43
mf v[44:47],v[188:191],a[244:247],v[44:47]
ds_read_b128 v[180:183],v1 offset:20480
ds_read_b128 v[184:187],v1 offset:29696
mf v[44:47],v[192:195],a[248:251],v[44:47]
mf v[48:51],v[192:195],a[252:255],v[48:51]
mf v[48:51],v[188:191],v[244:247],v[48:51]
buffer_load_dwordx4 v3,s[4:7],s60 offen lds
mf v[52:55],v[196:199],a[112:115],v[52:55]
ds_read_b128 v[188:191],v8 offset:3072
ds_read_b128 v[192:195],v8 offset:12288
mf v[52:55],v[200:203],v[228:231],v[52:55]
s_nop 0
v_mul_f32 v44,v44,v116
v_mul_f32 v45,v45,v117
mf v[56:59],v[200:203],v[232:235],v[56:59]
v_mul_f32 v46,v46,v118
v_mul_f32 v47,v47,v119
mf v[56:59],v[196:199],v[224:227],v[56:59]
v_cvt_pk_bf16_f32 v110,v44,v45
s_waitcnt lgkmcnt(2)
mf v[52:55],v[204:207],v[236:239],v[52:55]
ds_read_b128 v[196:199],v8 offset:21504
ds_read_b128 v[200:203],v8 offset:30720
mf v[52:55],v[208:211],v[252:255],v[52:55]
s_add_u32 s60,s75,36864
s_add_u32 m0,s61,73728
mf v[56:59],v[208:211],a[120:123],v[56:59]
buffer_load_dwordx4 v1,s[4:7],s60 offen lds
mf v[56:59],v[204:207],v[240:243],v[56:59]
v_cvt_pk_bf16_f32 v111,v46,v47
v_mul_f32 v48,v48,v120
mf v[52:55],v[212:215],a[124:127],v[52:55]
ds_read_b128 v[204:207],v1 offset:3072
ds_read_b128 v[208:211],v1 offset:12288
mf v[52:55],v[216:219],a[136:139],v[52:55]
buffer_store_dwordx4 v[108:111],v1,s[20:23],s48 offen sc1
mf v[56:59],v[216:219],a[140:143],v[56:59]
v_mul_f32 v49,v49,v121
v_mul_f32 v50,v50,v122
mf v[56:59],v[212:215],a[128:131],v[56:59]
v_mul_f32 v51,v51,v123
v_cvt_pk_bf16_f32 v114,v48,v49
mf v[52:55],v[180:183],a[244:247],v[52:55]
ds_read_b128 v[212:215],v1 offset:21504
ds_read_b128 v[216:219],v1 offset:30720
mf v[52:55],v[184:187],a[248:251],v[52:55]
buffer_load_dwordx4 v1,s[4:7],s60 offen offset:1024 lds
mf v[56:59],v[184:187],a[252:255],v[56:59]
v_cvt_pk_bf16_f32 v115,v50,v51
mf v[56:59],v[180:183],v[244:247],v[56:59]
s_waitcnt lgkmcnt(2)
mf v[60:63],v[188:191],a[112:115],v[60:63]
ds_read_b128 v[180:183],v8 offset:4096
ds_read_b128 v[184:187],v8 offset:13312
mf v[60:63],v[192:195],v[228:231],v[60:63]
v_mul_f32 v52,v52,v124
v_mul_f32 v53,v53,v125
mf v[64:67],v[192:195],v[232:235],v[64:67]
v_mul_f32 v54,v54,v126
v_mul_f32 v55,v55,v127
mf v[64:67],v[188:191],v[224:227],v[64:67]
v_cvt_pk_bf16_f32 v124,v52,v53
v_cvt_pk_bf16_f32 v125,v54,v55
mf v[60:63],v[196:199],v[236:239],v[60:63]
buffer_load_dwordx4 v1,s[4:7],s60 offen offset:2048 lds
mf v[60:63],v[200:203],v[252:255],v[60:63]
ds_read_b128 v[188:191],v8 offset:22528
ds_read_b128 v[192:195],v8 offset:31744
mf v[64:67],v[200:203],a[120:123],v[64:67]
v_mul_f32 v56,v56,v128
v_mul_f32 v57,v57,v129
mf v[64:67],v[196:199],v[240:243],v[64:67]
buffer_store_dwordx4 v[112:115],v1,s[20:23],s49 offen sc1
mf v[60:63],v[204:207],a[124:127],v[60:63]
ds_read_b128 v[196:199],v1 offset:4096
ds_read_b128 v[200:203],v1 offset:13312
mf v[60:63],v[208:211],a[136:139],v[60:63]
v_mul_f32 v58,v58,v130
v_mul_f32 v59,v59,v131
mf v[64:67],v[208:211],a[140:143],v[64:67]
v_cvt_pk_bf16_f32 v128,v56,v57
v_cvt_pk_bf16_f32 v129,v58,v59
mf v[64:67],v[204:207],a[128:131],v[64:67]
s_waitcnt lgkmcnt(2)
mf v[60:63],v[212:215],a[244:247],v[60:63]
buffer_load_dwordx4 v1,s[4:7],s60 offen offset:3072 lds
mf v[60:63],v[216:219],a[248:251],v[60:63]
ds_read_b128 v[204:207],v1 offset:22528
ds_read_b128 v[208:211],v1 offset:31744
mf v[64:67],v[216:219],a[252:255],v[64:67]
s_add_u32 m0,s61,77824
mf v[64:67],v[212:215],v[244:247],v[64:67]
mf v[68:71],v[180:183],a[112:115],v[68:71]
ds_read_b128 v[212:215],v8 offset:5120
ds_read_b128 v[216:219],v8 offset:14336
mf v[68:71],v[184:187],v[228:231],v[68:71]
v_mul_f32 v60,v60,v132
v_mul_f32 v61,v61,v133
mf v[72:75],v[184:187],v[232:235],v[72:75]
v_mul_f32 v62,v62,v134
v_mul_f32 v63,v63,v135
mf v[72:75],v[180:183],v[224:227],v[72:75]
buffer_load_dwordx4 v2,s[4:7],s60 offen lds
mf v[68:71],v[188:191],v[236:239],v[68:71]
ds_read_b128 v[180:183],v8 offset:23552
ds_read_b128 v[184:187],v8 offset:32768
mf v[68:71],v[192:195],v[252:255],v[68:71]
v_cvt_pk_bf16_f32 v126,v60,v61
v_cvt_pk_bf16_f32 v127,v62,v63
mf v[72:75],v[192:195],a[120:123],v[72:75]
v_mul_f32 v64,v64,v136
v_mul_f32 v65,v65,v137
mf v[72:75],v[188:191],v[240:243],v[72:75]
v_mul_f32 v66,v66,v138
s_waitcnt lgkmcnt(2)
mf v[68:71],v[196:199],a[124:127],v[68:71]
ds_read_b128 v[188:191],v1 offset:5120
ds_read_b128 v[192:195],v1 offset:14336
mf v[68:71],v[200:203],a[136:139],v[68:71]
buffer_store_dwordx4 v[124:127],v1,s[20:23],s48 offen offset:1024 sc1
mf v[72:75],v[200:203],a[140:143],v[72:75]
v_mul_f32 v67,v67,v139
v_cvt_pk_bf16_f32 v130,v64,v65
mf v[72:75],v[196:199],a[128:131],v[72:75]
buffer_load_dwordx4 v2,s[4:7],s60 offen offset:1024 lds
mf v[68:71],v[204:207],a[244:247],v[68:71]
ds_read_b128 v[196:199],v1 offset:23552
ds_read_b128 v[200:203],v1 offset:32768
mf v[68:71],v[208:211],a[248:251],v[68:71]
v_cvt_pk_bf16_f32 v131,v66,v67
mf v[72:75],v[208:211],a[252:255],v[72:75]
mf v[72:75],v[204:207],v[244:247],v[72:75]
mf v[76:79],v[212:215],a[112:115],v[76:79]
ds_read_b128 v[204:207],v8 offset:6144
ds_read_b128 v[208:211],v8 offset:15360
mf v[76:79],v[216:219],v[228:231],v[76:79]
s_nop 0
v_mul_f32 v68,v68,v140
v_mul_f32 v69,v69,v141
mf v[80:83],v[216:219],v[232:235],v[80:83]
v_mul_f32 v70,v70,v142
v_mul_f32 v71,v71,v143
mf v[80:83],v[212:215],v[224:227],v[80:83]
v_cvt_pk_bf16_f32 v140,v68,v69
s_waitcnt lgkmcnt(2)
mf v[76:79],v[180:183],v[236:239],v[76:79]
buffer_load_dwordx4 v2,s[4:7],s60 offen offset:2048 lds
mf v[76:79],v[184:187],v[252:255],v[76:79]
ds_read_b128 v[212:215],v8 offset:24576
ds_read_b128 v[216:219],v8 offset:33792
mf v[80:83],v[184:187],a[120:123],v[80:83]
v_cvt_pk_bf16_f32 v141,v70,v71
v_mul_f32 v72,v72,v144
mf v[80:83],v[180:183],v[240:243],v[80:83]
buffer_store_dwordx4 v[128:131],v1,s[20:23],s49 offen offset:1024 sc1
mf v[76:79],v[188:191],a[124:127],v[76:79]
ds_read_b128 v[180:183],v1 offset:6144
ds_read_b128 v[184:187],v1 offset:15360
mf v[76:79],v[192:195],a[136:139],v[76:79]
v_mul_f32 v73,v73,v145
v_mul_f32 v74,v74,v146
mf v[80:83],v[192:195],a[140:143],v[80:83]
v_mul_f32 v75,v75,v147
v_cvt_pk_bf16_f32 v144,v72,v73
mf v[80:83],v[188:191],a[128:131],v[80:83]
v_cvt_pk_bf16_f32 v145,v74,v75
mf v[76:79],v[196:199],a[244:247],v[76:79]
buffer_load_dwordx4 v2,s[4:7],s60 offen offset:3072 lds
mf v[76:79],v[200:203],a[248:251],v[76:79]
ds_read_b128 v[188:191],v1 offset:24576
ds_read_b128 v[192:195],v1 offset:33792
mf v[80:83],v[200:203],a[252:255],v[80:83]
s_add_u32 m0,s61,81920
mf v[80:83],v[196:199],v[244:247],v[80:83]
s_waitcnt lgkmcnt(2)
mf v[84:87],v[204:207],a[112:115],v[84:87]
ds_read_b128 v[196:199],v8 offset:7168
ds_read_b128 v[200:203],v8 offset:16384
mf v[84:87],v[208:211],v[228:231],v[84:87]
v_mul_f32 v76,v76,v148
v_mul_f32 v77,v77,v149
mf v[88:91],v[208:211],v[232:235],v[88:91]
v_mul_f32 v78,v78,v150
v_mul_f32 v79,v79,v151
mf v[88:91],v[204:207],v[224:227],v[88:91]
v_cvt_pk_bf16_f32 v142,v76,v77
v_cvt_pk_bf16_f32 v143,v78,v79
mf v[84:87],v[212:215],v[236:239],v[84:87]
buffer_load_dwordx4 v3,s[4:7],s60 offen lds
mf v[84:87],v[216:219],v[252:255],v[84:87]
ds_read_b128 v[204:207],v8 offset:25600
ds_read_b128 v[208:211],v8 offset:34816
mf v[88:91],v[216:219],a[120:123],v[88:91]
v_mul_f32 v80,v80,v152
v_mul_f32 v81,v81,v153
mf v[88:91],v[212:215],v[240:243],v[88:91]
buffer_store_dwordx4 v[140:143],v1,s[20:23],s48 offen offset:2048 sc1
mf v[84:87],v[180:183],a[124:127],v[84:87]
ds_read_b128 v[212:215],v1 offset:7168
ds_read_b128 v[216:219],v1 offset:16384
mf v[84:87],v[184:187],a[136:139],v[84:87]
v_mul_f32 v82,v82,v154
v_mul_f32 v83,v83,v155
mf v[88:91],v[184:187],a[140:143],v[88:91]
v_cvt_pk_bf16_f32 v146,v80,v81
v_cvt_pk_bf16_f32 v147,v82,v83
mf v[88:91],v[180:183],a[128:131],v[88:91]
s_waitcnt lgkmcnt(2)
mf v[84:87],v[188:191],a[244:247],v[84:87]
ds_read_b128 v[180:183],v1 offset:25600
ds_read_b128 v[184:187],v1 offset:34816
mf v[84:87],v[192:195],a[248:251],v[84:87]
mf v[88:91],v[192:195],a[252:255],v[88:91]
mf v[88:91],v[188:191],v[244:247],v[88:91]
mf v[92:95],v[196:199],a[112:115],v[92:95]
ds_read_b128 v[188:191],v8 offset:8192
ds_read_b128 v[192:195],v8 offset:17408
mf v[92:95],v[200:203],v[228:231],v[92:95]
s_nop 1
v_mul_f32 v84,v84,v156
v_mul_f32 v85,v85,v157
mf v[96:99],v[200:203],v[232:235],v[96:99]
v_mul_f32 v86,v86,v158
v_mul_f32 v87,v87,v159
mf v[96:99],v[196:199],v[224:227],v[96:99]
v_cvt_pk_bf16_f32 v156,v84,v85
v_cvt_pk_bf16_f32 v157,v86,v87
mf v[92:95],v[204:207],v[236:239],v[92:95]
ds_read_b128 v[196:199],v8 offset:26624
ds_read_b128 v[200:203],v8 offset:35840
mf v[92:95],v[208:211],v[252:255],v[92:95]
buffer_store_dwordx4 v[144:147],v1,s[20:23],s49 offen offset:2048 sc1
mf v[96:99],v[208:211],a[120:123],v[96:99]
v_mul_f32 v88,v88,v160
v_mul_f32 v89,v89,v161
mf v[96:99],v[204:207],v[240:243],v[96:99]
v_mul_f32 v90,v90,v162
s_waitcnt lgkmcnt(2)
mf v[92:95],v[212:215],a[124:127],v[92:95]
ds_read_b128 v[204:207],v1 offset:8192
ds_read_b128 v[208:211],v1 offset:17408
mf v[92:95],v[216:219],a[136:139],v[92:95]
v_mul_f32 v91,v91,v163
v_cvt_pk_bf16_f32 v160,v88,v89
mf v[96:99],v[216:219],a[140:143],v[96:99]
v_cvt_pk_bf16_f32 v161,v90,v91
mf v[96:99],v[212:215],a[128:131],v[96:99]
mf v[92:95],v[180:183],a[244:247],v[92:95]
ds_read_b128 v[212:215],v1 offset:26624
ds_read_b128 v[216:219],v1 offset:35840
mf v[92:95],v[184:187],a[248:251],v[92:95]
mf v[96:99],v[184:187],a[252:255],v[96:99]
mf v[96:99],v[180:183],v[244:247],v[96:99]
mf v[100:103],v[188:191],a[112:115],v[100:103]
s_waitcnt vmcnt(15)
s_barrier
ds_read_b128 v[180:183],v6
ds_read_b128 v[184:187],v6 offset:9216
mf v[100:103],v[192:195],v[228:231],v[100:103]
v_mul_f32 v92,v92,v164
v_mul_f32 v93,v93,v165
mf v[104:107],v[192:195],v[232:235],v[104:107]
v_mul_f32 v94,v94,v166
v_mul_f32 v95,v95,v167
mf v[104:107],v[188:191],v[224:227],v[104:107]
v_cvt_pk_bf16_f32 v158,v92,v93
s_waitcnt lgkmcnt(2)
mf v[100:103],v[196:199],v[236:239],v[100:103]
ds_read_b128 v[188:191],v6 offset:1024
ds_read_b128 v[192:195],v6 offset:10240
mf v[100:103],v[200:203],v[252:255],v[100:103]
v_cvt_pk_bf16_f32 v159,v94,v95
v_mul_f32 v96,v96,v168
mf v[104:107],v[200:203],a[120:123],v[104:107]
buffer_store_dwordx4 v[156:159],v1,s[20:23],s48 offen offset:3072 sc1
mf v[104:107],v[196:199],v[240:243],v[104:107]
v_mul_f32 v97,v97,v169
v_mul_f32 v98,v98,v170
s_waitcnt vmcnt(5)
s_mov_b64 exec,1
v_mov_b32 v11,1
buffer_atomic_add v11,v10,s[20:23],s52 offen sc1
s_mov_b64 exec,-1
mf v[100:103],v[204:207],a[124:127],v[100:103]
ds_read_b128 v[196:199],v6 offset:2048
ds_read_b128 v[200:203],v6 offset:11264
mf v[100:103],v[208:211],a[136:139],v[100:103]
v_mul_f32 v99,v99,v171
v_cvt_pk_bf16_f32 v162,v96,v97
mf v[104:107],v[208:211],a[140:143],v[104:107]
v_cvt_pk_bf16_f32 v163,v98,v99
mf v[104:107],v[204:207],a[128:131],v[104:107]
mf v[100:103],v[212:215],a[244:247],v[100:103]
ds_read_b128 v[204:207],v6 offset:3072
ds_read_b128 v[208:211],v6 offset:12288
mf v[100:103],v[216:219],a[248:251],v[100:103]
mf v[104:107],v[216:219],a[252:255],v[104:107]
mf v[104:107],v[212:215],v[244:247],v[104:107]
s_barrier
s_cmp_lg_u32 s24,3
s_cbranch_scc1 Lwc97
s_getpc_b64 s[16:17]
Lwc97a:
s_mov_b32 s18,Lexit-Lwc97a
s_mov_b32 s19,0x20000
s_lshr_b32 s87,s2,3
s_mul_i32 s87,s87,1024
v_lshlrev_b32 v24,7,v0
s_mov_b32 exec_hi,0
s_mov_b32 exec_lo,255
buffer_load_dword v25,v24,s[16:19],s87 offen
s_mov_b64 exec,-1
Lwc97:
s_waitcnt lgkmcnt(2)
mf v[36:39],v[180:183],v[108:111],0
ds_read_b128 v[212:215],v6 offset:4096
ds_read_b128 v[216:219],v6 offset:13312
mf v[36:39],v[184:187],v[124:127],v[36:39]
v_mul_f32 v100,v100,v172
v_mul_f32 v101,v101,v173
mf v[40:43],v[184:187],v[128:131],0
v_mul_f32 v102,v102,v174
v_mul_f32 v103,v103,v175
mf v[40:43],v[180:183],v[112:115],v[40:43]
v_cvt_pk_bf16_f32 v172,v100,v101
v_cvt_pk_bf16_f32 v173,v102,v103
mf v[44:47],v[188:191],v[108:111],0
ds_read_b128 v[180:183],v6 offset:5120
ds_read_b128 v[184:187],v6 offset:14336
mf v[44:47],v[192:195],v[124:127],v[44:47]
buffer_store_dwordx4 v[160:163],v1,s[20:23],s49 offen offset:3072 sc1
mf v[48:51],v[192:195],v[128:131],0
v_mul_f32 v104,v104,v176
v_mul_f32 v105,v105,v177
mf v[48:51],v[188:191],v[112:115],v[48:51]
v_mul_f32 v106,v106,v178
v_mul_f32 v107,v107,v179
mf v[52:55],v[196:199],v[108:111],0
ds_read_b128 v[188:191],v6 offset:6144
ds_read_b128 v[192:195],v6 offset:15360
mf v[52:55],v[200:203],v[124:127],v[52:55]
v_cvt_pk_bf16_f32 v176,v104,v105
v_cvt_pk_bf16_f32 v177,v106,v107
mf v[56:59],v[200:203],v[128:131],0
v_add_u32 v18,s61,v8
mf v[56:59],v[196:199],v[112:115],v[56:59]
s_mov_b64 exec,1
v_mov_b32 v17,0
buffer_atomic_add v17,v10,s[20:23],s52 offen sc0 sc1
s_mov_b64 exec,-1
s_waitcnt lgkmcnt(2)
mf v[60:63],v[204:207],v[108:111],0
ds_read_b128 v[196:199],v6 offset:7168
ds_read_b128 v[200:203],v6 offset:16384
mf v[60:63],v[208:211],v[124:127],v[60:63]
buffer_store_dwordx2 v[172:173],v20,s[20:23],s50 offen sc1
mf v[64:67],v[208:211],v[128:131],0
ds_write_b128 v18,a[76:79]
mf v[64:67],v[204:207],v[112:115],v[64:67]
mf v[68:71],v[212:215],v[108:111],0
ds_read_b128 v[204:207],v6 offset:8192
ds_read_b128 v[208:211],v6 offset:17408
mf v[68:71],v[216:219],v[124:127],v[68:71]
ds_write_b128 v18,a[104:107] offset:1024
mf v[72:75],v[216:219],v[128:131],0
mf v[72:75],v[212:215],v[112:115],v[72:75]
mf v[76:79],v[180:183],v[108:111],0
ds_read_b128 v[212:215],v6 offset:18432
ds_read_b128 v[216:219],v6 offset:27648
mf v[76:79],v[184:187],v[124:127],v[76:79]
buffer_store_dwordx2 v[176:177],v20,s[20:23],s51 offen sc1
mf v[80:83],v[184:187],v[128:131],0
mf v[80:83],v[180:183],v[112:115],v[80:83]
s_waitcnt lgkmcnt(3)
mf v[84:87],v[188:191],v[108:111],0
ds_read_b128 v[180:183],v6 offset:19456
ds_read_b128 v[184:187],v6 offset:28672
mf v[84:87],v[192:195],v[124:127],v[84:87]
ds_write_b128 v18,a[116:119] offset:2048
mf v[88:91],v[192:195],v[128:131],0
mf v[88:91],v[188:191],v[112:115],v[88:91]
mf v[92:95],v[196:199],v[108:111],0
ds_read_b128 v[188:191],v6 offset:20480
ds_read_b128 v[192:195],v6 offset:29696
mf v[92:95],v[200:203],v[124:127],v[92:95]
mf v[96:99],v[200:203],v[128:131],0
mf v[96:99],v[196:199],v[112:115],v[96:99]
mf v[100:103],v[204:207],v[108:111],0
ds_read_b128 v[196:199],v6 offset:21504
ds_read_b128 v[200:203],v6 offset:30720
mf v[100:103],v[208:211],v[124:127],v[100:103]
ds_write_b128 v18,a[132:135] offset:3072
mf v[104:107],v[208:211],v[128:131],0
mf v[104:107],v[204:207],v[112:115],v[104:107]
s_waitcnt lgkmcnt(3)
mf v[36:39],v[212:215],v[140:143],v[36:39]
ds_read_b128 v[204:207],v6 offset:22528
ds_read_b128 v[208:211],v6 offset:31744
mf v[36:39],v[216:219],v[156:159],v[36:39]
mf v[40:43],v[216:219],v[160:163],v[40:43]
mf v[40:43],v[212:215],v[144:147],v[40:43]
mf v[44:47],v[180:183],v[140:143],v[44:47]
ds_read_b128 v[212:215],v6 offset:23552
ds_read_b128 v[216:219],v6 offset:32768
mf v[44:47],v[184:187],v[156:159],v[44:47]
ds_write_b128 v18,a[0:3] offset:4096
mf v[48:51],v[184:187],v[160:163],v[48:51]
mf v[48:51],v[180:183],v[144:147],v[48:51]
mf v[52:55],v[188:191],v[140:143],v[52:55]
ds_read_b128 v[180:183],v6 offset:24576
ds_read_b128 v[184:187],v6 offset:33792
mf v[52:55],v[192:195],v[156:159],v[52:55]
mf v[56:59],v[192:195],v[160:163],v[56:59]
mf v[56:59],v[188:191],v[144:147],v[56:59]
s_waitcnt lgkmcnt(3)
mf v[60:63],v[196:199],v[140:143],v[60:63]
ds_read_b128 v[188:191],v6 offset:25600
ds_read_b128 v[192:195],v6 offset:34816
mf v[60:63],v[200:203],v[156:159],v[60:63]
ds_write_b128 v18,a[4:7] offset:5120
mf v[64:67],v[200:203],v[160:163],v[64:67]
mf v[64:67],v[196:199],v[144:147],v[64:67]
s_waitcnt vmcnt(2)
v_readfirstlane_b32 s87,v17
s_nop 0
s_bfe_u32 s87,s87,524288
s_cmp_eq_u32 s87,4
s_cbranch_scc1 Lc98
s_mov_b64 exec,1
s_mov_b32 s56,0
v_mov_b32 v14,0
buffer_atomic_add v14,v10,s[20:23],s52 offen sc0 sc1
s_sleep 4
v_mov_b32 v15,0
buffer_atomic_add v15,v10,s[20:23],s52 offen sc0 sc1
s_sleep 4
Lp99:
v_mov_b32 v16,0
buffer_atomic_add v16,v10,s[20:23],s52 offen sc0 sc1
s_waitcnt vmcnt(2)
v_bfe_u32 v14,v14,0,8
v_cmp_ne_u32 vcc,4,v14
s_nop 0
s_cbranch_vccz Lpd100
v_mov_b32 v14,0
buffer_atomic_add v14,v10,s[20:23],s52 offen sc0 sc1
s_waitcnt vmcnt(2)
v_bfe_u32 v15,v15,0,8
v_cmp_ne_u32 vcc,4,v15
s_nop 0
s_cbranch_vccz Lpd100
v_mov_b32 v15,0
buffer_atomic_add v15,v10,s[20:23],s52 offen sc0 sc1
s_waitcnt vmcnt(2)
v_bfe_u32 v16,v16,0,8
v_cmp_ne_u32 vcc,4,v16
s_nop 0
s_cbranch_vccz Lpd100
s_add_u32 s56,s56,1
s_cmp_lt_u32 s56,0x40000
s_cbranch_scc1 Lp99
Lpd100:
s_mov_b64 exec,-1
Lc98:
buffer_load_dwordx4 a[56:59],v1,s[20:23],s67 offen sc1
buffer_load_dwordx4 a[60:63],v1,s[20:23],s68 offen sc1
mf v[68:71],v[204:207],v[140:143],v[68:71]
ds_read_b128 v[196:199],v6 offset:26624
ds_read_b128 v[200:203],v6 offset:35840
mf v[68:71],v[208:211],v[156:159],v[68:71]
mf v[72:75],v[208:211],v[160:163],v[72:75]
mf v[72:75],v[204:207],v[144:147],v[72:75]
buffer_load_dwordx4 a[64:67],v1,s[20:23],s69 offen sc1
mf v[76:79],v[212:215],v[140:143],v[76:79]
s_barrier
ds_read_b128 v[204:207],v7
ds_read_b128 v[208:211],v7 offset:9216
mf v[76:79],v[216:219],v[156:159],v[76:79]
ds_write_b128 v18,a[8:11] offset:6144
mf v[80:83],v[216:219],v[160:163],v[80:83]
mf v[80:83],v[212:215],v[144:147],v[80:83]
s_waitcnt lgkmcnt(3)
mf v[84:87],v[180:183],v[140:143],v[84:87]
buffer_load_dwordx4 a[68:71],v1,s[20:23],s72 offen sc1
mf v[84:87],v[184:187],v[156:159],v[84:87]
ds_read_b128 v[212:215],v7 offset:1024
ds_read_b128 v[216:219],v7 offset:10240
mf v[88:91],v[184:187],v[160:163],v[88:91]
mf v[88:91],v[180:183],v[144:147],v[88:91]
s_waitcnt vmcnt(4)
s_mov_b64 exec,1
v_mov_b32 v11,256
buffer_atomic_add v11,v10,s[20:23],s52 offen sc1
s_mov_b64 exec,-1
mf v[92:95],v[188:191],v[140:143],v[92:95]
buffer_load_dwordx4 a[72:75],v1,s[20:23],s94 offen sc1
mf v[92:95],v[192:195],v[156:159],v[92:95]
ds_read_b128 v[180:183],v7 offset:2048
ds_read_b128 v[184:187],v7 offset:11264
mf v[96:99],v[192:195],v[160:163],v[96:99]
ds_write_b128 v18,a[12:15] offset:7168
mf v[96:99],v[188:191],v[144:147],v[96:99]
mf v[100:103],v[196:199],v[140:143],v[100:103]
buffer_load_dwordx4 a[80:83],v1,s[20:23],s95 offen sc1
mf v[100:103],v[200:203],v[156:159],v[100:103]
ds_read_b128 v[188:191],v7 offset:3072
ds_read_b128 v[192:195],v7 offset:12288
mf v[104:107],v[200:203],v[160:163],v[104:107]
mf v[104:107],v[196:199],v[144:147],v[104:107]
s_barrier
s_waitcnt vmcnt(3)
s_waitcnt lgkmcnt(3)
mf v[36:39],v[204:207],a[56:59],v[36:39]
buffer_load_dwordx4 a[84:87],v1,s[20:23],s67 offen offset:1024 sc1
mf v[36:39],v[208:211],a[64:67],v[36:39]
ds_read_b128 v[196:199],v7 offset:4096
ds_read_b128 v[200:203],v7 offset:13312
mf v[40:43],v[208:211],a[68:71],v[40:43]
s_mov_b32 s16,s20
s_mov_b32 s17,s21
mf v[40:43],v[204:207],a[60:63],v[40:43]
s_mov_b32 s19,0x20000
mf v[44:47],v[212:215],a[56:59],v[44:47]
buffer_load_dwordx4 a[88:91],v1,s[20:23],s68 offen offset:1024 sc1
mf v[44:47],v[216:219],a[64:67],v[44:47]
ds_read_b128 v[204:207],v7 offset:5120
ds_read_b128 v[208:211],v7 offset:14336
mf v[48:51],v[216:219],a[68:71],v[48:51]
s_cmp_eq_u32 s24,s84
s_cselect_b32 s18,0,s22
mf v[48:51],v[212:215],a[60:63],v[48:51]
ds_write_b128 v18,a[16:19] offset:8192
mf v[52:55],v[180:183],a[56:59],v[52:55]
buffer_load_dwordx4 a[92:95],v1,s[20:23],s69 offen offset:1024 sc1
mf v[52:55],v[184:187],a[64:67],v[52:55]
ds_read_b128 v[212:215],v7 offset:6144
ds_read_b128 v[216:219],v7 offset:15360
mf v[56:59],v[184:187],a[68:71],v[56:59]
v_add_u32 v18,s61,v1
mf v[56:59],v[180:183],a[60:63],v[56:59]
s_mov_b64 exec,1
v_mov_b32 v17,0
buffer_atomic_add v17,v10,s[20:23],s52 offen sc0 sc1
s_mov_b64 exec,-1
s_waitcnt lgkmcnt(3)
mf v[60:63],v[188:191],a[56:59],v[60:63]
buffer_load_dwordx4 a[96:99],v1,s[20:23],s72 offen offset:1024 sc1
mf v[60:63],v[192:195],a[64:67],v[60:63]
ds_read_b128 v[180:183],v7 offset:7168
ds_read_b128 v[184:187],v7 offset:16384
mf v[64:67],v[192:195],a[68:71],v[64:67]
ds_write_b128 v18,a[20:23]
mf v[64:67],v[188:191],a[60:63],v[64:67]
mf v[68:71],v[196:199],a[56:59],v[68:71]
buffer_load_dwordx4 a[100:103],v1,s[20:23],s94 offen offset:1024 sc1
mf v[68:71],v[200:203],a[64:67],v[68:71]
ds_read_b128 v[188:191],v7 offset:8192
ds_read_b128 v[192:195],v7 offset:17408
mf v[72:75],v[200:203],a[68:71],v[72:75]
ds_write_b128 v18,a[24:27] offset:1024
mf v[72:75],v[196:199],a[60:63],v[72:75]
mf v[76:79],v[204:207],a[56:59],v[76:79]
buffer_load_dwordx4 a[108:111],v1,s[20:23],s95 offen offset:1024 sc1
mf v[76:79],v[208:211],a[64:67],v[76:79]
ds_read_b128 v[196:199],v7 offset:18432
ds_read_b128 v[200:203],v7 offset:27648
mf v[80:83],v[208:211],a[68:71],v[80:83]
s_add_u32 s60,s76,147456
s_add_u32 m0,s77,36864
mf v[80:83],v[204:207],a[60:63],v[80:83]
s_waitcnt lgkmcnt(3)
mf v[84:87],v[212:215],a[56:59],v[84:87]
buffer_load_dwordx4 v1,s[4:7],s60 offen lds
mf v[84:87],v[216:219],a[64:67],v[84:87]
ds_read_b128 v[204:207],v7 offset:19456
ds_read_b128 v[208:211],v7 offset:28672
mf v[88:91],v[216:219],a[68:71],v[88:91]
ds_write_b128 v18,a[28:31] offset:2048
mf v[88:91],v[212:215],a[60:63],v[88:91]
mf v[92:95],v[180:183],a[56:59],v[92:95]
buffer_load_dwordx4 v1,s[4:7],s60 offen offset:1024 lds
mf v[92:95],v[184:187],a[64:67],v[92:95]
ds_read_b128 v[212:215],v7 offset:20480
ds_read_b128 v[216:219],v7 offset:29696
mf v[96:99],v[184:187],a[68:71],v[96:99]
mf v[96:99],v[180:183],a[60:63],v[96:99]
mf v[100:103],v[188:191],a[56:59],v[100:103]
buffer_load_dwordx4 v1,s[4:7],s60 offen offset:2048 lds
mf v[100:103],v[192:195],a[64:67],v[100:103]
ds_read_b128 v[180:183],v7 offset:21504
ds_read_b128 v[184:187],v7 offset:30720
mf v[104:107],v[192:195],a[68:71],v[104:107]
ds_write_b128 v18,a[32:35] offset:3072
mf v[104:107],v[188:191],a[60:63],v[104:107]
s_waitcnt vmcnt(8)
s_waitcnt lgkmcnt(3)
mf v[36:39],v[196:199],a[72:75],v[36:39]
buffer_load_dwordx4 v1,s[4:7],s60 offen offset:3072 lds
mf v[36:39],v[200:203],a[84:87],v[36:39]
ds_read_b128 v[188:191],v7 offset:22528
ds_read_b128 v[192:195],v7 offset:31744
mf v[40:43],v[200:203],a[88:91],v[40:43]
s_add_u32 m0,s77,40960
mf v[40:43],v[196:199],a[80:83],v[40:43]
mf v[44:47],v[204:207],a[72:75],v[44:47]
buffer_load_dwordx4 v2,s[4:7],s60 offen lds
mf v[44:47],v[208:211],a[84:87],v[44:47]
ds_read_b128 v[196:199],v7 offset:23552
ds_read_b128 v[200:203],v7 offset:32768
mf v[48:51],v[208:211],a[88:91],v[48:51]
ds_write_b128 v18,a[36:39] offset:4096
mf v[48:51],v[204:207],a[80:83],v[48:51]
mf v[52:55],v[212:215],a[72:75],v[52:55]
ds_read_b128 v[204:207],v7 offset:24576
ds_read_b128 v[208:211],v7 offset:33792
mf v[52:55],v[216:219],a[84:87],v[52:55]
mf v[56:59],v[216:219],a[88:91],v[56:59]
mf v[56:59],v[212:215],a[80:83],v[56:59]
s_waitcnt lgkmcnt(3)
mf v[60:63],v[180:183],a[72:75],v[60:63]
ds_read_b128 v[212:215],v7 offset:25600
ds_read_b128 v[216:219],v7 offset:34816
mf v[60:63],v[184:187],a[84:87],v[60:63]
ds_write_b128 v18,a[40:43] offset:5120
mf v[64:67],v[184:187],a[88:91],v[64:67]
mf v[64:67],v[180:183],a[80:83],v[64:67]
s_waitcnt vmcnt(8)
v_readfirstlane_b32 s87,v17
s_nop 0
s_bfe_u32 s87,s87,524296
s_cmp_eq_u32 s87,4
s_cbranch_scc1 Lc101
s_mov_b64 exec,1
s_mov_b32 s56,0
v_mov_b32 v14,0
buffer_atomic_add v14,v10,s[20:23],s52 offen sc0 sc1
s_sleep 4
v_mov_b32 v15,0
buffer_atomic_add v15,v10,s[20:23],s52 offen sc0 sc1
s_sleep 4
Lp102:
v_mov_b32 v16,0
buffer_atomic_add v16,v10,s[20:23],s52 offen sc0 sc1
s_waitcnt vmcnt(2)
v_bfe_u32 v14,v14,8,8
v_cmp_ne_u32 vcc,4,v14
s_nop 0
s_cbranch_vccz Lpd103
v_mov_b32 v14,0
buffer_atomic_add v14,v10,s[20:23],s52 offen sc0 sc1
s_waitcnt vmcnt(2)
v_bfe_u32 v15,v15,8,8
v_cmp_ne_u32 vcc,4,v15
s_nop 0
s_cbranch_vccz Lpd103
v_mov_b32 v15,0
buffer_atomic_add v15,v10,s[20:23],s52 offen sc0 sc1
s_waitcnt vmcnt(2)
v_bfe_u32 v16,v16,8,8
v_cmp_ne_u32 vcc,4,v16
s_nop 0
s_cbranch_vccz Lpd103
s_add_u32 s56,s56,1
s_cmp_lt_u32 s56,0x40000
s_cbranch_scc1 Lp102
Lpd103:
s_mov_b64 exec,-1
Lc101:
buffer_load_dwordx4 a[112:115],v1,s[20:23],s67 offen offset:2048 sc1
buffer_load_dwordx4 a[120:123],v1,s[20:23],s68 offen offset:2048 sc1
mf v[68:71],v[188:191],a[72:75],v[68:71]
ds_read_b128 v[180:183],v7 offset:26624
ds_read_b128 v[184:187],v7 offset:35840
mf v[68:71],v[192:195],a[84:87],v[68:71]
mf v[72:75],v[192:195],a[88:91],v[72:75]
mf v[72:75],v[188:191],a[80:83],v[72:75]
buffer_load_dwordx4 a[124:127],v1,s[20:23],s69 offen offset:2048 sc1
mf v[76:79],v[196:199],a[72:75],v[76:79]
ds_write_b128 v18,a[44:47] offset:6144
s_barrier
ds_read_b128 v[188:191],v8
ds_read_b128 v[192:195],v8 offset:9216
mf v[76:79],v[200:203],a[84:87],v[76:79]
mf v[80:83],v[200:203],a[88:91],v[80:83]
mf v[80:83],v[196:199],a[80:83],v[80:83]
s_waitcnt lgkmcnt(3)
mf v[84:87],v[204:207],a[72:75],v[84:87]
buffer_load_dwordx4 a[128:131],v1,s[20:23],s72 offen offset:2048 sc1
mf v[84:87],v[208:211],a[84:87],v[84:87]
ds_read_b128 v[196:199],v8 offset:1024
ds_read_b128 v[200:203],v8 offset:10240
mf v[88:91],v[208:211],a[88:91],v[88:91]
mf v[88:91],v[204:207],a[80:83],v[88:91]
mf v[92:95],v[212:215],a[72:75],v[92:95]
buffer_load_dwordx4 a[136:139],v1,s[20:23],s94 offen offset:2048 sc1
mf v[92:95],v[216:219],a[84:87],v[92:95]
ds_read_b128 v[204:207],v8 offset:2048
ds_read_b128 v[208:211],v8 offset:11264
mf v[96:99],v[216:219],a[88:91],v[96:99]
ds_write_b128 v18,a[48:51] offset:7168
mf v[96:99],v[212:215],a[80:83],v[96:99]
mf v[100:103],v[180:183],a[72:75],v[100:103]
buffer_load_dwordx4 a[140:143],v1,s[20:23],s95 offen offset:2048 sc1
mf v[100:103],v[184:187],a[84:87],v[100:103]
ds_read_b128 v[212:215],v8 offset:3072
ds_read_b128 v[216:219],v8 offset:12288
mf v[104:107],v[184:187],a[88:91],v[104:107]
mf v[104:107],v[180:183],a[80:83],v[104:107]
s_waitcnt vmcnt(11)
s_waitcnt lgkmcnt(3)
mf v[36:39],v[188:191],a[92:95],v[36:39]
buffer_load_dwordx4 a[244:247],v1,s[20:23],s67 offen offset:3072 sc1
mf v[36:39],v[192:195],a[100:103],v[36:39]
ds_read_b128 v[180:183],v8 offset:4096
ds_read_b128 v[184:187],v8 offset:13312
mf v[40:43],v[192:195],a[108:111],v[40:43]
ds_write_b128 v18,a[52:55] offset:8192
mf v[40:43],v[188:191],a[96:99],v[40:43]
mf v[44:47],v[196:199],a[92:95],v[44:47]
buffer_load_dwordx4 a[248:251],v1,s[20:23],s68 offen offset:3072 sc1
mf v[44:47],v[200:203],a[100:103],v[44:47]
ds_read_b128 v[188:191],v8 offset:5120
ds_read_b128 v[192:195],v8 offset:14336
mf v[48:51],v[200:203],a[108:111],v[48:51]
mf v[48:51],v[196:199],a[96:99],v[48:51]
mf v[52:55],v[204:207],a[92:95],v[52:55]
buffer_load_dwordx4 a[252:255],v1,s[20:23],s69 offen offset:3072 sc1
mf v[52:55],v[208:211],a[100:103],v[52:55]
ds_read_b128 v[196:199],v8 offset:6144
ds_read_b128 v[200:203],v8 offset:15360
mf v[56:59],v[208:211],a[108:111],v[56:59]
mf v[56:59],v[204:207],a[96:99],v[56:59]
s_waitcnt lgkmcnt(2)
mf v[60:63],v[212:215],a[92:95],v[60:63]
buffer_load_dwordx4 a[76:79],v1,s[20:23],s72 offen offset:3072 sc1
mf v[60:63],v[216:219],a[100:103],v[60:63]
ds_read_b128 v[204:207],v8 offset:7168
ds_read_b128 v[208:211],v8 offset:16384
mf v[64:67],v[216:219],a[108:111],v[64:67]
mf v[64:67],v[212:215],a[96:99],v[64:67]
mf v[68:71],v[180:183],a[92:95],v[68:71]
buffer_load_dwordx4 a[104:107],v1,s[20:23],s94 offen offset:3072 sc1
mf v[68:71],v[184:187],a[100:103],v[68:71]
ds_read_b128 v[212:215],v8 offset:8192
ds_read_b128 v[216:219],v8 offset:17408
mf v[72:75],v[184:187],a[108:111],v[72:75]
mf v[72:75],v[180:183],a[96:99],v[72:75]
mf v[76:79],v[188:191],a[92:95],v[76:79]
buffer_load_dwordx4 a[116:119],v1,s[20:23],s95 offen offset:3072 sc1
mf v[76:79],v[192:195],a[100:103],v[76:79]
ds_read_b128 v[180:183],v8 offset:22528
ds_read_b128 v[184:187],v8 offset:31744
mf v[80:83],v[192:195],a[108:111],v[80:83]
mf v[80:83],v[188:191],a[96:99],v[80:83]
s_waitcnt lgkmcnt(2)
mf v[84:87],v[196:199],a[92:95],v[84:87]
buffer_load_dwordx2 a[132:133],v20,s[20:23],s96 offen sc1
mf v[84:87],v[200:203],a[100:103],v[84:87]
ds_read_b128 v[188:191],v8 offset:23552
ds_read_b128 v[192:195],v8 offset:32768
mf v[88:91],v[200:203],a[108:111],v[88:91]
mf v[88:91],v[196:199],a[96:99],v[88:91]
mf v[92:95],v[204:207],a[92:95],v[92:95]
buffer_load_dwordx2 a[134:135],v20,s[20:23],s96 offen offset:512 sc1
mf v[92:95],v[208:211],a[100:103],v[92:95]
ds_read_b128 v[196:199],v8 offset:24576
ds_read_b128 v[200:203],v8 offset:33792
mf v[96:99],v[208:211],a[108:111],v[96:99]
mf v[96:99],v[204:207],a[96:99],v[96:99]
mf v[100:103],v[212:215],a[92:95],v[100:103]
buffer_load_dwordx2 a[0:1],v20,s[20:23],s97 offen sc1
mf v[100:103],v[216:219],a[100:103],v[100:103]
ds_read_b128 v[204:207],v8 offset:25600
ds_read_b128 v[208:211],v8 offset:34816
mf v[104:107],v[216:219],a[108:111],v[104:107]
mf v[104:107],v[212:215],a[96:99],v[104:107]
s_waitcnt vmcnt(11)
s_waitcnt lgkmcnt(2)
mf v[68:71],v[180:183],a[112:115],v[68:71]
buffer_load_dwordx2 a[2:3],v20,s[20:23],s97 offen offset:512 sc1
mf v[68:71],v[184:187],a[124:127],v[68:71]
ds_read_b128 v[212:215],v8 offset:26624
ds_read_b128 v[216:219],v8 offset:35840
mf v[72:75],v[184:187],a[128:131],v[72:75]
mf v[72:75],v[180:183],a[120:123],v[72:75]
mf v[76:79],v[188:191],a[112:115],v[76:79]
buffer_load_dwordx2 a[4:5],v20,s[20:23],s96 offen offset:1024 sc1
mf v[76:79],v[192:195],a[124:127],v[76:79]
s_barrier
ds_read_b128 v[180:183],v1 offset:4096
ds_read_b128 v[184:187],v1 offset:13312
mf v[80:83],v[192:195],a[128:131],v[80:83]
mf v[80:83],v[188:191],a[120:123],v[80:83]
mf v[84:87],v[196:199],a[112:115],v[84:87]
buffer_load_dwordx2 a[6:7],v20,s[20:23],s96 offen offset:1536 sc1
mf v[84:87],v[200:203],a[124:127],v[84:87]
ds_read_b128 v[188:191],v1 offset:5120
ds_read_b128 v[192:195],v1 offset:14336
mf v[88:91],v[200:203],a[128:131],v[88:91]
mf v[88:91],v[196:199],a[120:123],v[88:91]
s_waitcnt lgkmcnt(2)
mf v[92:95],v[204:207],a[112:115],v[92:95]
buffer_load_dwordx2 a[8:9],v20,s[20:23],s97 offen offset:1024 sc1
mf v[92:95],v[208:211],a[124:127],v[92:95]
ds_read_b128 v[196:199],v1 offset:6144
ds_read_b128 v[200:203],v1 offset:15360
mf v[96:99],v[208:211],a[128:131],v[96:99]
mf v[96:99],v[204:207],a[120:123],v[96:99]
mf v[100:103],v[212:215],a[112:115],v[100:103]
buffer_load_dwordx2 a[10:11],v20,s[20:23],s97 offen offset:1536 sc1
mf v[100:103],v[216:219],a[124:127],v[100:103]
ds_read_b128 v[204:207],v1 offset:7168
ds_read_b128 v[208:211],v1 offset:16384
mf v[104:107],v[216:219],a[128:131],v[104:107]
mf v[104:107],v[212:215],a[120:123],v[104:107]
s_waitcnt vmcnt(12)
mf v[68:71],v[180:183],a[136:139],v[68:71]
s_add_u32 s87,s82,2359296
buffer_load_dwordx4 v[244:247],v1,s[20:23],s87 offen sc1
mf v[68:71],v[184:187],a[244:247],v[68:71]
ds_read_b128 v[212:215],v1 offset:8192
ds_read_b128 v[216:219],v1 offset:17408
mf v[72:75],v[184:187],a[248:251],v[72:75]
mf v[72:75],v[180:183],a[140:143],v[72:75]
s_waitcnt lgkmcnt(2)
mf v[76:79],v[188:191],a[136:139],v[76:79]
buffer_load_dwordx4 v[148:151],v1,s[20:23],s87 offen offset:2048 sc1
mf v[76:79],v[192:195],a[244:247],v[76:79]
ds_read_b128 v[180:183],v1 offset:22528
ds_read_b128 v[184:187],v1 offset:31744
mf v[80:83],v[192:195],a[248:251],v[80:83]
mf v[80:83],v[188:191],a[140:143],v[80:83]
mf v[84:87],v[196:199],a[136:139],v[84:87]
s_add_u32 s87,s83,2359296
buffer_load_dword v152,v22,s[20:23],s87 offen sc1
mf v[84:87],v[200:203],a[244:247],v[84:87]
ds_read_b128 v[188:191],v1 offset:23552
ds_read_b128 v[192:195],v1 offset:32768
mf v[88:91],v[200:203],a[248:251],v[88:91]
mf v[88:91],v[196:199],a[140:143],v[88:91]
mf v[92:95],v[204:207],a[136:139],v[92:95]
ds_read_b128 v[196:199],v1 offset:24576
ds_read_b128 v[200:203],v1 offset:33792
mf v[92:95],v[208:211],a[244:247],v[92:95]
mf v[96:99],v[208:211],a[248:251],v[96:99]
mf v[96:99],v[204:207],a[140:143],v[96:99]
s_waitcnt lgkmcnt(2)
mf v[100:103],v[212:215],a[136:139],v[100:103]
ds_read_b128 v[204:207],v1 offset:25600
ds_read_b128 v[208:211],v1 offset:34816
mf v[100:103],v[216:219],a[244:247],v[100:103]
mf v[104:107],v[216:219],a[248:251],v[104:107]
mf v[104:107],v[212:215],a[140:143],v[104:107]
s_waitcnt vmcnt(11)
mf v[68:71],v[180:183],a[252:255],v[68:71]
ds_read_b128 v[212:215],v1 offset:26624
ds_read_b128 v[216:219],v1 offset:35840
mf v[68:71],v[184:187],a[104:107],v[68:71]
mf v[72:75],v[184:187],a[116:119],v[72:75]
mf v[72:75],v[180:183],a[76:79],v[72:75]
mf v[76:79],v[188:191],a[252:255],v[76:79]
s_barrier
ds_read_b128 v[180:183],v6 offset:4096
ds_read_b128 v[184:187],v6 offset:13312
mf v[76:79],v[192:195],a[104:107],v[76:79]
mf v[80:83],v[192:195],a[116:119],v[80:83]
mf v[80:83],v[188:191],a[76:79],v[80:83]
s_waitcnt lgkmcnt(2)
mf v[84:87],v[196:199],a[252:255],v[84:87]
ds_read_b128 v[188:191],v6 offset:5120
ds_read_b128 v[192:195],v6 offset:14336
mf v[84:87],v[200:203],a[104:107],v[84:87]
mf v[88:91],v[200:203],a[116:119],v[88:91]
mf v[88:91],v[196:199],a[76:79],v[88:91]
mf v[92:95],v[204:207],a[252:255],v[92:95]
ds_read_b128 v[196:199],v6 offset:6144
ds_read_b128 v[200:203],v6 offset:15360
mf v[92:95],v[208:211],a[104:107],v[92:95]
mf v[96:99],v[208:211],a[116:119],v[96:99]
mf v[96:99],v[204:207],a[76:79],v[96:99]
mf v[100:103],v[212:215],a[252:255],v[100:103]
ds_read_b128 v[204:207],v6 offset:7168
ds_read_b128 v[208:211],v6 offset:16384
mf v[100:103],v[216:219],a[104:107],v[100:103]
mf v[104:107],v[216:219],a[116:119],v[104:107]
mf v[104:107],v[212:215],a[76:79],v[104:107]
s_waitcnt vmcnt(3)
s_waitcnt lgkmcnt(2)
mf v[68:71],v[180:183],a[132:135],v[68:71]
ds_read_b128 v[212:215],v6 offset:8192
ds_read_b128 v[216:219],v6 offset:17408
mf v[68:71],v[184:187],a[4:7],v[68:71]
mf v[72:75],v[184:187],a[8:11],v[72:75]
mf v[72:75],v[180:183],a[0:3],v[72:75]
mf v[76:79],v[188:191],a[132:135],v[76:79]
ds_read_b128 v[180:183],v8 offset:18432
ds_read_b128 v[184:187],v8 offset:27648
mf v[76:79],v[192:195],a[4:7],v[76:79]
mf v[80:83],v[192:195],a[8:11],v[80:83]
mf v[80:83],v[188:191],a[0:3],v[80:83]
mf v[84:87],v[196:199],a[132:135],v[84:87]
ds_read_b128 v[188:191],v8 offset:19456
ds_read_b128 v[192:195],v8 offset:28672
mf v[84:87],v[200:203],a[4:7],v[84:87]
mf v[88:91],v[200:203],a[8:11],v[88:91]
mf v[88:91],v[196:199],a[0:3],v[88:91]
s_waitcnt lgkmcnt(2)
mf v[92:95],v[204:207],a[132:135],v[92:95]
ds_read_b128 v[196:199],v8 offset:20480
ds_read_b128 v[200:203],v8 offset:29696
mf v[92:95],v[208:211],a[4:7],v[92:95]
mf v[96:99],v[208:211],a[8:11],v[96:99]
mf v[96:99],v[204:207],a[0:3],v[96:99]
mf v[100:103],v[212:215],a[132:135],v[100:103]
ds_read_b128 v[204:207],v8 offset:21504
ds_read_b128 v[208:211],v8 offset:30720
mf v[100:103],v[216:219],a[4:7],v[100:103]
mf v[104:107],v[216:219],a[8:11],v[104:107]
mf v[104:107],v[212:215],a[0:3],v[104:107]
mf v[36:39],v[180:183],a[112:115],v[36:39]
ds_read_b128 v[212:215],v1
ds_read_b128 v[216:219],v1 offset:9216
mf v[36:39],v[184:187],a[124:127],v[36:39]
v_cvt_pk_bf16_f32 v128,v68,v76
v_cvt_pk_bf16_f32 v129,v84,v92
mf v[40:43],v[184:187],a[128:131],v[40:43]
v_cvt_pk_bf16_f32 v130,v69,v77
v_cvt_pk_bf16_f32 v131,v85,v93
mf v[40:43],v[180:183],a[120:123],v[40:43]
s_waitcnt lgkmcnt(2)
mf v[44:47],v[188:191],a[112:115],v[44:47]
ds_read_b128 v[180:183],v1 offset:1024
ds_read_b128 v[184:187],v1 offset:10240
mf v[44:47],v[192:195],a[124:127],v[44:47]
buffer_store_dwordx4 v[128:131],v1,s[16:19],s80 offen offset:2048 sc1
mf v[48:51],v[192:195],a[128:131],v[48:51]
v_cvt_pk_bf16_f32 v132,v70,v78
v_cvt_pk_bf16_f32 v133,v86,v94
mf v[48:51],v[188:191],a[120:123],v[48:51]
v_cvt_pk_bf16_f32 v134,v71,v79
v_cvt_pk_bf16_f32 v135,v87,v95
mf v[52:55],v[196:199],a[112:115],v[52:55]
ds_read_b128 v[188:191],v1 offset:2048
ds_read_b128 v[192:195],v1 offset:11264
mf v[52:55],v[200:203],a[124:127],v[52:55]
buffer_store_dwordx4 v[132:135],v1,s[16:19],s80 offen offset:3072 sc1
mf v[56:59],v[200:203],a[128:131],v[56:59]
v_cvt_pk_bf16_f32 v136,v72,v80
v_cvt_pk_bf16_f32 v137,v88,v96
mf v[56:59],v[196:199],a[120:123],v[56:59]
v_cvt_pk_bf16_f32 v138,v73,v81
v_cvt_pk_bf16_f32 v139,v89,v97
mf v[60:63],v[204:207],a[112:115],v[60:63]
ds_read_b128 v[196:199],v1 offset:3072
ds_read_b128 v[200:203],v1 offset:12288
mf v[60:63],v[208:211],a[124:127],v[60:63]
buffer_store_dwordx4 v[136:139],v1,s[16:19],s53 offen offset:2048 sc1
mf v[64:67],v[208:211],a[128:131],v[64:67]
v_cvt_pk_bf16_f32 v140,v74,v82
v_cvt_pk_bf16_f32 v141,v90,v98
mf v[64:67],v[204:207],a[120:123],v[64:67]
v_cvt_pk_bf16_f32 v142,v75,v83
s_waitcnt lgkmcnt(2)
mf v[36:39],v[212:215],a[136:139],v[36:39]
ds_read_b128 v[204:207],v1 offset:18432
ds_read_b128 v[208:211],v1 offset:27648
mf v[36:39],v[216:219],a[244:247],v[36:39]
v_cvt_pk_bf16_f32 v143,v91,v99
mf v[40:43],v[216:219],a[248:251],v[40:43]
buffer_store_dwordx4 v[140:143],v1,s[16:19],s53 offen offset:3072 sc1
mf v[40:43],v[212:215],a[140:143],v[40:43]
v_cvt_pk_bf16_f32 v108,v100,v101
v_cvt_pk_bf16_f32 v109,v102,v103
mf v[44:47],v[180:183],a[136:139],v[44:47]
ds_read_b128 v[212:215],v1 offset:19456
ds_read_b128 v[216:219],v1 offset:28672
mf v[44:47],v[184:187],a[244:247],v[44:47]
v_cvt_pk_bf16_f32 v110,v104,v105
v_cvt_pk_bf16_f32 v111,v106,v107
mf v[48:51],v[184:187],a[248:251],v[48:51]
s_mov_b32 s50,0x3f80
s_mov_b32 s51,0x3f800000
mf v[48:51],v[180:183],a[140:143],v[48:51]
v_permlane16_swap_b32 v108,v110
v_permlane16_swap_b32 v109,v111
mf v[52:55],v[188:191],a[136:139],v[52:55]
ds_read_b128 v[180:183],v1 offset:20480
ds_read_b128 v[184:187],v1 offset:29696
mf v[52:55],v[192:195],a[244:247],v[52:55]
buffer_store_dwordx4 v[108:111],v21,s[16:19],s81 offen sc1
mf v[56:59],v[192:195],a[248:251],v[56:59]
s_waitcnt vmcnt(5)
v_lshlrev_b32 v220,16,v244
mf v[56:59],v[188:191],a[140:143],v[56:59]
v_and_b32 v221,0xffff0000,v244
s_waitcnt lgkmcnt(2)
mf v[60:63],v[196:199],a[136:139],v[60:63]
ds_read_b128 v[188:191],v1 offset:21504
ds_read_b128 v[192:195],v1 offset:30720
mf v[60:63],v[200:203],a[244:247],v[60:63]
v_lshlrev_b32 v222,16,v245
v_and_b32 v223,0xffff0000,v245
mf v[64:67],v[200:203],a[248:251],v[64:67]
v_lshlrev_b32 v224,16,v246
v_and_b32 v225,0xffff0000,v246
mf v[64:67],v[196:199],a[140:143],v[64:67]
v_lshlrev_b32 v226,16,v247
v_and_b32 v227,0xffff0000,v247
mf v[36:39],v[204:207],a[252:255],v[36:39]
ds_read_b128 v[196:199],v6
ds_read_b128 v[200:203],v6 offset:9216
mf v[36:39],v[208:211],a[104:107],v[36:39]
v_lshlrev_b32 v228,16,v148
v_and_b32 v229,0xffff0000,v148
mf v[40:43],v[208:211],a[116:119],v[40:43]
v_lshlrev_b32 v230,16,v149
v_and_b32 v231,0xffff0000,v149
mf v[40:43],v[204:207],a[76:79],v[40:43]
v_lshlrev_b32 v232,16,v150
v_and_b32 v233,0xffff0000,v150
mf v[44:47],v[212:215],a[252:255],v[44:47]
ds_read_b128 v[204:207],v6 offset:1024
ds_read_b128 v[208:211],v6 offset:10240
mf v[44:47],v[216:219],a[104:107],v[44:47]
v_lshlrev_b32 v234,16,v151
v_and_b32 v235,0xffff0000,v151
mf v[48:51],v[216:219],a[116:119],v[48:51]
v_lshlrev_b32 v236,16,v152
v_and_b32 v237,0xffff0000,v152
mf v[48:51],v[212:215],a[76:79],v[48:51]
s_waitcnt lgkmcnt(2)
mf v[52:55],v[180:183],a[252:255],v[52:55]
ds_read_b128 v[212:215],v6 offset:2048
ds_read_b128 v[216:219],v6 offset:11264
mf v[52:55],v[184:187],a[104:107],v[52:55]
mf v[56:59],v[184:187],a[116:119],v[56:59]
mf v[56:59],v[180:183],a[76:79],v[56:59]
mf v[60:63],v[188:191],a[252:255],v[60:63]
ds_read_b128 v[180:183],v6 offset:3072
ds_read_b128 v[184:187],v6 offset:12288
mf v[60:63],v[192:195],a[104:107],v[60:63]
mf v[64:67],v[192:195],a[116:119],v[64:67]
mf v[64:67],v[188:191],a[76:79],v[64:67]
mf v[36:39],v[196:199],a[132:135],v[36:39]
mf v[36:39],v[200:203],a[4:7],v[36:39]
mf v[40:43],v[200:203],a[8:11],v[40:43]
mf v[40:43],v[196:199],a[0:3],v[40:43]
s_waitcnt lgkmcnt(0)
mf v[44:47],v[204:207],a[132:135],v[44:47]
mf v[44:47],v[208:211],a[4:7],v[44:47]
mf v[48:51],v[208:211],a[8:11],v[48:51]
mf v[48:51],v[204:207],a[0:3],v[48:51]
mf v[52:55],v[212:215],a[132:135],v[52:55]
mf v[52:55],v[216:219],a[4:7],v[52:55]
mf v[56:59],v[216:219],a[8:11],v[56:59]
mf v[56:59],v[212:215],a[0:3],v[56:59]
mf v[60:63],v[180:183],a[132:135],v[60:63]
mf v[60:63],v[184:187],a[4:7],v[60:63]
mf v[64:67],v[184:187],a[8:11],v[64:67]
mf v[64:67],v[180:183],a[0:3],v[64:67]
v_cvt_pk_bf16_f32 v112,v36,v44
s_nop 4
v_cvt_pk_bf16_f32 v113,v52,v60
v_cvt_pk_bf16_f32 v114,v37,v45
v_cvt_pk_bf16_f32 v115,v53,v61
buffer_store_dwordx4 v[112:115],v1,s[16:19],s80 offen sc1
v_cvt_pk_bf16_f32 v116,v38,v46
v_cvt_pk_bf16_f32 v117,v54,v62
v_cvt_pk_bf16_f32 v118,v39,v47
v_cvt_pk_bf16_f32 v119,v55,v63
buffer_store_dwordx4 v[116:119],v1,s[16:19],s80 offen offset:1024 sc1
v_cvt_pk_bf16_f32 v120,v40,v48
v_cvt_pk_bf16_f32 v121,v56,v64
v_cvt_pk_bf16_f32 v122,v41,v49
v_cvt_pk_bf16_f32 v123,v57,v65
buffer_store_dwordx4 v[120:123],v1,s[16:19],s53 offen sc1
v_cvt_pk_bf16_f32 v124,v42,v50
v_cvt_pk_bf16_f32 v125,v58,v66
v_cvt_pk_bf16_f32 v126,v43,v51
v_cvt_pk_bf16_f32 v127,v59,v67
buffer_store_dwordx4 v[124:127],v1,s[16:19],s53 offen offset:1024 sc1
s_add_u32 s48,s82,24444928
s_add_u32 s49,s83,24444928
s_cmp_lg_u32 s24,s84
s_cbranch_scc1 Lo104
v_add_u32 v24,150336,v1
v_and_b32 v25,1,v5
v_lshlrev_b32 v25,9,v25
v_lshrrev_b32 v26,1,v5
v_lshl_add_u32 v25,v26,8,v25
v_lshl_add_u32 v25,v4,4,v25
v_add_u32 v25,158528,v25
ds_write_b128 v24,v[112:115]
ds_write_b128 v24,v[116:119] offset:1024
ds_write_b128 v24,v[120:123] offset:4096
ds_write_b128 v24,v[124:127] offset:5120
ds_write_b128 v24,v[128:131] offset:2048
ds_write_b128 v24,v[132:135] offset:3072
ds_write_b128 v24,v[136:139] offset:6144
ds_write_b128 v24,v[140:143] offset:7168
ds_write_b128 v25,v[108:111]
Lo104:
s_lshr_b32 s87,s24,1
s_lshl_b32 s60,s87,12
s_lshl_b32 s52,s90,10
s_add_u32 s60,s60,s52
s_add_u32 s60,s60,150336
v_add_u32 v24,s60,v1
s_lshl_b32 s60,s87,9
s_lshl_b32 s52,s90,7
s_add_u32 s60,s60,s52
s_add_u32 s60,s60,158528
v_add_u32 v25,s60,v22
s_add_u32 s67,s84,1
s_and_b32 s67,s67,3
s_mul_i32 s67,s67,2359296
s_add_u32 s68,s84,2
s_and_b32 s68,s68,3
s_mul_i32 s68,s68,2359296
s_add_u32 s69,s84,3
s_and_b32 s69,s69,3
s_mul_i32 s69,s69,2359296
s_cmp_lg_u32 s29,0
s_cbranch_scc1 Ltail1
s_add_u32 s86,s82,2048
s_mul_i32 s60,s26,3
s_add_u32 s60,s60,s24
s_lshl_b32 s60,s60,4
s_add_u32 s60,s60,1
v_add_u32 v12,s60,v4
v_lshlrev_b32 v254,31,v12
v_or_b32 v254,1.0,v254
s_mul_i32 s60,s26,96
v_lshl_add_u32 v13,v5,3,s60
v_mul_u32_u24 v13,v13,v12
v_cvt_f32_u32 v12,v12
v_mul_f32 v12,0x3ae38e39,v12
v_cvt_f32_u32 v13,v13
v_mul_f32 v13,0x3ae38e39,v13
v_fract_f32 v13,v13
v_fmamk_f32 v14,v12,0x00000000,v13
v_fmamk_f32 v15,v12,0x3f800000,v13
v_cos_f32 v16,v14
v_cos_f32 v17,v15
v_sin_f32 v18,v14
v_sin_f32_e64 v19,v15
v_cvt_pk_bf16_f32 v100,v16,v17
v_cvt_pk_bf16_f32 v104,v18,v19
v_fmamk_f32 v14,v12,0x40000000,v13
v_fmamk_f32 v15,v12,0x40400000,v13
v_cos_f32 v16,v14
v_cos_f32 v17,v15
v_sin_f32 v18,v14
v_sin_f32 v19,v15
v_cvt_pk_bf16_f32 v101,v16,v17
v_cvt_pk_bf16_f32 v105,v18,v19
v_fmamk_f32 v14,v12,0x40800000,v13
v_fmamk_f32 v15,v12,0x40a00000,v13
v_cos_f32 v16,v14
v_cos_f32 v17,v15
v_sin_f32 v18,v14
v_sin_f32 v19,v15
v_cvt_pk_bf16_f32 v102,v16,v17
v_cvt_pk_bf16_f32 v106,v18,v19
v_fmamk_f32 v14,v12,0x40c00000,v13
v_fmamk_f32 v15,v12,0x40e00000,v13
v_cos_f32 v16,v14
v_cos_f32 v17,v15
v_sin_f32 v18,v14
v_sin_f32 v19,v15
v_cvt_pk_bf16_f32 v103,v16,v17
v_cvt_pk_bf16_f32 v107,v18,v19
s_waitcnt vmcnt(4)
s_mov_b64 exec,1
v_mov_b32 v11,1
buffer_atomic_add v11,v10,s[20:23],s54 offen sc1
s_mov_b64 exec,-1
v_fmamk_f32 v14,v12,0x42000000,v13
v_fmamk_f32 v15,v12,0x42040000,v13
v_cos_f32 v16,v14
v_cos_f32 v17,v15
v_sin_f32 v18,v14
v_sin_f32 v19,v15
v_cvt_pk_bf16_f32 v108,v16,v17
v_cvt_pk_bf16_f32 v112,v18,v19
v_fmamk_f32 v14,v12,0x42080000,v13
v_fmamk_f32 v15,v12,0x420c0000,v13
v_cos_f32 v16,v14
v_cos_f32 v17,v15
v_sin_f32 v18,v14
v_sin_f32 v19,v15
v_cvt_pk_bf16_f32 v109,v16,v17
v_cvt_pk_bf16_f32 v113,v18,v19
v_fmamk_f32 v14,v12,0x42100000,v13
v_fmamk_f32 v15,v12,0x42140000,v13
v_cos_f32 v16,v14
v_cos_f32 v17,v15
v_sin_f32 v18,v14
v_sin_f32 v19,v15
v_cvt_pk_bf16_f32 v110,v16,v17
v_cvt_pk_bf16_f32 v114,v18,v19
v_fmamk_f32 v14,v12,0x42180000,v13
v_fmamk_f32 v15,v12,0x421c0000,v13
v_cos_f32 v16,v14
v_cos_f32 v17,v15
v_sin_f32 v18,v14
v_sin_f32 v19,v15
v_cvt_pk_bf16_f32 v111,v16,v17
v_cvt_pk_bf16_f32 v115,v18,v19
v_fmamk_f32 v14,v12,0x42800000,v13
v_fmamk_f32 v15,v12,0x42820000,v13
v_cos_f32 v16,v14
v_cos_f32 v17,v15
v_sin_f32 v18,v14
v_sin_f32 v19,v15
v_cvt_pk_bf16_f32 v116,v16,v17
v_cvt_pk_bf16_f32 v120,v18,v19
v_fmamk_f32 v14,v12,0x42840000,v13
v_fmamk_f32 v15,v12,0x42860000,v13
v_cos_f32 v16,v14
v_cos_f32 v17,v15
v_sin_f32 v18,v14
v_sin_f32 v19,v15
v_cvt_pk_bf16_f32 v117,v16,v17
v_cvt_pk_bf16_f32 v121,v18,v19
v_fmamk_f32 v14,v12,0x42880000,v13
v_fmamk_f32 v15,v12,0x428a0000,v13
v_cos_f32 v16,v14
v_cos_f32 v17,v15
v_sin_f32 v18,v14
v_sin_f32 v19,v15
v_cvt_pk_bf16_f32 v118,v16,v17
v_cvt_pk_bf16_f32 v122,v18,v19
v_fmamk_f32 v14,v12,0x428c0000,v13
v_fmamk_f32 v15,v12,0x428e0000,v13
v_cos_f32 v16,v14
v_cos_f32 v17,v15
v_sin_f32 v18,v14
v_sin_f32 v19,v15
v_cvt_pk_bf16_f32 v119,v16,v17
v_cvt_pk_bf16_f32 v123,v18,v19
v_fmamk_f32 v14,v12,0x42c00000,v13
v_fmamk_f32 v15,v12,0x42c20000,v13
v_cos_f32 v16,v14
v_cos_f32 v17,v15
v_sin_f32 v18,v14
v_sin_f32 v19,v15
v_cvt_pk_bf16_f32 v124,v16,v17
v_cvt_pk_bf16_f32 v128,v18,v19
v_fmamk_f32 v14,v12,0x42c40000,v13
v_fmamk_f32 v15,v12,0x42c60000,v13
v_cos_f32 v16,v14
v_cos_f32 v17,v15
v_sin_f32 v18,v14
v_sin_f32 v19,v15
v_cvt_pk_bf16_f32 v125,v16,v17
v_cvt_pk_bf16_f32 v129,v18,v19
v_fmamk_f32 v14,v12,0x42c80000,v13
v_fmamk_f32 v15,v12,0x42ca0000,v13
v_cos_f32 v16,v14
v_cos_f32 v17,v15
v_sin_f32 v18,v14
v_sin_f32 v19,v15
v_cvt_pk_bf16_f32 v126,v16,v17
v_cvt_pk_bf16_f32 v130,v18,v19
v_fmamk_f32 v14,v12,0x42cc0000,v13
v_fmamk_f32 v15,v12,0x42ce0000,v13
v_cos_f32 v16,v14
v_cos_f32 v17,v15
v_sin_f32 v18,v14
v_sin_f32 v19,v15
v_cvt_pk_bf16_f32 v127,v16,v17
v_cvt_pk_bf16_f32 v131,v18,v19
s_waitcnt vmcnt(4)
s_mov_b64 exec,1
v_mov_b32 v251,0
buffer_atomic_add v251,v10,s[20:23],s55 offen sc0 sc1
s_mov_b64 exec,-1
s_waitcnt vmcnt(2)
s_mov_b64 exec,1
v_mov_b32 v20,256
buffer_atomic_add v20,v10,s[20:23],s54 offen sc1
s_mov_b64 exec,-1
s_mov_b64 exec,1
v_mov_b32 v208,0
buffer_atomic_add v208,v10,s[20:23],s55 offen sc0 sc1
s_mov_b64 exec,-1
v_fmamk_f32 v14,v12,0x43000000,v13
v_fmamk_f32 v15,v12,0x43010000,v13
v_cos_f32 v16,v14
v_cos_f32 v17,v15
v_sin_f32 v18,v14
v_sin_f32 v19,v15
v_cvt_pk_bf16_f32 v132,v16,v17
v_cvt_pk_bf16_f32 v136,v18,v19
v_fmamk_f32 v14,v12,0x43020000,v13
v_fmamk_f32 v15,v12,0x43030000,v13
v_cos_f32 v16,v14
v_cos_f32 v17,v15
v_sin_f32 v18,v14
v_sin_f32 v19,v15
v_cvt_pk_bf16_f32 v133,v16,v17
v_cvt_pk_bf16_f32 v137,v18,v19
v_fmamk_f32 v14,v12,0x43040000,v13
v_fmamk_f32 v15,v12,0x43050000,v13
v_cos_f32 v16,v14
v_cos_f32 v17,v15
v_sin_f32 v18,v14
v_sin_f32 v19,v15
v_cvt_pk_bf16_f32 v134,v16,v17
v_cvt_pk_bf16_f32 v138,v18,v19
v_fmamk_f32 v14,v12,0x43060000,v13
v_fmamk_f32 v15,v12,0x43070000,v13
v_cos_f32 v16,v14
v_cos_f32 v17,v15
v_sin_f32 v18,v14
v_sin_f32 v19,v15
v_cvt_pk_bf16_f32 v135,v16,v17
v_cvt_pk_bf16_f32 v139,v18,v19
v_fmamk_f32 v14,v12,0x43200000,v13
v_fmamk_f32 v15,v12,0x43210000,v13
v_cos_f32 v16,v14
v_cos_f32 v17,v15
v_sin_f32 v18,v14
v_sin_f32 v19,v15
v_cvt_pk_bf16_f32 v140,v16,v17
v_cvt_pk_bf16_f32 v144,v18,v19
v_fmamk_f32 v14,v12,0x43220000,v13
v_fmamk_f32 v15,v12,0x43230000,v13
v_cos_f32 v16,v14
v_cos_f32 v17,v15
v_sin_f32 v18,v14
v_sin_f32 v19,v15
v_cvt_pk_bf16_f32 v141,v16,v17
v_cvt_pk_bf16_f32 v145,v18,v19
v_fmamk_f32 v14,v12,0x43240000,v13
v_fmamk_f32 v15,v12,0x43250000,v13
v_cos_f32 v16,v14
v_cos_f32 v17,v15
v_sin_f32 v18,v14
v_sin_f32 v19,v15
v_cvt_pk_bf16_f32 v142,v16,v17
v_cvt_pk_bf16_f32 v146,v18,v19
v_fmamk_f32 v14,v12,0x43260000,v13
v_fmamk_f32 v15,v12,0x43270000,v13
v_cos_f32 v16,v14
v_cos_f32 v17,v15
v_sin_f32 v18,v14
v_sin_f32 v19,v15
v_cvt_pk_bf16_f32 v143,v16,v17
v_cvt_pk_bf16_f32 v147,v18,v19
v_fmamk_f32 v14,v12,0x43400000,v13
v_fmamk_f32 v15,v12,0x43410000,v13
v_cos_f32 v16,v14
v_cos_f32 v17,v15
v_sin_f32 v18,v14
v_sin_f32 v19,v15
v_cvt_pk_bf16_f32 v148,v16,v17
v_cvt_pk_bf16_f32 v152,v18,v19
v_fmamk_f32 v14,v12,0x43420000,v13
v_fmamk_f32 v15,v12,0x43430000,v13
v_cos_f32 v16,v14
v_cos_f32 v17,v15
v_sin_f32 v18,v14
v_sin_f32 v19,v15
v_cvt_pk_bf16_f32 v149,v16,v17
v_cvt_pk_bf16_f32 v153,v18,v19
v_fmamk_f32 v14,v12,0x43440000,v13
v_fmamk_f32 v15,v12,0x43450000,v13
v_cos_f32 v16,v14
v_cos_f32 v17,v15
v_sin_f32 v18,v14
v_sin_f32 v19,v15
v_cvt_pk_bf16_f32 v150,v16,v17
v_cvt_pk_bf16_f32 v154,v18,v19
v_fmamk_f32 v14,v12,0x43460000,v13
v_fmamk_f32 v15,v12,0x43470000,v13
v_cos_f32 v16,v14
v_cos_f32 v17,v15
v_sin_f32 v18,v14
v_sin_f32 v19,v15
v_cvt_pk_bf16_f32 v151,v16,v17
v_cvt_pk_bf16_f32 v155,v18,v19
s_waitcnt vmcnt(2)
v_readfirstlane_b32 s87,v251
s_nop 0
s_bfe_u32 s87,s87,524288
s_cmp_eq_u32 s87,4
s_cbranch_scc1 Lr105
s_mov_b64 exec,1
s_mov_b32 s56,0
v_mov_b32 v205,0
buffer_atomic_add v205,v10,s[20:23],s55 offen sc0 sc1
s_sleep 4
v_mov_b32 v206,0
buffer_atomic_add v206,v10,s[20:23],s55 offen sc0 sc1
s_sleep 4
Lp107:
v_mov_b32 v207,0
buffer_atomic_add v207,v10,s[20:23],s55 offen sc0 sc1
s_waitcnt vmcnt(2)
v_bfe_u32 v205,v205,0,8
v_cmp_ne_u32 vcc,4,v205
s_nop 0
s_cbranch_vccz Lpd108
v_mov_b32 v205,0
buffer_atomic_add v205,v10,s[20:23],s55 offen sc0 sc1
s_waitcnt vmcnt(2)
v_bfe_u32 v206,v206,0,8
v_cmp_ne_u32 vcc,4,v206
s_nop 0
s_cbranch_vccz Lpd108
v_mov_b32 v206,0
buffer_atomic_add v206,v10,s[20:23],s55 offen sc0 sc1
s_waitcnt vmcnt(2)
v_bfe_u32 v207,v207,0,8
v_cmp_ne_u32 vcc,4,v207
s_nop 0
s_cbranch_vccz Lpd108
s_add_u32 s56,s56,1
s_cmp_lt_u32 s56,0x40000
s_cbranch_scc1 Lp107
Lpd108:
s_mov_b64 exec,-1
Lr105:
s_mov_b64 exec,1
v_mov_b32 v209,0
buffer_atomic_add v209,v10,s[20:23],s55 offen sc0 sc1
s_mov_b64 exec,-1
s_add_u32 s87,s48,s67
s_add_u32 s60,s49,s67
buffer_load_dwordx4 v[44:47],v1,s[20:23],s87 offen offset:2048 sc1
buffer_load_dword v48,v22,s[20:23],s60 offen sc1
s_add_u32 s87,s48,s68
s_add_u32 s60,s49,s68
buffer_load_dwordx4 v[52:55],v1,s[20:23],s87 offen offset:2048 sc1
buffer_load_dword v56,v22,s[20:23],s60 offen sc1
s_add_u32 s87,s48,s69
s_add_u32 s60,s49,s69
buffer_load_dwordx4 v[60:63],v1,s[20:23],s87 offen offset:2048 sc1
buffer_load_dword v64,v22,s[20:23],s60 offen sc1
s_waitcnt vmcnt(7)
v_readfirstlane_b32 s87,v208
s_nop 0
s_bfe_u32 s87,s87,524296
s_cmp_eq_u32 s87,4
s_cbranch_scc1 Lr106
s_waitcnt vmcnt(6)
v_readfirstlane_b32 s87,v209
s_nop 0
s_bfe_u32 s87,s87,524296
s_cmp_eq_u32 s87,4
s_cbranch_scc1 Lr106
s_mov_b64 exec,1
s_mov_b32 s56,0
v_mov_b32 v248,0
buffer_atomic_add v248,v10,s[20:23],s55 offen sc0 sc1
s_sleep 4
v_mov_b32 v249,0
buffer_atomic_add v249,v10,s[20:23],s55 offen sc0 sc1
s_sleep 4
Lp109:
v_mov_b32 v250,0
buffer_atomic_add v250,v10,s[20:23],s55 offen sc0 sc1
s_waitcnt vmcnt(2)
v_bfe_u32 v248,v248,8,8
v_cmp_ne_u32 vcc,4,v248
s_nop 0
s_cbranch_vccz Lpd110
v_mov_b32 v248,0
buffer_atomic_add v248,v10,s[20:23],s55 offen sc0 sc1
s_waitcnt vmcnt(2)
v_bfe_u32 v249,v249,8,8
v_cmp_ne_u32 vcc,4,v249
s_nop 0
s_cbranch_vccz Lpd110
v_mov_b32 v249,0
buffer_atomic_add v249,v10,s[20:23],s55 offen sc0 sc1
s_waitcnt vmcnt(2)
v_bfe_u32 v250,v250,8,8
v_cmp_ne_u32 vcc,4,v250
s_nop 0
s_cbranch_vccz Lpd110
s_add_u32 s56,s56,1
s_cmp_lt_u32 s56,0x40000
s_cbranch_scc1 Lp109
Lpd110:
s_mov_b64 exec,-1
Lr106:
s_add_u32 s87,s48,s67
buffer_load_dwordx4 v[184:187],v1,s[20:23],s87 offen sc1
s_add_u32 s87,s48,s68
buffer_load_dwordx4 v[188:191],v1,s[20:23],s87 offen sc1
s_add_u32 s87,s48,s69
buffer_load_dwordx4 v[192:195],v1,s[20:23],s87 offen sc1
s_waitcnt lgkmcnt(0)
s_barrier
ds_read_b128 v[36:39],v24 offset:2048
ds_read_b32 v40,v25
ds_read_b128 v[180:183],v24
v_fmamk_f32 v14,v12,0x43600000,v13
v_fmamk_f32 v15,v12,0x43610000,v13
v_cos_f32 v16,v14
v_cos_f32 v17,v15
v_sin_f32 v18,v14
v_sin_f32_e64 v19,v15
v_cvt_pk_bf16_f32 v156,v16,v17
v_cvt_pk_bf16_f32 v160,v18,v19
v_fmamk_f32 v14,v12,0x43620000,v13
v_fmamk_f32 v15,v12,0x43630000,v13
v_cos_f32 v16,v14
v_cos_f32 v17,v15
v_sin_f32 v18,v14
v_sin_f32 v19,v15
v_cvt_pk_bf16_f32 v157,v16,v17
v_cvt_pk_bf16_f32 v161,v18,v19
v_fmamk_f32 v14,v12,0x43640000,v13
v_fmamk_f32 v15,v12,0x43650000,v13
v_cos_f32 v16,v14
v_cos_f32 v17,v15
v_sin_f32 v18,v14
v_sin_f32 v19,v15
v_cvt_pk_bf16_f32 v158,v16,v17
v_cvt_pk_bf16_f32 v162,v18,v19
v_fmamk_f32 v14,v12,0x43660000,v13
v_fmamk_f32 v15,v12,0x43670000,v13
v_cos_f32 v16,v14
v_cos_f32 v17,v15
v_sin_f32 v18,v14
v_sin_f32 v19,v15
v_cvt_pk_bf16_f32 v159,v16,v17
v_cvt_pk_bf16_f32 v163,v18,v19
v_fmamk_f32 v14,v12,0x43800000,v13
v_fmamk_f32 v15,v12,0x43808000,v13
v_cos_f32 v16,v14
v_cos_f32 v17,v15
v_sin_f32 v18,v14
v_sin_f32 v19,v15
v_cvt_pk_bf16_f32 v164,v16,v17
v_cvt_pk_bf16_f32 v168,v18,v19
v_fmamk_f32 v14,v12,0x43810000,v13
v_fmamk_f32 v15,v12,0x43818000,v13
v_cos_f32 v16,v14
v_cos_f32 v17,v15
v_sin_f32 v18,v14
v_sin_f32 v19,v15
v_cvt_pk_bf16_f32 v165,v16,v17
v_cvt_pk_bf16_f32 v169,v18,v19
v_fmamk_f32 v14,v12,0x43820000,v13
v_fmamk_f32 v15,v12,0x43828000,v13
v_cos_f32 v16,v14
v_cos_f32 v17,v15
v_sin_f32 v18,v14
v_sin_f32 v19,v15
v_cvt_pk_bf16_f32 v166,v16,v17
v_cvt_pk_bf16_f32 v170,v18,v19
v_fmamk_f32 v14,v12,0x43830000,v13
v_fmamk_f32 v15,v12,0x43838000,v13
v_cos_f32 v16,v14
v_cos_f32 v17,v15
v_sin_f32 v18,v14
v_sin_f32 v19,v15
v_cvt_pk_bf16_f32 v167,v16,v17
v_cvt_pk_bf16_f32 v171,v18,v19
v_mov_b32 v240,0x3f803f80
v_mov_b32 v241,0x3f803f80
v_mov_b32 v242,0x3f803f80
v_mov_b32 v243,0x3f803f80
s_nop 1
mf v[172:175],v[240:243],v[100:103],0
mf v[176:179],v[240:243],v[104:107],0
mf v[172:175],v[240:243],v[108:111],v[172:175]
mf v[176:179],v[240:243],v[112:115],v[176:179]
mf v[172:175],v[240:243],v[116:119],v[172:175]
mf v[176:179],v[240:243],v[120:123],v[176:179]
mf v[172:175],v[240:243],v[124:127],v[172:175]
mf v[176:179],v[240:243],v[128:131],v[176:179]
mf v[172:175],v[240:243],v[132:135],v[172:175]
mf v[176:179],v[240:243],v[136:139],v[176:179]
mf v[172:175],v[240:243],v[140:143],v[172:175]
mf v[176:179],v[240:243],v[144:147],v[176:179]
mf v[172:175],v[240:243],v[148:151],v[172:175]
mf v[176:179],v[240:243],v[152:155],v[176:179]
mf v[172:175],v[240:243],v[156:159],v[172:175]
mf v[176:179],v[240:243],v[160:163],v[176:179]
mf v[172:175],v[240:243],v[164:167],v[172:175]
mf v[176:179],v[240:243],v[168:171],v[176:179]
v_cvt_f32_u32 v12,v4
v_mul_f32 v12,0x3d800000,v12
v_lshlrev_b32 v13,2,v5
v_cvt_f32_u32 v13,v13
v_mul_f32 v13,v12,v13
v_fmamk_f32 v14,v12,0x00000000,v13
v_fmamk_f32 v15,v12,0x3f800000,v13
v_cos_f32 v16,v14
v_cos_f32 v17,v15
v_sin_f32 v18,v14
v_sin_f32_e64 v19,v15
v_cvt_pk_bf16_f32 v28,v16,v17
v_cvt_pk_bf16_f32 v34,v16,v17
v_cvt_pk_bf16_f32 v32,v18,v19
v_cvt_pk_bf16_f32 v30,-v18,-v19
v_fmamk_f32 v14,v12,0x40000000,v13
v_fmamk_f32 v15,v12,0x40400000,v13
v_cos_f32 v16,v14
v_cos_f32 v17,v15
v_sin_f32 v18,v14
v_sin_f32 v19,v15
v_cvt_pk_bf16_f32 v29,v16,v17
v_cvt_pk_bf16_f32 v35,v16,v17
v_cvt_pk_bf16_f32 v33,v18,v19
v_cvt_pk_bf16_f32 v31,-v18,-v19
v_fma_f32 v238,v172,v254,v172
v_fma_f32 v239,v176,v254,v176
s_waitcnt lgkmcnt(0)
v_dot2c_f32_bf16 v228,s50,v36
v_dot2c_f32_bf16 v229,s51,v36
v_dot2c_f32_bf16 v230,s50,v37
v_dot2c_f32_bf16 v231,s51,v37
v_dot2c_f32_bf16 v232,s50,v38
v_dot2c_f32_bf16 v233,s51,v38
v_dot2c_f32_bf16 v234,s50,v39
v_dot2c_f32_bf16 v235,s51,v39
v_dot2c_f32_bf16 v236,s50,v40
v_dot2c_f32_bf16 v237,s51,v40
s_waitcnt vmcnt(7)
v_dot2c_f32_bf16 v228,s50,v44
v_dot2c_f32_bf16 v229,s51,v44
v_dot2c_f32_bf16 v230,s50,v45
v_dot2c_f32_bf16 v231,s51,v45
v_dot2c_f32_bf16 v232,s50,v46
v_dot2c_f32_bf16 v233,s51,v46
v_dot2c_f32_bf16 v234,s50,v47
v_dot2c_f32_bf16 v235,s51,v47
v_dot2c_f32_bf16 v236,s50,v48
v_dot2c_f32_bf16 v237,s51,v48
s_waitcnt vmcnt(5)
v_dot2c_f32_bf16 v228,s50,v52
v_dot2c_f32_bf16 v229,s51,v52
v_dot2c_f32_bf16 v230,s50,v53
v_dot2c_f32_bf16 v231,s51,v53
v_dot2c_f32_bf16 v232,s50,v54
v_dot2c_f32_bf16 v233,s51,v54
v_dot2c_f32_bf16 v234,s50,v55
v_dot2c_f32_bf16 v235,s51,v55
v_dot2c_f32_bf16 v236,s50,v56
v_dot2c_f32_bf16 v237,s51,v56
s_waitcnt vmcnt(3)
v_dot2c_f32_bf16 v228,s50,v60
v_dot2c_f32_bf16 v229,s51,v60
v_dot2c_f32_bf16 v230,s50,v61
v_dot2c_f32_bf16 v231,s51,v61
v_dot2c_f32_bf16 v232,s50,v62
v_dot2c_f32_bf16 v233,s51,v62
v_dot2c_f32_bf16 v234,s50,v63
v_dot2c_f32_bf16 v235,s51,v63
v_dot2c_f32_bf16 v236,s50,v64
v_dot2c_f32_bf16 v237,s51,v64
v_cvt_pk_bf16_f32 v200,v228,v229
v_cvt_pk_bf16_f32 v201,v230,v231
v_cvt_pk_bf16_f32 v202,v232,v233
v_cvt_pk_bf16_f32 v203,v234,v235
v_cvt_pk_bf16_f32 v204,v236,v237
buffer_store_dwordx4 v[200:203],v1,s[12:15],s86 offen sc1
buffer_store_dword v204,v22,s[12:15],s83 offen sc1
s_lshl_b32 s60,s31,2
s_add_u32 s60,s60,s24
s_lshl_b32 s60,s60,4
s_add_u32 s60,s60,s30
v_lshl_add_u32 v210,v4,7,s60
v_cvt_f32_u32 v210,v210
s_mov_b32 s74,0xba000000
s_cmp_ge_u32 s26,3
s_cselect_b32 s74,0x3a000000,s74
v_mul_f32 v210,s74,v210
v_and_b32 v211,1,v5
v_lshlrev_b32 v211,6,v211
v_lshrrev_b32 v212,1,v5
v_add_u32 v211,v211,v212
v_cvt_f32_u32 v211,v211
v_mul_f32 v211,v210,v211
v_fmamk_f32 v212,v210,0x00000000,v211
v_fmamk_f32 v213,v210,0x41800000,v211
v_cos_f32 v214,v212
v_sin_f32 v215,v212
v_cos_f32 v216,v213
v_sin_f32_e64 v217,v213
v_cvt_pk_bf16_f32 v68,v214,v215
v_cvt_pk_bf16_f32 v69,v216,v217
v_fmamk_f32 v212,v210,0x42000000,v211
v_fmamk_f32 v213,v210,0x42400000,v211
v_cos_f32 v214,v212
v_sin_f32 v215,v212
v_cos_f32 v216,v213
v_sin_f32 v217,v213
v_cvt_pk_bf16_f32 v70,v214,v215
v_cvt_pk_bf16_f32 v71,v216,v217
v_fmamk_f32 v212,v210,0x40000000,v211
v_fmamk_f32 v213,v210,0x41900000,v211
v_cos_f32 v214,v212
v_sin_f32 v215,v212
v_cos_f32 v216,v213
v_sin_f32 v217,v213
v_cvt_pk_bf16_f32 v72,v214,v215
v_cvt_pk_bf16_f32 v73,v216,v217
v_fmamk_f32 v212,v210,0x42080000,v211
v_fmamk_f32 v213,v210,0x42480000,v211
v_cos_f32 v214,v212
v_sin_f32 v215,v212
v_cos_f32 v216,v213
v_sin_f32_e64 v217,v213
v_cvt_pk_bf16_f32 v74,v214,v215
v_cvt_pk_bf16_f32 v75,v216,v217
v_dot2c_f32_bf16 v220,s50,v180
v_dot2c_f32_bf16 v221,s51,v180
v_dot2c_f32_bf16 v222,s50,v181
v_dot2c_f32_bf16 v223,s51,v181
v_dot2c_f32_bf16 v224,s50,v182
v_dot2c_f32_bf16 v225,s51,v182
v_dot2c_f32_bf16 v226,s50,v183
v_dot2c_f32_bf16 v227,s51,v183
s_waitcnt vmcnt(4)
v_dot2c_f32_bf16 v220,s50,v184
v_dot2c_f32_bf16 v221,s51,v184
v_dot2c_f32_bf16 v222,s50,v185
v_dot2c_f32_bf16 v223,s51,v185
v_dot2c_f32_bf16 v224,s50,v186
v_dot2c_f32_bf16 v225,s51,v186
v_dot2c_f32_bf16 v226,s50,v187
v_dot2c_f32_bf16 v227,s51,v187
s_waitcnt vmcnt(3)
v_dot2c_f32_bf16 v220,s50,v188
v_dot2c_f32_bf16 v221,s51,v188
v_dot2c_f32_bf16 v222,s50,v189
v_dot2c_f32_bf16 v223,s51,v189
v_dot2c_f32_bf16 v224,s50,v190
v_dot2c_f32_bf16 v225,s51,v190
v_dot2c_f32_bf16 v226,s50,v191
v_dot2c_f32_bf16 v227,s51,v191
s_waitcnt vmcnt(2)
v_dot2c_f32_bf16 v220,s50,v192
v_dot2c_f32_bf16 v221,s51,v192
v_dot2c_f32_bf16 v222,s50,v193
v_dot2c_f32_bf16 v223,s51,v193
v_dot2c_f32_bf16 v224,s50,v194
v_dot2c_f32_bf16 v225,s51,v194
v_dot2c_f32_bf16 v226,s50,v195
v_dot2c_f32_bf16 v227,s51,v195
v_cvt_pk_bf16_f32 v196,v220,v221
v_cvt_pk_bf16_f32 v197,v222,v223
v_cvt_pk_bf16_f32 v198,v224,v225
v_cvt_pk_bf16_f32 v199,v226,v227
buffer_store_dwordx4 v[196:199],v1,s[12:15],s82 offen sc1
s_mov_b32 s29,1
s_mov_b32 s63,0x3727c5ac
s_mul_i32 s79,s89,256
s_add_u32 s79,s79,5521408
s_add_u32 s8,s44,17825792
s_addc_u32 s9,s45,0
s_mov_b32 s10,2359296
s_mov_b32 s11,0x20000
s_mov_b32 s12,s40
s_mov_b32 s13,s41
s_mov_b32 s14,2359296
s_mov_b32 s15,0x20000
s_add_u32 s20,s44,57671680
s_addc_u32 s21,s45,0
s_mov_b32 s22,34603008
s_mov_b32 s23,0x20000
s_mov_b64 exec,1
v_mov_b32 v11,1
buffer_atomic_add v11,v10,s[20:23],s79 offen sc1
s_mov_b64 exec,-1
s_cmp_lt_u32 s26,6
s_cbranch_scc1 Ls111
s_waitcnt vmcnt(0)
s_mov_b64 exec,1
v_mov_b32 v12,256
buffer_atomic_add v12,v10,s[20:23],s79 offen sc1
s_mov_b64 exec,-1
s_waitcnt lgkmcnt(0)
s_barrier
s_mul_i32 s48,s24,36864
s_add_u32 s49,s62,s48
s_add_u32 s60,s49,0
s_add_u32 m0,s48,0
s_nop 0
buffer_load_dwordx4 v1,s[4:7],s60 offen lds
buffer_load_dwordx4 v1,s[4:7],s60 offen offset:1024 lds
buffer_load_dwordx4 v1,s[4:7],s60 offen offset:2048 lds
buffer_load_dwordx4 v1,s[4:7],s60 offen offset:3072 lds
s_add_u32 m0,s48,4096
s_nop 0
buffer_load_dwordx4 v2,s[4:7],s60 offen lds
buffer_load_dwordx4 v2,s[4:7],s60 offen offset:1024 lds
buffer_load_dwordx4 v2,s[4:7],s60 offen offset:2048 lds
buffer_load_dwordx4 v2,s[4:7],s60 offen offset:3072 lds
s_add_u32 m0,s48,8192
s_nop 0
buffer_load_dwordx4 v3,s[4:7],s60 offen lds
buffer_load_dwordx4 v3,s[4:7],s60 offen offset:1024 lds
buffer_load_dwordx4 v3,s[4:7],s60 offen offset:2048 lds
buffer_load_dwordx4 v3,s[4:7],s60 offen offset:3072 lds
s_add_u32 s60,s49,12288
s_add_u32 m0,s48,12288
s_nop 0
buffer_load_dwordx4 v1,s[4:7],s60 offen lds
buffer_load_dwordx4 v1,s[4:7],s60 offen offset:1024 lds
buffer_load_dwordx4 v1,s[4:7],s60 offen offset:2048 lds
buffer_load_dwordx4 v1,s[4:7],s60 offen offset:3072 lds
s_add_u32 m0,s48,16384
s_nop 0
buffer_load_dwordx4 v2,s[4:7],s60 offen lds
buffer_load_dwordx4 v2,s[4:7],s60 offen offset:1024 lds
buffer_load_dwordx4 v2,s[4:7],s60 offen offset:2048 lds
buffer_load_dwordx4 v2,s[4:7],s60 offen offset:3072 lds
s_add_u32 m0,s48,20480
s_nop 0
buffer_load_dwordx4 v3,s[4:7],s60 offen lds
buffer_load_dwordx4 v3,s[4:7],s60 offen offset:1024 lds
buffer_load_dwordx4 v3,s[4:7],s60 offen offset:2048 lds
buffer_load_dwordx4 v3,s[4:7],s60 offen offset:3072 lds
s_add_u32 s60,s49,24576
s_add_u32 m0,s48,24576
s_nop 0
buffer_load_dwordx4 v1,s[4:7],s60 offen lds
buffer_load_dwordx4 v1,s[4:7],s60 offen offset:1024 lds
buffer_load_dwordx4 v1,s[4:7],s60 offen offset:2048 lds
buffer_load_dwordx4 v1,s[4:7],s60 offen offset:3072 lds
s_add_u32 m0,s48,28672
s_nop 0
buffer_load_dwordx4 v2,s[4:7],s60 offen lds
buffer_load_dwordx4 v2,s[4:7],s60 offen offset:1024 lds
buffer_load_dwordx4 v2,s[4:7],s60 offen offset:2048 lds
buffer_load_dwordx4 v2,s[4:7],s60 offen offset:3072 lds
s_add_u32 m0,s48,32768
s_nop 0
buffer_load_dwordx4 v3,s[4:7],s60 offen lds
buffer_load_dwordx4 v3,s[4:7],s60 offen offset:1024 lds
buffer_load_dwordx4 v3,s[4:7],s60 offen offset:2048 lds
buffer_load_dwordx4 v3,s[4:7],s60 offen offset:3072 lds
v_mov_b32 v16,-1
v_mov_b32 v17,-1
v_mov_b32 v18,-1
v_mov_b32 v19,-1
s_lshl_b32 s48,s25,1
s_and_b32 s49,s26,1
s_add_u32 s48,s48,s49
s_lshl_b32 s48,s48,2
s_add_u32 s48,s48,s24
s_mul_i32 s48,s48,36864
s_add_u32 s48,s48,24444928
s_lshr_b32 s49,s25,3
s_cmp_eq_u32 s49,s24
s_cbranch_scc1 Ls112
s_add_u32 s49,s48,0
s_waitcnt vmcnt(2)
buffer_store_dwordx4 v[16:19],v1,s[20:23],s49 offen sc1
buffer_store_dwordx4 v[16:19],v1,s[20:23],s49 offen offset:1024 sc1
s_add_u32 s49,s48,4096
s_waitcnt vmcnt(2)
buffer_store_dwordx4 v[16:19],v1,s[20:23],s49 offen sc1
buffer_store_dwordx4 v[16:19],v1,s[20:23],s49 offen offset:1024 sc1
s_add_u32 s49,s48,8192
s_waitcnt vmcnt(2)
buffer_store_dwordx4 v[16:19],v1,s[20:23],s49 offen sc1
buffer_store_dwordx4 v[16:19],v1,s[20:23],s49 offen offset:1024 sc1
s_add_u32 s49,s48,12288
s_waitcnt vmcnt(2)
buffer_store_dwordx4 v[16:19],v1,s[20:23],s49 offen sc1
buffer_store_dwordx4 v[16:19],v1,s[20:23],s49 offen offset:1024 sc1
s_add_u32 s49,s48,18432
s_waitcnt vmcnt(2)
buffer_store_dwordx4 v[16:19],v1,s[20:23],s49 offen sc1
buffer_store_dwordx4 v[16:19],v1,s[20:23],s49 offen offset:1024 sc1
s_add_u32 s49,s48,22528
s_waitcnt vmcnt(2)
buffer_store_dwordx4 v[16:19],v1,s[20:23],s49 offen sc1
buffer_store_dwordx4 v[16:19],v1,s[20:23],s49 offen offset:1024 sc1
s_add_u32 s49,s48,26624
s_waitcnt vmcnt(2)
buffer_store_dwordx4 v[16:19],v1,s[20:23],s49 offen sc1
buffer_store_dwordx4 v[16:19],v1,s[20:23],s49 offen offset:1024 sc1
s_add_u32 s49,s48,30720
s_waitcnt vmcnt(2)
buffer_store_dwordx4 v[16:19],v1,s[20:23],s49 offen sc1
buffer_store_dwordx4 v[16:19],v1,s[20:23],s49 offen offset:1024 sc1
Ls112:
s_waitcnt vmcnt(0)
s_branch Ljoin1
Ls111:
s_lshl_b32 s89,s25,2
s_add_u32 s89,s89,s24
s_mul_i32 s89,s89,18432
s_add_u32 s91,s89,18432
s_mul_i32 s48,s26,3072
s_add_u32 s87,s89,s48
s_lshl_b32 s90,s24,10
v_mov_b32 v21,v7
v_mov_b32 v22,v8
s_lshl_b32 s48,s25,2
s_add_u32 s48,s48,s24
s_mul_i32 s48,s48,256
s_add_u32 s84,s48,5521408
s_mov_b64 exec,1
s_mov_b32 s56,0
v_mov_b32 v24,0
buffer_atomic_add v24,v10,s[20:23],s84 offen sc0 sc1
s_mov_b64 exec,-1
v_fmamk_f32 v212,v210,0x40800000,v211
v_fmamk_f32 v213,v210,0x41a00000,v211
v_cos_f32 v214,v212
v_sin_f32 v215,v212
v_cos_f32 v216,v213
v_sin_f32 v217,v213
v_cvt_pk_bf16_f32 v76,v214,v215
v_cvt_pk_bf16_f32 v77,v216,v217
v_fmamk_f32 v212,v210,0x42100000,v211
v_fmamk_f32 v213,v210,0x42500000,v211
v_cos_f32 v214,v212
v_sin_f32 v215,v212
v_cos_f32 v216,v213
v_sin_f32 v217,v213
v_cvt_pk_bf16_f32 v78,v214,v215
v_cvt_pk_bf16_f32 v79,v216,v217
v_fmamk_f32 v212,v210,0x40c00000,v211
v_fmamk_f32 v213,v210,0x41b00000,v211
v_cos_f32 v214,v212
v_sin_f32 v215,v212
v_cos_f32 v216,v213
v_sin_f32 v217,v213
v_cvt_pk_bf16_f32 v80,v214,v215
v_cvt_pk_bf16_f32 v81,v216,v217
v_fmamk_f32 v212,v210,0x42180000,v211
v_fmamk_f32 v213,v210,0x42580000,v211
v_cos_f32 v214,v212
v_sin_f32 v215,v212
v_cos_f32 v216,v213
v_sin_f32 v217,v213
v_cvt_pk_bf16_f32 v82,v214,v215
v_cvt_pk_bf16_f32 v83,v216,v217
v_fmamk_f32 v212,v210,0x41000000,v211
v_fmamk_f32 v213,v210,0x41c00000,v211
v_cos_f32 v214,v212
v_sin_f32 v215,v212
v_cos_f32 v216,v213
v_sin_f32 v217,v213
v_cvt_pk_bf16_f32 v84,v214,v215
v_cvt_pk_bf16_f32 v85,v216,v217
v_fmamk_f32 v212,v210,0x42200000,v211
v_fmamk_f32 v213,v210,0x42600000,v211
v_cos_f32 v214,v212
v_sin_f32 v215,v212
v_cos_f32 v216,v213
v_sin_f32 v217,v213
v_cvt_pk_bf16_f32 v86,v214,v215
v_cvt_pk_bf16_f32 v87,v216,v217
v_fmamk_f32 v212,v210,0x41200000,v211
v_fmamk_f32 v213,v210,0x41d00000,v211
v_cos_f32 v214,v212
v_sin_f32 v215,v212
v_cos_f32 v216,v213
v_sin_f32 v217,v213
v_cvt_pk_bf16_f32 v88,v214,v215
v_cvt_pk_bf16_f32 v89,v216,v217
v_fmamk_f32 v212,v210,0x42280000,v211
v_fmamk_f32 v213,v210,0x42680000,v211
v_cos_f32 v214,v212
v_sin_f32 v215,v212
v_cos_f32 v216,v213
v_sin_f32 v217,v213
v_cvt_pk_bf16_f32 v90,v214,v215
v_cvt_pk_bf16_f32 v91,v216,v217
v_fmamk_f32 v212,v210,0x41400000,v211
v_fmamk_f32 v213,v210,0x41e00000,v211
v_cos_f32 v214,v212
v_sin_f32 v215,v212
v_cos_f32 v216,v213
v_sin_f32 v217,v213
v_cvt_pk_bf16_f32 v92,v214,v215
v_cvt_pk_bf16_f32 v93,v216,v217
v_fmamk_f32 v212,v210,0x42300000,v211
v_fmamk_f32 v213,v210,0x42700000,v211
v_cos_f32 v214,v212
v_sin_f32 v215,v212
v_cos_f32 v216,v213
v_sin_f32 v217,v213
v_cvt_pk_bf16_f32 v94,v214,v215
v_cvt_pk_bf16_f32 v95,v216,v217
v_fmamk_f32 v212,v210,0x41600000,v211
v_fmamk_f32 v213,v210,0x41f00000,v211
v_cos_f32 v214,v212
v_sin_f32 v215,v212
v_cos_f32 v216,v213
v_sin_f32 v217,v213
v_cvt_pk_bf16_f32 v96,v214,v215
v_cvt_pk_bf16_f32 v97,v216,v217
v_fmamk_f32 v212,v210,0x42380000,v211
v_fmamk_f32 v213,v210,0x42780000,v211
v_cos_f32 v214,v212
v_sin_f32 v215,v212
v_cos_f32 v216,v213
v_sin_f32 v217,v213
v_cvt_pk_bf16_f32 v98,v214,v215
v_cvt_pk_bf16_f32 v99,v216,v217
s_mov_b64 exec,1
v_mov_b32 v25,0
buffer_atomic_add v25,v10,s[20:23],s84 offen sc0 sc1
s_mov_b64 exec,-1
s_lshl_b32 s60,s24,13
v_add_u32 v218,s60,v1
ds_write_b128 v218,v[68:71]
ds_write_b128 v218,v[72:75] offset:1024
ds_write_b128 v218,v[76:79] offset:2048
ds_write_b128 v218,v[80:83] offset:3072
ds_write_b128 v218,v[84:87] offset:4096
ds_write_b128 v218,v[88:91] offset:5120
ds_write_b128 v218,v[92:95] offset:6144
ds_write_b128 v218,v[96:99] offset:7168
s_mov_b64 exec,1
Lp113:
v_mov_b32 v26,0
buffer_atomic_add v26,v10,s[20:23],s84 offen sc0 sc1
s_waitcnt vmcnt(2)
v_bfe_u32 v24,v24,0,8
v_cmp_ne_u32 vcc,8,v24
s_nop 0
s_cbranch_vccz Lpd114
v_mov_b32 v24,0
buffer_atomic_add v24,v10,s[20:23],s84 offen sc0 sc1
s_waitcnt vmcnt(2)
v_bfe_u32 v25,v25,0,8
v_cmp_ne_u32 vcc,8,v25
s_nop 0
s_cbranch_vccz Lpd114
v_mov_b32 v25,0
buffer_atomic_add v25,v10,s[20:23],s84 offen sc0 sc1
s_waitcnt vmcnt(2)
v_bfe_u32 v26,v26,0,8
v_cmp_ne_u32 vcc,8,v26
s_nop 0
s_cbranch_vccz Lpd114
s_add_u32 s56,s56,1
s_cmp_lt_u32 s56,0x40000
s_cbranch_scc1 Lp113
Lpd114:
s_mov_b64 exec,-1
s_add_u32 m0,s90,73728
s_nop 0
buffer_load_dwordx4 v1,s[8:11],s87 offen sc1 lds
s_add_u32 m0,s90,76800
s_nop 0
buffer_load_dwordx4 v1,s[8:11],s87 offen offset:1024 sc1 lds
s_add_u32 m0,s90,79872
s_nop 0
buffer_load_dwordx4 v1,s[8:11],s87 offen offset:2048 sc1 lds
s_add_u32 s87,s87,3072
s_cmp_eq_u32 s87,s91
s_cselect_b32 s87,s89,s87
s_add_u32 m0,s90,86016
s_nop 0
buffer_load_dwordx4 v1,s[8:11],s87 offen sc1 lds
s_waitcnt lgkmcnt(0)
s_barrier
s_add_u32 m0,s90,89088
s_nop 0
buffer_load_dwordx4 v1,s[8:11],s87 offen offset:1024 sc1 lds
s_add_u32 m0,s90,92160
s_nop 0
buffer_load_dwordx4 v1,s[8:11],s87 offen offset:2048 sc1 lds
s_add_u32 s87,s87,3072
s_cmp_eq_u32 s87,s91
s_cselect_b32 s87,s89,s87
s_add_u32 m0,s90,98304
s_nop 0
buffer_load_dwordx4 v1,s[8:11],s87 offen sc1 lds
s_add_u32 m0,s90,101376
s_nop 0
buffer_load_dwordx4 v1,s[8:11],s87 offen offset:1024 sc1 lds
s_add_u32 m0,s90,104448
s_nop 0
buffer_load_dwordx4 v1,s[8:11],s87 offen offset:2048 sc1 lds
s_mov_b64 exec,1
v_mov_b32 v12,256
buffer_atomic_add v12,v10,s[20:23],s79 offen sc1
s_mov_b64 exec,-1
s_mov_b32 s85,0
s_cmp_eq_u32 s24,3
s_cbranch_scc1 La115
ds_read_b128 a[0:3],v1
ds_read_b128 a[4:7],v1 offset:1024
ds_read_b128 a[8:11],v1 offset:2048
ds_read_b128 a[12:15],v1 offset:3072
ds_read_b128 a[16:19],v1 offset:4096
ds_read_b128 a[20:23],v1 offset:5120
ds_read_b128 a[24:27],v1 offset:6144
ds_read_b128 a[28:31],v1 offset:7168
ds_read_b128 a[32:35],v1 offset:8192
ds_read_b128 a[36:39],v1 offset:9216
ds_read_b128 a[40:43],v1 offset:10240
ds_read_b128 a[44:47],v1 offset:11264
La115:
v_mov_b32 v23,v1
s_add_u32 s95,s62,s61
Lre117:
s_cmp_eq_u32 s24,3
s_cbranch_scc1 Lst116
v_lshlrev_b32 v11,4,v5
v_add_u32 v11,148736,v11
v_mul_u32_u24 v10,589824,v5
v_lshl_add_u32 v10,v4,4,v10
s_mul_i32 s50,s26,3
s_add_u32 s50,s50,s24
s_lshl_b32 s51,s50,8
s_mul_i32 s49,s25,4608
s_add_u32 s51,s51,s49
s_lshl_b32 s49,s24,12
v_add_u32 v252,s49,v21
v_mov_b32 v16,-1
v_mov_b32 v17,-1
v_mov_b32 v18,-1
v_mov_b32 v19,-1
s_waitcnt vmcnt(6)
s_barrier
ds_read_b128 v[204:207],v21
ds_read_b128 v[208:211],v21 offset:1024
ds_read_b128 v[212:215],v21 offset:2048
ds_read_b128 v[216:219],v21 offset:3072
ds_read_b128 v[220:223],v21 offset:4096
ds_read_b128 v[224:227],v21 offset:5120
s_waitcnt lgkmcnt(4)
mf v[36:39],v[204:207],v[100:103],0
ds_read_b128 v[228:231],v21 offset:6144
s_add_u32 s87,s87,3072
mf v[40:43],v[204:207],v[104:107],0
s_cmp_eq_u32 s87,s91
s_cselect_b32 s87,s89,s87
s_add_u32 m0,s90,110592
mf v[44:47],v[208:211],v[100:103],0
buffer_load_dwordx4 v1,s[8:11],s87 offen sc1 lds
mf v[48:51],v[208:211],v[104:107],0
ds_read_b128 v[232:235],v21 offset:7168
s_waitcnt lgkmcnt(4)
mf v[52:55],v[212:215],v[100:103],0
ds_read_b128 v[204:207],v21 offset:8192
s_add_u32 m0,s90,113664
mf v[56:59],v[212:215],v[104:107],0
ds_read_b128 a[48:51],v23 offset:12288
ds_read_b128 a[52:55],v23 offset:13312
mf v[60:63],v[216:219],v[100:103],0
buffer_load_dwordx4 v1,s[8:11],s87 offen offset:1024 sc1 lds
mf v[64:67],v[216:219],v[104:107],0
ds_read_b128 v[208:211],v21 offset:9216
s_waitcnt lgkmcnt(6)
mf v[36:39],v[220:223],v[108:111],v[36:39]
ds_read_b128 v[212:215],v21 offset:10240
s_add_u32 m0,s90,116736
mf v[40:43],v[220:223],v[112:115],v[40:43]
ds_read_b128 a[56:59],v23 offset:14336
ds_read_b128 a[60:63],v23 offset:15360
mf v[44:47],v[224:227],v[108:111],v[44:47]
buffer_load_dwordx4 v1,s[8:11],s87 offen offset:2048 sc1 lds
mf v[48:51],v[224:227],v[112:115],v[48:51]
ds_read_b128 v[216:219],v21 offset:11264
s_waitcnt lgkmcnt(8)
mf v[52:55],v[228:231],v[108:111],v[52:55]
ds_read_b128 v[220:223],v21 offset:12288
s_add_u32 s87,s87,3072
mf v[56:59],v[228:231],v[112:115],v[56:59]
s_cmp_eq_u32 s87,s91
s_cselect_b32 s87,s89,s87
s_add_u32 m0,s90,122880
mf v[60:63],v[232:235],v[108:111],v[60:63]
buffer_load_dwordx4 v1,s[8:11],s87 offen sc1 lds
mf v[64:67],v[232:235],v[112:115],v[64:67]
ds_read_b128 v[224:227],v21 offset:13312
s_waitcnt lgkmcnt(6)
mf v[36:39],v[204:207],v[116:119],v[36:39]
ds_read_b128 v[228:231],v21 offset:14336
s_add_u32 m0,s90,125952
mf v[40:43],v[204:207],v[120:123],v[40:43]
ds_read_b128 a[64:67],v23 offset:16384
ds_read_b128 a[68:71],v23 offset:17408
mf v[44:47],v[208:211],v[116:119],v[44:47]
buffer_load_dwordx4 v1,s[8:11],s87 offen offset:1024 sc1 lds
mf v[48:51],v[208:211],v[120:123],v[48:51]
ds_read_b128 v[232:235],v21 offset:15360
s_waitcnt lgkmcnt(6)
mf v[52:55],v[212:215],v[116:119],v[52:55]
s_waitcnt vmcnt(4)
s_barrier
ds_read_b128 v[204:207],v21 offset:16384
s_add_u32 m0,s90,129024
mf v[56:59],v[212:215],v[120:123],v[56:59]
ds_read_b128 a[72:75],v23 offset:18432
ds_read_b128 a[76:79],v23 offset:19456
mf v[60:63],v[216:219],v[116:119],v[60:63]
buffer_load_dwordx4 v1,s[8:11],s87 offen offset:2048 sc1 lds
mf v[64:67],v[216:219],v[120:123],v[64:67]
ds_read_b128 v[208:211],v21 offset:17408
s_waitcnt lgkmcnt(8)
mf v[36:39],v[220:223],v[124:127],v[36:39]
ds_read_b128 v[212:215],v21 offset:18432
s_add_u32 s87,s87,3072
mf v[40:43],v[220:223],v[128:131],v[40:43]
s_cmp_eq_u32 s87,s91
s_cselect_b32 s87,s89,s87
s_add_u32 m0,s90,135168
mf v[44:47],v[224:227],v[124:127],v[44:47]
buffer_load_dwordx4 v1,s[8:11],s87 offen sc1 lds
mf v[48:51],v[224:227],v[128:131],v[48:51]
ds_read_b128 v[216:219],v21 offset:19456
s_waitcnt lgkmcnt(6)
mf v[52:55],v[228:231],v[124:127],v[52:55]
ds_read_b128 v[220:223],v21 offset:20480
s_add_u32 m0,s90,138240
mf v[56:59],v[228:231],v[128:131],v[56:59]
ds_read_b128 a[80:83],v23 offset:20480
ds_read_b128 a[84:87],v23 offset:21504
mf v[60:63],v[232:235],v[124:127],v[60:63]
buffer_load_dwordx4 v1,s[8:11],s87 offen offset:1024 sc1 lds
mf v[64:67],v[232:235],v[128:131],v[64:67]
ds_read_b128 v[224:227],v21 offset:21504
s_waitcnt lgkmcnt(6)
mf v[36:39],v[204:207],v[132:135],v[36:39]
ds_read_b128 v[228:231],v21 offset:22528
s_add_u32 m0,s90,141312
mf v[40:43],v[204:207],v[136:139],v[40:43]
ds_read_b128 a[88:91],v23 offset:22528
ds_read_b128 a[92:95],v23 offset:23552
mf v[44:47],v[208:211],v[132:135],v[44:47]
buffer_load_dwordx4 v1,s[8:11],s87 offen offset:2048 sc1 lds
mf v[48:51],v[208:211],v[136:139],v[48:51]
ds_read_b128 v[232:235],v21 offset:23552
s_waitcnt lgkmcnt(8)
mf v[52:55],v[212:215],v[132:135],v[52:55]
ds_read_b128 v[204:207],v21 offset:24576
s_add_u32 s60,s95,36864
mf v[56:59],v[212:215],v[136:139],v[56:59]
s_add_u32 m0,s61,36864
ds_read_b128 a[96:99],v23 offset:24576
mf v[60:63],v[216:219],v[132:135],v[60:63]
buffer_load_dwordx4 v1,s[4:7],s60 offen lds
mf v[64:67],v[216:219],v[136:139],v[64:67]
ds_read_b128 v[208:211],v21 offset:25600
s_waitcnt lgkmcnt(7)
mf v[36:39],v[220:223],v[140:143],v[36:39]
ds_read_b128 v[212:215],v21 offset:26624
ds_read_b128 a[100:103],v23 offset:25600
mf v[40:43],v[220:223],v[144:147],v[40:43]
ds_read_b128 a[104:107],v23 offset:26624
ds_read_b128 a[108:111],v23 offset:27648
mf v[44:47],v[224:227],v[140:143],v[44:47]
buffer_load_dwordx4 v1,s[4:7],s60 offen offset:1024 lds
mf v[48:51],v[224:227],v[144:147],v[48:51]
ds_read_b128 v[216:219],v21 offset:27648
s_waitcnt lgkmcnt(8)
mf v[52:55],v[228:231],v[140:143],v[52:55]
ds_read_b128 v[220:223],v21 offset:28672
ds_read_b128 a[112:115],v23 offset:28672
mf v[56:59],v[228:231],v[144:147],v[56:59]
ds_read_b128 a[116:119],v23 offset:29696
ds_read_b128 a[120:123],v23 offset:30720
mf v[60:63],v[232:235],v[140:143],v[60:63]
buffer_load_dwordx4 v1,s[4:7],s60 offen offset:2048 lds
mf v[64:67],v[232:235],v[144:147],v[64:67]
ds_read_b128 v[224:227],v21 offset:29696
s_waitcnt lgkmcnt(10)
mf v[36:39],v[204:207],v[148:151],v[36:39]
ds_read_b128 v[228:231],v21 offset:30720
ds_read_b128 a[124:127],v23 offset:31744
mf v[40:43],v[204:207],v[152:155],v[40:43]
mf v[44:47],v[208:211],v[148:151],v[44:47]
buffer_load_dwordx4 v1,s[4:7],s60 offen offset:3072 lds
mf v[48:51],v[208:211],v[152:155],v[48:51]
ds_read_b128 v[232:235],v21 offset:31744
s_waitcnt lgkmcnt(8)
mf v[52:55],v[212:215],v[148:151],v[52:55]
ds_read_b128 v[204:207],v21 offset:32768
s_add_u32 m0,s61,40960
mf v[56:59],v[212:215],v[152:155],v[56:59]
mf v[60:63],v[216:219],v[148:151],v[60:63]
buffer_load_dwordx4 v2,s[4:7],s60 offen lds
mf v[64:67],v[216:219],v[152:155],v[64:67]
ds_read_b128 v[208:211],v21 offset:33792
s_waitcnt lgkmcnt(5)
mf v[36:39],v[220:223],v[156:159],v[36:39]
ds_read_b128 v[212:215],v21 offset:34816
mf v[40:43],v[220:223],v[160:163],v[40:43]
mf v[44:47],v[224:227],v[156:159],v[44:47]
buffer_load_dwordx4 v2,s[4:7],s60 offen offset:1024 lds
mf v[48:51],v[224:227],v[160:163],v[48:51]
ds_read_b128 v[216:219],v21 offset:35840
s_waitcnt lgkmcnt(4)
mf v[52:55],v[228:231],v[156:159],v[52:55]
ds_read_b128 v[220:223],v22
mf v[56:59],v[228:231],v[160:163],v[56:59]
mf v[60:63],v[232:235],v[156:159],v[60:63]
buffer_load_dwordx4 v2,s[4:7],s60 offen offset:2048 lds
mf v[64:67],v[232:235],v[160:163],v[64:67]
ds_read_b128 v[224:227],v22 offset:1024
s_waitcnt lgkmcnt(4)
mf v[36:39],v[204:207],v[164:167],v[36:39]
ds_read_b128 v[228:231],v22 offset:2048
mf v[40:43],v[204:207],v[168:171],v[40:43]
mf v[44:47],v[208:211],v[164:167],v[44:47]
buffer_load_dwordx4 v2,s[4:7],s60 offen offset:3072 lds
mf v[48:51],v[208:211],v[168:171],v[48:51]
ds_read_b128 v[232:235],v22 offset:3072
s_waitcnt lgkmcnt(4)
mf v[52:55],v[212:215],v[164:167],v[52:55]
s_waitcnt vmcnt(8)
s_barrier
ds_read_b128 v[204:207],v22 offset:4096
s_add_u32 m0,s61,45056
mf v[56:59],v[212:215],v[168:171],v[56:59]
mf v[60:63],v[216:219],v[164:167],v[60:63]
buffer_load_dwordx4 v3,s[4:7],s60 offen lds
mf v[64:67],v[216:219],v[168:171],v[64:67]
ds_read_b128 v[208:211],v22 offset:5120
s_waitcnt lgkmcnt(4)
mf v[172:175],v[220:223],v[100:103],0
ds_read_b128 v[212:215],v22 offset:6144
s_add_u32 s60,s95,0
mf v[176:179],v[220:223],v[104:107],0
s_add_u32 m0,s61,0
mf v[180:183],v[224:227],v[100:103],0
buffer_load_dwordx4 v1,s[4:7],s60 offen lds
mf v[184:187],v[224:227],v[104:107],0
ds_read_b128 v[216:219],v22 offset:7168
s_waitcnt lgkmcnt(4)
mf v[188:191],v[228:231],v[100:103],0
ds_read_b128 v[220:223],v22 offset:8192
mf v[192:195],v[228:231],v[104:107],0
mf v[196:199],v[232:235],v[100:103],0
buffer_load_dwordx4 v1,s[4:7],s60 offen offset:1024 lds
mf v[200:203],v[232:235],v[104:107],0
ds_read_b128 v[224:227],v22 offset:9216
s_waitcnt lgkmcnt(4)
mf v[172:175],v[204:207],v[108:111],v[172:175]
ds_read_b128 v[228:231],v22 offset:10240
mf v[176:179],v[204:207],v[112:115],v[176:179]
mf v[180:183],v[208:211],v[108:111],v[180:183]
buffer_load_dwordx4 v1,s[4:7],s60 offen offset:2048 lds
mf v[184:187],v[208:211],v[112:115],v[184:187]
ds_read_b128 v[232:235],v22 offset:11264
s_waitcnt lgkmcnt(4)
mf v[188:191],v[212:215],v[108:111],v[188:191]
ds_read_b128 v[204:207],v22 offset:12288
mf v[192:195],v[212:215],v[112:115],v[192:195]
mf v[196:199],v[216:219],v[108:111],v[196:199]
buffer_load_dwordx4 v1,s[4:7],s60 offen offset:3072 lds
mf v[200:203],v[216:219],v[112:115],v[200:203]
ds_read_b128 v[208:211],v22 offset:13312
s_waitcnt lgkmcnt(4)
mf v[172:175],v[220:223],v[116:119],v[172:175]
ds_read_b128 v[212:215],v22 offset:14336
s_add_u32 m0,s61,4096
mf v[176:179],v[220:223],v[120:123],v[176:179]
mf v[180:183],v[224:227],v[116:119],v[180:183]
buffer_load_dwordx4 v2,s[4:7],s60 offen lds
mf v[184:187],v[224:227],v[120:123],v[184:187]
ds_read_b128 v[216:219],v22 offset:15360
s_waitcnt lgkmcnt(4)
mf v[188:191],v[228:231],v[116:119],v[188:191]
ds_read_b128 v[220:223],v22 offset:16384
mf v[192:195],v[228:231],v[120:123],v[192:195]
mf v[196:199],v[232:235],v[116:119],v[196:199]
buffer_load_dwordx4 v2,s[4:7],s60 offen offset:1024 lds
mf v[200:203],v[232:235],v[120:123],v[200:203]
ds_read_b128 v[224:227],v22 offset:17408
s_waitcnt lgkmcnt(4)
mf v[172:175],v[204:207],v[124:127],v[172:175]
ds_read_b128 v[228:231],v22 offset:18432
mf v[176:179],v[204:207],v[128:131],v[176:179]
mf v[180:183],v[208:211],v[124:127],v[180:183]
buffer_load_dwordx4 v2,s[4:7],s60 offen offset:2048 lds
mf v[184:187],v[208:211],v[128:131],v[184:187]
ds_read_b128 v[232:235],v22 offset:19456
s_waitcnt lgkmcnt(4)
mf v[188:191],v[212:215],v[124:127],v[188:191]
ds_read_b128 v[204:207],v22 offset:20480
mf v[192:195],v[212:215],v[128:131],v[192:195]
mf v[196:199],v[216:219],v[124:127],v[196:199]
buffer_load_dwordx4 v2,s[4:7],s60 offen offset:3072 lds
mf v[200:203],v[216:219],v[128:131],v[200:203]
ds_read_b128 v[208:211],v22 offset:21504
s_waitcnt lgkmcnt(4)
mf v[172:175],v[220:223],v[132:135],v[172:175]
ds_read_b128 v[212:215],v22 offset:22528
s_add_u32 m0,s61,8192
mf v[176:179],v[220:223],v[136:139],v[176:179]
mf v[180:183],v[224:227],v[132:135],v[180:183]
buffer_load_dwordx4 v3,s[4:7],s60 offen lds
mf v[184:187],v[224:227],v[136:139],v[184:187]
ds_read_b128 v[216:219],v22 offset:23552
s_waitcnt lgkmcnt(4)
mf v[188:191],v[228:231],v[132:135],v[188:191]
ds_read_b128 v[220:223],v22 offset:24576
mf v[192:195],v[228:231],v[136:139],v[192:195]
mf v[196:199],v[232:235],v[132:135],v[196:199]
ds_read_b128 v[224:227],v22 offset:25600
mf v[200:203],v[232:235],v[136:139],v[200:203]
s_waitcnt lgkmcnt(4)
mf v[172:175],v[204:207],v[140:143],v[172:175]
ds_read_b128 v[228:231],v22 offset:26624
mf v[176:179],v[204:207],v[144:147],v[176:179]
mf v[180:183],v[208:211],v[140:143],v[180:183]
ds_read_b128 v[232:235],v22 offset:27648
mf v[184:187],v[208:211],v[144:147],v[184:187]
s_waitcnt lgkmcnt(4)
mf v[188:191],v[212:215],v[140:143],v[188:191]
ds_read_b128 v[204:207],v22 offset:28672
mf v[192:195],v[212:215],v[144:147],v[192:195]
mf v[196:199],v[216:219],v[140:143],v[196:199]
ds_read_b128 v[208:211],v22 offset:29696
mf v[200:203],v[216:219],v[144:147],v[200:203]
s_waitcnt lgkmcnt(4)
mf v[172:175],v[220:223],v[148:151],v[172:175]
ds_read_b128 v[212:215],v22 offset:30720
mf v[176:179],v[220:223],v[152:155],v[176:179]
mf v[180:183],v[224:227],v[148:151],v[180:183]
ds_read_b128 v[216:219],v22 offset:31744
mf v[184:187],v[224:227],v[152:155],v[184:187]
s_waitcnt lgkmcnt(4)
mf v[188:191],v[228:231],v[148:151],v[188:191]
ds_read_b128 v[220:223],v22 offset:32768
mf v[192:195],v[228:231],v[152:155],v[192:195]
mf v[196:199],v[232:235],v[148:151],v[196:199]
ds_read_b128 v[224:227],v22 offset:33792
mf v[200:203],v[232:235],v[152:155],v[200:203]
s_waitcnt lgkmcnt(4)
mf v[172:175],v[204:207],v[156:159],v[172:175]
ds_read_b128 v[228:231],v22 offset:34816
mf v[176:179],v[204:207],v[160:163],v[176:179]
mf v[180:183],v[208:211],v[156:159],v[180:183]
ds_read_b128 v[232:235],v22 offset:35840
mf v[184:187],v[208:211],v[160:163],v[184:187]
s_waitcnt lgkmcnt(4)
mf v[188:191],v[212:215],v[156:159],v[188:191]
mf v[192:195],v[212:215],v[160:163],v[192:195]
mf v[196:199],v[216:219],v[156:159],v[196:199]
mf v[200:203],v[216:219],v[160:163],v[200:203]
s_waitcnt lgkmcnt(2)
mf v[172:175],v[220:223],v[164:167],v[172:175]
mf v[176:179],v[220:223],v[168:171],v[176:179]
mf v[180:183],v[224:227],v[164:167],v[180:183]
mf v[184:187],v[224:227],v[168:171],v[184:187]
s_waitcnt lgkmcnt(0)
mf v[188:191],v[228:231],v[164:167],v[188:191]
mf v[192:195],v[228:231],v[168:171],v[192:195]
mf v[196:199],v[232:235],v[164:167],v[196:199]
mf v[200:203],v[232:235],v[168:171],v[200:203]
s_nop 0
v_pk_fma_f32 v[36:37],v[172:173],v[254:255],v[36:37] op_sel_hi:[1,0,1]
v_pk_fma_f32 v[38:39],v[174:175],v[254:255],v[38:39] op_sel_hi:[1,0,1]
v_pk_fma_f32 v[40:41],v[176:177],v[254:255],v[40:41] op_sel_hi:[1,0,1]
v_pk_fma_f32 v[42:43],v[178:179],v[254:255],v[42:43] op_sel_hi:[1,0,1]
v_pk_fma_f32 v[44:45],v[180:181],v[254:255],v[44:45] op_sel_hi:[1,0,1]
v_pk_fma_f32 v[46:47],v[182:183],v[254:255],v[46:47] op_sel_hi:[1,0,1]
v_pk_fma_f32 v[48:49],v[184:185],v[254:255],v[48:49] op_sel_hi:[1,0,1]
v_pk_fma_f32 v[50:51],v[186:187],v[254:255],v[50:51] op_sel_hi:[1,0,1]
v_pk_fma_f32 v[52:53],v[188:189],v[254:255],v[52:53] op_sel_hi:[1,0,1]
v_pk_fma_f32 v[54:55],v[190:191],v[254:255],v[54:55] op_sel_hi:[1,0,1]
v_pk_fma_f32 v[56:57],v[192:193],v[254:255],v[56:57] op_sel_hi:[1,0,1]
v_pk_fma_f32 v[58:59],v[194:195],v[254:255],v[58:59] op_sel_hi:[1,0,1]
v_pk_fma_f32 v[60:61],v[196:197],v[254:255],v[60:61] op_sel_hi:[1,0,1]
v_pk_fma_f32 v[62:63],v[198:199],v[254:255],v[62:63] op_sel_hi:[1,0,1]
v_pk_fma_f32 v[64:65],v[200:201],v[254:255],v[64:65] op_sel_hi:[1,0,1]
v_pk_fma_f32 v[66:67],v[202:203],v[254:255],v[66:67] op_sel_hi:[1,0,1]
s_barrier
ds_read_b32 v188,v11 offset:512
ds_read_b128 v[172:175],v11 offset:256
ds_read_b128 v[12:15],v11
ds_read_b128 v[176:179],v11 offset:320
ds_read_b128 v[16:19],v11 offset:64
ds_read_b128 v[180:183],v11 offset:384
ds_read_b128 v[20:23],v11 offset:128
ds_read_b128 v[184:187],v11 offset:448
ds_read_b128 v[24:27],v11 offset:192
s_waitcnt lgkmcnt(6)
v_readfirstlane_b32 s48,v188
s_nop 0
s_cmp_lg_u32 s48,0
s_cbranch_scc1 La121
v_pk_fma_f32 v[36:37],v[172:173],v[238:239],v[36:37] op_sel:[0,0,0] op_sel_hi:[1,0,1]
v_pk_fma_f32 v[38:39],v[174:175],v[238:239],v[38:39] op_sel:[0,0,0] op_sel_hi:[1,0,1]
v_pk_fma_f32 v[40:41],v[172:173],v[238:239],v[40:41] op_sel:[0,1,0] op_sel_hi:[1,1,1]
v_pk_fma_f32 v[42:43],v[174:175],v[238:239],v[42:43] op_sel:[0,1,0] op_sel_hi:[1,1,1]
v_pk_mul_f32 v[36:37],v[36:37],v[12:13]
v_pk_mul_f32 v[38:39],v[38:39],v[14:15]
v_pk_mul_f32 v[40:41],v[40:41],v[12:13]
v_pk_mul_f32 v[42:43],v[42:43],v[14:15]
v_cvt_pk_bf16_f32 v100,v36,v37
v_cvt_pk_bf16_f32 v101,v38,v39
v_cvt_pk_bf16_f32 v102,v40,v41
v_cvt_pk_bf16_f32 v103,v42,v43
s_waitcnt lgkmcnt(4)
s_nop 0
v_pk_fma_f32 v[44:45],v[176:177],v[238:239],v[44:45] op_sel:[0,0,0] op_sel_hi:[1,0,1]
v_pk_fma_f32 v[46:47],v[178:179],v[238:239],v[46:47] op_sel:[0,0,0] op_sel_hi:[1,0,1]
v_pk_fma_f32 v[48:49],v[176:177],v[238:239],v[48:49] op_sel:[0,1,0] op_sel_hi:[1,1,1]
v_pk_fma_f32 v[50:51],v[178:179],v[238:239],v[50:51] op_sel:[0,1,0] op_sel_hi:[1,1,1]
v_pk_mul_f32 v[44:45],v[44:45],v[16:17]
v_pk_mul_f32 v[46:47],v[46:47],v[18:19]
v_pk_mul_f32 v[48:49],v[48:49],v[16:17]
v_pk_mul_f32 v[50:51],v[50:51],v[18:19]
v_cvt_pk_bf16_f32 v104,v44,v45
v_cvt_pk_bf16_f32 v105,v46,v47
v_cvt_pk_bf16_f32 v106,v48,v49
v_cvt_pk_bf16_f32 v107,v50,v51
s_waitcnt lgkmcnt(2)
s_nop 0
v_pk_fma_f32 v[52:53],v[180:181],v[238:239],v[52:53] op_sel:[0,0,0] op_sel_hi:[1,0,1]
v_pk_fma_f32 v[54:55],v[182:183],v[238:239],v[54:55] op_sel:[0,0,0] op_sel_hi:[1,0,1]
v_pk_fma_f32 v[56:57],v[180:181],v[238:239],v[56:57] op_sel:[0,1,0] op_sel_hi:[1,1,1]
v_pk_fma_f32 v[58:59],v[182:183],v[238:239],v[58:59] op_sel:[0,1,0] op_sel_hi:[1,1,1]
v_pk_mul_f32 v[52:53],v[52:53],v[20:21]
v_pk_mul_f32 v[54:55],v[54:55],v[22:23]
v_pk_mul_f32 v[56:57],v[56:57],v[20:21]
v_pk_mul_f32 v[58:59],v[58:59],v[22:23]
v_cvt_pk_bf16_f32 v108,v52,v53
v_cvt_pk_bf16_f32 v109,v54,v55
v_cvt_pk_bf16_f32 v110,v56,v57
v_cvt_pk_bf16_f32 v111,v58,v59
s_waitcnt lgkmcnt(0)
s_nop 0
v_pk_fma_f32 v[60:61],v[184:185],v[238:239],v[60:61] op_sel:[0,0,0] op_sel_hi:[1,0,1]
v_pk_fma_f32 v[62:63],v[186:187],v[238:239],v[62:63] op_sel:[0,0,0] op_sel_hi:[1,0,1]
v_pk_fma_f32 v[64:65],v[184:185],v[238:239],v[64:65] op_sel:[0,1,0] op_sel_hi:[1,1,1]
v_pk_fma_f32 v[66:67],v[186:187],v[238:239],v[66:67] op_sel:[0,1,0] op_sel_hi:[1,1,1]
v_pk_mul_f32 v[60:61],v[60:61],v[24:25]
v_pk_mul_f32 v[62:63],v[62:63],v[26:27]
v_pk_mul_f32 v[64:65],v[64:65],v[24:25]
v_pk_mul_f32 v[66:67],v[66:67],v[26:27]
v_cvt_pk_bf16_f32 v112,v60,v61
v_cvt_pk_bf16_f32 v113,v62,v63
v_cvt_pk_bf16_f32 v114,v64,v65
v_cvt_pk_bf16_f32 v115,v66,v67
mf v[36:39],v[28:31],v[100:103],0
mf v[40:43],v[32:35],v[100:103],0
mf v[44:47],v[28:31],v[104:107],0
mf v[48:51],v[32:35],v[104:107],0
mf v[52:55],v[28:31],v[108:111],0
mf v[56:59],v[32:35],v[108:111],0
mf v[60:63],v[28:31],v[112:115],0
mf v[64:67],v[32:35],v[112:115],0
s_nop 1
v_cvt_pk_bf16_f32 v116,v36,v40
s_nop 0
v_cvt_pk_bf16_f32 v117,v44,v48
s_nop 0
v_cvt_pk_bf16_f32 v118,v52,v56
s_nop 0
v_cvt_pk_bf16_f32 v119,v60,v64
buffer_store_dwordx4 v[116:119],v10,s[20:23],s51 offen sc1
s_add_u32 s51,s51,147456
v_cvt_pk_bf16_f32 v120,v37,v41
v_cvt_pk_bf16_f32 v121,v45,v49
v_cvt_pk_bf16_f32 v122,v53,v57
v_cvt_pk_bf16_f32 v123,v61,v65
buffer_store_dwordx4 v[120:123],v10,s[20:23],s51 offen sc1
s_add_u32 s51,s51,147456
v_cvt_pk_bf16_f32 v124,v38,v42
v_cvt_pk_bf16_f32 v125,v46,v50
v_cvt_pk_bf16_f32 v126,v54,v58
v_cvt_pk_bf16_f32 v127,v62,v66
buffer_store_dwordx4 v[124:127],v10,s[20:23],s51 offen sc1
s_add_u32 s51,s51,147456
v_cvt_pk_bf16_f32 v128,v39,v43
v_cvt_pk_bf16_f32 v129,v47,v51
v_cvt_pk_bf16_f32 v130,v55,v59
v_cvt_pk_bf16_f32 v131,v63,v67
buffer_store_dwordx4 v[128:131],v10,s[20:23],s51 offen sc1
s_barrier
ds_read_b128 v[132:135],v252
ds_read_b128 v[136:139],v252 offset:1024
ds_read_b128 v[140:143],v252 offset:2048
ds_read_b128 v[144:147],v252 offset:3072
s_mul_i32 s48,s24,12288
s_add_u32 s49,s62,s48
s_add_u32 s60,s49,110592
s_add_u32 m0,s48,110592
s_nop 0
buffer_load_dwordx4 v1,s[4:7],s60 offen lds
buffer_load_dwordx4 v1,s[4:7],s60 offen offset:1024 lds
buffer_load_dwordx4 v1,s[4:7],s60 offen offset:2048 lds
buffer_load_dwordx4 v1,s[4:7],s60 offen offset:3072 lds
s_add_u32 m0,s48,114688
s_nop 0
buffer_load_dwordx4 v2,s[4:7],s60 offen lds
buffer_load_dwordx4 v2,s[4:7],s60 offen offset:1024 lds
buffer_load_dwordx4 v2,s[4:7],s60 offen offset:2048 lds
buffer_load_dwordx4 v2,s[4:7],s60 offen offset:3072 lds
s_add_u32 m0,s48,118784
s_nop 0
buffer_load_dwordx4 v3,s[4:7],s60 offen lds
buffer_load_dwordx4 v3,s[4:7],s60 offen offset:1024 lds
buffer_load_dwordx4 v3,s[4:7],s60 offen offset:2048 lds
buffer_load_dwordx4 v3,s[4:7],s60 offen offset:3072 lds
s_waitcnt lgkmcnt(0)
v_lshlrev_b32 v36,16,v132
v_and_b32 v37,0xffff0000,v132
v_lshlrev_b32 v38,16,v133
v_and_b32 v39,0xffff0000,v133
v_lshlrev_b32 v40,16,v134
v_and_b32 v41,0xffff0000,v134
v_lshlrev_b32 v42,16,v135
v_and_b32 v43,0xffff0000,v135
v_lshlrev_b32 v44,16,v136
v_and_b32 v45,0xffff0000,v136
v_lshlrev_b32 v46,16,v137
v_and_b32 v47,0xffff0000,v137
v_lshlrev_b32 v48,16,v138
v_and_b32 v49,0xffff0000,v138
v_lshlrev_b32 v50,16,v139
v_and_b32 v51,0xffff0000,v139
v_lshlrev_b32 v52,16,v140
v_and_b32 v53,0xffff0000,v140
v_lshlrev_b32 v54,16,v141
v_and_b32 v55,0xffff0000,v141
v_lshlrev_b32 v56,16,v142
v_and_b32 v57,0xffff0000,v142
v_lshlrev_b32 v58,16,v143
v_and_b32 v59,0xffff0000,v143
v_lshlrev_b32 v60,16,v144
v_and_b32 v61,0xffff0000,v144
v_lshlrev_b32 v62,16,v145
v_and_b32 v63,0xffff0000,v145
v_lshlrev_b32 v64,16,v146
v_and_b32 v65,0xffff0000,v146
v_lshlrev_b32 v66,16,v147
v_and_b32 v67,0xffff0000,v147
s_mul_i32 s50,s26,3
s_add_u32 s50,s50,s24
s_lshl_b32 s48,s50,5
v_lshrrev_b32 v10,2,v4
v_lshlrev_b32 v10,3,v10
v_and_b32 v11,3,v4
v_add3_u32 v10,v10,v11,s48
v_cmp_eq_u32 vcc,0,v10
s_sub_u32 s51,16,s30
s_and_b32 s51,s51,15
s_cmp_ge_u32 s26,3
s_cselect_b32 s48,-16,16
s_cselect_b32 s49,9200,-16
s_cselect_b32 s51,s51,s30
v_mul_lo_u32 v10,v10,s48
v_add_u32 v10,s49,v10
v_mul_u32_u24 v11,4608,v5
v_add_u32 v10,v10,v11
s_lshl_b32 s48,s48,2
v_add_u32 v11,s48,v10
v_mov_b32 v12,0x7ff00000
v_cndmask_b32 v10,v10,v12,vcc
s_mul_i32 s51,s51,147456
s_mul_i32 s85,s25,72
s_add_u32 s85,s85,s50
s_lshl_b32 s86,s85,7
s_add_u32 s86,s86,4718592
s_lshl_b32 s85,s85,10
s_add_u32 s85,s85,2359296
v_mul_u32_u24 v24,2304,v5
v_lshl_add_u32 v24,v4,3,v24
s_waitcnt vmcnt(12) lgkmcnt(0)
s_barrier
buffer_load_dwordx4 v[148:151],v10,s[20:23],s51 offen
buffer_load_dwordx4 v[152:155],v11,s[20:23],s51 offen
s_add_u32 s51,s51,18432
buffer_load_dwordx4 v[156:159],v10,s[20:23],s51 offen
buffer_load_dwordx4 v[160:163],v11,s[20:23],s51 offen
s_add_u32 s51,s51,18432
buffer_load_dwordx4 v[164:167],v10,s[20:23],s51 offen
buffer_load_dwordx4 v[168:171],v11,s[20:23],s51 offen
s_add_u32 s51,s51,18432
buffer_load_dwordx4 v[172:175],v10,s[20:23],s51 offen
buffer_load_dwordx4 v[176:179],v11,s[20:23],s51 offen
s_add_u32 s51,s51,18432
buffer_load_dwordx4 v[180:183],v10,s[20:23],s51 offen
buffer_load_dwordx4 v[184:187],v11,s[20:23],s51 offen
s_add_u32 s51,s51,18432
buffer_load_dwordx4 v[188:191],v10,s[20:23],s51 offen
buffer_load_dwordx4 v[192:195],v11,s[20:23],s51 offen
s_waitcnt vmcnt(10)
mf v[36:39],v[148:151],a[0:3],v[36:39]
mf v[40:43],v[152:155],a[0:3],v[40:43]
mf v[44:47],v[148:151],a[32:35],v[44:47]
s_add_u32 s51,s51,18432
buffer_load_dwordx4 v[196:199],v10,s[20:23],s51 offen
mf v[48:51],v[152:155],a[32:35],v[48:51]
mf v[52:55],v[148:151],a[64:67],v[52:55]
mf v[56:59],v[152:155],a[64:67],v[56:59]
buffer_load_dwordx4 v[200:203],v11,s[20:23],s51 offen
mf v[60:63],v[148:151],a[96:99],v[60:63]
mf v[64:67],v[152:155],a[96:99],v[64:67]
s_waitcnt vmcnt(10)
mf v[36:39],v[156:159],a[4:7],v[36:39]
s_add_u32 s51,s51,18432
buffer_load_dwordx4 v[204:207],v10,s[20:23],s51 offen
mf v[40:43],v[160:163],a[4:7],v[40:43]
mf v[44:47],v[156:159],a[36:39],v[44:47]
mf v[48:51],v[160:163],a[36:39],v[48:51]
buffer_load_dwordx4 v[208:211],v11,s[20:23],s51 offen
s_barrier
mf v[52:55],v[156:159],a[68:71],v[52:55]
mf v[56:59],v[160:163],a[68:71],v[56:59]
mf v[60:63],v[156:159],a[100:103],v[60:63]
mf v[64:67],v[160:163],a[100:103],v[64:67]
s_waitcnt vmcnt(10)
mf v[36:39],v[164:167],a[8:11],v[36:39]
mf v[40:43],v[168:171],a[8:11],v[40:43]
mf v[44:47],v[164:167],a[40:43],v[44:47]
mf v[48:51],v[168:171],a[40:43],v[48:51]
mf v[52:55],v[164:167],a[72:75],v[52:55]
mf v[56:59],v[168:171],a[72:75],v[56:59]
mf v[60:63],v[164:167],a[104:107],v[60:63]
mf v[64:67],v[168:171],a[104:107],v[64:67]
s_waitcnt vmcnt(8)
mf v[36:39],v[172:175],a[12:15],v[36:39]
mf v[40:43],v[176:179],a[12:15],v[40:43]
mf v[44:47],v[172:175],a[44:47],v[44:47]
mf v[48:51],v[176:179],a[44:47],v[48:51]
mf v[52:55],v[172:175],a[76:79],v[52:55]
mf v[56:59],v[176:179],a[76:79],v[56:59]
mf v[60:63],v[172:175],a[108:111],v[60:63]
mf v[64:67],v[176:179],a[108:111],v[64:67]
s_waitcnt vmcnt(6)
mf v[36:39],v[180:183],a[16:19],v[36:39]
mf v[40:43],v[184:187],a[16:19],v[40:43]
mf v[44:47],v[180:183],a[48:51],v[44:47]
mf v[48:51],v[184:187],a[48:51],v[48:51]
mf v[52:55],v[180:183],a[80:83],v[52:55]
mf v[56:59],v[184:187],a[80:83],v[56:59]
mf v[60:63],v[180:183],a[112:115],v[60:63]
mf v[64:67],v[184:187],a[112:115],v[64:67]
s_waitcnt vmcnt(4)
mf v[36:39],v[188:191],a[20:23],v[36:39]
mf v[40:43],v[192:195],a[20:23],v[40:43]
mf v[44:47],v[188:191],a[52:55],v[44:47]
mf v[48:51],v[192:195],a[52:55],v[48:51]
mf v[52:55],v[188:191],a[84:87],v[52:55]
mf v[56:59],v[192:195],a[84:87],v[56:59]
mf v[60:63],v[188:191],a[116:119],v[60:63]
mf v[64:67],v[192:195],a[116:119],v[64:67]
s_waitcnt vmcnt(2)
mf v[36:39],v[196:199],a[24:27],v[36:39]
mf v[40:43],v[200:203],a[24:27],v[40:43]
mf v[44:47],v[196:199],a[56:59],v[44:47]
mf v[48:51],v[200:203],a[56:59],v[48:51]
mf v[52:55],v[196:199],a[88:91],v[52:55]
mf v[56:59],v[200:203],a[88:91],v[56:59]
mf v[60:63],v[196:199],a[120:123],v[60:63]
mf v[64:67],v[200:203],a[120:123],v[64:67]
s_waitcnt vmcnt(0)
mf v[36:39],v[204:207],a[28:31],v[36:39]
mf v[40:43],v[208:211],a[28:31],v[40:43]
mf v[44:47],v[204:207],a[60:63],v[44:47]
mf v[48:51],v[208:211],a[60:63],v[48:51]
mf v[52:55],v[204:207],a[92:95],v[52:55]
mf v[56:59],v[208:211],a[92:95],v[56:59]
s_nop 3
v_add_f32 v25,v36,v40
v_add_f32 v26,v37,v41
mf v[60:63],v[204:207],a[124:127],v[60:63]
v_add_f32 v27,v38,v42
v_add_f32 v25,v25,v39
mf v[64:67],v[208:211],a[124:127],v[64:67]
v_add_f32 v26,v26,v43
v_add_f32 v25,v25,v27
v_cmp_u_f32 vcc,v25,v26
s_nop 0
s_cmp_lg_u64 vcc,0
s_cbranch_scc1 Lx122
Lx123:
v_cvt_pk_bf16_f32 v100,v36,v37
v_cvt_pk_bf16_f32 v101,v38,v39
v_cvt_pk_bf16_f32 v102,v40,v41
v_cvt_pk_bf16_f32 v103,v42,v43
buffer_store_dwordx4 v[100:103],v1,s[20:23],s85 offen sc1
s_add_u32 s85,s85,18432
v_cvt_pk_bf16_f32 v104,v44,v45
v_cvt_pk_bf16_f32 v105,v46,v47
v_cvt_pk_bf16_f32 v106,v48,v49
v_cvt_pk_bf16_f32 v107,v50,v51
buffer_store_dwordx4 v[104:107],v1,s[20:23],s85 offen sc1
s_add_u32 s85,s85,18432
v_cvt_pk_bf16_f32 v108,v52,v53
v_cvt_pk_bf16_f32 v109,v54,v55
v_cvt_pk_bf16_f32 v110,v56,v57
v_cvt_pk_bf16_f32 v111,v58,v59
buffer_store_dwordx4 v[108:111],v1,s[20:23],s85 offen sc1
s_add_u32 s85,s85,18432
v_cvt_pk_bf16_f32 v112,v60,v61
v_cvt_pk_bf16_f32 v113,v62,v63
v_cvt_pk_bf16_f32 v114,v64,v65
v_cvt_pk_bf16_f32 v115,v66,v67
buffer_store_dwordx4 v[112:115],v1,s[20:23],s85 offen sc1
v_pk_add_f32 v[20:21],v[36:37],v[38:39]
v_pk_mul_f32 v[22:23],v[36:37],v[36:37]
v_pk_add_f32 v[20:21],v[20:21],v[40:41]
v_pk_fma_f32 v[22:23],v[38:39],v[38:39],v[22:23]
v_pk_add_f32 v[20:21],v[20:21],v[42:43]
v_pk_fma_f32 v[22:23],v[40:41],v[40:41],v[22:23]
v_add_f32 v12,v20,v21
v_pk_fma_f32 v[22:23],v[42:43],v[42:43],v[22:23]
v_add_f32 v13,v22,v23
v_pk_add_f32 v[20:21],v[44:45],v[46:47]
v_pk_mul_f32 v[22:23],v[44:45],v[44:45]
v_pk_add_f32 v[20:21],v[20:21],v[48:49]
v_pk_fma_f32 v[22:23],v[46:47],v[46:47],v[22:23]
v_pk_add_f32 v[20:21],v[20:21],v[50:51]
v_pk_fma_f32 v[22:23],v[48:49],v[48:49],v[22:23]
v_add_f32 v14,v20,v21
v_pk_fma_f32 v[22:23],v[50:51],v[50:51],v[22:23]
v_add_f32 v15,v22,v23
v_pk_add_f32 v[20:21],v[52:53],v[54:55]
v_pk_mul_f32 v[22:23],v[52:53],v[52:53]
v_pk_add_f32 v[20:21],v[20:21],v[56:57]
v_pk_fma_f32 v[22:23],v[54:55],v[54:55],v[22:23]
v_pk_add_f32 v[20:21],v[20:21],v[58:59]
v_pk_fma_f32 v[22:23],v[56:57],v[56:57],v[22:23]
v_add_f32 v16,v20,v21
v_pk_fma_f32 v[22:23],v[58:59],v[58:59],v[22:23]
v_add_f32 v17,v22,v23
v_pk_add_f32 v[20:21],v[60:61],v[62:63]
v_pk_mul_f32 v[22:23],v[60:61],v[60:61]
v_pk_add_f32 v[20:21],v[20:21],v[64:65]
v_pk_fma_f32 v[22:23],v[62:63],v[62:63],v[22:23]
v_pk_add_f32 v[20:21],v[20:21],v[66:67]
v_pk_fma_f32 v[22:23],v[64:65],v[64:65],v[22:23]
v_add_f32 v18,v20,v21
v_pk_fma_f32 v[22:23],v[66:67],v[66:67],v[22:23]
v_add_f32 v19,v22,v23
v_permlane32_swap_b32 v12,v16
v_permlane32_swap_b32 v14,v18
v_add_f32 v12,v12,v16
v_add_f32 v14,v14,v18
s_nop 1
v_permlane16_swap_b32 v12,v14
v_add_f32 v12,v12,v14
v_permlane32_swap_b32 v13,v17
v_permlane32_swap_b32 v15,v19
v_add_f32 v13,v13,v17
v_add_f32 v15,v15,v19
s_nop 1
v_permlane16_swap_b32 v13,v15
v_add_f32 v13,v13,v15
buffer_store_dwordx2 v[12:13],v24,s[20:23],s86 offen sc1
s_waitcnt vmcnt(1)
s_branch Lae126
Lst116:
v_mov_b32 v100,0x3f803f80
v_mov_b32 v101,0x3f803f80
v_mov_b32 v102,0x3f803f80
v_mov_b32 v103,0x3f803f80
v_mov_b32 v105,0
v_and_b32 v10,3,v0
v_cmp_eq_u32 s[66:67],1,v10
v_cmp_eq_u32 s[68:69],2,v10
v_cmp_eq_u32 s[70:71],3,v10
v_lshlrev_b32 v10,2,v4
v_add_u32 v10,148736,v10
s_waitcnt vmcnt(6)
s_barrier
ds_read_b128 v[204:207],v21
ds_read_b128 v[208:211],v21 offset:1024
ds_read_b128 v[212:215],v21 offset:2048
ds_read_b128 v[216:219],v21 offset:3072
ds_read_b128 v[220:223],v21 offset:4096
ds_read_b128 v[224:227],v21 offset:5120
s_waitcnt lgkmcnt(4)
mf v[36:39],v[100:103],v[204:207],0
ds_read_b128 v[228:231],v21 offset:6144
s_add_u32 s87,s87,3072
mf v[40:43],v[204:207],v[204:207],0
s_cmp_eq_u32 s87,s91
s_cselect_b32 s87,s89,s87
s_add_u32 m0,s90,110592
mf v[44:47],v[100:103],v[208:211],0
buffer_load_dwordx4 v1,s[8:11],s87 offen sc1 lds
mf v[48:51],v[208:211],v[208:211],0
ds_read_b128 v[232:235],v21 offset:7168
s_waitcnt lgkmcnt(4)
mf v[52:55],v[100:103],v[212:215],0
ds_read_b128 v[204:207],v21 offset:8192
s_add_u32 m0,s90,113664
mf v[56:59],v[212:215],v[212:215],0
mf v[60:63],v[100:103],v[216:219],0
buffer_load_dwordx4 v1,s[8:11],s87 offen offset:1024 sc1 lds
mf v[64:67],v[216:219],v[216:219],0
ds_read_b128 v[208:211],v21 offset:9216
s_waitcnt lgkmcnt(4)
mf v[36:39],v[100:103],v[220:223],v[36:39]
ds_read_b128 v[212:215],v21 offset:10240
s_add_u32 m0,s90,116736
mf v[40:43],v[220:223],v[220:223],v[40:43]
mf v[44:47],v[100:103],v[224:227],v[44:47]
buffer_load_dwordx4 v1,s[8:11],s87 offen offset:2048 sc1 lds
mf v[48:51],v[224:227],v[224:227],v[48:51]
ds_read_b128 v[216:219],v21 offset:11264
s_waitcnt lgkmcnt(4)
mf v[52:55],v[100:103],v[228:231],v[52:55]
ds_read_b128 v[220:223],v21 offset:12288
s_add_u32 s87,s87,3072
mf v[56:59],v[228:231],v[228:231],v[56:59]
s_cmp_eq_u32 s87,s91
s_cselect_b32 s87,s89,s87
s_add_u32 m0,s90,122880
mf v[60:63],v[100:103],v[232:235],v[60:63]
buffer_load_dwordx4 v1,s[8:11],s87 offen sc1 lds
mf v[64:67],v[232:235],v[232:235],v[64:67]
ds_read_b128 v[224:227],v21 offset:13312
s_waitcnt lgkmcnt(4)
mf v[36:39],v[100:103],v[204:207],v[36:39]
ds_read_b128 v[228:231],v21 offset:14336
s_add_u32 m0,s90,125952
mf v[40:43],v[204:207],v[204:207],v[40:43]
mf v[44:47],v[100:103],v[208:211],v[44:47]
buffer_load_dwordx4 v1,s[8:11],s87 offen offset:1024 sc1 lds
mf v[48:51],v[208:211],v[208:211],v[48:51]
ds_read_b128 v[232:235],v21 offset:15360
s_waitcnt lgkmcnt(4)
mf v[52:55],v[100:103],v[212:215],v[52:55]
s_waitcnt vmcnt(4)
s_barrier
ds_read_b128 v[204:207],v21 offset:16384
s_add_u32 m0,s90,129024
mf v[56:59],v[212:215],v[212:215],v[56:59]
mf v[60:63],v[100:103],v[216:219],v[60:63]
buffer_load_dwordx4 v1,s[8:11],s87 offen offset:2048 sc1 lds
mf v[64:67],v[216:219],v[216:219],v[64:67]
ds_read_b128 v[208:211],v21 offset:17408
s_waitcnt lgkmcnt(4)
mf v[36:39],v[100:103],v[220:223],v[36:39]
ds_read_b128 v[212:215],v21 offset:18432
s_add_u32 s87,s87,3072
mf v[40:43],v[220:223],v[220:223],v[40:43]
s_cmp_eq_u32 s87,s91
s_cselect_b32 s87,s89,s87
s_add_u32 m0,s90,135168
mf v[44:47],v[100:103],v[224:227],v[44:47]
buffer_load_dwordx4 v1,s[8:11],s87 offen sc1 lds
mf v[48:51],v[224:227],v[224:227],v[48:51]
ds_read_b128 v[216:219],v21 offset:19456
s_waitcnt lgkmcnt(4)
mf v[52:55],v[100:103],v[228:231],v[52:55]
ds_read_b128 v[220:223],v21 offset:20480
s_add_u32 m0,s90,138240
mf v[56:59],v[228:231],v[228:231],v[56:59]
mf v[60:63],v[100:103],v[232:235],v[60:63]
buffer_load_dwordx4 v1,s[8:11],s87 offen offset:1024 sc1 lds
mf v[64:67],v[232:235],v[232:235],v[64:67]
ds_read_b128 v[224:227],v21 offset:21504
s_waitcnt lgkmcnt(4)
mf v[36:39],v[100:103],v[204:207],v[36:39]
ds_read_b128 v[228:231],v21 offset:22528
s_add_u32 m0,s90,141312
mf v[40:43],v[204:207],v[204:207],v[40:43]
mf v[44:47],v[100:103],v[208:211],v[44:47]
buffer_load_dwordx4 v1,s[8:11],s87 offen offset:2048 sc1 lds
mf v[48:51],v[208:211],v[208:211],v[48:51]
ds_read_b128 v[232:235],v21 offset:23552
s_waitcnt lgkmcnt(4)
mf v[52:55],v[100:103],v[212:215],v[52:55]
ds_read_b128 v[204:207],v21 offset:24576
s_add_u32 s60,s95,36864
mf v[56:59],v[212:215],v[212:215],v[56:59]
s_add_u32 m0,s61,36864
mf v[60:63],v[100:103],v[216:219],v[60:63]
buffer_load_dwordx4 v1,s[4:7],s60 offen lds
mf v[64:67],v[216:219],v[216:219],v[64:67]
ds_read_b128 v[208:211],v21 offset:25600
s_waitcnt lgkmcnt(4)
mf v[36:39],v[100:103],v[220:223],v[36:39]
ds_read_b128 v[212:215],v21 offset:26624
mf v[40:43],v[220:223],v[220:223],v[40:43]
mf v[44:47],v[100:103],v[224:227],v[44:47]
buffer_load_dwordx4 v1,s[4:7],s60 offen offset:1024 lds
mf v[48:51],v[224:227],v[224:227],v[48:51]
ds_read_b128 v[216:219],v21 offset:27648
s_waitcnt lgkmcnt(4)
mf v[52:55],v[100:103],v[228:231],v[52:55]
ds_read_b128 v[220:223],v21 offset:28672
mf v[56:59],v[228:231],v[228:231],v[56:59]
mf v[60:63],v[100:103],v[232:235],v[60:63]
buffer_load_dwordx4 v1,s[4:7],s60 offen offset:2048 lds
mf v[64:67],v[232:235],v[232:235],v[64:67]
ds_read_b128 v[224:227],v21 offset:29696
s_waitcnt lgkmcnt(4)
mf v[36:39],v[100:103],v[204:207],v[36:39]
ds_read_b128 v[228:231],v21 offset:30720
mf v[40:43],v[204:207],v[204:207],v[40:43]
mf v[44:47],v[100:103],v[208:211],v[44:47]
buffer_load_dwordx4 v1,s[4:7],s60 offen offset:3072 lds
mf v[48:51],v[208:211],v[208:211],v[48:51]
ds_read_b128 v[232:235],v21 offset:31744
s_waitcnt lgkmcnt(4)
mf v[52:55],v[100:103],v[212:215],v[52:55]
ds_read_b128 v[204:207],v21 offset:32768
s_add_u32 m0,s61,40960
mf v[56:59],v[212:215],v[212:215],v[56:59]
mf v[60:63],v[100:103],v[216:219],v[60:63]
buffer_load_dwordx4 v2,s[4:7],s60 offen lds
mf v[64:67],v[216:219],v[216:219],v[64:67]
ds_read_b128 v[208:211],v21 offset:33792
s_waitcnt lgkmcnt(4)
mf v[36:39],v[100:103],v[220:223],v[36:39]
ds_read_b128 v[212:215],v21 offset:34816
mf v[40:43],v[220:223],v[220:223],v[40:43]
mf v[44:47],v[100:103],v[224:227],v[44:47]
buffer_load_dwordx4 v2,s[4:7],s60 offen offset:1024 lds
mf v[48:51],v[224:227],v[224:227],v[48:51]
ds_read_b128 v[216:219],v21 offset:35840
s_waitcnt lgkmcnt(4)
mf v[52:55],v[100:103],v[228:231],v[52:55]
ds_read_b128 v[220:223],v22
mf v[56:59],v[228:231],v[228:231],v[56:59]
mf v[60:63],v[100:103],v[232:235],v[60:63]
buffer_load_dwordx4 v2,s[4:7],s60 offen offset:2048 lds
mf v[64:67],v[232:235],v[232:235],v[64:67]
ds_read_b128 v[224:227],v22 offset:1024
s_waitcnt lgkmcnt(4)
mf v[36:39],v[100:103],v[204:207],v[36:39]
ds_read_b128 v[228:231],v22 offset:2048
mf v[40:43],v[204:207],v[204:207],v[40:43]
mf v[44:47],v[100:103],v[208:211],v[44:47]
buffer_load_dwordx4 v2,s[4:7],s60 offen offset:3072 lds
mf v[48:51],v[208:211],v[208:211],v[48:51]
ds_read_b128 v[232:235],v22 offset:3072
s_waitcnt lgkmcnt(4)
mf v[52:55],v[100:103],v[212:215],v[52:55]
s_waitcnt vmcnt(8)
s_barrier
ds_read_b128 v[204:207],v22 offset:4096
s_add_u32 m0,s61,45056
mf v[56:59],v[212:215],v[212:215],v[56:59]
mf v[60:63],v[100:103],v[216:219],v[60:63]
buffer_load_dwordx4 v3,s[4:7],s60 offen lds
mf v[64:67],v[216:219],v[216:219],v[64:67]
ds_read_b128 v[208:211],v22 offset:5120
s_waitcnt lgkmcnt(4)
mf v[36:39],v[100:103],v[220:223],v[36:39]
ds_read_b128 v[212:215],v22 offset:6144
s_add_u32 s60,s95,0
mf v[40:43],v[220:223],v[220:223],v[40:43]
s_add_u32 m0,s61,0
mf v[44:47],v[100:103],v[224:227],v[44:47]
buffer_load_dwordx4 v1,s[4:7],s60 offen lds
mf v[48:51],v[224:227],v[224:227],v[48:51]
ds_read_b128 v[216:219],v22 offset:7168
s_waitcnt lgkmcnt(4)
mf v[52:55],v[100:103],v[228:231],v[52:55]
ds_read_b128 v[220:223],v22 offset:8192
mf v[56:59],v[228:231],v[228:231],v[56:59]
mf v[60:63],v[100:103],v[232:235],v[60:63]
buffer_load_dwordx4 v1,s[4:7],s60 offen offset:1024 lds
mf v[64:67],v[232:235],v[232:235],v[64:67]
ds_read_b128 v[224:227],v22 offset:9216
s_waitcnt lgkmcnt(4)
mf v[36:39],v[100:103],v[204:207],v[36:39]
ds_read_b128 v[228:231],v22 offset:10240
mf v[40:43],v[204:207],v[204:207],v[40:43]
mf v[44:47],v[100:103],v[208:211],v[44:47]
buffer_load_dwordx4 v1,s[4:7],s60 offen offset:2048 lds
mf v[48:51],v[208:211],v[208:211],v[48:51]
ds_read_b128 v[232:235],v22 offset:11264
s_waitcnt lgkmcnt(4)
mf v[52:55],v[100:103],v[212:215],v[52:55]
ds_read_b128 v[204:207],v22 offset:12288
mf v[56:59],v[212:215],v[212:215],v[56:59]
mf v[60:63],v[100:103],v[216:219],v[60:63]
buffer_load_dwordx4 v1,s[4:7],s60 offen offset:3072 lds
mf v[64:67],v[216:219],v[216:219],v[64:67]
ds_read_b128 v[208:211],v22 offset:13312
s_waitcnt lgkmcnt(4)
mf v[36:39],v[100:103],v[220:223],v[36:39]
ds_read_b128 v[212:215],v22 offset:14336
s_add_u32 m0,s61,4096
mf v[40:43],v[220:223],v[220:223],v[40:43]
mf v[44:47],v[100:103],v[224:227],v[44:47]
buffer_load_dwordx4 v2,s[4:7],s60 offen lds
mf v[48:51],v[224:227],v[224:227],v[48:51]
ds_read_b128 v[216:219],v22 offset:15360
s_waitcnt lgkmcnt(4)
mf v[52:55],v[100:103],v[228:231],v[52:55]
ds_read_b128 v[220:223],v22 offset:16384
mf v[56:59],v[228:231],v[228:231],v[56:59]
mf v[60:63],v[100:103],v[232:235],v[60:63]
buffer_load_dwordx4 v2,s[4:7],s60 offen offset:1024 lds
mf v[64:67],v[232:235],v[232:235],v[64:67]
ds_read_b128 v[224:227],v22 offset:17408
s_waitcnt lgkmcnt(4)
mf v[36:39],v[100:103],v[204:207],v[36:39]
ds_read_b128 v[228:231],v22 offset:18432
mf v[40:43],v[204:207],v[204:207],v[40:43]
mf v[44:47],v[100:103],v[208:211],v[44:47]
buffer_load_dwordx4 v2,s[4:7],s60 offen offset:2048 lds
mf v[48:51],v[208:211],v[208:211],v[48:51]
ds_read_b128 v[232:235],v22 offset:19456
s_waitcnt lgkmcnt(4)
mf v[52:55],v[100:103],v[212:215],v[52:55]
ds_read_b128 v[204:207],v22 offset:20480
mf v[56:59],v[212:215],v[212:215],v[56:59]
mf v[60:63],v[100:103],v[216:219],v[60:63]
buffer_load_dwordx4 v2,s[4:7],s60 offen offset:3072 lds
mf v[64:67],v[216:219],v[216:219],v[64:67]
ds_read_b128 v[208:211],v22 offset:21504
s_waitcnt lgkmcnt(4)
mf v[36:39],v[100:103],v[220:223],v[36:39]
ds_read_b128 v[212:215],v22 offset:22528
s_add_u32 m0,s61,8192
mf v[40:43],v[220:223],v[220:223],v[40:43]
mf v[44:47],v[100:103],v[224:227],v[44:47]
buffer_load_dwordx4 v3,s[4:7],s60 offen lds
mf v[48:51],v[224:227],v[224:227],v[48:51]
ds_read_b128 v[216:219],v22 offset:23552
s_waitcnt lgkmcnt(4)
mf v[52:55],v[100:103],v[228:231],v[52:55]
ds_read_b128 v[220:223],v22 offset:24576
mf v[56:59],v[228:231],v[228:231],v[56:59]
mf v[60:63],v[100:103],v[232:235],v[60:63]
ds_read_b128 v[224:227],v22 offset:25600
mf v[64:67],v[232:235],v[232:235],v[64:67]
s_waitcnt lgkmcnt(4)
mf v[36:39],v[100:103],v[204:207],v[36:39]
ds_read_b128 v[228:231],v22 offset:26624
mf v[40:43],v[204:207],v[204:207],v[40:43]
mf v[44:47],v[100:103],v[208:211],v[44:47]
ds_read_b128 v[232:235],v22 offset:27648
mf v[48:51],v[208:211],v[208:211],v[48:51]
s_waitcnt lgkmcnt(4)
mf v[52:55],v[100:103],v[212:215],v[52:55]
ds_read_b128 v[204:207],v22 offset:28672
mf v[56:59],v[212:215],v[212:215],v[56:59]
mf v[60:63],v[100:103],v[216:219],v[60:63]
ds_read_b128 v[208:211],v22 offset:29696
mf v[64:67],v[216:219],v[216:219],v[64:67]
s_waitcnt lgkmcnt(4)
mf v[36:39],v[100:103],v[220:223],v[36:39]
ds_read_b128 v[212:215],v22 offset:30720
mf v[40:43],v[220:223],v[220:223],v[40:43]
mf v[44:47],v[100:103],v[224:227],v[44:47]
ds_read_b128 v[216:219],v22 offset:31744
mf v[48:51],v[224:227],v[224:227],v[48:51]
s_waitcnt lgkmcnt(4)
mf v[52:55],v[100:103],v[228:231],v[52:55]
ds_read_b128 v[220:223],v22 offset:32768
mf v[56:59],v[228:231],v[228:231],v[56:59]
mf v[60:63],v[100:103],v[232:235],v[60:63]
ds_read_b128 v[224:227],v22 offset:33792
mf v[64:67],v[232:235],v[232:235],v[64:67]
s_waitcnt lgkmcnt(4)
mf v[36:39],v[100:103],v[204:207],v[36:39]
ds_read_b128 v[228:231],v22 offset:34816
mf v[40:43],v[204:207],v[204:207],v[40:43]
mf v[44:47],v[100:103],v[208:211],v[44:47]
ds_read_b128 v[232:235],v22 offset:35840
mf v[48:51],v[208:211],v[208:211],v[48:51]
s_waitcnt lgkmcnt(4)
mf v[52:55],v[100:103],v[212:215],v[52:55]
mf v[56:59],v[212:215],v[212:215],v[56:59]
mf v[60:63],v[100:103],v[216:219],v[60:63]
mf v[64:67],v[216:219],v[216:219],v[64:67]
s_waitcnt lgkmcnt(2)
mf v[36:39],v[100:103],v[220:223],v[36:39]
mf v[40:43],v[220:223],v[220:223],v[40:43]
mf v[44:47],v[100:103],v[224:227],v[44:47]
mf v[48:51],v[224:227],v[224:227],v[48:51]
s_waitcnt lgkmcnt(0)
mf v[52:55],v[100:103],v[228:231],v[52:55]
mf v[56:59],v[228:231],v[228:231],v[56:59]
mf v[60:63],v[100:103],v[232:235],v[60:63]
mf v[64:67],v[232:235],v[232:235],v[64:67]
s_nop 0
v_mul_f32 v28,0xbae38e39,v36
v_cndmask_b32 v16,v40,v41,s[66:67]
v_cndmask_b32 v16,v16,v42,s[68:69]
v_cndmask_b32 v16,v16,v43,s[70:71]
v_fma_f32 v12,-v28,v28,s63
v_fmamk_f32 v16,v16,0x3ae38e39,v12
v_max_f32 v16,s63,v16
v_rsq_f32 v16,v16
v_mul_f32 v29,0xbae38e39,v44
v_cndmask_b32 v17,v48,v49,s[66:67]
v_cndmask_b32 v17,v17,v50,s[68:69]
v_cndmask_b32 v17,v17,v51,s[70:71]
v_fma_f32 v13,-v29,v29,s63
v_fmamk_f32 v17,v17,0x3ae38e39,v13
v_max_f32 v17,s63,v17
v_rsq_f32 v17,v17
v_mul_f32 v30,0xbae38e39,v52
v_cndmask_b32 v18,v56,v57,s[66:67]
v_cndmask_b32 v18,v18,v58,s[68:69]
v_cndmask_b32 v18,v18,v59,s[70:71]
v_fma_f32 v14,-v30,v30,s63
v_fmamk_f32 v18,v18,0x3ae38e39,v14
v_max_f32 v18,s63,v18
v_rsq_f32 v18,v18
v_mul_f32 v31,0xbae38e39,v60
v_cndmask_b32 v19,v64,v65,s[66:67]
v_cndmask_b32 v19,v19,v66,s[68:69]
v_cndmask_b32 v19,v19,v67,s[70:71]
v_fma_f32 v15,-v31,v31,s63
v_fmamk_f32 v19,v19,0x3ae38e39,v15
v_max_f32 v19,s63,v19
v_rsq_f32 v19,v19
v_add_f32 v32,v28,v29
v_add_f32 v33,v30,v31
v_cmp_u_f32 vcc,v32,v33
s_nop 0
s_cmp_lg_u64 vcc,0
s_cselect_b32 s86,1,0
s_andn2_b32 s86,s86,s85
v_mov_b32 v32,s86
ds_write_b32 v10,v32 offset:512
s_mov_b32 exec_lo,0x00f0000f
s_mov_b32 exec_hi,0xf0000f00
ds_write2_b32 v10,v16,v28 offset0:0 offset1:64
ds_write2_b32 v10,v17,v29 offset0:16 offset1:80
ds_write2_b32 v10,v18,v30 offset0:32 offset1:96
ds_write2_b32 v10,v19,v31 offset0:48 offset1:112
s_mov_b64 exec,-1
s_waitcnt lgkmcnt(0)
s_barrier
s_cmp_lg_u32 s86,0
s_cbranch_scc1 Lag118
s_lshl_b32 s48,s26,1
s_lshr_b32 s49,s25,4
s_add_u32 s48,s48,s49
s_mul_i32 s48,s48,256
s_add_u32 s78,s48,5275648
v_mul_u32_u24 v12,3072,v0
s_lshl_b32 s48,s26,2
s_lshr_b32 s49,0x024310,s48
s_and_b32 s49,s49,15
s_lshr_b32 s50,0x444664,s48
s_and_b32 s50,s50,15
s_bfm_b64 s[66:67],s50,0
s_lshl_b32 s49,s49,1
s_mul_i32 s50,s30,12
s_add_u32 s49,s49,s50
s_mul_i32 s49,s49,256
s_add_u32 s79,s49,5275648
v_mul_u32_u24 v13,256,v0
s_barrier
s_mov_b64 exec,65535
v_mov_b32 v11,1
buffer_atomic_add v11,v12,s[20:23],s78 offen sc1
s_mov_b64 exec,-1
s_mov_b64 exec,s[66:67]
s_mov_b32 s56,0
v_mov_b32 v28,0
buffer_atomic_add v28,v13,s[20:23],s79 offen sc0 sc1
s_sleep 7
Lp127:
v_mov_b32 v29,0
buffer_atomic_add v29,v13,s[20:23],s79 offen sc0 sc1
s_waitcnt vmcnt(1)
v_bfe_u32 v28,v28,0,8
v_cmp_ne_u32 vcc,16,v28
s_nop 0
s_cbranch_vccz Lpd128
v_mov_b32 v28,0
buffer_atomic_add v28,v13,s[20:23],s79 offen sc0 sc1
s_waitcnt vmcnt(1)
v_bfe_u32 v29,v29,0,8
v_cmp_ne_u32 vcc,16,v29
s_nop 0
s_cbranch_vccz Lpd128
s_add_u32 s56,s56,1
s_cmp_lt_u32 s56,0x40000
s_cbranch_scc1 Lp127
Lpd128:
s_mov_b64 exec,-1
s_barrier
s_mov_b64 exec,65535
v_mov_b32 v14,256
buffer_atomic_add v14,v12,s[20:23],s78 offen sc1
s_mov_b64 exec,-1
s_barrier
s_add_u32 s60,s62,73728
s_mov_b32 m0,73728
s_nop 0
buffer_load_dwordx4 v1,s[4:7],s60 offen lds
buffer_load_dwordx4 v1,s[4:7],s60 offen offset:1024 lds
buffer_load_dwordx4 v1,s[4:7],s60 offen offset:2048 lds
buffer_load_dwordx4 v1,s[4:7],s60 offen offset:3072 lds
s_mov_b32 m0,77824
s_nop 0
buffer_load_dwordx4 v2,s[4:7],s60 offen lds
buffer_load_dwordx4 v2,s[4:7],s60 offen offset:1024 lds
buffer_load_dwordx4 v2,s[4:7],s60 offen offset:2048 lds
buffer_load_dwordx4 v2,s[4:7],s60 offen offset:3072 lds
s_mov_b32 m0,81920
s_nop 0
buffer_load_dwordx4 v3,s[4:7],s60 offen lds
buffer_load_dwordx4 v3,s[4:7],s60 offen offset:1024 lds
buffer_load_dwordx4 v3,s[4:7],s60 offen offset:2048 lds
buffer_load_dwordx4 v3,s[4:7],s60 offen offset:3072 lds
s_add_u32 s60,s62,86016
s_mov_b32 m0,86016
s_nop 0
buffer_load_dwordx4 v1,s[4:7],s60 offen lds
buffer_load_dwordx4 v1,s[4:7],s60 offen offset:1024 lds
buffer_load_dwordx4 v1,s[4:7],s60 offen offset:2048 lds
buffer_load_dwordx4 v1,s[4:7],s60 offen offset:3072 lds
s_mov_b32 m0,90112
s_nop 0
buffer_load_dwordx4 v2,s[4:7],s60 offen lds
buffer_load_dwordx4 v2,s[4:7],s60 offen offset:1024 lds
buffer_load_dwordx4 v2,s[4:7],s60 offen offset:2048 lds
buffer_load_dwordx4 v2,s[4:7],s60 offen offset:3072 lds
s_mov_b32 m0,94208
s_nop 0
buffer_load_dwordx4 v3,s[4:7],s60 offen lds
buffer_load_dwordx4 v3,s[4:7],s60 offen offset:1024 lds
buffer_load_dwordx4 v3,s[4:7],s60 offen offset:2048 lds
buffer_load_dwordx4 v3,s[4:7],s60 offen offset:3072 lds
s_add_u32 s60,s62,98304
s_mov_b32 m0,98304
s_nop 0
buffer_load_dwordx4 v1,s[4:7],s60 offen lds
buffer_load_dwordx4 v1,s[4:7],s60 offen offset:1024 lds
buffer_load_dwordx4 v1,s[4:7],s60 offen offset:2048 lds
buffer_load_dwordx4 v1,s[4:7],s60 offen offset:3072 lds
s_mov_b32 m0,102400
s_nop 0
buffer_load_dwordx4 v2,s[4:7],s60 offen lds
buffer_load_dwordx4 v2,s[4:7],s60 offen offset:1024 lds
buffer_load_dwordx4 v2,s[4:7],s60 offen offset:2048 lds
buffer_load_dwordx4 v2,s[4:7],s60 offen offset:3072 lds
s_mov_b32 m0,106496
s_nop 0
buffer_load_dwordx4 v3,s[4:7],s60 offen lds
buffer_load_dwordx4 v3,s[4:7],s60 offen offset:1024 lds
buffer_load_dwordx4 v3,s[4:7],s60 offen offset:2048 lds
buffer_load_dwordx4 v3,s[4:7],s60 offen offset:3072 lds
Lae126:
s_barrier
s_cmp_lg_u32 s24,0
s_cbranch_scc1 Lj129
s_mul_i32 s48,s30,1024
s_add_u32 s48,s48,5357568
v_mul_u32_u24 v10,256,v0
s_mov_b64 exec,15
v_mov_b32 v11,2
buffer_atomic_add v11,v10,s[20:23],s48 offen sc1
s_mov_b64 exec,-1
Lj129:
s_branch Ljoin1
Ltail1:
s_and_b32 s82,s89,7
s_lshl_b32 s82,s82,4
s_add_u32 s82,s82,s27
s_mul_i32 s82,s82,1152
s_lshl_b32 s83,s85,5
s_add_u32 s83,s83,1024
s_add_u32 s83,s83,s82
s_mul_i32 s86,s90,1179648
s_add_u32 s83,s83,s86
s_lshl_b32 s86,s85,8
s_add_u32 s82,s82,s86
s_lshl_b32 s86,s90,6
s_add_u32 s82,s82,s86
s_add_u32 s86,s82,128
v_mul_u32_u24 v27,147456,v4
v_lshl_add_u32 v27,v5,4,v27
v_bfe_u32 v23,v0,2,3
v_mul_u32_u24 v23,147456,v23
v_lshrrev_b32 v26,5,v0
v_lshl_add_u32 v23,v26,4,v23
v_and_b32 v26,3,v0
v_lshl_add_u32 v23,v26,2,v23
s_waitcnt vmcnt(4)
s_mov_b64 exec,1
v_mov_b32 v11,1
buffer_atomic_add v11,v10,s[20:23],s54 offen sc1
s_mov_b64 exec,-1
s_mov_b64 exec,1
s_mov_b32 s56,0
v_mov_b32 v248,0
buffer_atomic_add v248,v10,s[20:23],s55 offen sc0 sc1
s_sleep 4
v_mov_b32 v249,0
buffer_atomic_add v249,v10,s[20:23],s55 offen sc0 sc1
s_sleep 4
Lp130:
v_mov_b32 v250,0
buffer_atomic_add v250,v10,s[20:23],s55 offen sc0 sc1
s_waitcnt vmcnt(2)
v_bfe_u32 v248,v248,0,8
v_cmp_ne_u32 vcc,4,v248
s_nop 0
s_cbranch_vccz Lpd131
v_mov_b32 v248,0
buffer_atomic_add v248,v10,s[20:23],s55 offen sc0 sc1
s_waitcnt vmcnt(2)
v_bfe_u32 v249,v249,0,8
v_cmp_ne_u32 vcc,4,v249
s_nop 0
s_cbranch_vccz Lpd131
v_mov_b32 v249,0
buffer_atomic_add v249,v10,s[20:23],s55 offen sc0 sc1
s_waitcnt vmcnt(2)
v_bfe_u32 v250,v250,0,8
v_cmp_ne_u32 vcc,4,v250
s_nop 0
s_cbranch_vccz Lpd131
s_add_u32 s56,s56,1
s_cmp_lt_u32 s56,0x40000
s_cbranch_scc1 Lp130
Lpd131:
s_mov_b64 exec,-1
s_add_u32 s87,s48,s67
s_add_u32 s60,s49,s67
buffer_load_dwordx4 v[44:47],v1,s[20:23],s87 offen offset:2048 sc1
buffer_load_dword v48,v22,s[20:23],s60 offen sc1
s_add_u32 s87,s48,s68
s_add_u32 s60,s49,s68
buffer_load_dwordx4 v[52:55],v1,s[20:23],s87 offen offset:2048 sc1
buffer_load_dword v56,v22,s[20:23],s60 offen sc1
s_add_u32 s87,s48,s69
s_add_u32 s60,s49,s69
buffer_load_dwordx4 v[60:63],v1,s[20:23],s87 offen offset:2048 sc1
buffer_load_dword v64,v22,s[20:23],s60 offen sc1
s_add_u32 s87,s48,s67
buffer_load_dwordx4 v[184:187],v1,s[20:23],s87 offen sc1
s_add_u32 s87,s48,s68
buffer_load_dwordx4 v[188:191],v1,s[20:23],s87 offen sc1
s_add_u32 s87,s48,s69
buffer_load_dwordx4 v[192:195],v1,s[20:23],s87 offen sc1
s_mov_b64 exec,1
v_mov_b32 v20,256
buffer_atomic_add v20,v10,s[20:23],s54 offen sc1
s_mov_b64 exec,-1
s_waitcnt lgkmcnt(0)
s_barrier
ds_read_b128 v[36:39],v24 offset:2048
ds_read_b32 v40,v25
ds_read_b128 v[180:183],v24
s_waitcnt lgkmcnt(0)
v_dot2c_f32_bf16 v228,s50,v36
v_dot2c_f32_bf16 v229,s51,v36
v_dot2c_f32_bf16 v230,s50,v37
v_dot2c_f32_bf16 v231,s51,v37
v_dot2c_f32_bf16 v232,s50,v38
v_dot2c_f32_bf16 v233,s51,v38
v_dot2c_f32_bf16 v234,s50,v39
v_dot2c_f32_bf16 v235,s51,v39
v_dot2c_f32_bf16 v236,s50,v40
v_dot2c_f32_bf16 v237,s51,v40
s_waitcnt vmcnt(8)
v_dot2c_f32_bf16 v228,s50,v44
v_dot2c_f32_bf16 v229,s51,v44
v_dot2c_f32_bf16 v230,s50,v45
v_dot2c_f32_bf16 v231,s51,v45
v_dot2c_f32_bf16 v232,s50,v46
v_dot2c_f32_bf16 v233,s51,v46
v_dot2c_f32_bf16 v234,s50,v47
v_dot2c_f32_bf16 v235,s51,v47
v_dot2c_f32_bf16 v236,s50,v48
v_dot2c_f32_bf16 v237,s51,v48
s_waitcnt vmcnt(6)
v_dot2c_f32_bf16 v228,s50,v52
v_dot2c_f32_bf16 v229,s51,v52
v_dot2c_f32_bf16 v230,s50,v53
v_dot2c_f32_bf16 v231,s51,v53
v_dot2c_f32_bf16 v232,s50,v54
v_dot2c_f32_bf16 v233,s51,v54
v_dot2c_f32_bf16 v234,s50,v55
v_dot2c_f32_bf16 v235,s51,v55
v_dot2c_f32_bf16 v236,s50,v56
v_dot2c_f32_bf16 v237,s51,v56
s_waitcnt vmcnt(4)
v_dot2c_f32_bf16 v228,s50,v60
v_dot2c_f32_bf16 v229,s51,v60
v_dot2c_f32_bf16 v230,s50,v61
v_dot2c_f32_bf16 v231,s51,v61
v_dot2c_f32_bf16 v232,s50,v62
v_dot2c_f32_bf16 v233,s51,v62
v_dot2c_f32_bf16 v234,s50,v63
v_dot2c_f32_bf16 v235,s51,v63
v_dot2c_f32_bf16 v236,s50,v64
v_dot2c_f32_bf16 v237,s51,v64
s_nop 0
v_cvt_pk_bf16_f32 v200,v228,v229
v_cvt_pk_bf16_f32 v201,v230,v231
v_cvt_pk_bf16_f32 v202,v232,v233
v_cvt_pk_bf16_f32 v203,v234,v235
v_cvt_pk_bf16_f32 v204,v236,v237
buffer_store_dwordx4 v[200:203],v27,s[12:15],s86 offen sc1
buffer_store_dword v204,v23,s[12:15],s83 offen
v_dot2c_f32_bf16 v220,s50,v180
v_dot2c_f32_bf16 v221,s51,v180
v_dot2c_f32_bf16 v222,s50,v181
v_dot2c_f32_bf16 v223,s51,v181
v_dot2c_f32_bf16 v224,s50,v182
v_dot2c_f32_bf16 v225,s51,v182
v_dot2c_f32_bf16 v226,s50,v183
v_dot2c_f32_bf16 v227,s51,v183
s_waitcnt vmcnt(5)
v_dot2c_f32_bf16 v220,s50,v184
v_dot2c_f32_bf16 v221,s51,v184
v_dot2c_f32_bf16 v222,s50,v185
v_dot2c_f32_bf16 v223,s51,v185
v_dot2c_f32_bf16 v224,s50,v186
v_dot2c_f32_bf16 v225,s51,v186
v_dot2c_f32_bf16 v226,s50,v187
v_dot2c_f32_bf16 v227,s51,v187
s_waitcnt vmcnt(4)
v_dot2c_f32_bf16 v220,s50,v188
v_dot2c_f32_bf16 v221,s51,v188
v_dot2c_f32_bf16 v222,s50,v189
v_dot2c_f32_bf16 v223,s51,v189
v_dot2c_f32_bf16 v224,s50,v190
v_dot2c_f32_bf16 v225,s51,v190
v_dot2c_f32_bf16 v226,s50,v191
v_dot2c_f32_bf16 v227,s51,v191
s_waitcnt vmcnt(3)
v_dot2c_f32_bf16 v220,s50,v192
v_dot2c_f32_bf16 v221,s51,v192
v_dot2c_f32_bf16 v222,s50,v193
v_dot2c_f32_bf16 v223,s51,v193
v_dot2c_f32_bf16 v224,s50,v194
v_dot2c_f32_bf16 v225,s51,v194
v_dot2c_f32_bf16 v226,s50,v195
v_dot2c_f32_bf16 v227,s51,v195
v_pk_add_f32 v[196:197],v[220:221],v[222:223]
s_nop 1
v_pk_add_f32 v[198:199],v[224:225],v[226:227]
v_pk_add_f32 v[196:197],v[196:197],v[198:199]
v_cmp_u_f32 vcc,v196,v197
s_nop 0
s_cmp_lg_u64 vcc,0
s_cbranch_scc1 Lx132
Lx133:
v_cvt_pk_bf16_f32 v196,v220,v221
v_cvt_pk_bf16_f32 v197,v222,v223
v_cvt_pk_bf16_f32 v198,v224,v225
v_cvt_pk_bf16_f32 v199,v226,v227
buffer_store_dwordx4 v[196:199],v27,s[12:15],s82 offen sc1
s_branch Lfin
Lag118:
s_mov_b32 s85,1
v_mov_b32 v10,0
s_mov_b64 exec,1
s_mov_b32 s56,0
Lp119:
v_mov_b32 v24,0
buffer_atomic_add v24,v10,s[20:23],s84 offen sc0 sc1
s_waitcnt vmcnt(0)
v_bfe_u32 v24,v24,8,8
v_cmp_ne_u32 vcc,8,v24
s_nop 0
s_cbranch_vccz Lpd120
s_add_u32 s56,s56,1
s_cmp_lt_u32 s56,0x40000
s_cbranch_scc1 Lp119
Lpd120:
s_mov_b64 exec,-1
s_mul_i32 s48,s26,3072
s_add_u32 s87,s89,s48
v_mov_b32 v21,v7
v_mov_b32 v22,v8
s_add_u32 m0,s90,73728
s_nop 0
buffer_load_dwordx4 v1,s[8:11],s87 offen sc1 lds
s_add_u32 m0,s90,76800
s_nop 0
buffer_load_dwordx4 v1,s[8:11],s87 offen offset:1024 sc1 lds
s_add_u32 m0,s90,79872
s_nop 0
buffer_load_dwordx4 v1,s[8:11],s87 offen offset:2048 sc1 lds
s_add_u32 s87,s87,3072
s_cmp_eq_u32 s87,s91
s_cselect_b32 s87,s89,s87
s_add_u32 m0,s90,86016
s_nop 0
buffer_load_dwordx4 v1,s[8:11],s87 offen sc1 lds
s_add_u32 m0,s90,89088
s_nop 0
buffer_load_dwordx4 v1,s[8:11],s87 offen offset:1024 sc1 lds
s_add_u32 m0,s90,92160
s_nop 0
buffer_load_dwordx4 v1,s[8:11],s87 offen offset:2048 sc1 lds
s_add_u32 s87,s87,3072
s_cmp_eq_u32 s87,s91
s_cselect_b32 s87,s89,s87
s_add_u32 m0,s90,98304
s_nop 0
buffer_load_dwordx4 v1,s[8:11],s87 offen sc1 lds
s_add_u32 m0,s90,101376
s_nop 0
buffer_load_dwordx4 v1,s[8:11],s87 offen offset:1024 sc1 lds
s_add_u32 m0,s90,104448
s_nop 0
buffer_load_dwordx4 v1,s[8:11],s87 offen offset:2048 sc1 lds
s_waitcnt vmcnt(0)
s_barrier
s_lshl_b32 s60,s24,13
v_add_u32 v23,s60,v1
ds_write_b128 v23,v[68:71]
ds_write_b128 v23,v[72:75] offset:1024
ds_write_b128 v23,v[76:79] offset:2048
ds_write_b128 v23,v[80:83] offset:3072
ds_write_b128 v23,v[84:87] offset:4096
ds_write_b128 v23,v[88:91] offset:5120
ds_write_b128 v23,v[92:95] offset:6144
ds_write_b128 v23,v[96:99] offset:7168
v_mov_b32 v23,v1
s_waitcnt lgkmcnt(0)
s_branch Lre117
La121:
s_waitcnt lgkmcnt(0)
s_branch Lag118
Lx122:
s_lshl_b32 s48,s26,2
s_lshr_b32 s49,0x024310,s48
s_and_b32 s49,s49,15
s_lshr_b32 s50,0x444664,s48
s_and_b32 s50,s50,15
s_bfm_b64 s[66:67],s50,0
s_lshl_b32 s49,s49,1
s_mul_i32 s50,s30,12
s_add_u32 s49,s49,s50
s_mul_i32 s49,s49,256
s_add_u32 s79,s49,5275648
v_mul_u32_u24 v13,256,v0
s_mov_b64 exec,s[66:67]
s_mov_b32 s56,0
Lp124:
v_mov_b32 v14,0
buffer_atomic_add v14,v13,s[20:23],s79 offen sc0 sc1
s_waitcnt vmcnt(0)
v_bfe_u32 v14,v14,8,8
v_cmp_ne_u32 vcc,16,v14
s_nop 0
s_cbranch_vccz Lpd125
s_add_u32 s56,s56,1
s_cmp_lt_u32 s56,0x40000
s_cbranch_scc1 Lp124
Lpd125:
s_mov_b64 exec,-1
s_sub_u32 s51,s51,129024
buffer_load_dwordx4 v[148:151],v10,s[20:23],s51 offen sc1
buffer_load_dwordx4 v[152:155],v11,s[20:23],s51 offen sc1
s_add_u32 s51,s51,18432
buffer_load_dwordx4 v[156:159],v10,s[20:23],s51 offen sc1
buffer_load_dwordx4 v[160:163],v11,s[20:23],s51 offen sc1
s_add_u32 s51,s51,18432
buffer_load_dwordx4 v[164:167],v10,s[20:23],s51 offen sc1
buffer_load_dwordx4 v[168:171],v11,s[20:23],s51 offen sc1
s_add_u32 s51,s51,18432
buffer_load_dwordx4 v[172:175],v10,s[20:23],s51 offen sc1
buffer_load_dwordx4 v[176:179],v11,s[20:23],s51 offen sc1
s_add_u32 s51,s51,18432
buffer_load_dwordx4 v[180:183],v10,s[20:23],s51 offen sc1
buffer_load_dwordx4 v[184:187],v11,s[20:23],s51 offen sc1
s_add_u32 s51,s51,18432
buffer_load_dwordx4 v[188:191],v10,s[20:23],s51 offen sc1
buffer_load_dwordx4 v[192:195],v11,s[20:23],s51 offen sc1
s_add_u32 s51,s51,18432
buffer_load_dwordx4 v[196:199],v10,s[20:23],s51 offen sc1
buffer_load_dwordx4 v[200:203],v11,s[20:23],s51 offen sc1
s_add_u32 s51,s51,18432
buffer_load_dwordx4 v[204:207],v10,s[20:23],s51 offen sc1
buffer_load_dwordx4 v[208:211],v11,s[20:23],s51 offen sc1
s_add_u32 s51,s51,18432
v_lshlrev_b32 v36,16,v132
v_and_b32 v37,0xffff0000,v132
v_lshlrev_b32 v38,16,v133
v_and_b32 v39,0xffff0000,v133
v_lshlrev_b32 v40,16,v134
v_and_b32 v41,0xffff0000,v134
v_lshlrev_b32 v42,16,v135
v_and_b32 v43,0xffff0000,v135
v_lshlrev_b32 v44,16,v136
v_and_b32 v45,0xffff0000,v136
v_lshlrev_b32 v46,16,v137
v_and_b32 v47,0xffff0000,v137
v_lshlrev_b32 v48,16,v138
v_and_b32 v49,0xffff0000,v138
v_lshlrev_b32 v50,16,v139
v_and_b32 v51,0xffff0000,v139
v_lshlrev_b32 v52,16,v140
v_and_b32 v53,0xffff0000,v140
v_lshlrev_b32 v54,16,v141
v_and_b32 v55,0xffff0000,v141
v_lshlrev_b32 v56,16,v142
v_and_b32 v57,0xffff0000,v142
v_lshlrev_b32 v58,16,v143
v_and_b32 v59,0xffff0000,v143
v_lshlrev_b32 v60,16,v144
v_and_b32 v61,0xffff0000,v144
v_lshlrev_b32 v62,16,v145
v_and_b32 v63,0xffff0000,v145
v_lshlrev_b32 v64,16,v146
v_and_b32 v65,0xffff0000,v146
v_lshlrev_b32 v66,16,v147
v_and_b32 v67,0xffff0000,v147
s_waitcnt vmcnt(0)
mf v[36:39],v[148:151],a[0:3],v[36:39]
mf v[40:43],v[152:155],a[0:3],v[40:43]
mf v[44:47],v[148:151],a[32:35],v[44:47]
mf v[48:51],v[152:155],a[32:35],v[48:51]
mf v[52:55],v[148:151],a[64:67],v[52:55]
mf v[56:59],v[152:155],a[64:67],v[56:59]
mf v[60:63],v[148:151],a[96:99],v[60:63]
mf v[64:67],v[152:155],a[96:99],v[64:67]
mf v[36:39],v[156:159],a[4:7],v[36:39]
mf v[40:43],v[160:163],a[4:7],v[40:43]
mf v[44:47],v[156:159],a[36:39],v[44:47]
mf v[48:51],v[160:163],a[36:39],v[48:51]
mf v[52:55],v[156:159],a[68:71],v[52:55]
mf v[56:59],v[160:163],a[68:71],v[56:59]
mf v[60:63],v[156:159],a[100:103],v[60:63]
mf v[64:67],v[160:163],a[100:103],v[64:67]
mf v[36:39],v[164:167],a[8:11],v[36:39]
mf v[40:43],v[168:171],a[8:11],v[40:43]
mf v[44:47],v[164:167],a[40:43],v[44:47]
mf v[48:51],v[168:171],a[40:43],v[48:51]
mf v[52:55],v[164:167],a[72:75],v[52:55]
mf v[56:59],v[168:171],a[72:75],v[56:59]
mf v[60:63],v[164:167],a[104:107],v[60:63]
mf v[64:67],v[168:171],a[104:107],v[64:67]
mf v[36:39],v[172:175],a[12:15],v[36:39]
mf v[40:43],v[176:179],a[12:15],v[40:43]
mf v[44:47],v[172:175],a[44:47],v[44:47]
mf v[48:51],v[176:179],a[44:47],v[48:51]
mf v[52:55],v[172:175],a[76:79],v[52:55]
mf v[56:59],v[176:179],a[76:79],v[56:59]
mf v[60:63],v[172:175],a[108:111],v[60:63]
mf v[64:67],v[176:179],a[108:111],v[64:67]
mf v[36:39],v[180:183],a[16:19],v[36:39]
mf v[40:43],v[184:187],a[16:19],v[40:43]
mf v[44:47],v[180:183],a[48:51],v[44:47]
mf v[48:51],v[184:187],a[48:51],v[48:51]
mf v[52:55],v[180:183],a[80:83],v[52:55]
mf v[56:59],v[184:187],a[80:83],v[56:59]
mf v[60:63],v[180:183],a[112:115],v[60:63]
mf v[64:67],v[184:187],a[112:115],v[64:67]
mf v[36:39],v[188:191],a[20:23],v[36:39]
mf v[40:43],v[192:195],a[20:23],v[40:43]
mf v[44:47],v[188:191],a[52:55],v[44:47]
mf v[48:51],v[192:195],a[52:55],v[48:51]
mf v[52:55],v[188:191],a[84:87],v[52:55]
mf v[56:59],v[192:195],a[84:87],v[56:59]
mf v[60:63],v[188:191],a[116:119],v[60:63]
mf v[64:67],v[192:195],a[116:119],v[64:67]
mf v[36:39],v[196:199],a[24:27],v[36:39]
mf v[40:43],v[200:203],a[24:27],v[40:43]
mf v[44:47],v[196:199],a[56:59],v[44:47]
mf v[48:51],v[200:203],a[56:59],v[48:51]
mf v[52:55],v[196:199],a[88:91],v[52:55]
mf v[56:59],v[200:203],a[88:91],v[56:59]
mf v[60:63],v[196:199],a[120:123],v[60:63]
mf v[64:67],v[200:203],a[120:123],v[64:67]
mf v[36:39],v[204:207],a[28:31],v[36:39]
mf v[40:43],v[208:211],a[28:31],v[40:43]
mf v[44:47],v[204:207],a[60:63],v[44:47]
mf v[48:51],v[208:211],a[60:63],v[48:51]
mf v[52:55],v[204:207],a[92:95],v[52:55]
mf v[56:59],v[208:211],a[92:95],v[56:59]
mf v[60:63],v[204:207],a[124:127],v[60:63]
mf v[64:67],v[208:211],a[124:127],v[64:67]
s_nop 7
s_nop 1
s_branch Lx123
Lx132:
s_mov_b64 exec,1
s_mov_b32 s56,0
Lp134:
v_mov_b32 v205,0
buffer_atomic_add v205,v10,s[20:23],s55 offen sc0 sc1
s_waitcnt vmcnt(0)
v_bfe_u32 v205,v205,8,8
v_cmp_ne_u32 vcc,4,v205
s_nop 0
s_cbranch_vccz Lpd135
s_add_u32 s56,s56,1
s_cmp_lt_u32 s56,0x40000
s_cbranch_scc1 Lp134
Lpd135:
s_mov_b64 exec,-1
s_add_u32 s87,s48,s67
buffer_load_dwordx4 v[184:187],v1,s[20:23],s87 offen sc1
s_add_u32 s87,s48,s68
buffer_load_dwordx4 v[188:191],v1,s[20:23],s87 offen sc1
s_add_u32 s87,s48,s69
buffer_load_dwordx4 v[192:195],v1,s[20:23],s87 offen sc1
v_lshlrev_b32 v220,16,v244
v_and_b32 v221,0xffff0000,v244
v_lshlrev_b32 v222,16,v245
v_and_b32 v223,0xffff0000,v245
v_lshlrev_b32 v224,16,v246
v_and_b32 v225,0xffff0000,v246
v_lshlrev_b32 v226,16,v247
v_and_b32 v227,0xffff0000,v247
s_waitcnt vmcnt(0)
v_dot2c_f32_bf16 v220,s50,v180
v_dot2c_f32_bf16 v221,s51,v180
v_dot2c_f32_bf16 v222,s50,v181
v_dot2c_f32_bf16 v223,s51,v181
v_dot2c_f32_bf16 v224,s50,v182
v_dot2c_f32_bf16 v225,s51,v182
v_dot2c_f32_bf16 v226,s50,v183
v_dot2c_f32_bf16 v227,s51,v183
v_dot2c_f32_bf16 v220,s50,v184
v_dot2c_f32_bf16 v221,s51,v184
v_dot2c_f32_bf16 v222,s50,v185
v_dot2c_f32_bf16 v223,s51,v185
v_dot2c_f32_bf16 v224,s50,v186
v_dot2c_f32_bf16 v225,s51,v186
v_dot2c_f32_bf16 v226,s50,v187
v_dot2c_f32_bf16 v227,s51,v187
v_dot2c_f32_bf16 v220,s50,v188
v_dot2c_f32_bf16 v221,s51,v188
v_dot2c_f32_bf16 v222,s50,v189
v_dot2c_f32_bf16 v223,s51,v189
v_dot2c_f32_bf16 v224,s50,v190
v_dot2c_f32_bf16 v225,s51,v190
v_dot2c_f32_bf16 v226,s50,v191
v_dot2c_f32_bf16 v227,s51,v191
v_dot2c_f32_bf16 v220,s50,v192
v_dot2c_f32_bf16 v221,s51,v192
v_dot2c_f32_bf16 v222,s50,v193
v_dot2c_f32_bf16 v223,s51,v193
v_dot2c_f32_bf16 v224,s50,v194
v_dot2c_f32_bf16 v225,s51,v194
v_dot2c_f32_bf16 v226,s50,v195
v_dot2c_f32_bf16 v227,s51,v195
s_nop 1
s_nop 1
s_branch Lx133
Lfin:
s_waitcnt vmcnt(0)
Lexit:
s_endpgm
.section .rodata,"a"
.p2align 6
.amdhsa_kernel interleave_layers__spectral_fnet__mixer_gmlp__prompt_kernel
  .amdhsa_next_free_vgpr 512
  .amdhsa_next_free_sgpr 102
  .amdhsa_accum_offset 256
  .amdhsa_group_segment_fixed_size 0
  .amdhsa_kernarg_size 104
  .amdhsa_user_sgpr_count 2
  .amdhsa_user_sgpr_kernarg_segment_ptr 1
  .amdhsa_system_sgpr_workgroup_id_x 1
  .amdhsa_float_denorm_mode_32 3
.end_amdhsa_kernel
```
